```python
import torch

def _softmax(x, axis=-1):
    return torch.softmax(x, dim=axis)
def _gelu(x):
    return torch.nn.functional.gelu(x, approximate="tanh")
def _silu(x):
    return torch.nn.functional.silu(x)
def _sigmoid(x):
    return torch.sigmoid(x)
def _layernorm(x, axis=-1, eps=1e-5):
    m = x.mean(dim=axis, keepdim=True)
    v = x.var(dim=axis, keepdim=True, unbiased=False)
    return (x - m) / torch.sqrt(v + eps)
def _scatter_add(tgt, idx, src, axis=0):
    return tgt.clone().index_add_(axis, idx, src)
def _segment_sum(src, seg, n):
    out = torch.zeros((n,) + src.shape[1:], dtype=src.dtype)
    return out.index_add_(0, seg, src)
def _pad(x, pw):
    flat = tuple(v for pair in reversed(pw) for v in pair)
    return torch.nn.functional.pad(x, flat)

kernel_name = 'sequential_preLN__linear_attn_block__swiglu_ffn__prompt'

def setup_inputs():

    _w = (lambda a: (lambda t: t.to(torch.bfloat16) if t.is_floating_point() else t)(torch.as_tensor(a)))
    def _A_setup():
        B, S, D = 1, 2048, 576
        return {
            "x": _w((lambda *s: torch.randn(*s, dtype=torch.bfloat16) * 0.05)(B, S, D)),
            "wqkv": _w((lambda *s: torch.randn(*s, dtype=torch.bfloat16) * 0.05)(D, 3 * D)),
            "wo": _w((lambda *s: torch.randn(*s, dtype=torch.bfloat16) * 0.05)(D, D)),
        }
    _A_in = _A_setup()

    def _B_setup():
        B, S, D, F = 1, 2048, 576, 4608
        return {
            "x": _w((lambda *s: torch.randn(*s, dtype=torch.bfloat16) * 0.05)(B, S, D)),
            "w_gate": _w((lambda *s: torch.randn(*s, dtype=torch.bfloat16) * 0.05)(D, F)),
            "w_up": _w((lambda *s: torch.randn(*s, dtype=torch.bfloat16) * 0.05)(D, F)),
            "w_down": _w((lambda *s: torch.randn(*s, dtype=torch.bfloat16) * 0.05)(F, D)),
        }
    _B_in = _B_setup()

    return {
        "A_x": _A_in["x"],
        "A_wqkv": _A_in["wqkv"],
        "A_wo": _A_in["wo"],
        "B_x": _B_in["x"],
        "B_w_gate": _B_in["w_gate"],
        "B_w_up": _B_in["w_up"],
        "B_w_down": _B_in["w_down"],
    }

def reference(A_x, A_wqkv, A_wo, B_x, B_w_gate, B_w_up, B_w_down):
    def _A_ref(x, wqkv, wo):
        B, S, D = x.shape
        H = 32; Dh = D // H
        qkv = (lambda x, *d: x.permute(*d))((x @ wqkv).reshape(B, S, 3, H, Dh), 2, 0, 3, 1, 4)
        q, k, v = qkv[0], qkv[1], qkv[2]
        phi = lambda t: torch.where(t > 0, t + 1, torch.exp(t)) + 1e-6
        pq, pk = phi(q), phi(k)
        kv = torch.einsum("bhsd,bhse->bhde", pk, v)
        z = torch.einsum("bhsd->bhd", pk)
        num = torch.einsum("bhqd,bhde->bhqe", pq, kv)
        den = torch.einsum("bhqd,bhd->bhq", pq, z)[..., None] + 1e-6
        o = num / den
        return (lambda x, *d: x.permute(*d))(o, 0, 2, 1, 3).reshape(B, S, D) @ wo

    def _B_ref(x, w_gate, w_up, w_down):
        g = _silu(x @ w_gate)
        u = x @ w_up
        return (g * u) @ w_down

    x = A_x
    h = x + _A_ref(_layernorm(x, axis=-1), A_wqkv, A_wo)
    h2 = h + _B_ref(_layernorm(h, axis=-1), B_w_gate, B_w_up, B_w_down)
    return h2
```

```asm
; @launch kernel=k1_kernel grid=(256,1,1) block=(512,1,1) lds=163840
; @launch kernel=k2_kernel grid=(256,1,1) block=(512,1,1) lds=147456
; @launch kernel=k3_kernel grid=(256,1,1) block=(512,1,1) lds=148608
; @launch kernel=k4_kernel grid=(256,1,1) block=(512,1,1) lds=147456
.amdgcn_target "amdgcn-amd-amdhsa--gfx950"
.text
.globl k1_kernel
.p2align 8
.type k1_kernel,@function
k1_kernel:

    s_cmp_ge_u32 s2, 256
    s_cbranch_scc1 Lk1_kernel_end
    s_load_dwordx4 s[4:7], s[0:1], 0
    s_load_dwordx4 s[20:23], s[0:1], 64
    s_load_dwordx2 s[84:85], s[0:1], 16
    s_load_dwordx4 s[88:91], s[0:1], 32
    s_load_dwordx2 s[92:93], s[0:1], 48
    v_lshrrev_b32 v100, 6, v0
    s_nop 0
    v_readfirstlane_b32 s30, v100
    v_and_b32 v97, 63, v0
    s_and_b32 s31, s2, 7
    s_lshr_b32 s32, s2, 3
    s_and_b32 s33, s31, 1
    s_lshl_b32 s33, s33, 3
    s_lshr_b32 s34, s32, 2
    s_add_u32 s33, s33, s34
    s_lshr_b32 s34, s31, 1
    s_lshl_b32 s34, s34, 2
    s_and_b32 s32, s32, 3
    s_add_u32 s32, s32, s34
    s_and_b32 s41, s30, 3
    s_lshr_b32 s39, s30, 2
    v_lshlrev_b32 v96, 4, v97
    v_lshrrev_b32 v100, 4, v97
    s_and_b32 s42, s30, 1
    s_lshl_b32 s42, s42, 2
    v_add_u32 v100, s42, v100
    v_and_b32 v101, 7, v97
    v_xor_b32 v100, v100, v101
    v_lshrrev_b32 v101, 3, v97
    v_mul_u32_u24 v101, 1152, v101
    v_lshl_add_u32 v94, v100, 4, v101
    v_lshrrev_b32 v100, 4, v97
    v_and_b32 v103, 3, v97
    v_lshl_add_u32 v100, v100, 2, v103
    v_min_u32 v100, 14, v100
    v_mul_u32_u24 v101, 52, v100
    v_lshrrev_b32 v101, 8, v101
    v_mul_u32_u24 v103, 5, v101
    v_sub_u32 v100, v100, v103
    v_bfe_u32 v102, v97, 2, 2
    v_mul_u32_u24 v102, 3456, v102
    v_mul_u32_u24 v101, 1152, v101
    v_add_u32 v102, v102, v101
    v_lshl_add_u32 v95, v100, 4, v102
    s_xor_b32 s38, s33, 1
    s_mul_i32 s44, s33, 72
    s_and_b32 s44, s44, 0xfffffff0
    s_mul_i32 s37, s38, 72
    s_and_b32 s37, s37, 0xfffffff0
    v_mov_b32 v100, s44
    v_mov_b32 v103, s37
    v_cmp_eq_u32 vcc, 0, v101
    s_nop 1
    v_cndmask_b32 v100, v100, v103, vcc
    v_add_u32 v95, v95, v100
    s_waitcnt lgkmcnt(0)
    s_mov_b32 s8, s4
    s_mov_b32 s9, s5
    s_mov_b32 s10, 2359296
    s_mov_b32 s11, 0x20000
    s_mov_b32 s12, s6
    s_mov_b32 s13, s7
    s_mov_b32 s14, 1990656
    s_mov_b32 s15, 0x20000
    s_mov_b32 s16, s22
    s_mov_b32 s17, s23
    s_mov_b32 s18, 268435456
    s_mov_b32 s19, 0x20000
    s_cmp_ge_u32 s2, 80
    s_cbranch_scc1 Lk1_kernel_nz
    s_cmp_lg_u32 s30, 7
    s_cbranch_scc1 Lk1_kernel_nz
    s_lshl_b32 s42, s2, 7
    s_add_u32 s42, s42, 14417920
    s_cmp_ge_u32 s2, 64
    s_cselect_b32 s43, 57344, 0
    s_add_u32 s42, s42, s43
    s_cmp_ge_u32 s2, 72
    s_cselect_b32 s43, 64512, 0
    s_add_u32 s42, s42, s43
    v_mov_b32 v104, 0
    v_lshlrev_b32 v105, 2, v97
    s_mov_b32 exec_hi, 0
    buffer_store_dword v104, v105, s[16:19], s42 offen
    s_mov_b64 exec, -1
Lk1_kernel_nz:
    s_lshl_b32 s40, s32, 7
    s_lshl_b32 s42, s30, 3
    s_add_u32 s40, s40, s42
    s_mul_i32 s40, s40, 1152
    s_add_u32 s43, s40, 73728
    s_mul_i32 s44, s30, 13824
    s_lshl_b32 s45, s30, 10
    s_add_u32 m0, s45, 0
    s_nop 0
    buffer_load_dwordx4 v94, s[8:11], s40 offen  lds
    s_add_u32 m0, s45, 16384
    s_nop 0
    buffer_load_dwordx4 v95, s[12:15], s44 offen  lds
    s_add_u32 s44, s44, 110592
    s_add_u32 m0, s45, 8192
    s_nop 0
    buffer_load_dwordx4 v94, s[8:11], s43 offen  lds
    s_add_u32 s40, s40, 128
    s_add_u32 s43, s43, 128
    s_add_u32 m0, s45, 24576
    s_nop 0
    buffer_load_dwordx4 v95, s[12:15], s44 offen  lds
    s_add_u32 s44, s44, 110592
    v_and_b32 v100, 31, v97
    v_lshrrev_b32 v101, 5, v97
    v_bfe_u32 v102, v97, 1, 3
    s_lshl_b32 s42, s41, 5
    v_add_u32 v100, s42, v100
    v_lshlrev_b32 v100, 7, v100
    v_add_u32 v103, 0, v101
    v_xor_b32 v103, v103, v102
    v_lshl_add_u32 v88, v103, 4, v100
    v_add_u32 v103, 2, v101
    v_xor_b32 v103, v103, v102
    v_lshl_add_u32 v89, v103, 4, v100
    v_add_u32 v103, 4, v101
    v_xor_b32 v103, v103, v102
    v_lshl_add_u32 v90, v103, 4, v100
    v_add_u32 v103, 6, v101
    v_xor_b32 v103, v103, v102
    v_lshl_add_u32 v91, v103, 4, v100
    v_bfe_u32 v104, v97, 4, 1
    v_and_b32 v107, 3, v97
    v_lshl_add_u32 v104, v104, 2, v107
    s_and_b32 s46, s33, 1
    s_cmp_eq_u32 s39, 0
    s_cbranch_scc0 Lk1_kernel_u1
    s_xor_b32 s37, s46, 1
    v_add_u32 v105, s37, v104
    v_add_u32 v106, s46, v104
    v_add_u32 v106, 10, v106
    s_branch Lk1_kernel_uj
Lk1_kernel_u1:
    v_add_u32 v105, 19, v104
    v_cmp_eq_u32 vcc, 0, v104
    v_mov_b32 v107, 18
    s_nop 0
    v_cndmask_b32 v105, v105, v107, vcc
    v_add_u32 v105, s46, v105
    v_add_u32 v106, 27, v104
    v_add_u32 v106, s46, v106
    s_xor_b32 s37, s46, 1
    s_add_u32 s37, s37, 8
    v_cmp_gt_u32 vcc, 2, v104
    v_mov_b32 v107, s37
    s_nop 0
    v_cndmask_b32 v106, v107, v106, vcc
Lk1_kernel_uj:
    s_nop 15
    s_nop 3
    v_lshrrev_b32 v109, 5, v97
    v_lshlrev_b32 v109, 11, v109
    v_bfe_u32 v107, v97, 2, 2
    v_lshl_add_u32 v109, v107, 6, v109
    v_add_u32 v109, 16384, v109
    v_lshrrev_b32 v107, 3, v105
    v_lshl_add_u32 v92, v107, 8, v109
    v_and_b32 v107, 7, v105
    v_lshl_add_u32 v92, v107, 3, v92
    v_lshrrev_b32 v107, 3, v106
    v_lshl_add_u32 v93, v107, 8, v109
    v_and_b32 v107, 7, v106
    v_lshl_add_u32 v93, v107, 3, v93
    v_add_u32 v110, 65536, v88
    v_add_u32 v111, 65536, v89
    v_add_u32 v112, 65536, v90
    v_add_u32 v113, 65536, v91
    v_add_u32 v114, 65536, v92
    v_add_u32 v115, 65536, v93
    v_add_u32 v126, 131072, v88
    v_add_u32 v127, 131072, v89
    v_add_u32 v128, 131072, v90
    v_add_u32 v129, 131072, v91
    v_add_u32 v130, 131072, v92
    v_add_u32 v131, 131072, v93
    v_mov_b32 v0, 0
    v_mov_b32 v1, 0
    v_mov_b32 v2, 0
    v_mov_b32 v3, 0
    v_mov_b32 v4, 0
    v_mov_b32 v5, 0
    v_mov_b32 v6, 0
    v_mov_b32 v7, 0
    v_mov_b32 v8, 0
    v_mov_b32 v9, 0
    v_mov_b32 v10, 0
    v_mov_b32 v11, 0
    v_mov_b32 v12, 0
    v_mov_b32 v13, 0
    v_mov_b32 v14, 0
    v_mov_b32 v15, 0
    v_mov_b32 v16, 0
    v_mov_b32 v17, 0
    v_mov_b32 v18, 0
    v_mov_b32 v19, 0
    v_mov_b32 v20, 0
    v_mov_b32 v21, 0
    v_mov_b32 v22, 0
    v_mov_b32 v23, 0
    v_mov_b32 v24, 0
    v_mov_b32 v25, 0
    v_mov_b32 v26, 0
    v_mov_b32 v27, 0
    v_mov_b32 v28, 0
    v_mov_b32 v29, 0
    v_mov_b32 v30, 0
    v_mov_b32 v31, 0
    v_mov_b32 v80, 0
    v_mov_b32 v81, 0
    v_mov_b32 v82, 0
    v_mov_b32 v83, 0
    v_mov_b32 v84, 0
    v_mov_b32 v85, 0
    s_mov_b32 s47, 0x3f803f80
    s_add_u32 m0, s45, 32768
    s_nop 0
    buffer_load_dwordx4 v94, s[8:11], s40 offen  lds
    s_add_u32 m0, s45, 49152
    s_nop 0
    buffer_load_dwordx4 v95, s[12:15], s44 offen  lds
    s_add_u32 s44, s44, 110592
    s_add_u32 m0, s45, 40960
    s_nop 0
    buffer_load_dwordx4 v94, s[8:11], s43 offen  lds
    s_add_u32 s40, s40, 128
    s_add_u32 s43, s43, 128
    s_add_u32 m0, s45, 57344
    s_nop 0
    buffer_load_dwordx4 v95, s[12:15], s44 offen  lds
    s_add_u32 s44, s44, 110592
    s_waitcnt vmcnt(4)
    s_barrier
    s_lshr_b32 s46, s2, 3
    s_lshl_b32 s46, s46, 3
    s_add_u32 s46, s46, s30
    v_lshlrev_b32 v120, 7, v97
    s_lshr_b32 s48, s31, 1
    s_mul_i32 s48, s48, 589824
    s_mul_i32 s49, s46, 2304
    s_add_u32 s48, s48, s49
    s_mul_i32 s49, s46, 34
    v_add_u32 v121, s49, v97
    s_mov_b32 s49, 0xCCCD
    v_mul_lo_u32 v122, v121, s49
    v_lshrrev_b32 v122, 18, v122
    v_mul_u32_u24 v123, 5, v122
    v_sub_u32 v121, v121, v123
    v_mul_u32_u24 v122, 1152, v122
    v_lshl_add_u32 v121, v121, 7, v122
    s_and_b32 s49, s31, 1
    s_lshl_b32 s49, s49, 9
    s_mov_b32 exec_hi, 0
    s_mov_b32 exec_lo, 0x3ffff
    buffer_load_dword v180, v120, s[8:11], s48 offen
    s_mov_b32 exec_hi, 3
    s_mov_b32 exec_lo, -1
    buffer_load_dword v181, v121, s[12:15], s49 offen
    s_mov_b64 exec, -1
    s_getpc_b64 s[94:95]
Lk1_kernel_pc:
    s_sub_u32 s94, s94, (Lk1_kernel_pc - k1_kernel)
    s_subb_u32 s95, s95, 0
    s_lshl_b32 s49, s46, 10
    v_add_u32 v122, s49, v120
    v_cmp_gt_u32 vcc, (Lcode_end - k1_kernel), v122
    s_nop 1
    s_and_b32 exec_lo, vcc_lo, 0xff
    s_mov_b32 exec_hi, 0
    s_cbranch_execz Lk1_kernel_nocp
    global_load_dword v182, v122, s[94:95]
Lk1_kernel_nocp:
    s_mov_b64 exec, -1
    s_cmp_eq_u32 s39, 0
    s_cbranch_scc0 Lk1_kernel_cg1
    ds_read_b128 v[32:35], v88 offset:0
    ds_read_b64_tr_b16 v[48:49], v92 offset:0
    ds_read_b64_tr_b16 v[50:51], v92 offset:1024
    ds_read_b64_tr_b16 v[52:53], v93 offset:0
    ds_read_b64_tr_b16 v[54:55], v93 offset:1024
    ds_read_b128 v[36:39], v89 offset:0
    ds_read_b64_tr_b16 v[56:57], v92 offset:4096
    ds_read_b64_tr_b16 v[58:59], v92 offset:5120
    ds_read_b64_tr_b16 v[60:61], v93 offset:4096
    ds_read_b64_tr_b16 v[62:63], v93 offset:5120
    ds_read_b128 v[40:43], v90 offset:0
    ds_read_b64_tr_b16 v[64:65], v92 offset:8192
    ds_read_b64_tr_b16 v[66:67], v92 offset:9216
    ds_read_b64_tr_b16 v[68:69], v93 offset:8192
    ds_read_b64_tr_b16 v[70:71], v93 offset:9216
    s_waitcnt lgkmcnt(12)
    v_mfma_f32_32x32x16_bf16 v[0:15], v[48:51], v[32:35], v[0:15]
    v_dot2c_f32_bf16 v80, s47, v32
    v_dot2c_f32_bf16 v82, v32, v32
    v_dot2c_f32_bf16 v81, s47, v33
    v_dot2c_f32_bf16 v83, v33, v33
    ds_read_b128 v[44:47], v91 offset:0
    ds_read_b64_tr_b16 v[72:73], v92 offset:12288
    ds_read_b64_tr_b16 v[74:75], v92 offset:13312
    s_waitcnt lgkmcnt(13)
    v_mfma_f32_32x32x16_bf16 v[16:31], v[32:35], v[52:55], v[16:31]
    v_dot2c_f32_bf16 v80, s47, v34
    v_dot2c_f32_bf16 v82, v34, v34
    v_dot2c_f32_bf16 v81, s47, v35
    v_dot2c_f32_bf16 v83, v35, v35
    s_cmp_lg_u32 s41, 0
    s_cbranch_scc1 Lk1_kernel_ncs1
    v_dot2c_f32_bf16 v84, s47, v48
    v_dot2c_f32_bf16 v84, s47, v49
    v_dot2c_f32_bf16 v84, s47, v50
    v_dot2c_f32_bf16 v84, s47, v51
    v_dot2c_f32_bf16 v85, s47, v52
    v_dot2c_f32_bf16 v85, s47, v53
    v_dot2c_f32_bf16 v85, s47, v54
    v_dot2c_f32_bf16 v85, s47, v55
Lk1_kernel_ncs1:
    ds_read_b64_tr_b16 v[76:77], v93 offset:12288
    ds_read_b64_tr_b16 v[78:79], v93 offset:13312
    s_waitcnt vmcnt(2)
    s_barrier
    s_waitcnt lgkmcnt(12)
    v_mfma_f32_32x32x16_bf16 v[0:15], v[56:59], v[36:39], v[0:15]
    v_dot2c_f32_bf16 v80, s47, v36
    v_dot2c_f32_bf16 v82, v36, v36
    v_dot2c_f32_bf16 v81, s47, v37
    v_dot2c_f32_bf16 v83, v37, v37
    ds_read_b128 v[32:35], v88 offset:32768
    ds_read_b64_tr_b16 v[48:49], v92 offset:32768
    ds_read_b64_tr_b16 v[50:51], v92 offset:33792
    s_add_u32 m0, s45, 65536
    s_nop 0
    buffer_load_dwordx4 v94, s[8:11], s40 offen  lds
    s_waitcnt lgkmcnt(13)
    v_mfma_f32_32x32x16_bf16 v[16:31], v[36:39], v[60:63], v[16:31]
    v_dot2c_f32_bf16 v80, s47, v38
    v_dot2c_f32_bf16 v82, v38, v38
    v_dot2c_f32_bf16 v81, s47, v39
    v_dot2c_f32_bf16 v83, v39, v39
    s_cmp_lg_u32 s41, 1
    s_cbranch_scc1 Lk1_kernel_ncs2
    v_dot2c_f32_bf16 v84, s47, v56
    v_dot2c_f32_bf16 v84, s47, v57
    v_dot2c_f32_bf16 v84, s47, v58
    v_dot2c_f32_bf16 v84, s47, v59
    v_dot2c_f32_bf16 v85, s47, v60
    v_dot2c_f32_bf16 v85, s47, v61
    v_dot2c_f32_bf16 v85, s47, v62
    v_dot2c_f32_bf16 v85, s47, v63
Lk1_kernel_ncs2:
    ds_read_b64_tr_b16 v[52:53], v93 offset:32768
    ds_read_b64_tr_b16 v[54:55], v93 offset:33792
    s_add_u32 m0, s45, 81920
    s_nop 0
    buffer_load_dwordx4 v95, s[12:15], s44 offen  lds
    s_add_u32 s44, s44, 110592
    s_waitcnt lgkmcnt(12)
    v_mfma_f32_32x32x16_bf16 v[0:15], v[64:67], v[40:43], v[0:15]
    ds_read_b128 v[36:39], v89 offset:32768
    ds_read_b64_tr_b16 v[56:57], v92 offset:36864
    ds_read_b64_tr_b16 v[58:59], v92 offset:37888
    s_add_u32 m0, s45, 73728
    s_nop 0
    buffer_load_dwordx4 v94, s[8:11], s43 offen  lds
    s_add_u32 s40, s40, 128
    s_add_u32 s43, s43, 128
    s_waitcnt lgkmcnt(13)
    v_mfma_f32_32x32x16_bf16 v[16:31], v[40:43], v[68:71], v[16:31]
    s_cmp_lg_u32 s41, 2
    s_cbranch_scc1 Lk1_kernel_ncs3
    v_dot2c_f32_bf16 v84, s47, v64
    v_dot2c_f32_bf16 v84, s47, v65
    v_dot2c_f32_bf16 v84, s47, v66
    v_dot2c_f32_bf16 v84, s47, v67
    v_dot2c_f32_bf16 v85, s47, v68
    v_dot2c_f32_bf16 v85, s47, v69
    v_dot2c_f32_bf16 v85, s47, v70
    v_dot2c_f32_bf16 v85, s47, v71
Lk1_kernel_ncs3:
    ds_read_b64_tr_b16 v[60:61], v93 offset:36864
    ds_read_b64_tr_b16 v[62:63], v93 offset:37888
    s_add_u32 m0, s45, 90112
    s_nop 0
    buffer_load_dwordx4 v95, s[12:15], s44 offen  lds
    s_add_u32 s44, s44, 110592
    s_waitcnt lgkmcnt(12)
    v_mfma_f32_32x32x16_bf16 v[0:15], v[72:75], v[44:47], v[0:15]
    ds_read_b128 v[40:43], v90 offset:32768
    ds_read_b64_tr_b16 v[64:65], v92 offset:40960
    ds_read_b64_tr_b16 v[66:67], v92 offset:41984
    s_add_u32 m0, s45, 98304
    s_nop 0
    buffer_load_dwordx4 v94, s[8:11], s40 offen  lds
    s_waitcnt lgkmcnt(13)
    v_mfma_f32_32x32x16_bf16 v[16:31], v[44:47], v[76:79], v[16:31]
    s_cmp_lg_u32 s41, 3
    s_cbranch_scc1 Lk1_kernel_ncs4
    v_dot2c_f32_bf16 v84, s47, v72
    v_dot2c_f32_bf16 v84, s47, v73
    v_dot2c_f32_bf16 v84, s47, v74
    v_dot2c_f32_bf16 v84, s47, v75
    v_dot2c_f32_bf16 v85, s47, v76
    v_dot2c_f32_bf16 v85, s47, v77
    v_dot2c_f32_bf16 v85, s47, v78
    v_dot2c_f32_bf16 v85, s47, v79
Lk1_kernel_ncs4:
    ds_read_b64_tr_b16 v[68:69], v93 offset:40960
    ds_read_b64_tr_b16 v[70:71], v93 offset:41984
    s_add_u32 m0, s45, 114688
    s_nop 0
    buffer_load_dwordx4 v95, s[12:15], s44 offen  lds
    s_add_u32 s44, s44, 110592
    s_waitcnt lgkmcnt(12)
    v_mfma_f32_32x32x16_bf16 v[0:15], v[48:51], v[32:35], v[0:15]
    v_dot2c_f32_bf16 v80, s47, v32
    v_dot2c_f32_bf16 v82, v32, v32
    v_dot2c_f32_bf16 v81, s47, v33
    v_dot2c_f32_bf16 v83, v33, v33
    ds_read_b128 v[44:47], v91 offset:32768
    ds_read_b64_tr_b16 v[72:73], v92 offset:45056
    ds_read_b64_tr_b16 v[74:75], v92 offset:46080
    s_add_u32 m0, s45, 106496
    s_nop 0
    buffer_load_dwordx4 v94, s[8:11], s43 offen  lds
    s_add_u32 s40, s40, 128
    s_add_u32 s43, s43, 128
    s_waitcnt lgkmcnt(13)
    v_mfma_f32_32x32x16_bf16 v[16:31], v[32:35], v[52:55], v[16:31]
    v_dot2c_f32_bf16 v80, s47, v34
    v_dot2c_f32_bf16 v82, v34, v34
    v_dot2c_f32_bf16 v81, s47, v35
    v_dot2c_f32_bf16 v83, v35, v35
    s_cmp_lg_u32 s41, 0
    s_cbranch_scc1 Lk1_kernel_ncs5
    v_dot2c_f32_bf16 v84, s47, v48
    v_dot2c_f32_bf16 v84, s47, v49
    v_dot2c_f32_bf16 v84, s47, v50
    v_dot2c_f32_bf16 v84, s47, v51
    v_dot2c_f32_bf16 v85, s47, v52
    v_dot2c_f32_bf16 v85, s47, v53
    v_dot2c_f32_bf16 v85, s47, v54
    v_dot2c_f32_bf16 v85, s47, v55
Lk1_kernel_ncs5:
    ds_read_b64_tr_b16 v[76:77], v93 offset:45056
    ds_read_b64_tr_b16 v[78:79], v93 offset:46080
    s_add_u32 m0, s45, 122880
    s_nop 0
    buffer_load_dwordx4 v95, s[12:15], s44 offen  lds
    s_add_u32 s44, s44, 110592
    s_waitcnt vmcnt(4)
    s_barrier
    s_waitcnt lgkmcnt(12)
    v_mfma_f32_32x32x16_bf16 v[0:15], v[56:59], v[36:39], v[0:15]
    v_dot2c_f32_bf16 v80, s47, v36
    v_dot2c_f32_bf16 v82, v36, v36
    v_dot2c_f32_bf16 v81, s47, v37
    v_dot2c_f32_bf16 v83, v37, v37
    ds_read_b128 v[32:35], v110 offset:0
    ds_read_b64_tr_b16 v[48:49], v114 offset:0
    ds_read_b64_tr_b16 v[50:51], v114 offset:1024
    s_add_u32 m0, s45, 131072
    s_nop 0
    buffer_load_dwordx4 v94, s[8:11], s40 offen  lds
    s_waitcnt lgkmcnt(13)
    v_mfma_f32_32x32x16_bf16 v[16:31], v[36:39], v[60:63], v[16:31]
    v_dot2c_f32_bf16 v80, s47, v38
    v_dot2c_f32_bf16 v82, v38, v38
    v_dot2c_f32_bf16 v81, s47, v39
    v_dot2c_f32_bf16 v83, v39, v39
    s_cmp_lg_u32 s41, 1
    s_cbranch_scc1 Lk1_kernel_ncs6
    v_dot2c_f32_bf16 v84, s47, v56
    v_dot2c_f32_bf16 v84, s47, v57
    v_dot2c_f32_bf16 v84, s47, v58
    v_dot2c_f32_bf16 v84, s47, v59
    v_dot2c_f32_bf16 v85, s47, v60
    v_dot2c_f32_bf16 v85, s47, v61
    v_dot2c_f32_bf16 v85, s47, v62
    v_dot2c_f32_bf16 v85, s47, v63
Lk1_kernel_ncs6:
    ds_read_b64_tr_b16 v[52:53], v115 offset:0
    ds_read_b64_tr_b16 v[54:55], v115 offset:1024
    s_add_u32 m0, s45, 147456
    s_nop 0
    buffer_load_dwordx4 v95, s[12:15], s44 offen  lds
    s_add_u32 s44, s44, 110592
    s_waitcnt lgkmcnt(12)
    v_mfma_f32_32x32x16_bf16 v[0:15], v[64:67], v[40:43], v[0:15]
    ds_read_b128 v[36:39], v111 offset:0
    ds_read_b64_tr_b16 v[56:57], v114 offset:4096
    ds_read_b64_tr_b16 v[58:59], v114 offset:5120
    s_add_u32 m0, s45, 139264
    s_nop 0
    buffer_load_dwordx4 v94, s[8:11], s43 offen  lds
    s_add_u32 s40, s40, 128
    s_add_u32 s43, s43, 128
    s_waitcnt lgkmcnt(13)
    v_mfma_f32_32x32x16_bf16 v[16:31], v[40:43], v[68:71], v[16:31]
    s_cmp_lg_u32 s41, 2
    s_cbranch_scc1 Lk1_kernel_ncs7
    v_dot2c_f32_bf16 v84, s47, v64
    v_dot2c_f32_bf16 v84, s47, v65
    v_dot2c_f32_bf16 v84, s47, v66
    v_dot2c_f32_bf16 v84, s47, v67
    v_dot2c_f32_bf16 v85, s47, v68
    v_dot2c_f32_bf16 v85, s47, v69
    v_dot2c_f32_bf16 v85, s47, v70
    v_dot2c_f32_bf16 v85, s47, v71
Lk1_kernel_ncs7:
    ds_read_b64_tr_b16 v[60:61], v115 offset:4096
    ds_read_b64_tr_b16 v[62:63], v115 offset:5120
    s_add_u32 m0, s45, 155648
    s_nop 0
    buffer_load_dwordx4 v95, s[12:15], s44 offen  lds
    s_add_u32 s44, s44, 110592
    s_waitcnt lgkmcnt(12)
    v_mfma_f32_32x32x16_bf16 v[0:15], v[72:75], v[44:47], v[0:15]
    ds_read_b128 v[40:43], v112 offset:0
    ds_read_b64_tr_b16 v[64:65], v114 offset:8192
    ds_read_b64_tr_b16 v[66:67], v114 offset:9216
    s_add_u32 m0, s45, 0
    s_nop 0
    buffer_load_dwordx4 v94, s[8:11], s40 offen  lds
    s_waitcnt lgkmcnt(13)
    v_mfma_f32_32x32x16_bf16 v[16:31], v[44:47], v[76:79], v[16:31]
    s_cmp_lg_u32 s41, 3
    s_cbranch_scc1 Lk1_kernel_ncs8
    v_dot2c_f32_bf16 v84, s47, v72
    v_dot2c_f32_bf16 v84, s47, v73
    v_dot2c_f32_bf16 v84, s47, v74
    v_dot2c_f32_bf16 v84, s47, v75
    v_dot2c_f32_bf16 v85, s47, v76
    v_dot2c_f32_bf16 v85, s47, v77
    v_dot2c_f32_bf16 v85, s47, v78
    v_dot2c_f32_bf16 v85, s47, v79
Lk1_kernel_ncs8:
    ds_read_b64_tr_b16 v[68:69], v115 offset:8192
    ds_read_b64_tr_b16 v[70:71], v115 offset:9216
    s_add_u32 m0, s45, 16384
    s_nop 0
    buffer_load_dwordx4 v95, s[12:15], s44 offen  lds
    s_add_u32 s44, s44, 110592
    s_waitcnt lgkmcnt(12)
    v_mfma_f32_32x32x16_bf16 v[0:15], v[48:51], v[32:35], v[0:15]
    v_dot2c_f32_bf16 v80, s47, v32
    v_dot2c_f32_bf16 v82, v32, v32
    v_dot2c_f32_bf16 v81, s47, v33
    v_dot2c_f32_bf16 v83, v33, v33
    ds_read_b128 v[44:47], v113 offset:0
    ds_read_b64_tr_b16 v[72:73], v114 offset:12288
    ds_read_b64_tr_b16 v[74:75], v114 offset:13312
    s_add_u32 m0, s45, 8192
    s_nop 0
    buffer_load_dwordx4 v94, s[8:11], s43 offen  lds
    s_add_u32 s40, s40, 128
    s_add_u32 s43, s43, 128
    s_waitcnt lgkmcnt(13)
    v_mfma_f32_32x32x16_bf16 v[16:31], v[32:35], v[52:55], v[16:31]
    v_dot2c_f32_bf16 v80, s47, v34
    v_dot2c_f32_bf16 v82, v34, v34
    v_dot2c_f32_bf16 v81, s47, v35
    v_dot2c_f32_bf16 v83, v35, v35
    s_cmp_lg_u32 s41, 0
    s_cbranch_scc1 Lk1_kernel_ncs9
    v_dot2c_f32_bf16 v84, s47, v48
    v_dot2c_f32_bf16 v84, s47, v49
    v_dot2c_f32_bf16 v84, s47, v50
    v_dot2c_f32_bf16 v84, s47, v51
    v_dot2c_f32_bf16 v85, s47, v52
    v_dot2c_f32_bf16 v85, s47, v53
    v_dot2c_f32_bf16 v85, s47, v54
    v_dot2c_f32_bf16 v85, s47, v55
Lk1_kernel_ncs9:
    ds_read_b64_tr_b16 v[76:77], v115 offset:12288
    ds_read_b64_tr_b16 v[78:79], v115 offset:13312
    s_waitcnt vmcnt(7)
    s_barrier
    s_waitcnt lgkmcnt(12)
    v_mfma_f32_32x32x16_bf16 v[0:15], v[56:59], v[36:39], v[0:15]
    v_dot2c_f32_bf16 v80, s47, v36
    v_dot2c_f32_bf16 v82, v36, v36
    v_dot2c_f32_bf16 v81, s47, v37
    v_dot2c_f32_bf16 v83, v37, v37
    ds_read_b128 v[32:35], v110 offset:32768
    ds_read_b64_tr_b16 v[48:49], v114 offset:32768
    ds_read_b64_tr_b16 v[50:51], v114 offset:33792
    s_add_u32 m0, s45, 24576
    s_nop 0
    buffer_load_dwordx4 v95, s[12:15], s44 offen  lds
    s_add_u32 s44, s44, 110592
    s_waitcnt lgkmcnt(13)
    v_mfma_f32_32x32x16_bf16 v[16:31], v[36:39], v[60:63], v[16:31]
    v_dot2c_f32_bf16 v80, s47, v38
    v_dot2c_f32_bf16 v82, v38, v38
    v_dot2c_f32_bf16 v81, s47, v39
    v_dot2c_f32_bf16 v83, v39, v39
    s_cmp_lg_u32 s41, 1
    s_cbranch_scc1 Lk1_kernel_ncs10
    v_dot2c_f32_bf16 v84, s47, v56
    v_dot2c_f32_bf16 v84, s47, v57
    v_dot2c_f32_bf16 v84, s47, v58
    v_dot2c_f32_bf16 v84, s47, v59
    v_dot2c_f32_bf16 v85, s47, v60
    v_dot2c_f32_bf16 v85, s47, v61
    v_dot2c_f32_bf16 v85, s47, v62
    v_dot2c_f32_bf16 v85, s47, v63
Lk1_kernel_ncs10:
    ds_read_b64_tr_b16 v[52:53], v115 offset:32768
    ds_read_b64_tr_b16 v[54:55], v115 offset:33792
    s_waitcnt lgkmcnt(12)
    v_mfma_f32_32x32x16_bf16 v[0:15], v[64:67], v[40:43], v[0:15]
    ds_read_b128 v[36:39], v111 offset:32768
    ds_read_b64_tr_b16 v[56:57], v114 offset:36864
    ds_read_b64_tr_b16 v[58:59], v114 offset:37888
    s_add_u32 m0, s45, 32768
    s_nop 0
    buffer_load_dwordx4 v94, s[8:11], s40 offen  lds
    s_waitcnt lgkmcnt(13)
    v_mfma_f32_32x32x16_bf16 v[16:31], v[40:43], v[68:71], v[16:31]
    s_cmp_lg_u32 s41, 2
    s_cbranch_scc1 Lk1_kernel_ncs11
    v_dot2c_f32_bf16 v84, s47, v64
    v_dot2c_f32_bf16 v84, s47, v65
    v_dot2c_f32_bf16 v84, s47, v66
    v_dot2c_f32_bf16 v84, s47, v67
    v_dot2c_f32_bf16 v85, s47, v68
    v_dot2c_f32_bf16 v85, s47, v69
    v_dot2c_f32_bf16 v85, s47, v70
    v_dot2c_f32_bf16 v85, s47, v71
Lk1_kernel_ncs11:
    ds_read_b64_tr_b16 v[60:61], v115 offset:36864
    ds_read_b64_tr_b16 v[62:63], v115 offset:37888
    s_waitcnt lgkmcnt(12)
    v_mfma_f32_32x32x16_bf16 v[0:15], v[72:75], v[44:47], v[0:15]
    ds_read_b128 v[40:43], v112 offset:32768
    ds_read_b64_tr_b16 v[64:65], v114 offset:40960
    ds_read_b64_tr_b16 v[66:67], v114 offset:41984
    s_add_u32 m0, s45, 49152
    s_nop 0
    buffer_load_dwordx4 v95, s[12:15], s44 offen  lds
    s_add_u32 s44, s44, 110592
    s_waitcnt lgkmcnt(13)
    v_mfma_f32_32x32x16_bf16 v[16:31], v[44:47], v[76:79], v[16:31]
    s_cmp_lg_u32 s41, 3
    s_cbranch_scc1 Lk1_kernel_ncs12
    v_dot2c_f32_bf16 v84, s47, v72
    v_dot2c_f32_bf16 v84, s47, v73
    v_dot2c_f32_bf16 v84, s47, v74
    v_dot2c_f32_bf16 v84, s47, v75
    v_dot2c_f32_bf16 v85, s47, v76
    v_dot2c_f32_bf16 v85, s47, v77
    v_dot2c_f32_bf16 v85, s47, v78
    v_dot2c_f32_bf16 v85, s47, v79
Lk1_kernel_ncs12:
    ds_read_b64_tr_b16 v[68:69], v115 offset:40960
    ds_read_b64_tr_b16 v[70:71], v115 offset:41984
    s_waitcnt lgkmcnt(12)
    v_mfma_f32_32x32x16_bf16 v[0:15], v[48:51], v[32:35], v[0:15]
    v_dot2c_f32_bf16 v80, s47, v32
    v_dot2c_f32_bf16 v82, v32, v32
    v_dot2c_f32_bf16 v81, s47, v33
    v_dot2c_f32_bf16 v83, v33, v33
    ds_read_b128 v[44:47], v113 offset:32768
    ds_read_b64_tr_b16 v[72:73], v114 offset:45056
    ds_read_b64_tr_b16 v[74:75], v114 offset:46080
    s_add_u32 m0, s45, 40960
    s_nop 0
    buffer_load_dwordx4 v94, s[8:11], s43 offen  lds
    s_add_u32 s40, s40, 128
    s_add_u32 s43, s43, 128
    s_waitcnt lgkmcnt(13)
    v_mfma_f32_32x32x16_bf16 v[16:31], v[32:35], v[52:55], v[16:31]
    v_dot2c_f32_bf16 v80, s47, v34
    v_dot2c_f32_bf16 v82, v34, v34
    v_dot2c_f32_bf16 v81, s47, v35
    v_dot2c_f32_bf16 v83, v35, v35
    s_cmp_lg_u32 s41, 0
    s_cbranch_scc1 Lk1_kernel_ncs13
    v_dot2c_f32_bf16 v84, s47, v48
    v_dot2c_f32_bf16 v84, s47, v49
    v_dot2c_f32_bf16 v84, s47, v50
    v_dot2c_f32_bf16 v84, s47, v51
    v_dot2c_f32_bf16 v85, s47, v52
    v_dot2c_f32_bf16 v85, s47, v53
    v_dot2c_f32_bf16 v85, s47, v54
    v_dot2c_f32_bf16 v85, s47, v55
Lk1_kernel_ncs13:
    ds_read_b64_tr_b16 v[76:77], v115 offset:45056
    ds_read_b64_tr_b16 v[78:79], v115 offset:46080
    s_waitcnt vmcnt(7)
    s_barrier
    s_waitcnt lgkmcnt(12)
    v_mfma_f32_32x32x16_bf16 v[0:15], v[56:59], v[36:39], v[0:15]
    v_dot2c_f32_bf16 v80, s47, v36
    v_dot2c_f32_bf16 v82, v36, v36
    v_dot2c_f32_bf16 v81, s47, v37
    v_dot2c_f32_bf16 v83, v37, v37
    ds_read_b128 v[32:35], v126 offset:0
    ds_read_b64_tr_b16 v[48:49], v130 offset:0
    ds_read_b64_tr_b16 v[50:51], v130 offset:1024
    s_add_u32 m0, s45, 57344
    s_nop 0
    buffer_load_dwordx4 v95, s[12:15], s44 offen  lds
    s_add_u32 s44, s44, 110592
    s_waitcnt lgkmcnt(13)
    v_mfma_f32_32x32x16_bf16 v[16:31], v[36:39], v[60:63], v[16:31]
    v_dot2c_f32_bf16 v80, s47, v38
    v_dot2c_f32_bf16 v82, v38, v38
    v_dot2c_f32_bf16 v81, s47, v39
    v_dot2c_f32_bf16 v83, v39, v39
    s_cmp_lg_u32 s41, 1
    s_cbranch_scc1 Lk1_kernel_ncs14
    v_dot2c_f32_bf16 v84, s47, v56
    v_dot2c_f32_bf16 v84, s47, v57
    v_dot2c_f32_bf16 v84, s47, v58
    v_dot2c_f32_bf16 v84, s47, v59
    v_dot2c_f32_bf16 v85, s47, v60
    v_dot2c_f32_bf16 v85, s47, v61
    v_dot2c_f32_bf16 v85, s47, v62
    v_dot2c_f32_bf16 v85, s47, v63
Lk1_kernel_ncs14:
    ds_read_b64_tr_b16 v[52:53], v131 offset:0
    ds_read_b64_tr_b16 v[54:55], v131 offset:1024
    s_waitcnt lgkmcnt(12)
    v_mfma_f32_32x32x16_bf16 v[0:15], v[64:67], v[40:43], v[0:15]
    ds_read_b128 v[36:39], v127 offset:0
    ds_read_b64_tr_b16 v[56:57], v130 offset:4096
    ds_read_b64_tr_b16 v[58:59], v130 offset:5120
    s_add_u32 m0, s45, 65536
    s_nop 0
    buffer_load_dwordx4 v94, s[8:11], s40 offen  lds
    s_waitcnt lgkmcnt(13)
    v_mfma_f32_32x32x16_bf16 v[16:31], v[40:43], v[68:71], v[16:31]
    s_cmp_lg_u32 s41, 2
    s_cbranch_scc1 Lk1_kernel_ncs15
    v_dot2c_f32_bf16 v84, s47, v64
    v_dot2c_f32_bf16 v84, s47, v65
    v_dot2c_f32_bf16 v84, s47, v66
    v_dot2c_f32_bf16 v84, s47, v67
    v_dot2c_f32_bf16 v85, s47, v68
    v_dot2c_f32_bf16 v85, s47, v69
    v_dot2c_f32_bf16 v85, s47, v70
    v_dot2c_f32_bf16 v85, s47, v71
Lk1_kernel_ncs15:
    ds_read_b64_tr_b16 v[60:61], v131 offset:4096
    ds_read_b64_tr_b16 v[62:63], v131 offset:5120
    s_waitcnt lgkmcnt(12)
    v_mfma_f32_32x32x16_bf16 v[0:15], v[72:75], v[44:47], v[0:15]
    ds_read_b128 v[40:43], v128 offset:0
    ds_read_b64_tr_b16 v[64:65], v130 offset:8192
    ds_read_b64_tr_b16 v[66:67], v130 offset:9216
    s_add_u32 m0, s45, 81920
    s_nop 0
    buffer_load_dwordx4 v95, s[12:15], s44 offen  lds
    s_add_u32 s44, s44, 110592
    s_waitcnt lgkmcnt(13)
    v_mfma_f32_32x32x16_bf16 v[16:31], v[44:47], v[76:79], v[16:31]
    s_cmp_lg_u32 s41, 3
    s_cbranch_scc1 Lk1_kernel_ncs16
    v_dot2c_f32_bf16 v84, s47, v72
    v_dot2c_f32_bf16 v84, s47, v73
    v_dot2c_f32_bf16 v84, s47, v74
    v_dot2c_f32_bf16 v84, s47, v75
    v_dot2c_f32_bf16 v85, s47, v76
    v_dot2c_f32_bf16 v85, s47, v77
    v_dot2c_f32_bf16 v85, s47, v78
    v_dot2c_f32_bf16 v85, s47, v79
Lk1_kernel_ncs16:
    ds_read_b64_tr_b16 v[68:69], v131 offset:8192
    ds_read_b64_tr_b16 v[70:71], v131 offset:9216
    s_waitcnt lgkmcnt(12)
    v_mfma_f32_32x32x16_bf16 v[0:15], v[48:51], v[32:35], v[0:15]
    v_dot2c_f32_bf16 v80, s47, v32
    v_dot2c_f32_bf16 v82, v32, v32
    v_dot2c_f32_bf16 v81, s47, v33
    v_dot2c_f32_bf16 v83, v33, v33
    ds_read_b128 v[44:47], v129 offset:0
    ds_read_b64_tr_b16 v[72:73], v130 offset:12288
    ds_read_b64_tr_b16 v[74:75], v130 offset:13312
    s_add_u32 m0, s45, 73728
    s_nop 0
    buffer_load_dwordx4 v94, s[8:11], s43 offen  lds
    s_add_u32 s40, s40, 128
    s_add_u32 s43, s43, 128
    s_waitcnt lgkmcnt(13)
    v_mfma_f32_32x32x16_bf16 v[16:31], v[32:35], v[52:55], v[16:31]
    v_dot2c_f32_bf16 v80, s47, v34
    v_dot2c_f32_bf16 v82, v34, v34
    v_dot2c_f32_bf16 v81, s47, v35
    v_dot2c_f32_bf16 v83, v35, v35
    s_cmp_lg_u32 s41, 0
    s_cbranch_scc1 Lk1_kernel_ncs17
    v_dot2c_f32_bf16 v84, s47, v48
    v_dot2c_f32_bf16 v84, s47, v49
    v_dot2c_f32_bf16 v84, s47, v50
    v_dot2c_f32_bf16 v84, s47, v51
    v_dot2c_f32_bf16 v85, s47, v52
    v_dot2c_f32_bf16 v85, s47, v53
    v_dot2c_f32_bf16 v85, s47, v54
    v_dot2c_f32_bf16 v85, s47, v55
Lk1_kernel_ncs17:
    ds_read_b64_tr_b16 v[76:77], v131 offset:12288
    ds_read_b64_tr_b16 v[78:79], v131 offset:13312
    s_waitcnt vmcnt(7)
    s_barrier
    s_waitcnt lgkmcnt(12)
    v_mfma_f32_32x32x16_bf16 v[0:15], v[56:59], v[36:39], v[0:15]
    v_dot2c_f32_bf16 v80, s47, v36
    v_dot2c_f32_bf16 v82, v36, v36
    v_dot2c_f32_bf16 v81, s47, v37
    v_dot2c_f32_bf16 v83, v37, v37
    ds_read_b128 v[32:35], v88 offset:0
    ds_read_b64_tr_b16 v[48:49], v92 offset:0
    ds_read_b64_tr_b16 v[50:51], v92 offset:1024
    s_add_u32 m0, s45, 90112
    s_nop 0
    buffer_load_dwordx4 v95, s[12:15], s44 offen  lds
    s_add_u32 s44, s44, 110592
    s_waitcnt lgkmcnt(13)
    v_mfma_f32_32x32x16_bf16 v[16:31], v[36:39], v[60:63], v[16:31]
    v_dot2c_f32_bf16 v80, s47, v38
    v_dot2c_f32_bf16 v82, v38, v38
    v_dot2c_f32_bf16 v81, s47, v39
    v_dot2c_f32_bf16 v83, v39, v39
    s_cmp_lg_u32 s41, 1
    s_cbranch_scc1 Lk1_kernel_ncs18
    v_dot2c_f32_bf16 v84, s47, v56
    v_dot2c_f32_bf16 v84, s47, v57
    v_dot2c_f32_bf16 v84, s47, v58
    v_dot2c_f32_bf16 v84, s47, v59
    v_dot2c_f32_bf16 v85, s47, v60
    v_dot2c_f32_bf16 v85, s47, v61
    v_dot2c_f32_bf16 v85, s47, v62
    v_dot2c_f32_bf16 v85, s47, v63
Lk1_kernel_ncs18:
    ds_read_b64_tr_b16 v[52:53], v93 offset:0
    ds_read_b64_tr_b16 v[54:55], v93 offset:1024
    s_waitcnt lgkmcnt(12)
    v_mfma_f32_32x32x16_bf16 v[0:15], v[64:67], v[40:43], v[0:15]
    ds_read_b128 v[36:39], v89 offset:0
    ds_read_b64_tr_b16 v[56:57], v92 offset:4096
    ds_read_b64_tr_b16 v[58:59], v92 offset:5120
    s_add_u32 m0, s45, 98304
    s_nop 0
    buffer_load_dwordx4 v94, s[8:11], s40 offen  lds
    s_waitcnt lgkmcnt(13)
    v_mfma_f32_32x32x16_bf16 v[16:31], v[40:43], v[68:71], v[16:31]
    s_cmp_lg_u32 s41, 2
    s_cbranch_scc1 Lk1_kernel_ncs19
    v_dot2c_f32_bf16 v84, s47, v64
    v_dot2c_f32_bf16 v84, s47, v65
    v_dot2c_f32_bf16 v84, s47, v66
    v_dot2c_f32_bf16 v84, s47, v67
    v_dot2c_f32_bf16 v85, s47, v68
    v_dot2c_f32_bf16 v85, s47, v69
    v_dot2c_f32_bf16 v85, s47, v70
    v_dot2c_f32_bf16 v85, s47, v71
Lk1_kernel_ncs19:
    ds_read_b64_tr_b16 v[60:61], v93 offset:4096
    ds_read_b64_tr_b16 v[62:63], v93 offset:5120
    s_waitcnt lgkmcnt(12)
    v_mfma_f32_32x32x16_bf16 v[0:15], v[72:75], v[44:47], v[0:15]
    ds_read_b128 v[40:43], v90 offset:0
    ds_read_b64_tr_b16 v[64:65], v92 offset:8192
    ds_read_b64_tr_b16 v[66:67], v92 offset:9216
    s_add_u32 m0, s45, 114688
    s_nop 0
    buffer_load_dwordx4 v95, s[12:15], s44 offen  lds
    s_add_u32 s44, s44, 110592
    s_waitcnt lgkmcnt(13)
    v_mfma_f32_32x32x16_bf16 v[16:31], v[44:47], v[76:79], v[16:31]
    s_cmp_lg_u32 s41, 3
    s_cbranch_scc1 Lk1_kernel_ncs20
    v_dot2c_f32_bf16 v84, s47, v72
    v_dot2c_f32_bf16 v84, s47, v73
    v_dot2c_f32_bf16 v84, s47, v74
    v_dot2c_f32_bf16 v84, s47, v75
    v_dot2c_f32_bf16 v85, s47, v76
    v_dot2c_f32_bf16 v85, s47, v77
    v_dot2c_f32_bf16 v85, s47, v78
    v_dot2c_f32_bf16 v85, s47, v79
Lk1_kernel_ncs20:
    ds_read_b64_tr_b16 v[68:69], v93 offset:8192
    ds_read_b64_tr_b16 v[70:71], v93 offset:9216
    s_waitcnt lgkmcnt(12)
    v_mfma_f32_32x32x16_bf16 v[0:15], v[48:51], v[32:35], v[0:15]
    v_dot2c_f32_bf16 v80, s47, v32
    v_dot2c_f32_bf16 v82, v32, v32
    v_dot2c_f32_bf16 v81, s47, v33
    v_dot2c_f32_bf16 v83, v33, v33
    ds_read_b128 v[44:47], v91 offset:0
    ds_read_b64_tr_b16 v[72:73], v92 offset:12288
    ds_read_b64_tr_b16 v[74:75], v92 offset:13312
    s_add_u32 m0, s45, 106496
    s_nop 0
    buffer_load_dwordx4 v94, s[8:11], s43 offen  lds
    s_add_u32 s40, s40, 128
    s_add_u32 s43, s43, 128
    s_waitcnt lgkmcnt(13)
    v_mfma_f32_32x32x16_bf16 v[16:31], v[32:35], v[52:55], v[16:31]
    v_dot2c_f32_bf16 v80, s47, v34
    v_dot2c_f32_bf16 v82, v34, v34
    v_dot2c_f32_bf16 v81, s47, v35
    v_dot2c_f32_bf16 v83, v35, v35
    s_cmp_lg_u32 s41, 0
    s_cbranch_scc1 Lk1_kernel_ncs21
    v_dot2c_f32_bf16 v84, s47, v48
    v_dot2c_f32_bf16 v84, s47, v49
    v_dot2c_f32_bf16 v84, s47, v50
    v_dot2c_f32_bf16 v84, s47, v51
    v_dot2c_f32_bf16 v85, s47, v52
    v_dot2c_f32_bf16 v85, s47, v53
    v_dot2c_f32_bf16 v85, s47, v54
    v_dot2c_f32_bf16 v85, s47, v55
Lk1_kernel_ncs21:
    ds_read_b64_tr_b16 v[76:77], v93 offset:12288
    ds_read_b64_tr_b16 v[78:79], v93 offset:13312
    s_waitcnt vmcnt(7)
    s_barrier
    s_lshr_b32 s46, s2, 3
    s_lshl_b32 s46, s46, 3
    s_add_u32 s46, s46, s30
    v_lshlrev_b32 v120, 7, v97
    s_mov_b32 s27, 0x20000
    s_mov_b32 exec_hi, 0
    s_mov_b32 exec_lo, 0x1fffff
    s_mul_i32 s48, s46, 2688
    s_mov_b32 s24, s84
    s_mov_b32 s25, s85
    s_mov_b32 s26, 0xa2000
    buffer_load_dword v179, v120, s[24:27], s48 offen
    s_mov_b64 exec, -1
    s_lshl_b32 s46, s2, 3
    s_add_u32 s46, s46, s30
    s_waitcnt lgkmcnt(12)
    v_mfma_f32_32x32x16_bf16 v[0:15], v[56:59], v[36:39], v[0:15]
    v_dot2c_f32_bf16 v80, s47, v36
    v_dot2c_f32_bf16 v82, v36, v36
    v_dot2c_f32_bf16 v81, s47, v37
    v_dot2c_f32_bf16 v83, v37, v37
    ds_read_b128 v[32:35], v88 offset:32768
    ds_read_b64_tr_b16 v[48:49], v92 offset:32768
    ds_read_b64_tr_b16 v[50:51], v92 offset:33792
    s_add_u32 m0, s45, 122880
    s_nop 0
    buffer_load_dwordx4 v95, s[12:15], s44 offen  lds
    s_add_u32 s44, s44, 110592
    s_waitcnt lgkmcnt(13)
    v_mfma_f32_32x32x16_bf16 v[16:31], v[36:39], v[60:63], v[16:31]
    v_dot2c_f32_bf16 v80, s47, v38
    v_dot2c_f32_bf16 v82, v38, v38
    v_dot2c_f32_bf16 v81, s47, v39
    v_dot2c_f32_bf16 v83, v39, v39
    s_cmp_lg_u32 s41, 1
    s_cbranch_scc1 Lk1_kernel_ncs22
    v_dot2c_f32_bf16 v84, s47, v56
    v_dot2c_f32_bf16 v84, s47, v57
    v_dot2c_f32_bf16 v84, s47, v58
    v_dot2c_f32_bf16 v84, s47, v59
    v_dot2c_f32_bf16 v85, s47, v60
    v_dot2c_f32_bf16 v85, s47, v61
    v_dot2c_f32_bf16 v85, s47, v62
    v_dot2c_f32_bf16 v85, s47, v63
Lk1_kernel_ncs22:
    ds_read_b64_tr_b16 v[52:53], v93 offset:32768
    ds_read_b64_tr_b16 v[54:55], v93 offset:33792
    s_waitcnt lgkmcnt(12)
    v_mfma_f32_32x32x16_bf16 v[0:15], v[64:67], v[40:43], v[0:15]
    ds_read_b128 v[36:39], v89 offset:32768
    ds_read_b64_tr_b16 v[56:57], v92 offset:36864
    ds_read_b64_tr_b16 v[58:59], v92 offset:37888
    s_waitcnt lgkmcnt(13)
    v_mfma_f32_32x32x16_bf16 v[16:31], v[40:43], v[68:71], v[16:31]
    s_cmp_lg_u32 s41, 2
    s_cbranch_scc1 Lk1_kernel_ncs23
    v_dot2c_f32_bf16 v84, s47, v64
    v_dot2c_f32_bf16 v84, s47, v65
    v_dot2c_f32_bf16 v84, s47, v66
    v_dot2c_f32_bf16 v84, s47, v67
    v_dot2c_f32_bf16 v85, s47, v68
    v_dot2c_f32_bf16 v85, s47, v69
    v_dot2c_f32_bf16 v85, s47, v70
    v_dot2c_f32_bf16 v85, s47, v71
Lk1_kernel_ncs23:
    ds_read_b64_tr_b16 v[60:61], v93 offset:36864
    ds_read_b64_tr_b16 v[62:63], v93 offset:37888
    s_waitcnt lgkmcnt(12)
    v_mfma_f32_32x32x16_bf16 v[0:15], v[72:75], v[44:47], v[0:15]
    ds_read_b128 v[40:43], v90 offset:32768
    ds_read_b64_tr_b16 v[64:65], v92 offset:40960
    ds_read_b64_tr_b16 v[66:67], v92 offset:41984
    s_waitcnt lgkmcnt(13)
    v_mfma_f32_32x32x16_bf16 v[16:31], v[44:47], v[76:79], v[16:31]
    s_cmp_lg_u32 s41, 3
    s_cbranch_scc1 Lk1_kernel_ncs24
    v_dot2c_f32_bf16 v84, s47, v72
    v_dot2c_f32_bf16 v84, s47, v73
    v_dot2c_f32_bf16 v84, s47, v74
    v_dot2c_f32_bf16 v84, s47, v75
    v_dot2c_f32_bf16 v85, s47, v76
    v_dot2c_f32_bf16 v85, s47, v77
    v_dot2c_f32_bf16 v85, s47, v78
    v_dot2c_f32_bf16 v85, s47, v79
Lk1_kernel_ncs24:
    ds_read_b64_tr_b16 v[68:69], v93 offset:40960
    ds_read_b64_tr_b16 v[70:71], v93 offset:41984
    s_waitcnt lgkmcnt(12)
    v_mfma_f32_32x32x16_bf16 v[0:15], v[48:51], v[32:35], v[0:15]
    v_dot2c_f32_bf16 v80, s47, v32
    v_dot2c_f32_bf16 v82, v32, v32
    v_dot2c_f32_bf16 v81, s47, v33
    v_dot2c_f32_bf16 v83, v33, v33
    ds_read_b128 v[44:47], v91 offset:32768
    ds_read_b64_tr_b16 v[72:73], v92 offset:45056
    ds_read_b64_tr_b16 v[74:75], v92 offset:46080
    s_waitcnt lgkmcnt(13)
    v_mfma_f32_32x32x16_bf16 v[16:31], v[32:35], v[52:55], v[16:31]
    v_dot2c_f32_bf16 v80, s47, v34
    v_dot2c_f32_bf16 v82, v34, v34
    v_dot2c_f32_bf16 v81, s47, v35
    v_dot2c_f32_bf16 v83, v35, v35
    s_cmp_lg_u32 s41, 0
    s_cbranch_scc1 Lk1_kernel_ncs25
    v_dot2c_f32_bf16 v84, s47, v48
    v_dot2c_f32_bf16 v84, s47, v49
    v_dot2c_f32_bf16 v84, s47, v50
    v_dot2c_f32_bf16 v84, s47, v51
    v_dot2c_f32_bf16 v85, s47, v52
    v_dot2c_f32_bf16 v85, s47, v53
    v_dot2c_f32_bf16 v85, s47, v54
    v_dot2c_f32_bf16 v85, s47, v55
Lk1_kernel_ncs25:
    ds_read_b64_tr_b16 v[76:77], v93 offset:45056
    ds_read_b64_tr_b16 v[78:79], v93 offset:46080
    s_waitcnt vmcnt(5)
    s_barrier
    s_lshr_b32 s46, s2, 3
    s_lshl_b32 s46, s46, 3
    s_add_u32 s46, s46, s30
    s_mul_i32 s46, s46, 21
    v_add_u32 v120, s46, v97
    s_mov_b32 s48, 0xE38F
    v_mul_lo_u32 v121, v120, s48
    v_lshrrev_b32 v121, 19, v121
    v_mul_u32_u24 v122, 9, v121
    v_sub_u32 v120, v120, v122
    v_mul_u32_u24 v121, 9216, v121
    v_lshl_add_u32 v120, v120, 7, v121
    s_mul_i32 s48, s31, 1152
    s_mov_b32 s26, 0x510000
    s_mov_b32 exec_hi, 0
    s_mov_b32 exec_lo, 0x1fffff
    s_mov_b32 s24, s88
    s_mov_b32 s25, s89
    buffer_load_dword v176, v120, s[24:27], s48 offen
    s_mov_b32 s24, s90
    s_mov_b32 s25, s91
    buffer_load_dword v177, v120, s[24:27], s48 offen
    s_mov_b64 exec, -1
    s_waitcnt lgkmcnt(12)
    v_mfma_f32_32x32x16_bf16 v[0:15], v[56:59], v[36:39], v[0:15]
    v_dot2c_f32_bf16 v80, s47, v36
    v_dot2c_f32_bf16 v82, v36, v36
    v_dot2c_f32_bf16 v81, s47, v37
    v_dot2c_f32_bf16 v83, v37, v37
    ds_read_b128 v[32:35], v110 offset:0
    ds_read_b64_tr_b16 v[48:49], v114 offset:0
    ds_read_b64_tr_b16 v[50:51], v114 offset:1024
    s_waitcnt lgkmcnt(13)
    v_mfma_f32_32x32x16_bf16 v[16:31], v[36:39], v[60:63], v[16:31]
    v_dot2c_f32_bf16 v80, s47, v38
    v_dot2c_f32_bf16 v82, v38, v38
    v_dot2c_f32_bf16 v81, s47, v39
    v_dot2c_f32_bf16 v83, v39, v39
    s_cmp_lg_u32 s41, 1
    s_cbranch_scc1 Lk1_kernel_ncs26
    v_dot2c_f32_bf16 v84, s47, v56
    v_dot2c_f32_bf16 v84, s47, v57
    v_dot2c_f32_bf16 v84, s47, v58
    v_dot2c_f32_bf16 v84, s47, v59
    v_dot2c_f32_bf16 v85, s47, v60
    v_dot2c_f32_bf16 v85, s47, v61
    v_dot2c_f32_bf16 v85, s47, v62
    v_dot2c_f32_bf16 v85, s47, v63
Lk1_kernel_ncs26:
    ds_read_b64_tr_b16 v[52:53], v115 offset:0
    ds_read_b64_tr_b16 v[54:55], v115 offset:1024
    s_waitcnt lgkmcnt(12)
    v_mfma_f32_32x32x16_bf16 v[0:15], v[64:67], v[40:43], v[0:15]
    ds_read_b128 v[36:39], v111 offset:0
    ds_read_b64_tr_b16 v[56:57], v114 offset:4096
    ds_read_b64_tr_b16 v[58:59], v114 offset:5120
    s_waitcnt lgkmcnt(13)
    v_mfma_f32_32x32x16_bf16 v[16:31], v[40:43], v[68:71], v[16:31]
    s_cmp_lg_u32 s41, 2
    s_cbranch_scc1 Lk1_kernel_ncs27
    v_dot2c_f32_bf16 v84, s47, v64
    v_dot2c_f32_bf16 v84, s47, v65
    v_dot2c_f32_bf16 v84, s47, v66
    v_dot2c_f32_bf16 v84, s47, v67
    v_dot2c_f32_bf16 v85, s47, v68
    v_dot2c_f32_bf16 v85, s47, v69
    v_dot2c_f32_bf16 v85, s47, v70
    v_dot2c_f32_bf16 v85, s47, v71
Lk1_kernel_ncs27:
    ds_read_b64_tr_b16 v[60:61], v115 offset:4096
    ds_read_b64_tr_b16 v[62:63], v115 offset:5120
    s_waitcnt lgkmcnt(12)
    v_mfma_f32_32x32x16_bf16 v[0:15], v[72:75], v[44:47], v[0:15]
    ds_read_b128 v[40:43], v112 offset:0
    ds_read_b64_tr_b16 v[64:65], v114 offset:8192
    ds_read_b64_tr_b16 v[66:67], v114 offset:9216
    s_waitcnt lgkmcnt(13)
    v_mfma_f32_32x32x16_bf16 v[16:31], v[44:47], v[76:79], v[16:31]
    s_cmp_lg_u32 s41, 3
    s_cbranch_scc1 Lk1_kernel_ncs28
    v_dot2c_f32_bf16 v84, s47, v72
    v_dot2c_f32_bf16 v84, s47, v73
    v_dot2c_f32_bf16 v84, s47, v74
    v_dot2c_f32_bf16 v84, s47, v75
    v_dot2c_f32_bf16 v85, s47, v76
    v_dot2c_f32_bf16 v85, s47, v77
    v_dot2c_f32_bf16 v85, s47, v78
    v_dot2c_f32_bf16 v85, s47, v79
Lk1_kernel_ncs28:
    ds_read_b64_tr_b16 v[68:69], v115 offset:8192
    ds_read_b64_tr_b16 v[70:71], v115 offset:9216
    s_waitcnt lgkmcnt(12)
    v_mfma_f32_32x32x16_bf16 v[0:15], v[48:51], v[32:35], v[0:15]
    v_dot2c_f32_bf16 v80, s47, v32
    v_dot2c_f32_bf16 v82, v32, v32
    v_dot2c_f32_bf16 v81, s47, v33
    v_dot2c_f32_bf16 v83, v33, v33
    ds_read_b128 v[44:47], v113 offset:0
    ds_read_b64_tr_b16 v[72:73], v114 offset:12288
    ds_read_b64_tr_b16 v[74:75], v114 offset:13312
    s_waitcnt lgkmcnt(13)
    v_mfma_f32_32x32x16_bf16 v[16:31], v[32:35], v[52:55], v[16:31]
    v_dot2c_f32_bf16 v80, s47, v34
    v_dot2c_f32_bf16 v82, v34, v34
    v_dot2c_f32_bf16 v81, s47, v35
    v_dot2c_f32_bf16 v83, v35, v35
    s_cmp_lg_u32 s41, 0
    s_cbranch_scc1 Lk1_kernel_ncs29
    v_dot2c_f32_bf16 v84, s47, v48
    v_dot2c_f32_bf16 v84, s47, v49
    v_dot2c_f32_bf16 v84, s47, v50
    v_dot2c_f32_bf16 v84, s47, v51
    v_dot2c_f32_bf16 v85, s47, v52
    v_dot2c_f32_bf16 v85, s47, v53
    v_dot2c_f32_bf16 v85, s47, v54
    v_dot2c_f32_bf16 v85, s47, v55
Lk1_kernel_ncs29:
    ds_read_b64_tr_b16 v[76:77], v115 offset:12288
    ds_read_b64_tr_b16 v[78:79], v115 offset:13312
    s_waitcnt vmcnt(2)
    s_barrier
    s_waitcnt lgkmcnt(12)
    v_mfma_f32_32x32x16_bf16 v[0:15], v[56:59], v[36:39], v[0:15]
    v_dot2c_f32_bf16 v80, s47, v36
    v_dot2c_f32_bf16 v82, v36, v36
    v_dot2c_f32_bf16 v81, s47, v37
    v_dot2c_f32_bf16 v83, v37, v37
    ds_read_b128 v[32:35], v110 offset:32768
    ds_read_b64_tr_b16 v[48:49], v114 offset:32768
    ds_read_b64_tr_b16 v[50:51], v114 offset:33792
    s_waitcnt lgkmcnt(13)
    v_mfma_f32_32x32x16_bf16 v[16:31], v[36:39], v[60:63], v[16:31]
    v_dot2c_f32_bf16 v80, s47, v38
    v_dot2c_f32_bf16 v82, v38, v38
    v_dot2c_f32_bf16 v81, s47, v39
    v_dot2c_f32_bf16 v83, v39, v39
    s_cmp_lg_u32 s41, 1
    s_cbranch_scc1 Lk1_kernel_ncs30
    v_dot2c_f32_bf16 v84, s47, v56
    v_dot2c_f32_bf16 v84, s47, v57
    v_dot2c_f32_bf16 v84, s47, v58
    v_dot2c_f32_bf16 v84, s47, v59
    v_dot2c_f32_bf16 v85, s47, v60
    v_dot2c_f32_bf16 v85, s47, v61
    v_dot2c_f32_bf16 v85, s47, v62
    v_dot2c_f32_bf16 v85, s47, v63
Lk1_kernel_ncs30:
    ds_read_b64_tr_b16 v[52:53], v115 offset:32768
    ds_read_b64_tr_b16 v[54:55], v115 offset:33792
    s_waitcnt lgkmcnt(12)
    v_mfma_f32_32x32x16_bf16 v[0:15], v[64:67], v[40:43], v[0:15]
    ds_read_b128 v[36:39], v111 offset:32768
    ds_read_b64_tr_b16 v[56:57], v114 offset:36864
    ds_read_b64_tr_b16 v[58:59], v114 offset:37888
    s_waitcnt lgkmcnt(13)
    v_mfma_f32_32x32x16_bf16 v[16:31], v[40:43], v[68:71], v[16:31]
    s_cmp_lg_u32 s41, 2
    s_cbranch_scc1 Lk1_kernel_ncs31
    v_dot2c_f32_bf16 v84, s47, v64
    v_dot2c_f32_bf16 v84, s47, v65
    v_dot2c_f32_bf16 v84, s47, v66
    v_dot2c_f32_bf16 v84, s47, v67
    v_dot2c_f32_bf16 v85, s47, v68
    v_dot2c_f32_bf16 v85, s47, v69
    v_dot2c_f32_bf16 v85, s47, v70
    v_dot2c_f32_bf16 v85, s47, v71
Lk1_kernel_ncs31:
    ds_read_b64_tr_b16 v[60:61], v115 offset:36864
    ds_read_b64_tr_b16 v[62:63], v115 offset:37888
    s_waitcnt lgkmcnt(12)
    v_mfma_f32_32x32x16_bf16 v[0:15], v[72:75], v[44:47], v[0:15]
    ds_read_b128 v[40:43], v112 offset:32768
    ds_read_b64_tr_b16 v[64:65], v114 offset:40960
    ds_read_b64_tr_b16 v[66:67], v114 offset:41984
    s_waitcnt lgkmcnt(13)
    v_mfma_f32_32x32x16_bf16 v[16:31], v[44:47], v[76:79], v[16:31]
    s_cmp_lg_u32 s41, 3
    s_cbranch_scc1 Lk1_kernel_ncs32
    v_dot2c_f32_bf16 v84, s47, v72
    v_dot2c_f32_bf16 v84, s47, v73
    v_dot2c_f32_bf16 v84, s47, v74
    v_dot2c_f32_bf16 v84, s47, v75
    v_dot2c_f32_bf16 v85, s47, v76
    v_dot2c_f32_bf16 v85, s47, v77
    v_dot2c_f32_bf16 v85, s47, v78
    v_dot2c_f32_bf16 v85, s47, v79
Lk1_kernel_ncs32:
    ds_read_b64_tr_b16 v[68:69], v115 offset:40960
    ds_read_b64_tr_b16 v[70:71], v115 offset:41984
    s_waitcnt lgkmcnt(12)
    v_mfma_f32_32x32x16_bf16 v[0:15], v[48:51], v[32:35], v[0:15]
    v_dot2c_f32_bf16 v80, s47, v32
    v_dot2c_f32_bf16 v82, v32, v32
    v_dot2c_f32_bf16 v81, s47, v33
    v_dot2c_f32_bf16 v83, v33, v33
    ds_read_b128 v[44:47], v113 offset:32768
    ds_read_b64_tr_b16 v[72:73], v114 offset:45056
    ds_read_b64_tr_b16 v[74:75], v114 offset:46080
    s_waitcnt lgkmcnt(13)
    v_mfma_f32_32x32x16_bf16 v[16:31], v[32:35], v[52:55], v[16:31]
    v_dot2c_f32_bf16 v80, s47, v34
    v_dot2c_f32_bf16 v82, v34, v34
    v_dot2c_f32_bf16 v81, s47, v35
    v_dot2c_f32_bf16 v83, v35, v35
    s_cmp_lg_u32 s41, 0
    s_cbranch_scc1 Lk1_kernel_ncs33
    v_dot2c_f32_bf16 v84, s47, v48
    v_dot2c_f32_bf16 v84, s47, v49
    v_dot2c_f32_bf16 v84, s47, v50
    v_dot2c_f32_bf16 v84, s47, v51
    v_dot2c_f32_bf16 v85, s47, v52
    v_dot2c_f32_bf16 v85, s47, v53
    v_dot2c_f32_bf16 v85, s47, v54
    v_dot2c_f32_bf16 v85, s47, v55
Lk1_kernel_ncs33:
    ds_read_b64_tr_b16 v[76:77], v115 offset:45056
    ds_read_b64_tr_b16 v[78:79], v115 offset:46080
    s_waitcnt lgkmcnt(12)
    v_mfma_f32_32x32x16_bf16 v[0:15], v[56:59], v[36:39], v[0:15]
    v_dot2c_f32_bf16 v80, s47, v36
    v_dot2c_f32_bf16 v82, v36, v36
    v_dot2c_f32_bf16 v81, s47, v37
    v_dot2c_f32_bf16 v83, v37, v37
    s_waitcnt lgkmcnt(10)
    v_mfma_f32_32x32x16_bf16 v[16:31], v[36:39], v[60:63], v[16:31]
    v_dot2c_f32_bf16 v80, s47, v38
    v_dot2c_f32_bf16 v82, v38, v38
    v_dot2c_f32_bf16 v81, s47, v39
    v_dot2c_f32_bf16 v83, v39, v39
    s_cmp_lg_u32 s41, 1
    s_cbranch_scc1 Lk1_kernel_ncs34
    v_dot2c_f32_bf16 v84, s47, v56
    v_dot2c_f32_bf16 v84, s47, v57
    v_dot2c_f32_bf16 v84, s47, v58
    v_dot2c_f32_bf16 v84, s47, v59
    v_dot2c_f32_bf16 v85, s47, v60
    v_dot2c_f32_bf16 v85, s47, v61
    v_dot2c_f32_bf16 v85, s47, v62
    v_dot2c_f32_bf16 v85, s47, v63
Lk1_kernel_ncs34:
    s_waitcnt lgkmcnt(7)
    v_mfma_f32_32x32x16_bf16 v[0:15], v[64:67], v[40:43], v[0:15]
    s_waitcnt lgkmcnt(5)
    v_mfma_f32_32x32x16_bf16 v[16:31], v[40:43], v[68:71], v[16:31]
    s_cmp_lg_u32 s41, 2
    s_cbranch_scc1 Lk1_kernel_ncs35
    v_dot2c_f32_bf16 v84, s47, v64
    v_dot2c_f32_bf16 v84, s47, v65
    v_dot2c_f32_bf16 v84, s47, v66
    v_dot2c_f32_bf16 v84, s47, v67
    v_dot2c_f32_bf16 v85, s47, v68
    v_dot2c_f32_bf16 v85, s47, v69
    v_dot2c_f32_bf16 v85, s47, v70
    v_dot2c_f32_bf16 v85, s47, v71
Lk1_kernel_ncs35:
    s_waitcnt lgkmcnt(2)
    v_mfma_f32_32x32x16_bf16 v[0:15], v[72:75], v[44:47], v[0:15]
    s_waitcnt lgkmcnt(0)
    v_mfma_f32_32x32x16_bf16 v[16:31], v[44:47], v[76:79], v[16:31]
    s_cmp_lg_u32 s41, 3
    s_cbranch_scc1 Lk1_kernel_ncs36
    v_dot2c_f32_bf16 v84, s47, v72
    v_dot2c_f32_bf16 v84, s47, v73
    v_dot2c_f32_bf16 v84, s47, v74
    v_dot2c_f32_bf16 v84, s47, v75
    v_dot2c_f32_bf16 v85, s47, v76
    v_dot2c_f32_bf16 v85, s47, v77
    v_dot2c_f32_bf16 v85, s47, v78
    v_dot2c_f32_bf16 v85, s47, v79
Lk1_kernel_ncs36:
    s_nop 4
    v_add_f32 v80, v80, v81
    v_add_f32 v81, v82, v83
    v_and_b32 v100, 31, v97
    v_lshrrev_b32 v101, 5, v97
    s_lshl_b32 s42, s41, 9
    v_lshl_add_u32 v102, v100, 4, s42
    v_lshl_add_u32 v103, v101, 3, v102
    v_add_u32 v103, 40960, v103
    ds_write_b64 v103, v[80:81]
    s_lshl_b32 s42, s41, 8
    v_lshl_add_u32 v104, v97, 2, s42
    v_add_u32 v104, 45056, v104
    ds_write_b32 v104, v84
    ds_write_b32 v104, v85 offset:1024
    s_waitcnt lgkmcnt(0)
    s_barrier
    v_add_u32 v102, 40960, v102
    ds_read_b128 v[32:35], v102
    ds_read_b128 v[36:39], v102 offset:2048
    v_lshlrev_b32 v104, 2, v100
    v_add_u32 v104, 45056, v104
    ds_read_b32 v40, v104 offset:0
    ds_read_b32 v41, v104 offset:128
    ds_read_b32 v42, v104 offset:256
    ds_read_b32 v43, v104 offset:384
    ds_read_b32 v44, v104 offset:512
    ds_read_b32 v45, v104 offset:640
    ds_read_b32 v46, v104 offset:768
    ds_read_b32 v47, v104 offset:896
    ds_read_b32 v48, v104 offset:1024
    ds_read_b32 v49, v104 offset:1152
    ds_read_b32 v50, v104 offset:1280
    ds_read_b32 v51, v104 offset:1408
    ds_read_b32 v52, v104 offset:1536
    ds_read_b32 v53, v104 offset:1664
    ds_read_b32 v54, v104 offset:1792
    ds_read_b32 v55, v104 offset:1920
    s_waitcnt lgkmcnt(0)
    v_add_f32 v32, v32, v34
    v_add_f32 v33, v33, v35
    v_add_f32 v36, v36, v38
    v_add_f32 v37, v37, v39
    v_add_f32 v32, v32, v36
    v_add_f32 v33, v33, v37
    s_mov_b32 s49, 0x3AE38E39
    v_mul_f32 v32, s49, v32
    v_mul_f32 v33, s49, v33
    v_fma_f32 v33, -v32, v32, v33
    v_max_f32 v33, 0, v33
    v_add_f32 v33, 0x3727c5ac, v33
    v_rsq_f32 v34, v33
    s_nop 0
    v_mul_f32 v35, v32, v34
    v_sub_f32 v35, 0, v35
    v_add_f32 v40, v40, v44
    v_add_f32 v41, v41, v45
    v_add_f32 v42, v42, v46
    v_add_f32 v43, v43, v47
    v_add_f32 v40, v40, v42
    v_add_f32 v41, v41, v43
    v_add_f32 v40, v40, v41
    v_add_f32 v48, v48, v52
    v_add_f32 v49, v49, v53
    v_add_f32 v50, v50, v54
    v_add_f32 v51, v51, v55
    v_add_f32 v48, v48, v50
    v_add_f32 v49, v49, v51
    v_add_f32 v48, v48, v49
    s_lshl_b32 s42, s30, 8
    s_add_u32 s42, s42, 49152
    v_lshl_add_u32 v102, v100, 3, s42
    ds_write_b64 v102, v[34:35]
    s_lshl_b32 s43, s30, 7
    s_add_u32 s43, s43, 51200
    v_lshl_add_u32 v103, v100, 2, s43
    ds_write_b32 v103, v40
    s_waitcnt lgkmcnt(0)
    v_lshl_add_u32 v102, v101, 5, s42
    ds_read_b128 v[112:115], v102 offset:0
    ds_read_b128 v[116:119], v102 offset:16
    ds_read_b128 v[120:123], v102 offset:64
    ds_read_b128 v[124:127], v102 offset:80
    ds_read_b128 v[128:131], v102 offset:128
    ds_read_b128 v[132:135], v102 offset:144
    ds_read_b128 v[136:139], v102 offset:192
    ds_read_b128 v[140:143], v102 offset:208
    v_lshl_add_u32 v103, v101, 4, s43
    ds_read_b128 v[144:147], v103 offset:0
    ds_read_b128 v[148:151], v103 offset:32
    ds_read_b128 v[152:155], v103 offset:64
    ds_read_b128 v[156:159], v103 offset:96
    s_waitcnt lgkmcnt(0)
    v_mul_f32 v56, v113, v48
    v_mul_f32 v57, v115, v48
    v_mul_f32 v58, v117, v48
    v_mul_f32 v59, v119, v48
    v_mul_f32 v60, v121, v48
    v_mul_f32 v61, v123, v48
    v_mul_f32 v62, v125, v48
    v_mul_f32 v63, v127, v48
    v_mul_f32 v64, v129, v48
    v_mul_f32 v65, v131, v48
    v_mul_f32 v66, v133, v48
    v_mul_f32 v67, v135, v48
    v_mul_f32 v68, v137, v48
    v_mul_f32 v69, v139, v48
    v_mul_f32 v70, v141, v48
    v_mul_f32 v71, v143, v48
    v_fma_f32 v16, v16, v112, v56
    v_fma_f32 v17, v17, v114, v57
    v_fma_f32 v18, v18, v116, v58
    v_fma_f32 v19, v19, v118, v59
    v_fma_f32 v20, v20, v120, v60
    v_fma_f32 v21, v21, v122, v61
    v_fma_f32 v22, v22, v124, v62
    v_fma_f32 v23, v23, v126, v63
    v_fma_f32 v24, v24, v128, v64
    v_fma_f32 v25, v25, v130, v65
    v_fma_f32 v26, v26, v132, v66
    v_fma_f32 v27, v27, v134, v67
    v_fma_f32 v28, v28, v136, v68
    v_fma_f32 v29, v29, v138, v69
    v_fma_f32 v30, v30, v140, v70
    v_fma_f32 v31, v31, v142, v71
    s_mov_b32 s48, 0x3fb8aa3b
    s_lshl_b32 s50, s32, 2
    s_add_u32 s50, s50, s41
    s_lshl_b32 s50, s50, 2
    s_lshr_b32 s51, s33, 2
    s_add_u32 s50, s50, s51
    s_mul_i32 s50, s50, 9216
    s_add_u32 s50, s50, 0
    s_and_b32 s51, s38, 3
    s_lshl_b32 s52, s41, 11
    v_add_u32 v100, s52, v96
    v_min_f32 v56, 0, v16
    v_min_f32 v57, 0, v17
    v_min_f32 v58, 0, v18
    v_min_f32 v59, 0, v19
    v_min_f32 v60, 0, v20
    v_min_f32 v61, 0, v21
    v_min_f32 v62, 0, v22
    v_min_f32 v63, 0, v23
    v_min_f32 v64, 0, v24
    v_min_f32 v65, 0, v25
    v_min_f32 v66, 0, v26
    v_min_f32 v67, 0, v27
    v_min_f32 v68, 0, v28
    v_min_f32 v69, 0, v29
    v_min_f32 v70, 0, v30
    v_min_f32 v71, 0, v31
    v_mul_f32 v56, s48, v56
    v_mul_f32 v57, s48, v57
    v_mul_f32 v58, s48, v58
    v_mul_f32 v59, s48, v59
    v_mul_f32 v60, s48, v60
    v_mul_f32 v61, s48, v61
    v_mul_f32 v62, s48, v62
    v_mul_f32 v63, s48, v63
    v_mul_f32 v64, s48, v64
    v_mul_f32 v65, s48, v65
    v_mul_f32 v66, s48, v66
    v_mul_f32 v67, s48, v67
    v_mul_f32 v68, s48, v68
    v_mul_f32 v69, s48, v69
    v_mul_f32 v70, s48, v70
    v_mul_f32 v71, s48, v71
    v_exp_f32 v56, v56
    v_exp_f32 v57, v57
    v_exp_f32 v58, v58
    v_exp_f32 v59, v59
    v_exp_f32 v60, v60
    v_exp_f32 v61, v61
    v_exp_f32 v62, v62
    v_exp_f32 v63, v63
    v_exp_f32 v64, v64
    v_exp_f32 v65, v65
    v_exp_f32 v66, v66
    v_exp_f32 v67, v67
    v_exp_f32 v68, v68
    v_exp_f32 v69, v69
    v_exp_f32 v70, v70
    v_exp_f32 v71, v71
    v_max_f32 v16, 0, v16
    v_max_f32 v17, 0, v17
    v_max_f32 v18, 0, v18
    v_max_f32 v19, 0, v19
    v_max_f32 v20, 0, v20
    v_max_f32 v21, 0, v21
    v_max_f32 v22, 0, v22
    v_max_f32 v23, 0, v23
    v_max_f32 v24, 0, v24
    v_max_f32 v25, 0, v25
    v_max_f32 v26, 0, v26
    v_max_f32 v27, 0, v27
    v_max_f32 v28, 0, v28
    v_max_f32 v29, 0, v29
    v_max_f32 v30, 0, v30
    v_max_f32 v31, 0, v31
    v_add_f32 v56, 0x358637bd, v56
    v_add_f32 v57, 0x358637bd, v57
    v_add_f32 v58, 0x358637bd, v58
    v_add_f32 v59, 0x358637bd, v59
    v_add_f32 v60, 0x358637bd, v60
    v_add_f32 v61, 0x358637bd, v61
    v_add_f32 v62, 0x358637bd, v62
    v_add_f32 v63, 0x358637bd, v63
    v_add_f32 v64, 0x358637bd, v64
    v_add_f32 v65, 0x358637bd, v65
    v_add_f32 v66, 0x358637bd, v66
    v_add_f32 v67, 0x358637bd, v67
    v_add_f32 v68, 0x358637bd, v68
    v_add_f32 v69, 0x358637bd, v69
    v_add_f32 v70, 0x358637bd, v70
    v_add_f32 v71, 0x358637bd, v71
    v_add_f32 v16, v16, v56
    v_add_f32 v17, v17, v57
    v_add_f32 v18, v18, v58
    v_add_f32 v19, v19, v59
    v_add_f32 v20, v20, v60
    v_add_f32 v21, v21, v61
    v_add_f32 v22, v22, v62
    v_add_f32 v23, v23, v63
    v_add_f32 v24, v24, v64
    v_add_f32 v25, v25, v65
    v_add_f32 v26, v26, v66
    v_add_f32 v27, v27, v67
    v_add_f32 v28, v28, v68
    v_add_f32 v29, v29, v69
    v_add_f32 v30, v30, v70
    v_add_f32 v31, v31, v71
    v_cvt_pk_bf16_f32 v72, v16, v17
    v_cvt_pk_bf16_f32 v73, v18, v19
    v_cvt_pk_bf16_f32 v74, v20, v21
    v_cvt_pk_bf16_f32 v75, v22, v23
    v_cvt_pk_bf16_f32 v76, v24, v25
    v_cvt_pk_bf16_f32 v77, v26, v27
    v_cvt_pk_bf16_f32 v78, v28, v29
    v_cvt_pk_bf16_f32 v79, v30, v31
    ds_write_b128 v100, v[72:75] offset:0
    ds_write_b128 v100, v[76:79] offset:1024
    s_waitcnt lgkmcnt(0)
    s_barrier
    v_mul_f32 v56, v35, v144
    v_mul_f32 v57, v35, v145
    v_mul_f32 v58, v35, v146
    v_mul_f32 v59, v35, v147
    v_mul_f32 v60, v35, v148
    v_mul_f32 v61, v35, v149
    v_mul_f32 v62, v35, v150
    v_mul_f32 v63, v35, v151
    v_mul_f32 v64, v35, v152
    v_mul_f32 v65, v35, v153
    v_mul_f32 v66, v35, v154
    v_mul_f32 v67, v35, v155
    v_mul_f32 v68, v35, v156
    v_mul_f32 v69, v35, v157
    v_mul_f32 v70, v35, v158
    v_mul_f32 v71, v35, v159
    v_fma_f32 v0, v0, v34, v56
    v_fma_f32 v1, v1, v34, v57
    v_fma_f32 v2, v2, v34, v58
    v_fma_f32 v3, v3, v34, v59
    v_fma_f32 v4, v4, v34, v60
    v_fma_f32 v5, v5, v34, v61
    v_fma_f32 v6, v6, v34, v62
    v_fma_f32 v7, v7, v34, v63
    v_fma_f32 v8, v8, v34, v64
    v_fma_f32 v9, v9, v34, v65
    v_fma_f32 v10, v10, v34, v66
    v_fma_f32 v11, v11, v34, v67
    v_fma_f32 v12, v12, v34, v68
    v_fma_f32 v13, v13, v34, v69
    v_fma_f32 v14, v14, v34, v70
    v_fma_f32 v15, v15, v34, v71
    v_min_f32 v56, 0, v0
    v_min_f32 v57, 0, v1
    v_min_f32 v58, 0, v2
    v_min_f32 v59, 0, v3
    v_min_f32 v60, 0, v4
    v_min_f32 v61, 0, v5
    v_min_f32 v62, 0, v6
    v_min_f32 v63, 0, v7
    v_min_f32 v64, 0, v8
    v_min_f32 v65, 0, v9
    v_min_f32 v66, 0, v10
    v_min_f32 v67, 0, v11
    v_min_f32 v68, 0, v12
    v_min_f32 v69, 0, v13
    v_min_f32 v70, 0, v14
    v_min_f32 v71, 0, v15
    v_mul_f32 v56, s48, v56
    v_mul_f32 v57, s48, v57
    v_mul_f32 v58, s48, v58
    v_mul_f32 v59, s48, v59
    v_mul_f32 v60, s48, v60
    v_mul_f32 v61, s48, v61
    v_mul_f32 v62, s48, v62
    v_mul_f32 v63, s48, v63
    v_mul_f32 v64, s48, v64
    v_mul_f32 v65, s48, v65
    v_mul_f32 v66, s48, v66
    v_mul_f32 v67, s48, v67
    v_mul_f32 v68, s48, v68
    v_mul_f32 v69, s48, v69
    v_mul_f32 v70, s48, v70
    v_mul_f32 v71, s48, v71
    v_exp_f32 v56, v56
    v_exp_f32 v57, v57
    v_exp_f32 v58, v58
    v_exp_f32 v59, v59
    v_exp_f32 v60, v60
    v_exp_f32 v61, v61
    v_exp_f32 v62, v62
    v_exp_f32 v63, v63
    v_exp_f32 v64, v64
    v_exp_f32 v65, v65
    v_exp_f32 v66, v66
    v_exp_f32 v67, v67
    v_exp_f32 v68, v68
    v_exp_f32 v69, v69
    v_exp_f32 v70, v70
    v_exp_f32 v71, v71
    v_max_f32 v0, 0, v0
    v_max_f32 v1, 0, v1
    v_max_f32 v2, 0, v2
    v_max_f32 v3, 0, v3
    v_max_f32 v4, 0, v4
    v_max_f32 v5, 0, v5
    v_max_f32 v6, 0, v6
    v_max_f32 v7, 0, v7
    v_max_f32 v8, 0, v8
    v_max_f32 v9, 0, v9
    v_max_f32 v10, 0, v10
    v_max_f32 v11, 0, v11
    v_max_f32 v12, 0, v12
    v_max_f32 v13, 0, v13
    v_max_f32 v14, 0, v14
    v_max_f32 v15, 0, v15
    v_add_f32 v56, 0x358637bd, v56
    v_add_f32 v57, 0x358637bd, v57
    v_add_f32 v58, 0x358637bd, v58
    v_add_f32 v59, 0x358637bd, v59
    v_add_f32 v60, 0x358637bd, v60
    v_add_f32 v61, 0x358637bd, v61
    v_add_f32 v62, 0x358637bd, v62
    v_add_f32 v63, 0x358637bd, v63
    v_add_f32 v64, 0x358637bd, v64
    v_add_f32 v65, 0x358637bd, v65
    v_add_f32 v66, 0x358637bd, v66
    v_add_f32 v67, 0x358637bd, v67
    v_add_f32 v68, 0x358637bd, v68
    v_add_f32 v69, 0x358637bd, v69
    v_add_f32 v70, 0x358637bd, v70
    v_add_f32 v71, 0x358637bd, v71
    v_add_f32 v0, v0, v56
    v_add_f32 v1, v1, v57
    v_add_f32 v2, v2, v58
    v_add_f32 v3, v3, v59
    v_add_f32 v4, v4, v60
    v_add_f32 v5, v5, v61
    v_add_f32 v6, v6, v62
    v_add_f32 v7, v7, v63
    v_add_f32 v8, v8, v64
    v_add_f32 v9, v9, v65
    v_add_f32 v10, v10, v66
    v_add_f32 v11, v11, v67
    v_add_f32 v12, v12, v68
    v_add_f32 v13, v13, v69
    v_add_f32 v14, v14, v70
    v_add_f32 v15, v15, v71
    v_cvt_pk_bf16_f32 v72, v0, v1
    v_cvt_pk_bf16_f32 v73, v2, v3
    v_cvt_pk_bf16_f32 v74, v4, v5
    v_cvt_pk_bf16_f32 v75, v6, v7
    v_cvt_pk_bf16_f32 v76, v8, v9
    v_cvt_pk_bf16_f32 v77, v10, v11
    v_cvt_pk_bf16_f32 v78, v12, v13
    v_cvt_pk_bf16_f32 v79, v14, v15
    s_lshl_b32 s53, s51, 11
    s_add_u32 s53, s53, s50
    buffer_store_dwordx4 v[72:75], v96, s[16:19], s53 offen
    buffer_store_dwordx4 v[76:79], v96, s[16:19], s53 offen offset:1024
    s_branch Lk1_kernel_nokv
Lk1_kernel_cg1:
    ds_read_b128 v[32:35], v88 offset:0
    ds_read_b64_tr_b16 v[48:49], v92 offset:0
    ds_read_b64_tr_b16 v[50:51], v92 offset:1024
    ds_read_b64_tr_b16 v[52:53], v93 offset:0
    ds_read_b64_tr_b16 v[54:55], v93 offset:1024
    ds_read_b128 v[36:39], v89 offset:0
    ds_read_b64_tr_b16 v[56:57], v92 offset:4096
    ds_read_b64_tr_b16 v[58:59], v92 offset:5120
    ds_read_b64_tr_b16 v[60:61], v93 offset:4096
    ds_read_b64_tr_b16 v[62:63], v93 offset:5120
    ds_read_b128 v[40:43], v90 offset:0
    ds_read_b64_tr_b16 v[64:65], v92 offset:8192
    ds_read_b64_tr_b16 v[66:67], v92 offset:9216
    ds_read_b64_tr_b16 v[68:69], v93 offset:8192
    ds_read_b64_tr_b16 v[70:71], v93 offset:9216
    s_waitcnt lgkmcnt(12)
    v_mfma_f32_32x32x16_bf16 v[0:15], v[32:35], v[48:51], v[0:15]
    ds_read_b128 v[44:47], v91 offset:0
    ds_read_b64_tr_b16 v[72:73], v92 offset:12288
    ds_read_b64_tr_b16 v[74:75], v92 offset:13312
    s_waitcnt lgkmcnt(13)
    v_mfma_f32_32x32x16_bf16 v[16:31], v[32:35], v[52:55], v[16:31]
    s_cmp_lg_u32 s41, 0
    s_cbranch_scc1 Lk1_kernel_ncs37
    v_dot2c_f32_bf16 v84, s47, v48
    v_dot2c_f32_bf16 v84, s47, v49
    v_dot2c_f32_bf16 v84, s47, v50
    v_dot2c_f32_bf16 v84, s47, v51
    v_dot2c_f32_bf16 v85, s47, v52
    v_dot2c_f32_bf16 v85, s47, v53
    v_dot2c_f32_bf16 v85, s47, v54
    v_dot2c_f32_bf16 v85, s47, v55
Lk1_kernel_ncs37:
    ds_read_b64_tr_b16 v[76:77], v93 offset:12288
    ds_read_b64_tr_b16 v[78:79], v93 offset:13312
    s_waitcnt vmcnt(2)
    s_barrier
    s_waitcnt lgkmcnt(12)
    v_mfma_f32_32x32x16_bf16 v[0:15], v[36:39], v[56:59], v[0:15]
    ds_read_b128 v[32:35], v88 offset:32768
    ds_read_b64_tr_b16 v[48:49], v92 offset:32768
    ds_read_b64_tr_b16 v[50:51], v92 offset:33792
    s_add_u32 m0, s45, 65536
    s_nop 0
    buffer_load_dwordx4 v94, s[8:11], s40 offen  lds
    s_waitcnt lgkmcnt(13)
    v_mfma_f32_32x32x16_bf16 v[16:31], v[36:39], v[60:63], v[16:31]
    s_cmp_lg_u32 s41, 1
    s_cbranch_scc1 Lk1_kernel_ncs38
    v_dot2c_f32_bf16 v84, s47, v56
    v_dot2c_f32_bf16 v84, s47, v57
    v_dot2c_f32_bf16 v84, s47, v58
    v_dot2c_f32_bf16 v84, s47, v59
    v_dot2c_f32_bf16 v85, s47, v60
    v_dot2c_f32_bf16 v85, s47, v61
    v_dot2c_f32_bf16 v85, s47, v62
    v_dot2c_f32_bf16 v85, s47, v63
Lk1_kernel_ncs38:
    ds_read_b64_tr_b16 v[52:53], v93 offset:32768
    ds_read_b64_tr_b16 v[54:55], v93 offset:33792
    s_add_u32 m0, s45, 81920
    s_nop 0
    buffer_load_dwordx4 v95, s[12:15], s44 offen  lds
    s_add_u32 s44, s44, 110592
    s_waitcnt lgkmcnt(12)
    v_mfma_f32_32x32x16_bf16 v[0:15], v[40:43], v[64:67], v[0:15]
    v_dot2c_f32_bf16 v80, s47, v40
    v_dot2c_f32_bf16 v82, v40, v40
    v_dot2c_f32_bf16 v81, s47, v41
    v_dot2c_f32_bf16 v83, v41, v41
    ds_read_b128 v[36:39], v89 offset:32768
    ds_read_b64_tr_b16 v[56:57], v92 offset:36864
    ds_read_b64_tr_b16 v[58:59], v92 offset:37888
    s_add_u32 m0, s45, 73728
    s_nop 0
    buffer_load_dwordx4 v94, s[8:11], s43 offen  lds
    s_add_u32 s40, s40, 128
    s_add_u32 s43, s43, 128
    s_waitcnt lgkmcnt(13)
    v_mfma_f32_32x32x16_bf16 v[16:31], v[40:43], v[68:71], v[16:31]
    v_dot2c_f32_bf16 v80, s47, v42
    v_dot2c_f32_bf16 v82, v42, v42
    v_dot2c_f32_bf16 v81, s47, v43
    v_dot2c_f32_bf16 v83, v43, v43
    s_cmp_lg_u32 s41, 2
    s_cbranch_scc1 Lk1_kernel_ncs39
    v_dot2c_f32_bf16 v84, s47, v64
    v_dot2c_f32_bf16 v84, s47, v65
    v_dot2c_f32_bf16 v84, s47, v66
    v_dot2c_f32_bf16 v84, s47, v67
    v_dot2c_f32_bf16 v85, s47, v68
    v_dot2c_f32_bf16 v85, s47, v69
    v_dot2c_f32_bf16 v85, s47, v70
    v_dot2c_f32_bf16 v85, s47, v71
Lk1_kernel_ncs39:
    ds_read_b64_tr_b16 v[60:61], v93 offset:36864
    ds_read_b64_tr_b16 v[62:63], v93 offset:37888
    s_add_u32 m0, s45, 90112
    s_nop 0
    buffer_load_dwordx4 v95, s[12:15], s44 offen  lds
    s_add_u32 s44, s44, 110592
    s_waitcnt lgkmcnt(12)
    v_mfma_f32_32x32x16_bf16 v[0:15], v[44:47], v[72:75], v[0:15]
    v_dot2c_f32_bf16 v80, s47, v44
    v_dot2c_f32_bf16 v82, v44, v44
    v_dot2c_f32_bf16 v81, s47, v45
    v_dot2c_f32_bf16 v83, v45, v45
    ds_read_b128 v[40:43], v90 offset:32768
    ds_read_b64_tr_b16 v[64:65], v92 offset:40960
    ds_read_b64_tr_b16 v[66:67], v92 offset:41984
    s_add_u32 m0, s45, 98304
    s_nop 0
    buffer_load_dwordx4 v94, s[8:11], s40 offen  lds
    s_waitcnt lgkmcnt(13)
    v_mfma_f32_32x32x16_bf16 v[16:31], v[44:47], v[76:79], v[16:31]
    v_dot2c_f32_bf16 v80, s47, v46
    v_dot2c_f32_bf16 v82, v46, v46
    v_dot2c_f32_bf16 v81, s47, v47
    v_dot2c_f32_bf16 v83, v47, v47
    s_cmp_lg_u32 s41, 3
    s_cbranch_scc1 Lk1_kernel_ncs40
    v_dot2c_f32_bf16 v84, s47, v72
    v_dot2c_f32_bf16 v84, s47, v73
    v_dot2c_f32_bf16 v84, s47, v74
    v_dot2c_f32_bf16 v84, s47, v75
    v_dot2c_f32_bf16 v85, s47, v76
    v_dot2c_f32_bf16 v85, s47, v77
    v_dot2c_f32_bf16 v85, s47, v78
    v_dot2c_f32_bf16 v85, s47, v79
Lk1_kernel_ncs40:
    ds_read_b64_tr_b16 v[68:69], v93 offset:40960
    ds_read_b64_tr_b16 v[70:71], v93 offset:41984
    s_add_u32 m0, s45, 114688
    s_nop 0
    buffer_load_dwordx4 v95, s[12:15], s44 offen  lds
    s_add_u32 s44, s44, 110592
    s_waitcnt lgkmcnt(12)
    v_mfma_f32_32x32x16_bf16 v[0:15], v[32:35], v[48:51], v[0:15]
    ds_read_b128 v[44:47], v91 offset:32768
    ds_read_b64_tr_b16 v[72:73], v92 offset:45056
    ds_read_b64_tr_b16 v[74:75], v92 offset:46080
    s_add_u32 m0, s45, 106496
    s_nop 0
    buffer_load_dwordx4 v94, s[8:11], s43 offen  lds
    s_add_u32 s40, s40, 128
    s_add_u32 s43, s43, 128
    s_waitcnt lgkmcnt(13)
    v_mfma_f32_32x32x16_bf16 v[16:31], v[32:35], v[52:55], v[16:31]
    s_cmp_lg_u32 s41, 0
    s_cbranch_scc1 Lk1_kernel_ncs41
    v_dot2c_f32_bf16 v84, s47, v48
    v_dot2c_f32_bf16 v84, s47, v49
    v_dot2c_f32_bf16 v84, s47, v50
    v_dot2c_f32_bf16 v84, s47, v51
    v_dot2c_f32_bf16 v85, s47, v52
    v_dot2c_f32_bf16 v85, s47, v53
    v_dot2c_f32_bf16 v85, s47, v54
    v_dot2c_f32_bf16 v85, s47, v55
Lk1_kernel_ncs41:
    ds_read_b64_tr_b16 v[76:77], v93 offset:45056
    ds_read_b64_tr_b16 v[78:79], v93 offset:46080
    s_add_u32 m0, s45, 122880
    s_nop 0
    buffer_load_dwordx4 v95, s[12:15], s44 offen  lds
    s_add_u32 s44, s44, 110592
    s_waitcnt vmcnt(4)
    s_barrier
    s_waitcnt lgkmcnt(12)
    v_mfma_f32_32x32x16_bf16 v[0:15], v[36:39], v[56:59], v[0:15]
    ds_read_b128 v[32:35], v110 offset:0
    ds_read_b64_tr_b16 v[48:49], v114 offset:0
    ds_read_b64_tr_b16 v[50:51], v114 offset:1024
    s_add_u32 m0, s45, 131072
    s_nop 0
    buffer_load_dwordx4 v94, s[8:11], s40 offen  lds
    s_waitcnt lgkmcnt(13)
    v_mfma_f32_32x32x16_bf16 v[16:31], v[36:39], v[60:63], v[16:31]
    s_cmp_lg_u32 s41, 1
    s_cbranch_scc1 Lk1_kernel_ncs42
    v_dot2c_f32_bf16 v84, s47, v56
    v_dot2c_f32_bf16 v84, s47, v57
    v_dot2c_f32_bf16 v84, s47, v58
    v_dot2c_f32_bf16 v84, s47, v59
    v_dot2c_f32_bf16 v85, s47, v60
    v_dot2c_f32_bf16 v85, s47, v61
    v_dot2c_f32_bf16 v85, s47, v62
    v_dot2c_f32_bf16 v85, s47, v63
Lk1_kernel_ncs42:
    ds_read_b64_tr_b16 v[52:53], v115 offset:0
    ds_read_b64_tr_b16 v[54:55], v115 offset:1024
    s_add_u32 m0, s45, 147456
    s_nop 0
    buffer_load_dwordx4 v95, s[12:15], s44 offen  lds
    s_add_u32 s44, s44, 110592
    s_waitcnt lgkmcnt(12)
    v_mfma_f32_32x32x16_bf16 v[0:15], v[40:43], v[64:67], v[0:15]
    v_dot2c_f32_bf16 v80, s47, v40
    v_dot2c_f32_bf16 v82, v40, v40
    v_dot2c_f32_bf16 v81, s47, v41
    v_dot2c_f32_bf16 v83, v41, v41
    ds_read_b128 v[36:39], v111 offset:0
    ds_read_b64_tr_b16 v[56:57], v114 offset:4096
    ds_read_b64_tr_b16 v[58:59], v114 offset:5120
    s_add_u32 m0, s45, 139264
    s_nop 0
    buffer_load_dwordx4 v94, s[8:11], s43 offen  lds
    s_add_u32 s40, s40, 128
    s_add_u32 s43, s43, 128
    s_waitcnt lgkmcnt(13)
    v_mfma_f32_32x32x16_bf16 v[16:31], v[40:43], v[68:71], v[16:31]
    v_dot2c_f32_bf16 v80, s47, v42
    v_dot2c_f32_bf16 v82, v42, v42
    v_dot2c_f32_bf16 v81, s47, v43
    v_dot2c_f32_bf16 v83, v43, v43
    s_cmp_lg_u32 s41, 2
    s_cbranch_scc1 Lk1_kernel_ncs43
    v_dot2c_f32_bf16 v84, s47, v64
    v_dot2c_f32_bf16 v84, s47, v65
    v_dot2c_f32_bf16 v84, s47, v66
    v_dot2c_f32_bf16 v84, s47, v67
    v_dot2c_f32_bf16 v85, s47, v68
    v_dot2c_f32_bf16 v85, s47, v69
    v_dot2c_f32_bf16 v85, s47, v70
    v_dot2c_f32_bf16 v85, s47, v71
Lk1_kernel_ncs43:
    ds_read_b64_tr_b16 v[60:61], v115 offset:4096
    ds_read_b64_tr_b16 v[62:63], v115 offset:5120
    s_add_u32 m0, s45, 155648
    s_nop 0
    buffer_load_dwordx4 v95, s[12:15], s44 offen  lds
    s_add_u32 s44, s44, 110592
    s_waitcnt lgkmcnt(12)
    v_mfma_f32_32x32x16_bf16 v[0:15], v[44:47], v[72:75], v[0:15]
    v_dot2c_f32_bf16 v80, s47, v44
    v_dot2c_f32_bf16 v82, v44, v44
    v_dot2c_f32_bf16 v81, s47, v45
    v_dot2c_f32_bf16 v83, v45, v45
    ds_read_b128 v[40:43], v112 offset:0
    ds_read_b64_tr_b16 v[64:65], v114 offset:8192
    ds_read_b64_tr_b16 v[66:67], v114 offset:9216
    s_add_u32 m0, s45, 0
    s_nop 0
    buffer_load_dwordx4 v94, s[8:11], s40 offen  lds
    s_waitcnt lgkmcnt(13)
    v_mfma_f32_32x32x16_bf16 v[16:31], v[44:47], v[76:79], v[16:31]
    v_dot2c_f32_bf16 v80, s47, v46
    v_dot2c_f32_bf16 v82, v46, v46
    v_dot2c_f32_bf16 v81, s47, v47
    v_dot2c_f32_bf16 v83, v47, v47
    s_cmp_lg_u32 s41, 3
    s_cbranch_scc1 Lk1_kernel_ncs44
    v_dot2c_f32_bf16 v84, s47, v72
    v_dot2c_f32_bf16 v84, s47, v73
    v_dot2c_f32_bf16 v84, s47, v74
    v_dot2c_f32_bf16 v84, s47, v75
    v_dot2c_f32_bf16 v85, s47, v76
    v_dot2c_f32_bf16 v85, s47, v77
    v_dot2c_f32_bf16 v85, s47, v78
    v_dot2c_f32_bf16 v85, s47, v79
Lk1_kernel_ncs44:
    ds_read_b64_tr_b16 v[68:69], v115 offset:8192
    ds_read_b64_tr_b16 v[70:71], v115 offset:9216
    s_add_u32 m0, s45, 16384
    s_nop 0
    buffer_load_dwordx4 v95, s[12:15], s44 offen  lds
    s_add_u32 s44, s44, 110592
    s_waitcnt lgkmcnt(12)
    v_mfma_f32_32x32x16_bf16 v[0:15], v[32:35], v[48:51], v[0:15]
    ds_read_b128 v[44:47], v113 offset:0
    ds_read_b64_tr_b16 v[72:73], v114 offset:12288
    ds_read_b64_tr_b16 v[74:75], v114 offset:13312
    s_add_u32 m0, s45, 8192
    s_nop 0
    buffer_load_dwordx4 v94, s[8:11], s43 offen  lds
    s_add_u32 s40, s40, 128
    s_add_u32 s43, s43, 128
    s_waitcnt lgkmcnt(13)
    v_mfma_f32_32x32x16_bf16 v[16:31], v[32:35], v[52:55], v[16:31]
    s_cmp_lg_u32 s41, 0
    s_cbranch_scc1 Lk1_kernel_ncs45
    v_dot2c_f32_bf16 v84, s47, v48
    v_dot2c_f32_bf16 v84, s47, v49
    v_dot2c_f32_bf16 v84, s47, v50
    v_dot2c_f32_bf16 v84, s47, v51
    v_dot2c_f32_bf16 v85, s47, v52
    v_dot2c_f32_bf16 v85, s47, v53
    v_dot2c_f32_bf16 v85, s47, v54
    v_dot2c_f32_bf16 v85, s47, v55
Lk1_kernel_ncs45:
    ds_read_b64_tr_b16 v[76:77], v115 offset:12288
    ds_read_b64_tr_b16 v[78:79], v115 offset:13312
    s_waitcnt vmcnt(7)
    s_barrier
    s_waitcnt lgkmcnt(12)
    v_mfma_f32_32x32x16_bf16 v[0:15], v[36:39], v[56:59], v[0:15]
    ds_read_b128 v[32:35], v110 offset:32768
    ds_read_b64_tr_b16 v[48:49], v114 offset:32768
    ds_read_b64_tr_b16 v[50:51], v114 offset:33792
    s_add_u32 m0, s45, 24576
    s_nop 0
    buffer_load_dwordx4 v95, s[12:15], s44 offen  lds
    s_add_u32 s44, s44, 110592
    s_waitcnt lgkmcnt(13)
    v_mfma_f32_32x32x16_bf16 v[16:31], v[36:39], v[60:63], v[16:31]
    s_cmp_lg_u32 s41, 1
    s_cbranch_scc1 Lk1_kernel_ncs46
    v_dot2c_f32_bf16 v84, s47, v56
    v_dot2c_f32_bf16 v84, s47, v57
    v_dot2c_f32_bf16 v84, s47, v58
    v_dot2c_f32_bf16 v84, s47, v59
    v_dot2c_f32_bf16 v85, s47, v60
    v_dot2c_f32_bf16 v85, s47, v61
    v_dot2c_f32_bf16 v85, s47, v62
    v_dot2c_f32_bf16 v85, s47, v63
Lk1_kernel_ncs46:
    ds_read_b64_tr_b16 v[52:53], v115 offset:32768
    ds_read_b64_tr_b16 v[54:55], v115 offset:33792
    s_waitcnt lgkmcnt(12)
    v_mfma_f32_32x32x16_bf16 v[0:15], v[40:43], v[64:67], v[0:15]
    v_dot2c_f32_bf16 v80, s47, v40
    v_dot2c_f32_bf16 v82, v40, v40
    v_dot2c_f32_bf16 v81, s47, v41
    v_dot2c_f32_bf16 v83, v41, v41
    ds_read_b128 v[36:39], v111 offset:32768
    ds_read_b64_tr_b16 v[56:57], v114 offset:36864
    ds_read_b64_tr_b16 v[58:59], v114 offset:37888
    s_add_u32 m0, s45, 32768
    s_nop 0
    buffer_load_dwordx4 v94, s[8:11], s40 offen  lds
    s_waitcnt lgkmcnt(13)
    v_mfma_f32_32x32x16_bf16 v[16:31], v[40:43], v[68:71], v[16:31]
    v_dot2c_f32_bf16 v80, s47, v42
    v_dot2c_f32_bf16 v82, v42, v42
    v_dot2c_f32_bf16 v81, s47, v43
    v_dot2c_f32_bf16 v83, v43, v43
    s_cmp_lg_u32 s41, 2
    s_cbranch_scc1 Lk1_kernel_ncs47
    v_dot2c_f32_bf16 v84, s47, v64
    v_dot2c_f32_bf16 v84, s47, v65
    v_dot2c_f32_bf16 v84, s47, v66
    v_dot2c_f32_bf16 v84, s47, v67
    v_dot2c_f32_bf16 v85, s47, v68
    v_dot2c_f32_bf16 v85, s47, v69
    v_dot2c_f32_bf16 v85, s47, v70
    v_dot2c_f32_bf16 v85, s47, v71
Lk1_kernel_ncs47:
    ds_read_b64_tr_b16 v[60:61], v115 offset:36864
    ds_read_b64_tr_b16 v[62:63], v115 offset:37888
    s_waitcnt lgkmcnt(12)
    v_mfma_f32_32x32x16_bf16 v[0:15], v[44:47], v[72:75], v[0:15]
    v_dot2c_f32_bf16 v80, s47, v44
    v_dot2c_f32_bf16 v82, v44, v44
    v_dot2c_f32_bf16 v81, s47, v45
    v_dot2c_f32_bf16 v83, v45, v45
    ds_read_b128 v[40:43], v112 offset:32768
    ds_read_b64_tr_b16 v[64:65], v114 offset:40960
    ds_read_b64_tr_b16 v[66:67], v114 offset:41984
    s_add_u32 m0, s45, 49152
    s_nop 0
    buffer_load_dwordx4 v95, s[12:15], s44 offen  lds
    s_add_u32 s44, s44, 110592
    s_waitcnt lgkmcnt(13)
    v_mfma_f32_32x32x16_bf16 v[16:31], v[44:47], v[76:79], v[16:31]
    v_dot2c_f32_bf16 v80, s47, v46
    v_dot2c_f32_bf16 v82, v46, v46
    v_dot2c_f32_bf16 v81, s47, v47
    v_dot2c_f32_bf16 v83, v47, v47
    s_cmp_lg_u32 s41, 3
    s_cbranch_scc1 Lk1_kernel_ncs48
    v_dot2c_f32_bf16 v84, s47, v72
    v_dot2c_f32_bf16 v84, s47, v73
    v_dot2c_f32_bf16 v84, s47, v74
    v_dot2c_f32_bf16 v84, s47, v75
    v_dot2c_f32_bf16 v85, s47, v76
    v_dot2c_f32_bf16 v85, s47, v77
    v_dot2c_f32_bf16 v85, s47, v78
    v_dot2c_f32_bf16 v85, s47, v79
Lk1_kernel_ncs48:
    ds_read_b64_tr_b16 v[68:69], v115 offset:40960
    ds_read_b64_tr_b16 v[70:71], v115 offset:41984
    s_waitcnt lgkmcnt(12)
    v_mfma_f32_32x32x16_bf16 v[0:15], v[32:35], v[48:51], v[0:15]
    ds_read_b128 v[44:47], v113 offset:32768
    ds_read_b64_tr_b16 v[72:73], v114 offset:45056
    ds_read_b64_tr_b16 v[74:75], v114 offset:46080
    s_add_u32 m0, s45, 40960
    s_nop 0
    buffer_load_dwordx4 v94, s[8:11], s43 offen  lds
    s_add_u32 s40, s40, 128
    s_add_u32 s43, s43, 128
    s_waitcnt lgkmcnt(13)
    v_mfma_f32_32x32x16_bf16 v[16:31], v[32:35], v[52:55], v[16:31]
    s_cmp_lg_u32 s41, 0
    s_cbranch_scc1 Lk1_kernel_ncs49
    v_dot2c_f32_bf16 v84, s47, v48
    v_dot2c_f32_bf16 v84, s47, v49
    v_dot2c_f32_bf16 v84, s47, v50
    v_dot2c_f32_bf16 v84, s47, v51
    v_dot2c_f32_bf16 v85, s47, v52
    v_dot2c_f32_bf16 v85, s47, v53
    v_dot2c_f32_bf16 v85, s47, v54
    v_dot2c_f32_bf16 v85, s47, v55
Lk1_kernel_ncs49:
    ds_read_b64_tr_b16 v[76:77], v115 offset:45056
    ds_read_b64_tr_b16 v[78:79], v115 offset:46080
    s_waitcnt vmcnt(7)
    s_barrier
    s_waitcnt lgkmcnt(12)
    v_mfma_f32_32x32x16_bf16 v[0:15], v[36:39], v[56:59], v[0:15]
    ds_read_b128 v[32:35], v126 offset:0
    ds_read_b64_tr_b16 v[48:49], v130 offset:0
    ds_read_b64_tr_b16 v[50:51], v130 offset:1024
    s_add_u32 m0, s45, 57344
    s_nop 0
    buffer_load_dwordx4 v95, s[12:15], s44 offen  lds
    s_add_u32 s44, s44, 110592
    s_waitcnt lgkmcnt(13)
    v_mfma_f32_32x32x16_bf16 v[16:31], v[36:39], v[60:63], v[16:31]
    s_cmp_lg_u32 s41, 1
    s_cbranch_scc1 Lk1_kernel_ncs50
    v_dot2c_f32_bf16 v84, s47, v56
    v_dot2c_f32_bf16 v84, s47, v57
    v_dot2c_f32_bf16 v84, s47, v58
    v_dot2c_f32_bf16 v84, s47, v59
    v_dot2c_f32_bf16 v85, s47, v60
    v_dot2c_f32_bf16 v85, s47, v61
    v_dot2c_f32_bf16 v85, s47, v62
    v_dot2c_f32_bf16 v85, s47, v63
Lk1_kernel_ncs50:
    ds_read_b64_tr_b16 v[52:53], v131 offset:0
    ds_read_b64_tr_b16 v[54:55], v131 offset:1024
    s_waitcnt lgkmcnt(12)
    v_mfma_f32_32x32x16_bf16 v[0:15], v[40:43], v[64:67], v[0:15]
    v_dot2c_f32_bf16 v80, s47, v40
    v_dot2c_f32_bf16 v82, v40, v40
    v_dot2c_f32_bf16 v81, s47, v41
    v_dot2c_f32_bf16 v83, v41, v41
    ds_read_b128 v[36:39], v127 offset:0
    ds_read_b64_tr_b16 v[56:57], v130 offset:4096
    ds_read_b64_tr_b16 v[58:59], v130 offset:5120
    s_add_u32 m0, s45, 65536
    s_nop 0
    buffer_load_dwordx4 v94, s[8:11], s40 offen  lds
    s_waitcnt lgkmcnt(13)
    v_mfma_f32_32x32x16_bf16 v[16:31], v[40:43], v[68:71], v[16:31]
    v_dot2c_f32_bf16 v80, s47, v42
    v_dot2c_f32_bf16 v82, v42, v42
    v_dot2c_f32_bf16 v81, s47, v43
    v_dot2c_f32_bf16 v83, v43, v43
    s_cmp_lg_u32 s41, 2
    s_cbranch_scc1 Lk1_kernel_ncs51
    v_dot2c_f32_bf16 v84, s47, v64
    v_dot2c_f32_bf16 v84, s47, v65
    v_dot2c_f32_bf16 v84, s47, v66
    v_dot2c_f32_bf16 v84, s47, v67
    v_dot2c_f32_bf16 v85, s47, v68
    v_dot2c_f32_bf16 v85, s47, v69
    v_dot2c_f32_bf16 v85, s47, v70
    v_dot2c_f32_bf16 v85, s47, v71
Lk1_kernel_ncs51:
    ds_read_b64_tr_b16 v[60:61], v131 offset:4096
    ds_read_b64_tr_b16 v[62:63], v131 offset:5120
    s_waitcnt lgkmcnt(12)
    v_mfma_f32_32x32x16_bf16 v[0:15], v[44:47], v[72:75], v[0:15]
    v_dot2c_f32_bf16 v80, s47, v44
    v_dot2c_f32_bf16 v82, v44, v44
    v_dot2c_f32_bf16 v81, s47, v45
    v_dot2c_f32_bf16 v83, v45, v45
    ds_read_b128 v[40:43], v128 offset:0
    ds_read_b64_tr_b16 v[64:65], v130 offset:8192
    ds_read_b64_tr_b16 v[66:67], v130 offset:9216
    s_add_u32 m0, s45, 81920
    s_nop 0
    buffer_load_dwordx4 v95, s[12:15], s44 offen  lds
    s_add_u32 s44, s44, 110592
    s_waitcnt lgkmcnt(13)
    v_mfma_f32_32x32x16_bf16 v[16:31], v[44:47], v[76:79], v[16:31]
    v_dot2c_f32_bf16 v80, s47, v46
    v_dot2c_f32_bf16 v82, v46, v46
    v_dot2c_f32_bf16 v81, s47, v47
    v_dot2c_f32_bf16 v83, v47, v47
    s_cmp_lg_u32 s41, 3
    s_cbranch_scc1 Lk1_kernel_ncs52
    v_dot2c_f32_bf16 v84, s47, v72
    v_dot2c_f32_bf16 v84, s47, v73
    v_dot2c_f32_bf16 v84, s47, v74
    v_dot2c_f32_bf16 v84, s47, v75
    v_dot2c_f32_bf16 v85, s47, v76
    v_dot2c_f32_bf16 v85, s47, v77
    v_dot2c_f32_bf16 v85, s47, v78
    v_dot2c_f32_bf16 v85, s47, v79
Lk1_kernel_ncs52:
    ds_read_b64_tr_b16 v[68:69], v131 offset:8192
    ds_read_b64_tr_b16 v[70:71], v131 offset:9216
    s_waitcnt lgkmcnt(12)
    v_mfma_f32_32x32x16_bf16 v[0:15], v[32:35], v[48:51], v[0:15]
    ds_read_b128 v[44:47], v129 offset:0
    ds_read_b64_tr_b16 v[72:73], v130 offset:12288
    ds_read_b64_tr_b16 v[74:75], v130 offset:13312
    s_add_u32 m0, s45, 73728
    s_nop 0
    buffer_load_dwordx4 v94, s[8:11], s43 offen  lds
    s_add_u32 s40, s40, 128
    s_add_u32 s43, s43, 128
    s_waitcnt lgkmcnt(13)
    v_mfma_f32_32x32x16_bf16 v[16:31], v[32:35], v[52:55], v[16:31]
    s_cmp_lg_u32 s41, 0
    s_cbranch_scc1 Lk1_kernel_ncs53
    v_dot2c_f32_bf16 v84, s47, v48
    v_dot2c_f32_bf16 v84, s47, v49
    v_dot2c_f32_bf16 v84, s47, v50
    v_dot2c_f32_bf16 v84, s47, v51
    v_dot2c_f32_bf16 v85, s47, v52
    v_dot2c_f32_bf16 v85, s47, v53
    v_dot2c_f32_bf16 v85, s47, v54
    v_dot2c_f32_bf16 v85, s47, v55
Lk1_kernel_ncs53:
    ds_read_b64_tr_b16 v[76:77], v131 offset:12288
    ds_read_b64_tr_b16 v[78:79], v131 offset:13312
    s_waitcnt vmcnt(7)
    s_barrier
    s_waitcnt lgkmcnt(12)
    v_mfma_f32_32x32x16_bf16 v[0:15], v[36:39], v[56:59], v[0:15]
    ds_read_b128 v[32:35], v88 offset:0
    ds_read_b64_tr_b16 v[48:49], v92 offset:0
    ds_read_b64_tr_b16 v[50:51], v92 offset:1024
    s_add_u32 m0, s45, 90112
    s_nop 0
    buffer_load_dwordx4 v95, s[12:15], s44 offen  lds
    s_add_u32 s44, s44, 110592
    s_waitcnt lgkmcnt(13)
    v_mfma_f32_32x32x16_bf16 v[16:31], v[36:39], v[60:63], v[16:31]
    s_cmp_lg_u32 s41, 1
    s_cbranch_scc1 Lk1_kernel_ncs54
    v_dot2c_f32_bf16 v84, s47, v56
    v_dot2c_f32_bf16 v84, s47, v57
    v_dot2c_f32_bf16 v84, s47, v58
    v_dot2c_f32_bf16 v84, s47, v59
    v_dot2c_f32_bf16 v85, s47, v60
    v_dot2c_f32_bf16 v85, s47, v61
    v_dot2c_f32_bf16 v85, s47, v62
    v_dot2c_f32_bf16 v85, s47, v63
Lk1_kernel_ncs54:
    ds_read_b64_tr_b16 v[52:53], v93 offset:0
    ds_read_b64_tr_b16 v[54:55], v93 offset:1024
    s_waitcnt lgkmcnt(12)
    v_mfma_f32_32x32x16_bf16 v[0:15], v[40:43], v[64:67], v[0:15]
    v_dot2c_f32_bf16 v80, s47, v40
    v_dot2c_f32_bf16 v82, v40, v40
    v_dot2c_f32_bf16 v81, s47, v41
    v_dot2c_f32_bf16 v83, v41, v41
    ds_read_b128 v[36:39], v89 offset:0
    ds_read_b64_tr_b16 v[56:57], v92 offset:4096
    ds_read_b64_tr_b16 v[58:59], v92 offset:5120
    s_add_u32 m0, s45, 98304
    s_nop 0
    buffer_load_dwordx4 v94, s[8:11], s40 offen  lds
    s_waitcnt lgkmcnt(13)
    v_mfma_f32_32x32x16_bf16 v[16:31], v[40:43], v[68:71], v[16:31]
    v_dot2c_f32_bf16 v80, s47, v42
    v_dot2c_f32_bf16 v82, v42, v42
    v_dot2c_f32_bf16 v81, s47, v43
    v_dot2c_f32_bf16 v83, v43, v43
    s_cmp_lg_u32 s41, 2
    s_cbranch_scc1 Lk1_kernel_ncs55
    v_dot2c_f32_bf16 v84, s47, v64
    v_dot2c_f32_bf16 v84, s47, v65
    v_dot2c_f32_bf16 v84, s47, v66
    v_dot2c_f32_bf16 v84, s47, v67
    v_dot2c_f32_bf16 v85, s47, v68
    v_dot2c_f32_bf16 v85, s47, v69
    v_dot2c_f32_bf16 v85, s47, v70
    v_dot2c_f32_bf16 v85, s47, v71
Lk1_kernel_ncs55:
    ds_read_b64_tr_b16 v[60:61], v93 offset:4096
    ds_read_b64_tr_b16 v[62:63], v93 offset:5120
    s_waitcnt lgkmcnt(12)
    v_mfma_f32_32x32x16_bf16 v[0:15], v[44:47], v[72:75], v[0:15]
    v_dot2c_f32_bf16 v80, s47, v44
    v_dot2c_f32_bf16 v82, v44, v44
    v_dot2c_f32_bf16 v81, s47, v45
    v_dot2c_f32_bf16 v83, v45, v45
    ds_read_b128 v[40:43], v90 offset:0
    ds_read_b64_tr_b16 v[64:65], v92 offset:8192
    ds_read_b64_tr_b16 v[66:67], v92 offset:9216
    s_add_u32 m0, s45, 114688
    s_nop 0
    buffer_load_dwordx4 v95, s[12:15], s44 offen  lds
    s_add_u32 s44, s44, 110592
    s_waitcnt lgkmcnt(13)
    v_mfma_f32_32x32x16_bf16 v[16:31], v[44:47], v[76:79], v[16:31]
    v_dot2c_f32_bf16 v80, s47, v46
    v_dot2c_f32_bf16 v82, v46, v46
    v_dot2c_f32_bf16 v81, s47, v47
    v_dot2c_f32_bf16 v83, v47, v47
    s_cmp_lg_u32 s41, 3
    s_cbranch_scc1 Lk1_kernel_ncs56
    v_dot2c_f32_bf16 v84, s47, v72
    v_dot2c_f32_bf16 v84, s47, v73
    v_dot2c_f32_bf16 v84, s47, v74
    v_dot2c_f32_bf16 v84, s47, v75
    v_dot2c_f32_bf16 v85, s47, v76
    v_dot2c_f32_bf16 v85, s47, v77
    v_dot2c_f32_bf16 v85, s47, v78
    v_dot2c_f32_bf16 v85, s47, v79
Lk1_kernel_ncs56:
    ds_read_b64_tr_b16 v[68:69], v93 offset:8192
    ds_read_b64_tr_b16 v[70:71], v93 offset:9216
    s_waitcnt lgkmcnt(12)
    v_mfma_f32_32x32x16_bf16 v[0:15], v[32:35], v[48:51], v[0:15]
    ds_read_b128 v[44:47], v91 offset:0
    ds_read_b64_tr_b16 v[72:73], v92 offset:12288
    ds_read_b64_tr_b16 v[74:75], v92 offset:13312
    s_add_u32 m0, s45, 106496
    s_nop 0
    buffer_load_dwordx4 v94, s[8:11], s43 offen  lds
    s_add_u32 s40, s40, 128
    s_add_u32 s43, s43, 128
    s_waitcnt lgkmcnt(13)
    v_mfma_f32_32x32x16_bf16 v[16:31], v[32:35], v[52:55], v[16:31]
    s_cmp_lg_u32 s41, 0
    s_cbranch_scc1 Lk1_kernel_ncs57
    v_dot2c_f32_bf16 v84, s47, v48
    v_dot2c_f32_bf16 v84, s47, v49
    v_dot2c_f32_bf16 v84, s47, v50
    v_dot2c_f32_bf16 v84, s47, v51
    v_dot2c_f32_bf16 v85, s47, v52
    v_dot2c_f32_bf16 v85, s47, v53
    v_dot2c_f32_bf16 v85, s47, v54
    v_dot2c_f32_bf16 v85, s47, v55
Lk1_kernel_ncs57:
    ds_read_b64_tr_b16 v[76:77], v93 offset:12288
    ds_read_b64_tr_b16 v[78:79], v93 offset:13312
    s_waitcnt vmcnt(7)
    s_barrier
    s_lshr_b32 s46, s2, 3
    s_lshl_b32 s46, s46, 3
    s_add_u32 s46, s46, s30
    v_lshlrev_b32 v120, 7, v97
    s_mov_b32 s27, 0x20000
    s_mov_b32 exec_hi, 0
    s_mov_b32 exec_lo, 0x1fffff
    s_mul_i32 s48, s46, 2688
    s_mov_b32 s24, s84
    s_mov_b32 s25, s85
    s_mov_b32 s26, 0xa2000
    buffer_load_dword v179, v120, s[24:27], s48 offen
    s_mov_b64 exec, -1
    s_lshl_b32 s46, s2, 3
    s_add_u32 s46, s46, s30
    s_waitcnt lgkmcnt(12)
    v_mfma_f32_32x32x16_bf16 v[0:15], v[36:39], v[56:59], v[0:15]
    ds_read_b128 v[32:35], v88 offset:32768
    ds_read_b64_tr_b16 v[48:49], v92 offset:32768
    ds_read_b64_tr_b16 v[50:51], v92 offset:33792
    s_add_u32 m0, s45, 122880
    s_nop 0
    buffer_load_dwordx4 v95, s[12:15], s44 offen  lds
    s_add_u32 s44, s44, 110592
    s_waitcnt lgkmcnt(13)
    v_mfma_f32_32x32x16_bf16 v[16:31], v[36:39], v[60:63], v[16:31]
    s_cmp_lg_u32 s41, 1
    s_cbranch_scc1 Lk1_kernel_ncs58
    v_dot2c_f32_bf16 v84, s47, v56
    v_dot2c_f32_bf16 v84, s47, v57
    v_dot2c_f32_bf16 v84, s47, v58
    v_dot2c_f32_bf16 v84, s47, v59
    v_dot2c_f32_bf16 v85, s47, v60
    v_dot2c_f32_bf16 v85, s47, v61
    v_dot2c_f32_bf16 v85, s47, v62
    v_dot2c_f32_bf16 v85, s47, v63
Lk1_kernel_ncs58:
    ds_read_b64_tr_b16 v[52:53], v93 offset:32768
    ds_read_b64_tr_b16 v[54:55], v93 offset:33792
    s_waitcnt lgkmcnt(12)
    v_mfma_f32_32x32x16_bf16 v[0:15], v[40:43], v[64:67], v[0:15]
    v_dot2c_f32_bf16 v80, s47, v40
    v_dot2c_f32_bf16 v82, v40, v40
    v_dot2c_f32_bf16 v81, s47, v41
    v_dot2c_f32_bf16 v83, v41, v41
    ds_read_b128 v[36:39], v89 offset:32768
    ds_read_b64_tr_b16 v[56:57], v92 offset:36864
    ds_read_b64_tr_b16 v[58:59], v92 offset:37888
    s_waitcnt lgkmcnt(13)
    v_mfma_f32_32x32x16_bf16 v[16:31], v[40:43], v[68:71], v[16:31]
    v_dot2c_f32_bf16 v80, s47, v42
    v_dot2c_f32_bf16 v82, v42, v42
    v_dot2c_f32_bf16 v81, s47, v43
    v_dot2c_f32_bf16 v83, v43, v43
    s_cmp_lg_u32 s41, 2
    s_cbranch_scc1 Lk1_kernel_ncs59
    v_dot2c_f32_bf16 v84, s47, v64
    v_dot2c_f32_bf16 v84, s47, v65
    v_dot2c_f32_bf16 v84, s47, v66
    v_dot2c_f32_bf16 v84, s47, v67
    v_dot2c_f32_bf16 v85, s47, v68
    v_dot2c_f32_bf16 v85, s47, v69
    v_dot2c_f32_bf16 v85, s47, v70
    v_dot2c_f32_bf16 v85, s47, v71
Lk1_kernel_ncs59:
    ds_read_b64_tr_b16 v[60:61], v93 offset:36864
    ds_read_b64_tr_b16 v[62:63], v93 offset:37888
    s_waitcnt lgkmcnt(12)
    v_mfma_f32_32x32x16_bf16 v[0:15], v[44:47], v[72:75], v[0:15]
    v_dot2c_f32_bf16 v80, s47, v44
    v_dot2c_f32_bf16 v82, v44, v44
    v_dot2c_f32_bf16 v81, s47, v45
    v_dot2c_f32_bf16 v83, v45, v45
    ds_read_b128 v[40:43], v90 offset:32768
    ds_read_b64_tr_b16 v[64:65], v92 offset:40960
    ds_read_b64_tr_b16 v[66:67], v92 offset:41984
    s_waitcnt lgkmcnt(13)
    v_mfma_f32_32x32x16_bf16 v[16:31], v[44:47], v[76:79], v[16:31]
    v_dot2c_f32_bf16 v80, s47, v46
    v_dot2c_f32_bf16 v82, v46, v46
    v_dot2c_f32_bf16 v81, s47, v47
    v_dot2c_f32_bf16 v83, v47, v47
    s_cmp_lg_u32 s41, 3
    s_cbranch_scc1 Lk1_kernel_ncs60
    v_dot2c_f32_bf16 v84, s47, v72
    v_dot2c_f32_bf16 v84, s47, v73
    v_dot2c_f32_bf16 v84, s47, v74
    v_dot2c_f32_bf16 v84, s47, v75
    v_dot2c_f32_bf16 v85, s47, v76
    v_dot2c_f32_bf16 v85, s47, v77
    v_dot2c_f32_bf16 v85, s47, v78
    v_dot2c_f32_bf16 v85, s47, v79
Lk1_kernel_ncs60:
    ds_read_b64_tr_b16 v[68:69], v93 offset:40960
    ds_read_b64_tr_b16 v[70:71], v93 offset:41984
    s_waitcnt lgkmcnt(12)
    v_mfma_f32_32x32x16_bf16 v[0:15], v[32:35], v[48:51], v[0:15]
    ds_read_b128 v[44:47], v91 offset:32768
    ds_read_b64_tr_b16 v[72:73], v92 offset:45056
    ds_read_b64_tr_b16 v[74:75], v92 offset:46080
    s_waitcnt lgkmcnt(13)
    v_mfma_f32_32x32x16_bf16 v[16:31], v[32:35], v[52:55], v[16:31]
    s_cmp_lg_u32 s41, 0
    s_cbranch_scc1 Lk1_kernel_ncs61
    v_dot2c_f32_bf16 v84, s47, v48
    v_dot2c_f32_bf16 v84, s47, v49
    v_dot2c_f32_bf16 v84, s47, v50
    v_dot2c_f32_bf16 v84, s47, v51
    v_dot2c_f32_bf16 v85, s47, v52
    v_dot2c_f32_bf16 v85, s47, v53
    v_dot2c_f32_bf16 v85, s47, v54
    v_dot2c_f32_bf16 v85, s47, v55
Lk1_kernel_ncs61:
    ds_read_b64_tr_b16 v[76:77], v93 offset:45056
    ds_read_b64_tr_b16 v[78:79], v93 offset:46080
    s_waitcnt vmcnt(5)
    s_barrier
    s_lshr_b32 s46, s2, 3
    s_lshl_b32 s46, s46, 3
    s_add_u32 s46, s46, s30
    s_mul_i32 s46, s46, 21
    v_add_u32 v120, s46, v97
    s_mov_b32 s48, 0xE38F
    v_mul_lo_u32 v121, v120, s48
    v_lshrrev_b32 v121, 19, v121
    v_mul_u32_u24 v122, 9, v121
    v_sub_u32 v120, v120, v122
    v_mul_u32_u24 v121, 9216, v121
    v_lshl_add_u32 v120, v120, 7, v121
    s_mul_i32 s48, s31, 1152
    s_mov_b32 s26, 0x510000
    s_mov_b32 exec_hi, 0
    s_mov_b32 exec_lo, 0x1fffff
    s_mov_b32 s24, s88
    s_mov_b32 s25, s89
    buffer_load_dword v176, v120, s[24:27], s48 offen
    s_mov_b32 s24, s90
    s_mov_b32 s25, s91
    buffer_load_dword v177, v120, s[24:27], s48 offen
    s_mov_b64 exec, -1
    s_waitcnt lgkmcnt(12)
    v_mfma_f32_32x32x16_bf16 v[0:15], v[36:39], v[56:59], v[0:15]
    ds_read_b128 v[32:35], v110 offset:0
    ds_read_b64_tr_b16 v[48:49], v114 offset:0
    ds_read_b64_tr_b16 v[50:51], v114 offset:1024
    s_waitcnt lgkmcnt(13)
    v_mfma_f32_32x32x16_bf16 v[16:31], v[36:39], v[60:63], v[16:31]
    s_cmp_lg_u32 s41, 1
    s_cbranch_scc1 Lk1_kernel_ncs62
    v_dot2c_f32_bf16 v84, s47, v56
    v_dot2c_f32_bf16 v84, s47, v57
    v_dot2c_f32_bf16 v84, s47, v58
    v_dot2c_f32_bf16 v84, s47, v59
    v_dot2c_f32_bf16 v85, s47, v60
    v_dot2c_f32_bf16 v85, s47, v61
    v_dot2c_f32_bf16 v85, s47, v62
    v_dot2c_f32_bf16 v85, s47, v63
Lk1_kernel_ncs62:
    ds_read_b64_tr_b16 v[52:53], v115 offset:0
    ds_read_b64_tr_b16 v[54:55], v115 offset:1024
    s_waitcnt lgkmcnt(12)
    v_mfma_f32_32x32x16_bf16 v[0:15], v[40:43], v[64:67], v[0:15]
    v_dot2c_f32_bf16 v80, s47, v40
    v_dot2c_f32_bf16 v82, v40, v40
    v_dot2c_f32_bf16 v81, s47, v41
    v_dot2c_f32_bf16 v83, v41, v41
    ds_read_b128 v[36:39], v111 offset:0
    ds_read_b64_tr_b16 v[56:57], v114 offset:4096
    ds_read_b64_tr_b16 v[58:59], v114 offset:5120
    s_waitcnt lgkmcnt(13)
    v_mfma_f32_32x32x16_bf16 v[16:31], v[40:43], v[68:71], v[16:31]
    v_dot2c_f32_bf16 v80, s47, v42
    v_dot2c_f32_bf16 v82, v42, v42
    v_dot2c_f32_bf16 v81, s47, v43
    v_dot2c_f32_bf16 v83, v43, v43
    s_cmp_lg_u32 s41, 2
    s_cbranch_scc1 Lk1_kernel_ncs63
    v_dot2c_f32_bf16 v84, s47, v64
    v_dot2c_f32_bf16 v84, s47, v65
    v_dot2c_f32_bf16 v84, s47, v66
    v_dot2c_f32_bf16 v84, s47, v67
    v_dot2c_f32_bf16 v85, s47, v68
    v_dot2c_f32_bf16 v85, s47, v69
    v_dot2c_f32_bf16 v85, s47, v70
    v_dot2c_f32_bf16 v85, s47, v71
Lk1_kernel_ncs63:
    ds_read_b64_tr_b16 v[60:61], v115 offset:4096
    ds_read_b64_tr_b16 v[62:63], v115 offset:5120
    s_waitcnt lgkmcnt(12)
    v_mfma_f32_32x32x16_bf16 v[0:15], v[44:47], v[72:75], v[0:15]
    v_dot2c_f32_bf16 v80, s47, v44
    v_dot2c_f32_bf16 v82, v44, v44
    v_dot2c_f32_bf16 v81, s47, v45
    v_dot2c_f32_bf16 v83, v45, v45
    ds_read_b128 v[40:43], v112 offset:0
    ds_read_b64_tr_b16 v[64:65], v114 offset:8192
    ds_read_b64_tr_b16 v[66:67], v114 offset:9216
    s_waitcnt lgkmcnt(13)
    v_mfma_f32_32x32x16_bf16 v[16:31], v[44:47], v[76:79], v[16:31]
    v_dot2c_f32_bf16 v80, s47, v46
    v_dot2c_f32_bf16 v82, v46, v46
    v_dot2c_f32_bf16 v81, s47, v47
    v_dot2c_f32_bf16 v83, v47, v47
    s_cmp_lg_u32 s41, 3
    s_cbranch_scc1 Lk1_kernel_ncs64
    v_dot2c_f32_bf16 v84, s47, v72
    v_dot2c_f32_bf16 v84, s47, v73
    v_dot2c_f32_bf16 v84, s47, v74
    v_dot2c_f32_bf16 v84, s47, v75
    v_dot2c_f32_bf16 v85, s47, v76
    v_dot2c_f32_bf16 v85, s47, v77
    v_dot2c_f32_bf16 v85, s47, v78
    v_dot2c_f32_bf16 v85, s47, v79
Lk1_kernel_ncs64:
    ds_read_b64_tr_b16 v[68:69], v115 offset:8192
    ds_read_b64_tr_b16 v[70:71], v115 offset:9216
    s_waitcnt lgkmcnt(12)
    v_mfma_f32_32x32x16_bf16 v[0:15], v[32:35], v[48:51], v[0:15]
    ds_read_b128 v[44:47], v113 offset:0
    ds_read_b64_tr_b16 v[72:73], v114 offset:12288
    ds_read_b64_tr_b16 v[74:75], v114 offset:13312
    s_waitcnt lgkmcnt(13)
    v_mfma_f32_32x32x16_bf16 v[16:31], v[32:35], v[52:55], v[16:31]
    s_cmp_lg_u32 s41, 0
    s_cbranch_scc1 Lk1_kernel_ncs65
    v_dot2c_f32_bf16 v84, s47, v48
    v_dot2c_f32_bf16 v84, s47, v49
    v_dot2c_f32_bf16 v84, s47, v50
    v_dot2c_f32_bf16 v84, s47, v51
    v_dot2c_f32_bf16 v85, s47, v52
    v_dot2c_f32_bf16 v85, s47, v53
    v_dot2c_f32_bf16 v85, s47, v54
    v_dot2c_f32_bf16 v85, s47, v55
Lk1_kernel_ncs65:
    ds_read_b64_tr_b16 v[76:77], v115 offset:12288
    ds_read_b64_tr_b16 v[78:79], v115 offset:13312
    s_waitcnt vmcnt(2)
    s_barrier
    s_waitcnt lgkmcnt(12)
    v_mfma_f32_32x32x16_bf16 v[0:15], v[36:39], v[56:59], v[0:15]
    ds_read_b128 v[32:35], v110 offset:32768
    ds_read_b64_tr_b16 v[48:49], v114 offset:32768
    ds_read_b64_tr_b16 v[50:51], v114 offset:33792
    s_waitcnt lgkmcnt(13)
    v_mfma_f32_32x32x16_bf16 v[16:31], v[36:39], v[60:63], v[16:31]
    s_cmp_lg_u32 s41, 1
    s_cbranch_scc1 Lk1_kernel_ncs66
    v_dot2c_f32_bf16 v84, s47, v56
    v_dot2c_f32_bf16 v84, s47, v57
    v_dot2c_f32_bf16 v84, s47, v58
    v_dot2c_f32_bf16 v84, s47, v59
    v_dot2c_f32_bf16 v85, s47, v60
    v_dot2c_f32_bf16 v85, s47, v61
    v_dot2c_f32_bf16 v85, s47, v62
    v_dot2c_f32_bf16 v85, s47, v63
Lk1_kernel_ncs66:
    ds_read_b64_tr_b16 v[52:53], v115 offset:32768
    ds_read_b64_tr_b16 v[54:55], v115 offset:33792
    s_waitcnt lgkmcnt(12)
    v_mfma_f32_32x32x16_bf16 v[0:15], v[40:43], v[64:67], v[0:15]
    v_dot2c_f32_bf16 v80, s47, v40
    v_dot2c_f32_bf16 v82, v40, v40
    v_dot2c_f32_bf16 v81, s47, v41
    v_dot2c_f32_bf16 v83, v41, v41
    ds_read_b128 v[36:39], v111 offset:32768
    ds_read_b64_tr_b16 v[56:57], v114 offset:36864
    ds_read_b64_tr_b16 v[58:59], v114 offset:37888
    s_waitcnt lgkmcnt(13)
    v_mfma_f32_32x32x16_bf16 v[16:31], v[40:43], v[68:71], v[16:31]
    v_dot2c_f32_bf16 v80, s47, v42
    v_dot2c_f32_bf16 v82, v42, v42
    v_dot2c_f32_bf16 v81, s47, v43
    v_dot2c_f32_bf16 v83, v43, v43
    s_cmp_lg_u32 s41, 2
    s_cbranch_scc1 Lk1_kernel_ncs67
    v_dot2c_f32_bf16 v84, s47, v64
    v_dot2c_f32_bf16 v84, s47, v65
    v_dot2c_f32_bf16 v84, s47, v66
    v_dot2c_f32_bf16 v84, s47, v67
    v_dot2c_f32_bf16 v85, s47, v68
    v_dot2c_f32_bf16 v85, s47, v69
    v_dot2c_f32_bf16 v85, s47, v70
    v_dot2c_f32_bf16 v85, s47, v71
Lk1_kernel_ncs67:
    ds_read_b64_tr_b16 v[60:61], v115 offset:36864
    ds_read_b64_tr_b16 v[62:63], v115 offset:37888
    s_waitcnt lgkmcnt(12)
    v_mfma_f32_32x32x16_bf16 v[0:15], v[44:47], v[72:75], v[0:15]
    v_dot2c_f32_bf16 v80, s47, v44
    v_dot2c_f32_bf16 v82, v44, v44
    v_dot2c_f32_bf16 v81, s47, v45
    v_dot2c_f32_bf16 v83, v45, v45
    ds_read_b128 v[40:43], v112 offset:32768
    ds_read_b64_tr_b16 v[64:65], v114 offset:40960
    ds_read_b64_tr_b16 v[66:67], v114 offset:41984
    s_waitcnt lgkmcnt(13)
    v_mfma_f32_32x32x16_bf16 v[16:31], v[44:47], v[76:79], v[16:31]
    v_dot2c_f32_bf16 v80, s47, v46
    v_dot2c_f32_bf16 v82, v46, v46
    v_dot2c_f32_bf16 v81, s47, v47
    v_dot2c_f32_bf16 v83, v47, v47
    s_cmp_lg_u32 s41, 3
    s_cbranch_scc1 Lk1_kernel_ncs68
    v_dot2c_f32_bf16 v84, s47, v72
    v_dot2c_f32_bf16 v84, s47, v73
    v_dot2c_f32_bf16 v84, s47, v74
    v_dot2c_f32_bf16 v84, s47, v75
    v_dot2c_f32_bf16 v85, s47, v76
    v_dot2c_f32_bf16 v85, s47, v77
    v_dot2c_f32_bf16 v85, s47, v78
    v_dot2c_f32_bf16 v85, s47, v79
Lk1_kernel_ncs68:
    ds_read_b64_tr_b16 v[68:69], v115 offset:40960
    ds_read_b64_tr_b16 v[70:71], v115 offset:41984
    s_waitcnt lgkmcnt(12)
    v_mfma_f32_32x32x16_bf16 v[0:15], v[32:35], v[48:51], v[0:15]
    ds_read_b128 v[44:47], v113 offset:32768
    ds_read_b64_tr_b16 v[72:73], v114 offset:45056
    ds_read_b64_tr_b16 v[74:75], v114 offset:46080
    s_waitcnt lgkmcnt(13)
    v_mfma_f32_32x32x16_bf16 v[16:31], v[32:35], v[52:55], v[16:31]
    s_cmp_lg_u32 s41, 0
    s_cbranch_scc1 Lk1_kernel_ncs69
    v_dot2c_f32_bf16 v84, s47, v48
    v_dot2c_f32_bf16 v84, s47, v49
    v_dot2c_f32_bf16 v84, s47, v50
    v_dot2c_f32_bf16 v84, s47, v51
    v_dot2c_f32_bf16 v85, s47, v52
    v_dot2c_f32_bf16 v85, s47, v53
    v_dot2c_f32_bf16 v85, s47, v54
    v_dot2c_f32_bf16 v85, s47, v55
Lk1_kernel_ncs69:
    ds_read_b64_tr_b16 v[76:77], v115 offset:45056
    ds_read_b64_tr_b16 v[78:79], v115 offset:46080
    s_waitcnt lgkmcnt(12)
    v_mfma_f32_32x32x16_bf16 v[0:15], v[36:39], v[56:59], v[0:15]
    s_waitcnt lgkmcnt(10)
    v_mfma_f32_32x32x16_bf16 v[16:31], v[36:39], v[60:63], v[16:31]
    s_cmp_lg_u32 s41, 1
    s_cbranch_scc1 Lk1_kernel_ncs70
    v_dot2c_f32_bf16 v84, s47, v56
    v_dot2c_f32_bf16 v84, s47, v57
    v_dot2c_f32_bf16 v84, s47, v58
    v_dot2c_f32_bf16 v84, s47, v59
    v_dot2c_f32_bf16 v85, s47, v60
    v_dot2c_f32_bf16 v85, s47, v61
    v_dot2c_f32_bf16 v85, s47, v62
    v_dot2c_f32_bf16 v85, s47, v63
Lk1_kernel_ncs70:
    s_waitcnt lgkmcnt(7)
    v_mfma_f32_32x32x16_bf16 v[0:15], v[40:43], v[64:67], v[0:15]
    v_dot2c_f32_bf16 v80, s47, v40
    v_dot2c_f32_bf16 v82, v40, v40
    v_dot2c_f32_bf16 v81, s47, v41
    v_dot2c_f32_bf16 v83, v41, v41
    s_waitcnt lgkmcnt(5)
    v_mfma_f32_32x32x16_bf16 v[16:31], v[40:43], v[68:71], v[16:31]
    v_dot2c_f32_bf16 v80, s47, v42
    v_dot2c_f32_bf16 v82, v42, v42
    v_dot2c_f32_bf16 v81, s47, v43
    v_dot2c_f32_bf16 v83, v43, v43
    s_cmp_lg_u32 s41, 2
    s_cbranch_scc1 Lk1_kernel_ncs71
    v_dot2c_f32_bf16 v84, s47, v64
    v_dot2c_f32_bf16 v84, s47, v65
    v_dot2c_f32_bf16 v84, s47, v66
    v_dot2c_f32_bf16 v84, s47, v67
    v_dot2c_f32_bf16 v85, s47, v68
    v_dot2c_f32_bf16 v85, s47, v69
    v_dot2c_f32_bf16 v85, s47, v70
    v_dot2c_f32_bf16 v85, s47, v71
Lk1_kernel_ncs71:
    s_waitcnt lgkmcnt(2)
    v_mfma_f32_32x32x16_bf16 v[0:15], v[44:47], v[72:75], v[0:15]
    v_dot2c_f32_bf16 v80, s47, v44
    v_dot2c_f32_bf16 v82, v44, v44
    v_dot2c_f32_bf16 v81, s47, v45
    v_dot2c_f32_bf16 v83, v45, v45
    s_waitcnt lgkmcnt(0)
    v_mfma_f32_32x32x16_bf16 v[16:31], v[44:47], v[76:79], v[16:31]
    v_dot2c_f32_bf16 v80, s47, v46
    v_dot2c_f32_bf16 v82, v46, v46
    v_dot2c_f32_bf16 v81, s47, v47
    v_dot2c_f32_bf16 v83, v47, v47
    s_cmp_lg_u32 s41, 3
    s_cbranch_scc1 Lk1_kernel_ncs72
    v_dot2c_f32_bf16 v84, s47, v72
    v_dot2c_f32_bf16 v84, s47, v73
    v_dot2c_f32_bf16 v84, s47, v74
    v_dot2c_f32_bf16 v84, s47, v75
    v_dot2c_f32_bf16 v85, s47, v76
    v_dot2c_f32_bf16 v85, s47, v77
    v_dot2c_f32_bf16 v85, s47, v78
    v_dot2c_f32_bf16 v85, s47, v79
Lk1_kernel_ncs72:
    s_nop 4
    v_add_f32 v80, v80, v81
    v_add_f32 v81, v82, v83
    v_and_b32 v100, 31, v97
    v_lshrrev_b32 v101, 5, v97
    s_lshl_b32 s42, s41, 9
    v_lshl_add_u32 v102, v100, 4, s42
    v_lshl_add_u32 v103, v101, 3, v102
    v_add_u32 v103, 43008, v103
    ds_write_b64 v103, v[80:81]
    s_lshl_b32 s42, s41, 8
    v_lshl_add_u32 v104, v97, 2, s42
    v_add_u32 v104, 47104, v104
    ds_write_b32 v104, v84
    ds_write_b32 v104, v85 offset:1024
    s_waitcnt lgkmcnt(0)
    s_barrier
    v_add_u32 v102, 40960, v102
    ds_read_b128 v[32:35], v102
    ds_read_b128 v[36:39], v102 offset:2048
    v_lshlrev_b32 v104, 2, v100
    v_add_u32 v104, 47104, v104
    ds_read_b32 v40, v104 offset:0
    ds_read_b32 v41, v104 offset:128
    ds_read_b32 v42, v104 offset:256
    ds_read_b32 v43, v104 offset:384
    ds_read_b32 v44, v104 offset:512
    ds_read_b32 v45, v104 offset:640
    ds_read_b32 v46, v104 offset:768
    ds_read_b32 v47, v104 offset:896
    ds_read_b32 v48, v104 offset:1024
    ds_read_b32 v49, v104 offset:1152
    ds_read_b32 v50, v104 offset:1280
    ds_read_b32 v51, v104 offset:1408
    ds_read_b32 v52, v104 offset:1536
    ds_read_b32 v53, v104 offset:1664
    ds_read_b32 v54, v104 offset:1792
    ds_read_b32 v55, v104 offset:1920
    s_waitcnt lgkmcnt(0)
    v_add_f32 v32, v32, v34
    v_add_f32 v33, v33, v35
    v_add_f32 v36, v36, v38
    v_add_f32 v37, v37, v39
    v_add_f32 v32, v32, v36
    v_add_f32 v33, v33, v37
    s_mov_b32 s49, 0x3AE38E39
    v_mul_f32 v32, s49, v32
    v_mul_f32 v33, s49, v33
    v_fma_f32 v33, -v32, v32, v33
    v_max_f32 v33, 0, v33
    v_add_f32 v33, 0x3727c5ac, v33
    v_rsq_f32 v34, v33
    s_nop 0
    v_mul_f32 v35, v32, v34
    v_sub_f32 v35, 0, v35
    v_add_f32 v40, v40, v44
    v_add_f32 v41, v41, v45
    v_add_f32 v42, v42, v46
    v_add_f32 v43, v43, v47
    v_add_f32 v40, v40, v42
    v_add_f32 v41, v41, v43
    v_add_f32 v40, v40, v41
    v_add_f32 v48, v48, v52
    v_add_f32 v49, v49, v53
    v_add_f32 v50, v50, v54
    v_add_f32 v51, v51, v55
    v_add_f32 v48, v48, v50
    v_add_f32 v49, v49, v51
    v_add_f32 v48, v48, v49
    s_lshl_b32 s42, s30, 8
    s_add_u32 s42, s42, 49152
    v_lshl_add_u32 v102, v100, 3, s42
    ds_write_b64 v102, v[34:35]
    s_waitcnt lgkmcnt(0)
    v_lshl_add_u32 v102, v101, 5, s42
    ds_read_b128 v[112:115], v102 offset:0
    ds_read_b128 v[116:119], v102 offset:16
    ds_read_b128 v[120:123], v102 offset:64
    ds_read_b128 v[124:127], v102 offset:80
    ds_read_b128 v[128:131], v102 offset:128
    ds_read_b128 v[132:135], v102 offset:144
    ds_read_b128 v[136:139], v102 offset:192
    ds_read_b128 v[140:143], v102 offset:208
    s_waitcnt lgkmcnt(0)
    v_mul_f32 v56, v113, v40
    v_mul_f32 v57, v115, v40
    v_mul_f32 v58, v117, v40
    v_mul_f32 v59, v119, v40
    v_mul_f32 v60, v121, v40
    v_mul_f32 v61, v123, v40
    v_mul_f32 v62, v125, v40
    v_mul_f32 v63, v127, v40
    v_mul_f32 v64, v129, v40
    v_mul_f32 v65, v131, v40
    v_mul_f32 v66, v133, v40
    v_mul_f32 v67, v135, v40
    v_mul_f32 v68, v137, v40
    v_mul_f32 v69, v139, v40
    v_mul_f32 v70, v141, v40
    v_mul_f32 v71, v143, v40
    v_fma_f32 v0, v0, v112, v56
    v_fma_f32 v1, v1, v114, v57
    v_fma_f32 v2, v2, v116, v58
    v_fma_f32 v3, v3, v118, v59
    v_fma_f32 v4, v4, v120, v60
    v_fma_f32 v5, v5, v122, v61
    v_fma_f32 v6, v6, v124, v62
    v_fma_f32 v7, v7, v126, v63
    v_fma_f32 v8, v8, v128, v64
    v_fma_f32 v9, v9, v130, v65
    v_fma_f32 v10, v10, v132, v66
    v_fma_f32 v11, v11, v134, v67
    v_fma_f32 v12, v12, v136, v68
    v_fma_f32 v13, v13, v138, v69
    v_fma_f32 v14, v14, v140, v70
    v_fma_f32 v15, v15, v142, v71
    v_mul_f32 v56, v113, v48
    v_mul_f32 v57, v115, v48
    v_mul_f32 v58, v117, v48
    v_mul_f32 v59, v119, v48
    v_mul_f32 v60, v121, v48
    v_mul_f32 v61, v123, v48
    v_mul_f32 v62, v125, v48
    v_mul_f32 v63, v127, v48
    v_mul_f32 v64, v129, v48
    v_mul_f32 v65, v131, v48
    v_mul_f32 v66, v133, v48
    v_mul_f32 v67, v135, v48
    v_mul_f32 v68, v137, v48
    v_mul_f32 v69, v139, v48
    v_mul_f32 v70, v141, v48
    v_mul_f32 v71, v143, v48
    v_fma_f32 v16, v16, v112, v56
    v_fma_f32 v17, v17, v114, v57
    v_fma_f32 v18, v18, v116, v58
    v_fma_f32 v19, v19, v118, v59
    v_fma_f32 v20, v20, v120, v60
    v_fma_f32 v21, v21, v122, v61
    v_fma_f32 v22, v22, v124, v62
    v_fma_f32 v23, v23, v126, v63
    v_fma_f32 v24, v24, v128, v64
    v_fma_f32 v25, v25, v130, v65
    v_fma_f32 v26, v26, v132, v66
    v_fma_f32 v27, v27, v134, v67
    v_fma_f32 v28, v28, v136, v68
    v_fma_f32 v29, v29, v138, v69
    v_fma_f32 v30, v30, v140, v70
    v_fma_f32 v31, v31, v142, v71
    s_mov_b32 s48, 0x3fb8aa3b
    s_lshl_b32 s50, s32, 2
    s_add_u32 s50, s50, s41
    s_lshl_b32 s50, s50, 2
    s_lshr_b32 s51, s33, 2
    s_add_u32 s50, s50, s51
    s_mul_i32 s50, s50, 9216
    s_add_u32 s50, s50, 0
    s_and_b32 s51, s38, 3
    s_lshl_b32 s52, s41, 11
    v_add_u32 v100, s52, v96
    s_mov_b32 exec_lo, 0xf
    s_mov_b32 exec_hi, 0xf
    v_min_f32 v56, 0, v0
    v_min_f32 v57, 0, v1
    v_min_f32 v58, 0, v2
    v_min_f32 v59, 0, v3
    v_min_f32 v60, 0, v4
    v_min_f32 v61, 0, v5
    v_min_f32 v62, 0, v6
    v_min_f32 v63, 0, v7
    v_min_f32 v64, 0, v8
    v_min_f32 v65, 0, v9
    v_min_f32 v66, 0, v10
    v_min_f32 v67, 0, v11
    v_min_f32 v68, 0, v12
    v_min_f32 v69, 0, v13
    v_min_f32 v70, 0, v14
    v_min_f32 v71, 0, v15
    v_mul_f32 v56, s48, v56
    v_mul_f32 v57, s48, v57
    v_mul_f32 v58, s48, v58
    v_mul_f32 v59, s48, v59
    v_mul_f32 v60, s48, v60
    v_mul_f32 v61, s48, v61
    v_mul_f32 v62, s48, v62
    v_mul_f32 v63, s48, v63
    v_mul_f32 v64, s48, v64
    v_mul_f32 v65, s48, v65
    v_mul_f32 v66, s48, v66
    v_mul_f32 v67, s48, v67
    v_mul_f32 v68, s48, v68
    v_mul_f32 v69, s48, v69
    v_mul_f32 v70, s48, v70
    v_mul_f32 v71, s48, v71
    v_exp_f32 v56, v56
    v_exp_f32 v57, v57
    v_exp_f32 v58, v58
    v_exp_f32 v59, v59
    v_exp_f32 v60, v60
    v_exp_f32 v61, v61
    v_exp_f32 v62, v62
    v_exp_f32 v63, v63
    v_exp_f32 v64, v64
    v_exp_f32 v65, v65
    v_exp_f32 v66, v66
    v_exp_f32 v67, v67
    v_exp_f32 v68, v68
    v_exp_f32 v69, v69
    v_exp_f32 v70, v70
    v_exp_f32 v71, v71
    v_max_f32 v0, 0, v0
    v_max_f32 v1, 0, v1
    v_max_f32 v2, 0, v2
    v_max_f32 v3, 0, v3
    v_max_f32 v4, 0, v4
    v_max_f32 v5, 0, v5
    v_max_f32 v6, 0, v6
    v_max_f32 v7, 0, v7
    v_max_f32 v8, 0, v8
    v_max_f32 v9, 0, v9
    v_max_f32 v10, 0, v10
    v_max_f32 v11, 0, v11
    v_max_f32 v12, 0, v12
    v_max_f32 v13, 0, v13
    v_max_f32 v14, 0, v14
    v_max_f32 v15, 0, v15
    v_add_f32 v56, 0x358637bd, v56
    v_add_f32 v57, 0x358637bd, v57
    v_add_f32 v58, 0x358637bd, v58
    v_add_f32 v59, 0x358637bd, v59
    v_add_f32 v60, 0x358637bd, v60
    v_add_f32 v61, 0x358637bd, v61
    v_add_f32 v62, 0x358637bd, v62
    v_add_f32 v63, 0x358637bd, v63
    v_add_f32 v64, 0x358637bd, v64
    v_add_f32 v65, 0x358637bd, v65
    v_add_f32 v66, 0x358637bd, v66
    v_add_f32 v67, 0x358637bd, v67
    v_add_f32 v68, 0x358637bd, v68
    v_add_f32 v69, 0x358637bd, v69
    v_add_f32 v70, 0x358637bd, v70
    v_add_f32 v71, 0x358637bd, v71
    v_add_f32 v0, v0, v56
    v_add_f32 v1, v1, v57
    v_add_f32 v2, v2, v58
    v_add_f32 v3, v3, v59
    v_add_f32 v4, v4, v60
    v_add_f32 v5, v5, v61
    v_add_f32 v6, v6, v62
    v_add_f32 v7, v7, v63
    v_add_f32 v8, v8, v64
    v_add_f32 v9, v9, v65
    v_add_f32 v10, v10, v66
    v_add_f32 v11, v11, v67
    v_add_f32 v12, v12, v68
    v_add_f32 v13, v13, v69
    v_add_f32 v14, v14, v70
    v_add_f32 v15, v15, v71
    s_mov_b32 exec_lo, 0xf00
    s_mov_b32 exec_hi, 0xf00
    v_min_f32 v56, 0, v16
    v_min_f32 v57, 0, v17
    v_min_f32 v58, 0, v18
    v_min_f32 v59, 0, v19
    v_min_f32 v60, 0, v20
    v_min_f32 v61, 0, v21
    v_min_f32 v62, 0, v22
    v_min_f32 v63, 0, v23
    v_min_f32 v64, 0, v24
    v_min_f32 v65, 0, v25
    v_min_f32 v66, 0, v26
    v_min_f32 v67, 0, v27
    v_min_f32 v68, 0, v28
    v_min_f32 v69, 0, v29
    v_min_f32 v70, 0, v30
    v_min_f32 v71, 0, v31
    v_mul_f32 v56, s48, v56
    v_mul_f32 v57, s48, v57
    v_mul_f32 v58, s48, v58
    v_mul_f32 v59, s48, v59
    v_mul_f32 v60, s48, v60
    v_mul_f32 v61, s48, v61
    v_mul_f32 v62, s48, v62
    v_mul_f32 v63, s48, v63
    v_mul_f32 v64, s48, v64
    v_mul_f32 v65, s48, v65
    v_mul_f32 v66, s48, v66
    v_mul_f32 v67, s48, v67
    v_mul_f32 v68, s48, v68
    v_mul_f32 v69, s48, v69
    v_mul_f32 v70, s48, v70
    v_mul_f32 v71, s48, v71
    v_exp_f32 v56, v56
    v_exp_f32 v57, v57
    v_exp_f32 v58, v58
    v_exp_f32 v59, v59
    v_exp_f32 v60, v60
    v_exp_f32 v61, v61
    v_exp_f32 v62, v62
    v_exp_f32 v63, v63
    v_exp_f32 v64, v64
    v_exp_f32 v65, v65
    v_exp_f32 v66, v66
    v_exp_f32 v67, v67
    v_exp_f32 v68, v68
    v_exp_f32 v69, v69
    v_exp_f32 v70, v70
    v_exp_f32 v71, v71
    v_max_f32 v16, 0, v16
    v_max_f32 v17, 0, v17
    v_max_f32 v18, 0, v18
    v_max_f32 v19, 0, v19
    v_max_f32 v20, 0, v20
    v_max_f32 v21, 0, v21
    v_max_f32 v22, 0, v22
    v_max_f32 v23, 0, v23
    v_max_f32 v24, 0, v24
    v_max_f32 v25, 0, v25
    v_max_f32 v26, 0, v26
    v_max_f32 v27, 0, v27
    v_max_f32 v28, 0, v28
    v_max_f32 v29, 0, v29
    v_max_f32 v30, 0, v30
    v_max_f32 v31, 0, v31
    v_add_f32 v56, 0x358637bd, v56
    v_add_f32 v57, 0x358637bd, v57
    v_add_f32 v58, 0x358637bd, v58
    v_add_f32 v59, 0x358637bd, v59
    v_add_f32 v60, 0x358637bd, v60
    v_add_f32 v61, 0x358637bd, v61
    v_add_f32 v62, 0x358637bd, v62
    v_add_f32 v63, 0x358637bd, v63
    v_add_f32 v64, 0x358637bd, v64
    v_add_f32 v65, 0x358637bd, v65
    v_add_f32 v66, 0x358637bd, v66
    v_add_f32 v67, 0x358637bd, v67
    v_add_f32 v68, 0x358637bd, v68
    v_add_f32 v69, 0x358637bd, v69
    v_add_f32 v70, 0x358637bd, v70
    v_add_f32 v71, 0x358637bd, v71
    v_add_f32 v16, v16, v56
    v_add_f32 v17, v17, v57
    v_add_f32 v18, v18, v58
    v_add_f32 v19, v19, v59
    v_add_f32 v20, v20, v60
    v_add_f32 v21, v21, v61
    v_add_f32 v22, v22, v62
    v_add_f32 v23, v23, v63
    v_add_f32 v24, v24, v64
    v_add_f32 v25, v25, v65
    v_add_f32 v26, v26, v66
    v_add_f32 v27, v27, v67
    v_add_f32 v28, v28, v68
    v_add_f32 v29, v29, v69
    v_add_f32 v30, v30, v70
    v_add_f32 v31, v31, v71
    s_mov_b32 exec_lo, 0x1000
    s_mov_b32 exec_hi, 0x1000
    v_mov_b32 v16, 1.0
    v_mov_b32 v17, 1.0
    v_mov_b32 v18, 1.0
    v_mov_b32 v19, 1.0
    v_mov_b32 v20, 1.0
    v_mov_b32 v21, 1.0
    v_mov_b32 v22, 1.0
    v_mov_b32 v23, 1.0
    v_mov_b32 v24, 1.0
    v_mov_b32 v25, 1.0
    v_mov_b32 v26, 1.0
    v_mov_b32 v27, 1.0
    v_mov_b32 v28, 1.0
    v_mov_b32 v29, 1.0
    v_mov_b32 v30, 1.0
    v_mov_b32 v31, 1.0
    s_mov_b64 exec, -1
    v_cvt_pk_bf16_f32 v72, v0, v1
    v_cvt_pk_bf16_f32 v73, v2, v3
    v_cvt_pk_bf16_f32 v74, v4, v5
    v_cvt_pk_bf16_f32 v75, v6, v7
    v_cvt_pk_bf16_f32 v76, v8, v9
    v_cvt_pk_bf16_f32 v77, v10, v11
    v_cvt_pk_bf16_f32 v78, v12, v13
    v_cvt_pk_bf16_f32 v79, v14, v15
    ds_write_b128 v100, v[72:75] offset:8192
    ds_write_b128 v100, v[76:79] offset:9216
    v_cvt_pk_bf16_f32 v72, v16, v17
    v_cvt_pk_bf16_f32 v73, v18, v19
    v_cvt_pk_bf16_f32 v74, v20, v21
    v_cvt_pk_bf16_f32 v75, v22, v23
    v_cvt_pk_bf16_f32 v76, v24, v25
    v_cvt_pk_bf16_f32 v77, v26, v27
    v_cvt_pk_bf16_f32 v78, v28, v29
    v_cvt_pk_bf16_f32 v79, v30, v31
    ds_write_b128 v100, v[72:75] offset:16384
    ds_write_b128 v100, v[76:79] offset:17408
    s_waitcnt lgkmcnt(0)
    s_barrier
    v_and_b32 v103, 31, v97
    v_subrev_u32 v103, 8, v103
    v_lshlrev_b32 v103, 1, v103
    v_lshrrev_b32 v104, 5, v97
    v_lshl_add_u32 v103, v104, 6, v103
    s_lshr_b32 s53, s51, 1
    s_lshl_b32 s53, s53, 9
    s_and_b32 s54, s51, 1
    s_lshl_b32 s54, s54, 3
    s_add_u32 s53, s53, s54
    s_add_u32 s53, s53, s50
    s_add_u32 s53, s53, 8192
    s_mov_b32 exec_lo, 0xf00
    s_mov_b32 exec_hi, 0xf00
    buffer_store_short v72, v103, s[16:19], s53 offen offset:0
    buffer_store_short_d16_hi v72, v103, s[16:19], s53 offen offset:16
    buffer_store_short v73, v103, s[16:19], s53 offen offset:32
    buffer_store_short_d16_hi v73, v103, s[16:19], s53 offen offset:48
    buffer_store_short v74, v103, s[16:19], s53 offen offset:128
    buffer_store_short_d16_hi v74, v103, s[16:19], s53 offen offset:144
    buffer_store_short v75, v103, s[16:19], s53 offen offset:160
    buffer_store_short_d16_hi v75, v103, s[16:19], s53 offen offset:176
    buffer_store_short v76, v103, s[16:19], s53 offen offset:256
    buffer_store_short_d16_hi v76, v103, s[16:19], s53 offen offset:272
    buffer_store_short v77, v103, s[16:19], s53 offen offset:288
    buffer_store_short_d16_hi v77, v103, s[16:19], s53 offen offset:304
    buffer_store_short v78, v103, s[16:19], s53 offen offset:384
    buffer_store_short_d16_hi v78, v103, s[16:19], s53 offen offset:400
    buffer_store_short v79, v103, s[16:19], s53 offen offset:416
    buffer_store_short_d16_hi v79, v103, s[16:19], s53 offen offset:432
    s_mov_b64 exec, -1
    s_lshr_b32 s52, s41, 1
    s_and_b32 s53, s41, 1
    s_lshl_b32 s54, s52, 13
    v_add_u32 v100, s54, v96
    s_add_u32 s54, s53, 1
    s_lshl_b32 s54, s54, 13
    v_add_u32 v101, s54, v96
    ds_read_b128 v[112:115], v100 offset:0
    ds_read_b128 v[116:119], v101 offset:0
    ds_read_b128 v[120:123], v100 offset:1024
    ds_read_b128 v[124:127], v101 offset:1024
    ds_read_b128 v[128:131], v100 offset:2048
    ds_read_b128 v[132:135], v101 offset:2048
    ds_read_b128 v[136:139], v100 offset:3072
    ds_read_b128 v[140:143], v101 offset:3072
    ds_read_b128 v[144:147], v100 offset:4096
    ds_read_b128 v[148:151], v101 offset:4096
    ds_read_b128 v[152:155], v100 offset:5120
    ds_read_b128 v[156:159], v101 offset:5120
    ds_read_b128 v[160:163], v100 offset:6144
    ds_read_b128 v[164:167], v101 offset:6144
    ds_read_b128 v[168:171], v100 offset:7168
    ds_read_b128 v[172:175], v101 offset:7168
    v_and_b32 v32, 31, v97
    v_lshrrev_b32 v33, 5, v97
    v_mov_b32 v38, 0x40000000
    s_cmp_eq_u32 s53, 0
    s_cselect_b32 s54, -4, 28
    v_add_u32 v34, s54, v32
    v_lshlrev_b32 v35, 2, v34
    v_cmp_gt_u32 vcc, 18, v34
    s_nop 1
    v_cndmask_b32 v35, v38, v35, vcc
    v_subrev_u32 v37, 18, v34
    v_lshlrev_b32 v36, 2, v37
    v_cmp_gt_u32 vcc, 18, v37
    s_nop 1
    v_cndmask_b32 v36, v38, v36, vcc
    v_cmp_eq_u32 vcc, 40, v34
    v_mov_b32 v37, 72
    s_nop 0
    v_cndmask_b32 v35, v35, v37, vcc
    v_cndmask_b32 v36, v36, v37, vcc
    v_mul_u32_u24 v37, 320, v33
    v_add_u32 v35, v35, v37
    v_add_u32 v36, v36, v37
    v_cmp_eq_u32 vcc, 0, v33
    s_nop 1
    v_cndmask_b32 v39, v36, v35, vcc
    s_lshl_b32 s55, s33, 4
    s_add_u32 s55, s55, s32
    s_mul_i32 s55, s55, 2880
    s_add_u32 s55, s55, 4718592
    s_waitcnt lgkmcnt(14)
    v_mfma_f32_32x32x16_bf16 v[0:15], v[112:115], v[116:119], 0
    s_waitcnt lgkmcnt(12)
    v_mfma_f32_32x32x16_bf16 v[0:15], v[120:123], v[124:127], v[0:15]
    s_waitcnt lgkmcnt(10)
    v_mfma_f32_32x32x16_bf16 v[0:15], v[128:131], v[132:135], v[0:15]
    s_waitcnt lgkmcnt(8)
    v_mfma_f32_32x32x16_bf16 v[0:15], v[136:139], v[140:143], v[0:15]
    s_waitcnt lgkmcnt(6)
    v_mfma_f32_32x32x16_bf16 v[0:15], v[144:147], v[148:151], v[0:15]
    s_waitcnt lgkmcnt(4)
    v_mfma_f32_32x32x16_bf16 v[0:15], v[152:155], v[156:159], v[0:15]
    s_waitcnt lgkmcnt(2)
    v_mfma_f32_32x32x16_bf16 v[0:15], v[160:163], v[164:167], v[0:15]
    s_waitcnt lgkmcnt(0)
    v_mfma_f32_32x32x16_bf16 v[0:15], v[168:171], v[172:175], v[0:15]
    s_cmp_eq_u32 s52, 0
    s_cbranch_scc0 Lk1_kernel_kvT2
    s_nop 9
    buffer_store_dword v0, v35, s[16:19], s55 offen offset:0
    buffer_store_dword v1, v35, s[16:19], s55 offen offset:80
    buffer_store_dword v2, v35, s[16:19], s55 offen offset:160
    buffer_store_dword v3, v35, s[16:19], s55 offen offset:240
    buffer_store_dword v4, v35, s[16:19], s55 offen offset:640
    buffer_store_dword v5, v35, s[16:19], s55 offen offset:720
    buffer_store_dword v6, v35, s[16:19], s55 offen offset:800
    buffer_store_dword v7, v35, s[16:19], s55 offen offset:880
    buffer_store_dword v8, v39, s[16:19], s55 offen offset:1280
    buffer_store_dword v9, v39, s[16:19], s55 offen offset:1360
    buffer_store_dword v10, v36, s[16:19], s55 offen offset:1440
    buffer_store_dword v11, v36, s[16:19], s55 offen offset:1520
    buffer_store_dword v12, v36, s[16:19], s55 offen offset:1920
    buffer_store_dword v13, v36, s[16:19], s55 offen offset:2000
    buffer_store_dword v14, v36, s[16:19], s55 offen offset:2080
    buffer_store_dword v15, v36, s[16:19], s55 offen offset:2160
    s_branch Lk1_kernel_nokv
Lk1_kernel_kvT2:
    s_nop 15
    s_nop 3
    s_mov_b32 exec_hi, 0
    buffer_store_dword v0, v36, s[16:19], s55 offen offset:2560
    buffer_store_dword v1, v36, s[16:19], s55 offen offset:2640
    buffer_store_dword v2, v36, s[16:19], s55 offen offset:2720
    buffer_store_dword v3, v36, s[16:19], s55 offen offset:2800
    s_mov_b64 exec, -1
Lk1_kernel_nokv:
Lk1_kernel_fin:
Lk1_kernel_end:
    s_endpgm

.globl k2_kernel
.p2align 8
.type k2_kernel,@function
k2_kernel:

    s_cmp_ge_u32 s2, 256
    s_cbranch_scc1 Lk2_kernel_end
    s_load_dwordx2 s[4:5], s[0:1], 0
    s_load_dwordx2 s[6:7], s[0:1], 16
    s_load_dwordx4 s[24:27], s[0:1], 32
    s_load_dwordx2 s[22:23], s[0:1], 72
    s_load_dwordx2 s[28:29], s[0:1], 48
    v_lshrrev_b32 v234, 6, v0
    s_nop 0
    v_readfirstlane_b32 s30, v234
    v_and_b32 v226, 63, v0
    v_lshlrev_b32 v225, 4, v226
    s_waitcnt lgkmcnt(0)
    s_mov_b32 s16, s22
    s_mov_b32 s17, s23
    s_mov_b32 s18, 268435456
    s_mov_b32 s19, 0x20000
    s_cmp_lt_u32 s2, 64
    s_cbranch_scc1 Lk2_kernel_cs
    s_sub_u32 s3, s2, 64
    s_mov_b32 s8, s4
    s_mov_b32 s9, s5
    s_mov_b32 s10, 2359296
    s_mov_b32 s11, 0x20000
    s_mov_b32 s12, s6
    s_mov_b32 s13, s7
    s_mov_b32 s14, 663552
    s_mov_b32 s15, 0x20000
    s_and_b32 s31, s3, 7
    s_lshr_b32 s34, s3, 3
    s_lshr_b32 s32, s31, 1
    s_lshl_b32 s32, s32, 3
    s_and_b32 s36, s34, 7
    s_add_u32 s32, s32, s36
    s_and_b32 s33, s31, 1
    s_mul_i32 s33, s33, 3
    s_lshr_b32 s36, s34, 3
    s_add_u32 s33, s33, s36
    s_and_b32 s41, s30, 1
    s_lshr_b32 s39, s30, 1
    s_lshl_b32 s35, s32, 1
    s_add_u32 s35, s35, s41
    s_lshl_b32 s40, s35, 2
    s_add_u32 s40, s40, s39
    s_mul_i32 s40, s40, 9216
    s_add_u32 s40, s40, 0
    buffer_load_dwordx4 v[0:3], v225, s[16:19], s40 offen offset:0
    buffer_load_dwordx4 v[4:7], v225, s[16:19], s40 offen offset:1024
    buffer_load_dwordx4 v[8:11], v225, s[16:19], s40 offen offset:2048
    buffer_load_dwordx4 v[12:15], v225, s[16:19], s40 offen offset:3072
    s_add_u32 s40, s40, 4096
    buffer_load_dwordx4 v[16:19], v225, s[16:19], s40 offen offset:0
    buffer_load_dwordx4 v[20:23], v225, s[16:19], s40 offen offset:1024
    buffer_load_dwordx4 v[24:27], v225, s[16:19], s40 offen offset:2048
    buffer_load_dwordx4 v[28:31], v225, s[16:19], s40 offen offset:3072
    s_add_u32 s40, s40, 4096
    buffer_load_dwordx4 v[32:35], v225, s[16:19], s40 offen offset:0
    v_lshrrev_b32 v234, 4, v226
    v_bfe_u32 v235, v226, 2, 2
    v_xor_b32 v235, v235, v234
    v_and_b32 v236, 3, v226
    v_lshl_add_u32 v235, v235, 2, v236
    v_mul_u32_u24 v234, 1152, v234
    v_lshl_add_u32 v237, v235, 4, v234
    s_mul_i32 s42, s33, 192
    s_and_b32 s43, s42, 0xffffff80
    s_sub_u32 s42, s42, s43
    s_mul_i32 s44, s30, 4608
    s_add_u32 s44, s44, s43
    s_lshl_b32 s45, s30, 10
    s_add_u32 m0, s45, 0
    s_nop 0
    buffer_load_dwordx4 v237, s[12:15], s44 offen lds
    s_add_u32 s44, s44, 36864
    s_add_u32 m0, s45, 8192
    s_nop 0
    buffer_load_dwordx4 v237, s[12:15], s44 offen lds
    s_add_u32 s44, s44, 36864
    s_add_u32 m0, s45, 16384
    s_nop 0
    buffer_load_dwordx4 v237, s[12:15], s44 offen lds
    s_add_u32 s44, s44, 36864
    s_add_u32 m0, s45, 24576
    s_nop 0
    buffer_load_dwordx4 v237, s[12:15], s44 offen lds
    s_add_u32 s44, s44, 36864
    s_add_u32 m0, s45, 32768
    s_nop 0
    buffer_load_dwordx4 v237, s[12:15], s44 offen lds
    s_add_u32 s44, s44, 36864
    s_add_u32 m0, s45, 40960
    s_nop 0
    buffer_load_dwordx4 v237, s[12:15], s44 offen lds
    s_add_u32 s44, s44, 36864
    s_add_u32 m0, s45, 49152
    s_nop 0
    buffer_load_dwordx4 v237, s[12:15], s44 offen lds
    s_add_u32 s44, s44, 36864
    s_add_u32 m0, s45, 57344
    s_nop 0
    buffer_load_dwordx4 v237, s[12:15], s44 offen lds
    s_add_u32 s44, s44, 36864
    s_add_u32 m0, s45, 65536
    s_nop 0
    buffer_load_dwordx4 v237, s[12:15], s44 offen lds
    s_add_u32 s44, s44, 36864
    s_add_u32 m0, s45, 73728
    s_nop 0
    buffer_load_dwordx4 v237, s[12:15], s44 offen lds
    s_add_u32 s44, s44, 36864
    s_add_u32 m0, s45, 81920
    s_nop 0
    buffer_load_dwordx4 v237, s[12:15], s44 offen lds
    s_add_u32 s44, s44, 36864
    s_add_u32 m0, s45, 90112
    s_nop 0
    buffer_load_dwordx4 v237, s[12:15], s44 offen lds
    s_add_u32 s44, s44, 36864
    s_add_u32 m0, s45, 98304
    s_nop 0
    buffer_load_dwordx4 v237, s[12:15], s44 offen lds
    s_add_u32 s44, s44, 36864
    s_add_u32 m0, s45, 106496
    s_nop 0
    buffer_load_dwordx4 v237, s[12:15], s44 offen lds
    s_add_u32 s44, s44, 36864
    s_add_u32 m0, s45, 114688
    s_nop 0
    buffer_load_dwordx4 v237, s[12:15], s44 offen lds
    s_add_u32 s44, s44, 36864
    s_add_u32 m0, s45, 122880
    s_nop 0
    buffer_load_dwordx4 v237, s[12:15], s44 offen lds
    s_add_u32 s44, s44, 36864
    s_add_u32 m0, s45, 131072
    s_nop 0
    buffer_load_dwordx4 v237, s[12:15], s44 offen lds
    s_add_u32 s44, s44, 36864
    s_add_u32 m0, s45, 139264
    s_nop 0
    buffer_load_dwordx4 v237, s[12:15], s44 offen lds
    s_add_u32 s44, s44, 36864
    v_and_b32 v234, 31, v226
    v_mul_u32_u24 v234, 1152, v234
    v_lshrrev_b32 v235, 5, v226
    v_lshl_add_u32 v234, v235, 3, v234
    s_mul_i32 s46, s35, 36864
    s_mul_i32 s47, s33, 192
    s_add_u32 s46, s46, s47
    s_mul_i32 s47, s39, 48
    s_add_u32 s46, s46, s47
    buffer_load_dwordx2 v[228:229], v234, s[8:11], s46 offen offset:0
    buffer_load_dwordx2 v[230:231], v234, s[8:11], s46 offen offset:16
    buffer_load_dwordx2 v[232:233], v234, s[8:11], s46 offen offset:32
    v_lshrrev_b32 v234, 5, v226
    v_bfe_u32 v235, v226, 4, 1
    v_bfe_u32 v236, v226, 2, 2
    v_and_b32 v238, 3, v226
    v_lshlrev_b32 v239, 5, v235
    v_lshl_add_u32 v239, v238, 3, v239
    s_mul_i32 s46, s39, 36864
    v_add_u32 v239, s46, v239
    s_lshr_b32 s42, s42, 6
    v_add_u32 v240, 0, v236
    v_and_b32 v240, 3, v240
    s_add_u32 s47, s42, 0
    v_xor_b32 v240, s47, v240
    v_lshl_add_u32 v216, v240, 6, v239
    v_lshl_add_u32 v240, v234, 3, v236
    v_lshl_add_u32 v216, v240, 8, v216
    v_add_u32 v240, 0, v236
    v_and_b32 v240, 3, v240
    s_add_u32 s47, s42, 1
    v_xor_b32 v240, s47, v240
    v_lshl_add_u32 v217, v240, 6, v239
    v_lshl_add_u32 v240, v234, 3, v236
    v_lshl_add_u32 v217, v240, 8, v217
    v_add_u32 v240, 0, v236
    v_and_b32 v240, 3, v240
    s_add_u32 s47, s42, 2
    v_xor_b32 v240, s47, v240
    v_lshl_add_u32 v218, v240, 6, v239
    v_lshl_add_u32 v240, v234, 3, v236
    v_lshl_add_u32 v218, v240, 8, v218
    v_add_u32 v240, 2, v236
    v_and_b32 v240, 3, v240
    s_add_u32 s47, s42, 0
    v_xor_b32 v240, s47, v240
    v_lshl_add_u32 v219, v240, 6, v239
    v_lshl_add_u32 v240, v234, 3, v236
    v_lshl_add_u32 v219, v240, 8, v219
    v_add_u32 v240, 2, v236
    v_and_b32 v240, 3, v240
    s_add_u32 s47, s42, 1
    v_xor_b32 v240, s47, v240
    v_lshl_add_u32 v220, v240, 6, v239
    v_lshl_add_u32 v240, v234, 3, v236
    v_lshl_add_u32 v220, v240, 8, v220
    v_add_u32 v240, 2, v236
    v_and_b32 v240, 3, v240
    s_add_u32 s47, s42, 2
    v_xor_b32 v240, s47, v240
    v_lshl_add_u32 v221, v240, 6, v239
    v_lshl_add_u32 v240, v234, 3, v236
    v_lshl_add_u32 v221, v240, 8, v221
    v_lshl_add_u32 v240, v236, 1, v234
    v_and_b32 v240, 3, v240
    s_add_u32 s47, s42, 0
    v_xor_b32 v240, s47, v240
    v_lshl_add_u32 v222, v240, 6, v239
    v_mul_u32_u24 v240, 18, v236
    v_add3_u32 v240, v240, v234, 16
    v_lshl_add_u32 v222, v240, 8, v222
    v_lshl_add_u32 v240, v236, 1, v234
    v_and_b32 v240, 3, v240
    s_add_u32 s47, s42, 1
    v_xor_b32 v240, s47, v240
    v_lshl_add_u32 v223, v240, 6, v239
    v_mul_u32_u24 v240, 18, v236
    v_add3_u32 v240, v240, v234, 16
    v_lshl_add_u32 v223, v240, 8, v223
    v_lshl_add_u32 v240, v236, 1, v234
    v_and_b32 v240, 3, v240
    s_add_u32 s47, s42, 2
    v_xor_b32 v240, s47, v240
    v_lshl_add_u32 v224, v240, 6, v239
    v_mul_u32_u24 v240, 18, v236
    v_add3_u32 v240, v240, v234, 16
    v_lshl_add_u32 v224, v240, 8, v224
    v_mov_b32 v168, 0
    v_mov_b32 v169, 0
    v_mov_b32 v170, 0
    v_mov_b32 v171, 0
    v_mov_b32 v172, 0
    v_mov_b32 v173, 0
    v_mov_b32 v174, 0
    v_mov_b32 v175, 0
    v_mov_b32 v176, 0
    v_mov_b32 v177, 0
    v_mov_b32 v178, 0
    v_mov_b32 v179, 0
    v_mov_b32 v180, 0
    v_mov_b32 v181, 0
    v_mov_b32 v182, 0
    v_mov_b32 v183, 0
    v_mov_b32 v184, 0
    v_mov_b32 v185, 0
    v_mov_b32 v186, 0
    v_mov_b32 v187, 0
    v_mov_b32 v188, 0
    v_mov_b32 v189, 0
    v_mov_b32 v190, 0
    v_mov_b32 v191, 0
    v_mov_b32 v192, 0
    v_mov_b32 v193, 0
    v_mov_b32 v194, 0
    v_mov_b32 v195, 0
    v_mov_b32 v196, 0
    v_mov_b32 v197, 0
    v_mov_b32 v198, 0
    v_mov_b32 v199, 0
    v_mov_b32 v200, 0
    v_mov_b32 v201, 0
    v_mov_b32 v202, 0
    v_mov_b32 v203, 0
    v_mov_b32 v204, 0
    v_mov_b32 v205, 0
    v_mov_b32 v206, 0
    v_mov_b32 v207, 0
    v_mov_b32 v208, 0
    v_mov_b32 v209, 0
    v_mov_b32 v210, 0
    v_mov_b32 v211, 0
    v_mov_b32 v212, 0
    v_mov_b32 v213, 0
    v_mov_b32 v214, 0
    v_mov_b32 v215, 0
    s_cmp_lg_u32 s30, 0
    s_cbranch_scc1 Lk2_kernel_nopoll
    s_and_b32 s46, s2, 7
    s_lshl_b32 s46, s46, 7
    s_add_u32 s46, s46, 14483456
    v_lshlrev_b32 v234, 2, v226
    s_mov_b64 exec, 0xffff
Lk2_kernel_poll:
    buffer_load_dword v235, v234, s[16:19], s46 offen sc1
    s_waitcnt vmcnt(0)
    v_cmp_ne_u32 vcc, 1, v235
    s_nop 4
    s_cbranch_vccz Lk2_kernel_polld
    s_sleep 2
    s_branch Lk2_kernel_poll
Lk2_kernel_polld:
    s_mov_b64 exec, -1
Lk2_kernel_nopoll:
    s_barrier
    s_lshl_b32 s40, s39, 14
    s_add_u32 s40, s40, 5455872
    buffer_load_dwordx4 v[36:39], v225, s[16:19], s40 offen offset:0 sc1
    buffer_load_dwordx4 v[40:43], v225, s[16:19], s40 offen offset:1024 sc1
    buffer_load_dwordx4 v[44:47], v225, s[16:19], s40 offen offset:2048 sc1
    buffer_load_dwordx4 v[48:51], v225, s[16:19], s40 offen offset:3072 sc1
    s_add_u32 s40, s40, 4096
    buffer_load_dwordx4 v[52:55], v225, s[16:19], s40 offen offset:0 sc1
    buffer_load_dwordx4 v[56:59], v225, s[16:19], s40 offen offset:1024 sc1
    buffer_load_dwordx4 v[60:63], v225, s[16:19], s40 offen offset:2048 sc1
    buffer_load_dwordx4 v[64:67], v225, s[16:19], s40 offen offset:3072 sc1
    s_add_u32 s40, s40, 4096
    buffer_load_dwordx4 v[68:71], v225, s[16:19], s40 offen offset:0 sc1
    buffer_load_dwordx4 v[72:75], v225, s[16:19], s40 offen offset:1024 sc1
    buffer_load_dwordx4 v[76:79], v225, s[16:19], s40 offen offset:2048 sc1
    buffer_load_dwordx4 v[80:83], v225, s[16:19], s40 offen offset:3072 sc1
    s_add_u32 s40, s40, 4096
    buffer_load_dwordx4 v[84:87], v225, s[16:19], s40 offen offset:0 sc1
    buffer_load_dwordx4 v[88:91], v225, s[16:19], s40 offen offset:1024 sc1
    buffer_load_dwordx4 v[92:95], v225, s[16:19], s40 offen offset:2048 sc1
    buffer_load_dwordx4 v[96:99], v225, s[16:19], s40 offen offset:3072 sc1
    s_waitcnt vmcnt(14)
    v_mfma_f32_32x32x16_bf16 v[100:115], v[36:39], v[0:3], 0
    v_mfma_f32_32x32x16_bf16 v[100:115], v[40:43], v[4:7], v[100:115]
    s_waitcnt vmcnt(12)
    v_mfma_f32_32x32x16_bf16 v[116:131], v[44:47], v[4:7], 0
    v_mfma_f32_32x32x16_bf16 v[116:131], v[48:51], v[32:35], v[116:131]
    s_nop 8
    v_add_f32 v109, 0x358637bd, v109
    v_rcp_f32 v109, v109
    s_nop 0
    v_mul_f32 v100, v100, v109
    v_mul_f32 v101, v101, v109
    v_mul_f32 v102, v102, v109
    v_mul_f32 v103, v103, v109
    v_mul_f32 v104, v104, v109
    v_mul_f32 v105, v105, v109
    v_mul_f32 v106, v106, v109
    v_mul_f32 v107, v107, v109
    v_mul_f32 v242, v108, v109
    v_cvt_pk_bf16_f32 v132, v100, v101
    v_cvt_pk_bf16_f32 v133, v102, v103
    v_cvt_pk_bf16_f32 v134, v104, v105
    v_cvt_pk_bf16_f32 v135, v106, v107
    s_waitcnt vmcnt(10)
    v_mfma_f32_32x32x16_bf16 v[100:115], v[52:55], v[8:11], 0
    v_mfma_f32_32x32x16_bf16 v[100:115], v[56:59], v[12:15], v[100:115]
    v_add_f32 v125, 0x358637bd, v125
    v_rcp_f32 v125, v125
    s_nop 0
    v_mul_f32 v116, v116, v125
    v_mul_f32 v117, v117, v125
    v_mul_f32 v118, v118, v125
    v_mul_f32 v119, v119, v125
    v_mul_f32 v120, v120, v125
    v_mul_f32 v121, v121, v125
    v_mul_f32 v122, v122, v125
    v_mul_f32 v123, v123, v125
    v_mul_f32 v243, v124, v125
    v_cvt_pk_bf16_f32 v136, v116, v117
    v_cvt_pk_bf16_f32 v137, v118, v119
    v_cvt_pk_bf16_f32 v138, v120, v121
    v_cvt_pk_bf16_f32 v139, v122, v123
    s_waitcnt vmcnt(8)
    v_mfma_f32_32x32x16_bf16 v[116:131], v[60:63], v[12:15], 0
    v_mfma_f32_32x32x16_bf16 v[116:131], v[64:67], v[32:35], v[116:131]
    v_add_f32 v109, 0x358637bd, v109
    v_rcp_f32 v109, v109
    s_nop 0
    v_mul_f32 v100, v100, v109
    v_mul_f32 v101, v101, v109
    v_mul_f32 v102, v102, v109
    v_mul_f32 v103, v103, v109
    v_mul_f32 v104, v104, v109
    v_mul_f32 v105, v105, v109
    v_mul_f32 v106, v106, v109
    v_mul_f32 v107, v107, v109
    v_mul_f32 v244, v108, v109
    v_cvt_pk_bf16_f32 v140, v100, v101
    v_cvt_pk_bf16_f32 v141, v102, v103
    v_cvt_pk_bf16_f32 v142, v104, v105
    v_cvt_pk_bf16_f32 v143, v106, v107
    s_waitcnt vmcnt(6)
    v_mfma_f32_32x32x16_bf16 v[100:115], v[68:71], v[16:19], 0
    v_mfma_f32_32x32x16_bf16 v[100:115], v[72:75], v[20:23], v[100:115]
    v_add_f32 v125, 0x358637bd, v125
    v_rcp_f32 v125, v125
    s_nop 0
    v_mul_f32 v116, v116, v125
    v_mul_f32 v117, v117, v125
    v_mul_f32 v118, v118, v125
    v_mul_f32 v119, v119, v125
    v_mul_f32 v120, v120, v125
    v_mul_f32 v121, v121, v125
    v_mul_f32 v122, v122, v125
    v_mul_f32 v123, v123, v125
    v_mul_f32 v245, v124, v125
    v_cvt_pk_bf16_f32 v144, v116, v117
    v_cvt_pk_bf16_f32 v145, v118, v119
    v_cvt_pk_bf16_f32 v146, v120, v121
    v_cvt_pk_bf16_f32 v147, v122, v123
    s_waitcnt vmcnt(4)
    v_mfma_f32_32x32x16_bf16 v[116:131], v[76:79], v[20:23], 0
    v_mfma_f32_32x32x16_bf16 v[116:131], v[80:83], v[32:35], v[116:131]
    v_add_f32 v109, 0x358637bd, v109
    v_rcp_f32 v109, v109
    s_nop 0
    v_mul_f32 v100, v100, v109
    v_mul_f32 v101, v101, v109
    v_mul_f32 v102, v102, v109
    v_mul_f32 v103, v103, v109
    v_mul_f32 v104, v104, v109
    v_mul_f32 v105, v105, v109
    v_mul_f32 v106, v106, v109
    v_mul_f32 v107, v107, v109
    v_mul_f32 v246, v108, v109
    v_cvt_pk_bf16_f32 v148, v100, v101
    v_cvt_pk_bf16_f32 v149, v102, v103
    v_cvt_pk_bf16_f32 v150, v104, v105
    v_cvt_pk_bf16_f32 v151, v106, v107
    s_waitcnt vmcnt(2)
    v_mfma_f32_32x32x16_bf16 v[100:115], v[84:87], v[24:27], 0
    v_mfma_f32_32x32x16_bf16 v[100:115], v[88:91], v[28:31], v[100:115]
    v_add_f32 v125, 0x358637bd, v125
    v_rcp_f32 v125, v125
    s_nop 0
    v_mul_f32 v116, v116, v125
    v_mul_f32 v117, v117, v125
    v_mul_f32 v118, v118, v125
    v_mul_f32 v119, v119, v125
    v_mul_f32 v120, v120, v125
    v_mul_f32 v121, v121, v125
    v_mul_f32 v122, v122, v125
    v_mul_f32 v123, v123, v125
    v_mul_f32 v247, v124, v125
    v_cvt_pk_bf16_f32 v152, v116, v117
    v_cvt_pk_bf16_f32 v153, v118, v119
    v_cvt_pk_bf16_f32 v154, v120, v121
    v_cvt_pk_bf16_f32 v155, v122, v123
    s_waitcnt vmcnt(0)
    v_mfma_f32_32x32x16_bf16 v[116:131], v[92:95], v[28:31], 0
    v_mfma_f32_32x32x16_bf16 v[116:131], v[96:99], v[32:35], v[116:131]
    v_add_f32 v109, 0x358637bd, v109
    v_rcp_f32 v109, v109
    s_nop 0
    v_mul_f32 v100, v100, v109
    v_mul_f32 v101, v101, v109
    v_mul_f32 v102, v102, v109
    v_mul_f32 v103, v103, v109
    v_mul_f32 v104, v104, v109
    v_mul_f32 v105, v105, v109
    v_mul_f32 v106, v106, v109
    v_mul_f32 v107, v107, v109
    v_mul_f32 v248, v108, v109
    v_cvt_pk_bf16_f32 v156, v100, v101
    v_cvt_pk_bf16_f32 v157, v102, v103
    v_cvt_pk_bf16_f32 v158, v104, v105
    v_cvt_pk_bf16_f32 v159, v106, v107
    v_add_f32 v125, 0x358637bd, v125
    v_rcp_f32 v125, v125
    s_nop 0
    v_mul_f32 v116, v116, v125
    v_mul_f32 v117, v117, v125
    v_mul_f32 v118, v118, v125
    v_mul_f32 v119, v119, v125
    v_mul_f32 v120, v120, v125
    v_mul_f32 v121, v121, v125
    v_mul_f32 v122, v122, v125
    v_mul_f32 v123, v123, v125
    v_mul_f32 v249, v124, v125
    v_cvt_pk_bf16_f32 v160, v116, v117
    v_cvt_pk_bf16_f32 v161, v118, v119
    v_cvt_pk_bf16_f32 v162, v120, v121
    v_cvt_pk_bf16_f32 v163, v122, v123
    v_cvt_pk_bf16_f32 v164, v242, v243
    v_cvt_pk_bf16_f32 v165, v244, v245
    v_cvt_pk_bf16_f32 v166, v246, v247
    v_cvt_pk_bf16_f32 v167, v248, v249
    s_barrier
    ds_read_b64_tr_b16 v[36:37], v216 offset:0
    ds_read_b64_tr_b16 v[38:39], v216 offset:1024
    ds_read_b64_tr_b16 v[40:41], v217 offset:0
    ds_read_b64_tr_b16 v[42:43], v217 offset:1024
    ds_read_b64_tr_b16 v[44:45], v218 offset:0
    ds_read_b64_tr_b16 v[46:47], v218 offset:1024
    ds_read_b64_tr_b16 v[48:49], v219 offset:4608
    ds_read_b64_tr_b16 v[50:51], v219 offset:5632
    ds_read_b64_tr_b16 v[52:53], v220 offset:4608
    ds_read_b64_tr_b16 v[54:55], v220 offset:5632
    s_waitcnt lgkmcnt(8)
    v_mfma_f32_32x32x16_bf16 v[168:183], v[36:39], v[132:135], v[168:183]
    ds_read_b64_tr_b16 v[56:57], v221 offset:4608
    ds_read_b64_tr_b16 v[58:59], v221 offset:5632
    s_waitcnt lgkmcnt(8)
    v_mfma_f32_32x32x16_bf16 v[184:199], v[40:43], v[132:135], v[184:199]
    ds_read_b64_tr_b16 v[60:61], v216 offset:9216
    ds_read_b64_tr_b16 v[62:63], v216 offset:10240
    s_waitcnt lgkmcnt(8)
    v_mfma_f32_32x32x16_bf16 v[200:215], v[44:47], v[132:135], v[200:215]
    ds_read_b64_tr_b16 v[64:65], v217 offset:9216
    ds_read_b64_tr_b16 v[66:67], v217 offset:10240
    s_waitcnt lgkmcnt(8)
    v_mfma_f32_32x32x16_bf16 v[168:183], v[48:51], v[136:139], v[168:183]
    ds_read_b64_tr_b16 v[36:37], v218 offset:9216
    ds_read_b64_tr_b16 v[38:39], v218 offset:10240
    s_waitcnt lgkmcnt(8)
    v_mfma_f32_32x32x16_bf16 v[184:199], v[52:55], v[136:139], v[184:199]
    ds_read_b64_tr_b16 v[40:41], v219 offset:13824
    ds_read_b64_tr_b16 v[42:43], v219 offset:14848
    s_waitcnt lgkmcnt(8)
    v_mfma_f32_32x32x16_bf16 v[200:215], v[56:59], v[136:139], v[200:215]
    ds_read_b64_tr_b16 v[44:45], v220 offset:13824
    ds_read_b64_tr_b16 v[46:47], v220 offset:14848
    s_waitcnt lgkmcnt(8)
    v_mfma_f32_32x32x16_bf16 v[168:183], v[60:63], v[140:143], v[168:183]
    ds_read_b64_tr_b16 v[48:49], v221 offset:13824
    ds_read_b64_tr_b16 v[50:51], v221 offset:14848
    s_waitcnt lgkmcnt(8)
    v_mfma_f32_32x32x16_bf16 v[184:199], v[64:67], v[140:143], v[184:199]
    ds_read_b64_tr_b16 v[52:53], v216 offset:18432
    ds_read_b64_tr_b16 v[54:55], v216 offset:19456
    s_waitcnt lgkmcnt(8)
    v_mfma_f32_32x32x16_bf16 v[200:215], v[36:39], v[140:143], v[200:215]
    ds_read_b64_tr_b16 v[56:57], v217 offset:18432
    ds_read_b64_tr_b16 v[58:59], v217 offset:19456
    s_waitcnt lgkmcnt(8)
    v_mfma_f32_32x32x16_bf16 v[168:183], v[40:43], v[144:147], v[168:183]
    ds_read_b64_tr_b16 v[60:61], v218 offset:18432
    ds_read_b64_tr_b16 v[62:63], v218 offset:19456
    s_waitcnt lgkmcnt(8)
    v_mfma_f32_32x32x16_bf16 v[184:199], v[44:47], v[144:147], v[184:199]
    ds_read_b64_tr_b16 v[64:65], v219 offset:23040
    ds_read_b64_tr_b16 v[66:67], v219 offset:24064
    s_waitcnt lgkmcnt(8)
    v_mfma_f32_32x32x16_bf16 v[200:215], v[48:51], v[144:147], v[200:215]
    ds_read_b64_tr_b16 v[36:37], v220 offset:23040
    ds_read_b64_tr_b16 v[38:39], v220 offset:24064
    s_waitcnt lgkmcnt(8)
    v_mfma_f32_32x32x16_bf16 v[168:183], v[52:55], v[148:151], v[168:183]
    ds_read_b64_tr_b16 v[40:41], v221 offset:23040
    ds_read_b64_tr_b16 v[42:43], v221 offset:24064
    s_waitcnt lgkmcnt(8)
    v_mfma_f32_32x32x16_bf16 v[184:199], v[56:59], v[148:151], v[184:199]
    ds_read_b64_tr_b16 v[44:45], v216 offset:27648
    ds_read_b64_tr_b16 v[46:47], v216 offset:28672
    s_waitcnt lgkmcnt(8)
    v_mfma_f32_32x32x16_bf16 v[200:215], v[60:63], v[148:151], v[200:215]
    ds_read_b64_tr_b16 v[48:49], v217 offset:27648
    ds_read_b64_tr_b16 v[50:51], v217 offset:28672
    s_waitcnt lgkmcnt(8)
    v_mfma_f32_32x32x16_bf16 v[168:183], v[64:67], v[152:155], v[168:183]
    ds_read_b64_tr_b16 v[52:53], v218 offset:27648
    ds_read_b64_tr_b16 v[54:55], v218 offset:28672
    s_waitcnt lgkmcnt(8)
    v_mfma_f32_32x32x16_bf16 v[184:199], v[36:39], v[152:155], v[184:199]
    ds_read_b64_tr_b16 v[56:57], v219 offset:32256
    ds_read_b64_tr_b16 v[58:59], v219 offset:33280
    s_waitcnt lgkmcnt(8)
    v_mfma_f32_32x32x16_bf16 v[200:215], v[40:43], v[152:155], v[200:215]
    ds_read_b64_tr_b16 v[60:61], v220 offset:32256
    ds_read_b64_tr_b16 v[62:63], v220 offset:33280
    s_waitcnt lgkmcnt(8)
    v_mfma_f32_32x32x16_bf16 v[168:183], v[44:47], v[156:159], v[168:183]
    ds_read_b64_tr_b16 v[64:65], v221 offset:32256
    ds_read_b64_tr_b16 v[66:67], v221 offset:33280
    s_waitcnt lgkmcnt(8)
    v_mfma_f32_32x32x16_bf16 v[184:199], v[48:51], v[156:159], v[184:199]
    ds_read_b64_tr_b16 v[36:37], v222 offset:0
    ds_read_b64_tr_b16 v[38:39], v222 offset:18432
    s_waitcnt lgkmcnt(8)
    v_mfma_f32_32x32x16_bf16 v[200:215], v[52:55], v[156:159], v[200:215]
    ds_read_b64_tr_b16 v[40:41], v223 offset:0
    ds_read_b64_tr_b16 v[42:43], v223 offset:18432
    s_waitcnt lgkmcnt(8)
    v_mfma_f32_32x32x16_bf16 v[168:183], v[56:59], v[160:163], v[168:183]
    ds_read_b64_tr_b16 v[44:45], v224 offset:0
    ds_read_b64_tr_b16 v[46:47], v224 offset:18432
    s_waitcnt lgkmcnt(8)
    v_mfma_f32_32x32x16_bf16 v[184:199], v[60:63], v[160:163], v[184:199]
    s_waitcnt lgkmcnt(6)
    v_mfma_f32_32x32x16_bf16 v[200:215], v[64:67], v[160:163], v[200:215]
    s_waitcnt lgkmcnt(4)
    v_mfma_f32_32x32x16_bf16 v[168:183], v[36:39], v[164:167], v[168:183]
    s_waitcnt lgkmcnt(2)
    v_mfma_f32_32x32x16_bf16 v[184:199], v[40:43], v[164:167], v[184:199]
    s_waitcnt lgkmcnt(0)
    v_mfma_f32_32x32x16_bf16 v[200:215], v[44:47], v[164:167], v[200:215]
    s_barrier
    s_lshl_b32 s46, s41, 2
    s_add_u32 s46, s46, s39
    s_mul_i32 s46, s46, 12288
    v_add_u32 v234, s46, v225
    s_nop 2
    ds_write_b128 v234, v[168:171] offset:0
    ds_write_b128 v234, v[172:175] offset:1024
    ds_write_b128 v234, v[176:179] offset:2048
    ds_write_b128 v234, v[180:183] offset:3072
    ds_write_b128 v234, v[184:187] offset:4096
    ds_write_b128 v234, v[188:191] offset:5120
    ds_write_b128 v234, v[192:195] offset:6144
    ds_write_b128 v234, v[196:199] offset:7168
    ds_write_b128 v234, v[200:203] offset:8192
    ds_write_b128 v234, v[204:207] offset:9216
    ds_write_b128 v234, v[208:211] offset:10240
    ds_write_b128 v234, v[212:215] offset:11264
    s_waitcnt lgkmcnt(0)
    s_barrier
    s_mul_i32 s46, s41, 49152
    s_mul_i32 s47, s39, 3072
    s_add_u32 s46, s46, s47
    v_add_u32 v234, s46, v225
    ds_read_b128 v[0:3], v234 offset:0
    ds_read_b128 v[4:7], v234 offset:1024
    ds_read_b128 v[8:11], v234 offset:2048
    ds_read_b128 v[12:15], v234 offset:12288
    ds_read_b128 v[16:19], v234 offset:13312
    ds_read_b128 v[20:23], v234 offset:14336
    ds_read_b128 v[24:27], v234 offset:24576
    ds_read_b128 v[28:31], v234 offset:25600
    ds_read_b128 v[32:35], v234 offset:26624
    ds_read_b128 v[36:39], v234 offset:36864
    ds_read_b128 v[40:43], v234 offset:37888
    ds_read_b128 v[44:47], v234 offset:38912
    s_waitcnt lgkmcnt(0)
    v_add_f32 v0, v0, v12
    v_add_f32 v1, v1, v13
    v_add_f32 v2, v2, v14
    v_add_f32 v3, v3, v15
    v_add_f32 v4, v4, v16
    v_add_f32 v5, v5, v17
    v_add_f32 v6, v6, v18
    v_add_f32 v7, v7, v19
    v_add_f32 v8, v8, v20
    v_add_f32 v9, v9, v21
    v_add_f32 v10, v10, v22
    v_add_f32 v11, v11, v23
    v_add_f32 v0, v0, v24
    v_add_f32 v1, v1, v25
    v_add_f32 v2, v2, v26
    v_add_f32 v3, v3, v27
    v_add_f32 v4, v4, v28
    v_add_f32 v5, v5, v29
    v_add_f32 v6, v6, v30
    v_add_f32 v7, v7, v31
    v_add_f32 v8, v8, v32
    v_add_f32 v9, v9, v33
    v_add_f32 v10, v10, v34
    v_add_f32 v11, v11, v35
    v_add_f32 v0, v0, v36
    v_add_f32 v1, v1, v37
    v_add_f32 v2, v2, v38
    v_add_f32 v3, v3, v39
    v_add_f32 v4, v4, v40
    v_add_f32 v5, v5, v41
    v_add_f32 v6, v6, v42
    v_add_f32 v7, v7, v43
    v_add_f32 v8, v8, v44
    v_add_f32 v9, v9, v45
    v_add_f32 v10, v10, v46
    v_add_f32 v11, v11, v47
    v_lshlrev_b32 v235, 16, v228
    v_and_b32 v236, 0xffff0000, v228
    v_add_f32 v0, v0, v235
    v_add_f32 v1, v1, v236
    v_cvt_pk_bf16_f32 v16, v0, v1
    v_lshlrev_b32 v235, 16, v229
    v_and_b32 v236, 0xffff0000, v229
    v_add_f32 v2, v2, v235
    v_add_f32 v3, v3, v236
    v_cvt_pk_bf16_f32 v17, v2, v3
    v_lshlrev_b32 v235, 16, v230
    v_and_b32 v236, 0xffff0000, v230
    v_add_f32 v4, v4, v235
    v_add_f32 v5, v5, v236
    v_cvt_pk_bf16_f32 v18, v4, v5
    v_lshlrev_b32 v235, 16, v231
    v_and_b32 v236, 0xffff0000, v231
    v_add_f32 v6, v6, v235
    v_add_f32 v7, v7, v236
    v_cvt_pk_bf16_f32 v19, v6, v7
    v_lshlrev_b32 v235, 16, v232
    v_and_b32 v236, 0xffff0000, v232
    v_add_f32 v8, v8, v235
    v_add_f32 v9, v9, v236
    v_cvt_pk_bf16_f32 v20, v8, v9
    v_lshlrev_b32 v235, 16, v233
    v_and_b32 v236, 0xffff0000, v233
    v_add_f32 v10, v10, v235
    v_add_f32 v11, v11, v236
    v_cvt_pk_bf16_f32 v21, v10, v11
    v_mov_b32 v24, 0
    v_mov_b32 v25, 0
    s_mov_b32 s47, 0x3f803f80
    v_dot2_f32_bf16 v24, v16, s47, v24
    v_dot2_f32_bf16 v25, v16, v16, v25
    v_dot2_f32_bf16 v24, v17, s47, v24
    v_dot2_f32_bf16 v25, v17, v17, v25
    v_dot2_f32_bf16 v24, v18, s47, v24
    v_dot2_f32_bf16 v25, v18, v18, v25
    v_dot2_f32_bf16 v24, v19, s47, v24
    v_dot2_f32_bf16 v25, v19, v19, v25
    v_dot2_f32_bf16 v24, v20, s47, v24
    v_dot2_f32_bf16 v25, v20, v20, v25
    v_dot2_f32_bf16 v24, v21, s47, v24
    v_dot2_f32_bf16 v25, v21, v21, v25
    s_nop 4
    v_bfe_u32 v235, v226, 4, 1
    v_lshrrev_b32 v236, 5, v226
    v_and_b32 v237, 15, v226
    v_lshl_add_u32 v236, v236, 4, v237
    v_mul_u32_u24 v237, 18432, v235
    v_lshl_add_u32 v238, v236, 4, v237
    v_lshl_add_u32 v239, v236, 3, v237
    s_mul_i32 s48, s35, 36864
    s_mul_i32 s49, s39, 3
    s_add_u32 s49, s49, 0
    s_lshr_b32 s50, s49, 1
    s_mul_i32 s51, s33, 6
    s_add_u32 s50, s50, s51
    s_and_b32 s49, s49, 1
    s_lshr_b32 s51, s50, 1
    s_lshl_b32 s51, s51, 10
    s_lshl_b32 s52, s49, 9
    s_add_u32 s51, s51, s52
    s_and_b32 s52, s50, 1
    s_lshl_b32 s52, s52, 3
    s_add_u32 s51, s51, s52
    s_add_u32 s51, s51, s48
    s_add_u32 s51, s51, 2359296
    buffer_store_dwordx2 v[16:17], v238, s[16:19], s51 offen
    s_lshl_b32 s51, s50, 9
    s_lshl_b32 s52, s49, 8
    s_add_u32 s51, s51, s52
    s_add_u32 s51, s51, s48
    s_add_u32 s51, s51, 10485760
    buffer_store_dwordx2 v[16:17], v239, s[16:19], s51 offen
    s_mul_i32 s49, s39, 3
    s_add_u32 s49, s49, 1
    s_lshr_b32 s50, s49, 1
    s_mul_i32 s51, s33, 6
    s_add_u32 s50, s50, s51
    s_and_b32 s49, s49, 1
    s_lshr_b32 s51, s50, 1
    s_lshl_b32 s51, s51, 10
    s_lshl_b32 s52, s49, 9
    s_add_u32 s51, s51, s52
    s_and_b32 s52, s50, 1
    s_lshl_b32 s52, s52, 3
    s_add_u32 s51, s51, s52
    s_add_u32 s51, s51, s48
    s_add_u32 s51, s51, 2359296
    buffer_store_dwordx2 v[18:19], v238, s[16:19], s51 offen
    s_lshl_b32 s51, s50, 9
    s_lshl_b32 s52, s49, 8
    s_add_u32 s51, s51, s52
    s_add_u32 s51, s51, s48
    s_add_u32 s51, s51, 10485760
    buffer_store_dwordx2 v[18:19], v239, s[16:19], s51 offen
    s_mul_i32 s49, s39, 3
    s_add_u32 s49, s49, 2
    s_lshr_b32 s50, s49, 1
    s_mul_i32 s51, s33, 6
    s_add_u32 s50, s50, s51
    s_and_b32 s49, s49, 1
    s_lshr_b32 s51, s50, 1
    s_lshl_b32 s51, s51, 10
    s_lshl_b32 s52, s49, 9
    s_add_u32 s51, s51, s52
    s_and_b32 s52, s50, 1
    s_lshl_b32 s52, s52, 3
    s_add_u32 s51, s51, s52
    s_add_u32 s51, s51, s48
    s_add_u32 s51, s51, 2359296
    buffer_store_dwordx2 v[20:21], v238, s[16:19], s51 offen
    s_lshl_b32 s51, s50, 9
    s_lshl_b32 s52, s49, 8
    s_add_u32 s51, s51, s52
    s_add_u32 s51, s51, s48
    s_add_u32 s51, s51, 10485760
    buffer_store_dwordx2 v[20:21], v239, s[16:19], s51 offen
    s_barrier
    s_lshl_b32 s46, s41, 2
    s_add_u32 s46, s46, s39
    s_lshl_b32 s46, s46, 9
    s_add_u32 s46, s46, 0x18000
    v_lshl_add_u32 v234, v226, 3, s46
    ds_write_b64 v234, v[24:25]
    s_waitcnt lgkmcnt(0)
    s_barrier
    s_cmp_lg_u32 s39, 0
    s_cbranch_scc1 Lk2_kernel_fin
    v_and_b32 v235, 31, v226
    s_lshl_b32 s46, s41, 11
    s_add_u32 s46, s46, 0x18000
    v_lshl_add_u32 v234, v235, 3, s46
    ds_read_b64 v[0:1], v234 offset:0
    ds_read_b64 v[2:3], v234 offset:256
    ds_read_b64 v[4:5], v234 offset:512
    ds_read_b64 v[6:7], v234 offset:768
    ds_read_b64 v[8:9], v234 offset:1024
    ds_read_b64 v[10:11], v234 offset:1280
    ds_read_b64 v[12:13], v234 offset:1536
    ds_read_b64 v[14:15], v234 offset:1792
    s_waitcnt lgkmcnt(0)
    v_add_f32 v0, v0, v2
    v_add_f32 v1, v1, v3
    v_add_f32 v0, v0, v4
    v_add_f32 v1, v1, v5
    v_add_f32 v0, v0, v6
    v_add_f32 v1, v1, v7
    v_add_f32 v0, v0, v8
    v_add_f32 v1, v1, v9
    v_add_f32 v0, v0, v10
    v_add_f32 v1, v1, v11
    v_add_f32 v0, v0, v12
    v_add_f32 v1, v1, v13
    v_add_f32 v0, v0, v14
    v_add_f32 v1, v1, v15
    v_lshrrev_b32 v236, 4, v235
    v_mul_u32_u24 v236, 768, v236
    v_and_b32 v235, 15, v235
    v_lshl_add_u32 v235, v235, 3, v236
    s_mul_i32 s46, s35, 1536
    s_lshl_b32 s47, s33, 7
    s_add_u32 s46, s46, s47
    s_add_u32 s46, s46, 13631488
    s_mov_b32 exec_hi, 0
    buffer_store_dwordx2 v[0:1], v235, s[16:19], s46 offen
    s_mov_b64 exec, -1
    s_branch Lk2_kernel_fin
Lk2_kernel_cs:
    s_cmp_ge_u32 s2, 16
    s_cbranch_scc1 Lk2_kernel_cs2
    s_mov_b32 s33, s2
    s_lshl_b32 s50, s30, 10
    v_add_u32 v234, s50, v225
    s_mul_i32 s55, s33, 46080
    s_add_u32 s55, s55, 4718592
    v_mov_b32 v235, 0x40000000
    v_cmp_gt_u32 vcc, 2880, v234
    s_nop 1
    v_cndmask_b32 v236, v235, v234, vcc
    s_cmp_ge_u32 s30, 3
    s_cbranch_scc1 Lk2_kernel_nored
    buffer_load_dwordx4 v[0:3], v236, s[16:19], s55 offen
    s_add_u32 s55, s55, 2880
    buffer_load_dwordx4 v[4:7], v236, s[16:19], s55 offen
    s_add_u32 s55, s55, 2880
    buffer_load_dwordx4 v[8:11], v236, s[16:19], s55 offen
    s_add_u32 s55, s55, 2880
    buffer_load_dwordx4 v[12:15], v236, s[16:19], s55 offen
    s_add_u32 s55, s55, 2880
    buffer_load_dwordx4 v[16:19], v236, s[16:19], s55 offen
    s_add_u32 s55, s55, 2880
    buffer_load_dwordx4 v[20:23], v236, s[16:19], s55 offen
    s_add_u32 s55, s55, 2880
    buffer_load_dwordx4 v[24:27], v236, s[16:19], s55 offen
    s_add_u32 s55, s55, 2880
    buffer_load_dwordx4 v[28:31], v236, s[16:19], s55 offen
    s_add_u32 s55, s55, 2880
    buffer_load_dwordx4 v[32:35], v236, s[16:19], s55 offen
    s_add_u32 s55, s55, 2880
    buffer_load_dwordx4 v[36:39], v236, s[16:19], s55 offen
    s_add_u32 s55, s55, 2880
    buffer_load_dwordx4 v[40:43], v236, s[16:19], s55 offen
    s_add_u32 s55, s55, 2880
    buffer_load_dwordx4 v[44:47], v236, s[16:19], s55 offen
    s_add_u32 s55, s55, 2880
    buffer_load_dwordx4 v[48:51], v236, s[16:19], s55 offen
    s_add_u32 s55, s55, 2880
    buffer_load_dwordx4 v[52:55], v236, s[16:19], s55 offen
    s_add_u32 s55, s55, 2880
    buffer_load_dwordx4 v[56:59], v236, s[16:19], s55 offen
    s_add_u32 s55, s55, 2880
    buffer_load_dwordx4 v[60:63], v236, s[16:19], s55 offen
    s_add_u32 s55, s55, 2880
Lk2_kernel_nored:
    s_lshr_b32 s52, s30, 1
    s_and_b32 s53, s30, 1
    s_add_u32 s54, s52, s53
    v_and_b32 v64, 31, v226
    v_lshrrev_b32 v65, 5, v226
    v_lshrrev_b32 v66, 3, v64
    v_and_b32 v68, 3, v64
    v_lshl_add_u32 v66, v66, 2, v68
    v_bfe_u32 v68, v64, 2, 1
    v_lshl_add_u32 v67, v68, 3, v66
    v_add_u32 v69, 16, v68
    v_cmp_eq_u32 vcc, 8, v66
    s_nop 1
    v_cndmask_b32 v67, v67, v69, vcc
    v_mov_b32 v69, 18
    v_cmp_eq_u32 vcc, 9, v66
    s_nop 1
    v_cndmask_b32 v67, v67, v69, vcc
    v_cmp_gt_u32 s[56:57], 10, v66
    v_mov_b32 v70, 2880
    s_mul_i32 s58, s52, 18
    s_and_b32 s51, s33, 3
    s_lshl_b32 s59, s54, 4
    s_add_u32 s59, s59, 0
    v_lshl_add_u32 v72, v65, 2, s59
    v_lshl_add_u32 v68, v65, 1, 0
    v_cmp_eq_u32 vcc, s51, v68
    v_mov_b32 v69, 32
    v_mov_b32 v68, 100
    v_cndmask_b32 v69, v68, v69, vcc
    s_cmp_eq_u32 s54, 2
    s_cselect_b64 vcc, -1, 0
    v_cndmask_b32 v72, v72, v69, vcc
    v_mul_u32_u24 v73, 20, v72
    v_add_lshl_u32 v73, v73, v67, 2
    v_subrev_u32 v68, s58, v72
    v_cmp_gt_u32 vcc, 18, v68
    s_nop 0
    s_and_b64 vcc, vcc, s[56:57]
    v_cndmask_b32 v73, v70, v73, vcc
    s_lshl_b32 s59, s54, 4
    s_add_u32 s59, s59, 1
    v_lshl_add_u32 v74, v65, 2, s59
    v_lshl_add_u32 v68, v65, 1, 0
    v_cmp_eq_u32 vcc, s51, v68
    v_mov_b32 v69, 33
    v_mov_b32 v68, 100
    v_cndmask_b32 v69, v68, v69, vcc
    s_cmp_eq_u32 s54, 2
    s_cselect_b64 vcc, -1, 0
    v_cndmask_b32 v74, v74, v69, vcc
    v_mul_u32_u24 v75, 20, v74
    v_add_lshl_u32 v75, v75, v67, 2
    v_subrev_u32 v68, s58, v74
    v_cmp_gt_u32 vcc, 18, v68
    s_nop 0
    s_and_b64 vcc, vcc, s[56:57]
    v_cndmask_b32 v75, v70, v75, vcc
    s_lshl_b32 s59, s54, 4
    s_add_u32 s59, s59, 2
    v_lshl_add_u32 v76, v65, 2, s59
    v_lshl_add_u32 v68, v65, 1, 0
    v_cmp_eq_u32 vcc, s51, v68
    v_mov_b32 v69, 34
    v_mov_b32 v68, 100
    v_cndmask_b32 v69, v68, v69, vcc
    s_cmp_eq_u32 s54, 2
    s_cselect_b64 vcc, -1, 0
    v_cndmask_b32 v76, v76, v69, vcc
    v_mul_u32_u24 v77, 20, v76
    v_add_lshl_u32 v77, v77, v67, 2
    v_subrev_u32 v68, s58, v76
    v_cmp_gt_u32 vcc, 18, v68
    s_nop 0
    s_and_b64 vcc, vcc, s[56:57]
    v_cndmask_b32 v77, v70, v77, vcc
    s_lshl_b32 s59, s54, 4
    s_add_u32 s59, s59, 3
    v_lshl_add_u32 v78, v65, 2, s59
    v_lshl_add_u32 v68, v65, 1, 0
    v_cmp_eq_u32 vcc, s51, v68
    v_mov_b32 v69, 35
    v_mov_b32 v68, 100
    v_cndmask_b32 v69, v68, v69, vcc
    s_cmp_eq_u32 s54, 2
    s_cselect_b64 vcc, -1, 0
    v_cndmask_b32 v78, v78, v69, vcc
    v_mul_u32_u24 v79, 20, v78
    v_add_lshl_u32 v79, v79, v67, 2
    v_subrev_u32 v68, s58, v78
    v_cmp_gt_u32 vcc, 18, v68
    s_nop 0
    s_and_b64 vcc, vcc, s[56:57]
    v_cndmask_b32 v79, v70, v79, vcc
    s_lshl_b32 s59, s54, 4
    s_add_u32 s59, s59, 8
    v_lshl_add_u32 v80, v65, 2, s59
    v_lshl_add_u32 v68, v65, 1, 1
    v_cmp_eq_u32 vcc, s51, v68
    v_mov_b32 v69, 32
    v_mov_b32 v68, 100
    v_cndmask_b32 v69, v68, v69, vcc
    s_cmp_eq_u32 s54, 2
    s_cselect_b64 vcc, -1, 0
    v_cndmask_b32 v80, v80, v69, vcc
    v_mul_u32_u24 v81, 20, v80
    v_add_lshl_u32 v81, v81, v67, 2
    v_subrev_u32 v68, s58, v80
    v_cmp_gt_u32 vcc, 18, v68
    s_nop 0
    s_and_b64 vcc, vcc, s[56:57]
    v_cndmask_b32 v81, v70, v81, vcc
    s_lshl_b32 s59, s54, 4
    s_add_u32 s59, s59, 9
    v_lshl_add_u32 v82, v65, 2, s59
    v_lshl_add_u32 v68, v65, 1, 1
    v_cmp_eq_u32 vcc, s51, v68
    v_mov_b32 v69, 33
    v_mov_b32 v68, 100
    v_cndmask_b32 v69, v68, v69, vcc
    s_cmp_eq_u32 s54, 2
    s_cselect_b64 vcc, -1, 0
    v_cndmask_b32 v82, v82, v69, vcc
    v_mul_u32_u24 v83, 20, v82
    v_add_lshl_u32 v83, v83, v67, 2
    v_subrev_u32 v68, s58, v82
    v_cmp_gt_u32 vcc, 18, v68
    s_nop 0
    s_and_b64 vcc, vcc, s[56:57]
    v_cndmask_b32 v83, v70, v83, vcc
    s_lshl_b32 s59, s54, 4
    s_add_u32 s59, s59, 10
    v_lshl_add_u32 v84, v65, 2, s59
    v_lshl_add_u32 v68, v65, 1, 1
    v_cmp_eq_u32 vcc, s51, v68
    v_mov_b32 v69, 34
    v_mov_b32 v68, 100
    v_cndmask_b32 v69, v68, v69, vcc
    s_cmp_eq_u32 s54, 2
    s_cselect_b64 vcc, -1, 0
    v_cndmask_b32 v84, v84, v69, vcc
    v_mul_u32_u24 v85, 20, v84
    v_add_lshl_u32 v85, v85, v67, 2
    v_subrev_u32 v68, s58, v84
    v_cmp_gt_u32 vcc, 18, v68
    s_nop 0
    s_and_b64 vcc, vcc, s[56:57]
    v_cndmask_b32 v85, v70, v85, vcc
    s_lshl_b32 s59, s54, 4
    s_add_u32 s59, s59, 11
    v_lshl_add_u32 v86, v65, 2, s59
    v_lshl_add_u32 v68, v65, 1, 1
    v_cmp_eq_u32 vcc, s51, v68
    v_mov_b32 v69, 35
    v_mov_b32 v68, 100
    v_cndmask_b32 v69, v68, v69, vcc
    s_cmp_eq_u32 s54, 2
    s_cselect_b64 vcc, -1, 0
    v_cndmask_b32 v86, v86, v69, vcc
    v_mul_u32_u24 v87, 20, v86
    v_add_lshl_u32 v87, v87, v67, 2
    v_subrev_u32 v68, s58, v86
    v_cmp_gt_u32 vcc, 18, v68
    s_nop 0
    s_and_b64 vcc, vcc, s[56:57]
    v_cndmask_b32 v87, v70, v87, vcc
    s_cmp_ge_u32 s30, 3
    s_cbranch_scc1 Lk2_kernel_nored2
    s_waitcnt vmcnt(14)
    v_add_f32 v0, v0, v4
    v_add_f32 v1, v1, v5
    v_add_f32 v2, v2, v6
    v_add_f32 v3, v3, v7
    s_waitcnt vmcnt(13)
    v_add_f32 v0, v0, v8
    v_add_f32 v1, v1, v9
    v_add_f32 v2, v2, v10
    v_add_f32 v3, v3, v11
    s_waitcnt vmcnt(12)
    v_add_f32 v0, v0, v12
    v_add_f32 v1, v1, v13
    v_add_f32 v2, v2, v14
    v_add_f32 v3, v3, v15
    s_waitcnt vmcnt(11)
    v_add_f32 v0, v0, v16
    v_add_f32 v1, v1, v17
    v_add_f32 v2, v2, v18
    v_add_f32 v3, v3, v19
    s_waitcnt vmcnt(10)
    v_add_f32 v0, v0, v20
    v_add_f32 v1, v1, v21
    v_add_f32 v2, v2, v22
    v_add_f32 v3, v3, v23
    s_waitcnt vmcnt(9)
    v_add_f32 v0, v0, v24
    v_add_f32 v1, v1, v25
    v_add_f32 v2, v2, v26
    v_add_f32 v3, v3, v27
    s_waitcnt vmcnt(8)
    v_add_f32 v0, v0, v28
    v_add_f32 v1, v1, v29
    v_add_f32 v2, v2, v30
    v_add_f32 v3, v3, v31
    s_waitcnt vmcnt(7)
    v_add_f32 v0, v0, v32
    v_add_f32 v1, v1, v33
    v_add_f32 v2, v2, v34
    v_add_f32 v3, v3, v35
    s_waitcnt vmcnt(6)
    v_add_f32 v0, v0, v36
    v_add_f32 v1, v1, v37
    v_add_f32 v2, v2, v38
    v_add_f32 v3, v3, v39
    s_waitcnt vmcnt(5)
    v_add_f32 v0, v0, v40
    v_add_f32 v1, v1, v41
    v_add_f32 v2, v2, v42
    v_add_f32 v3, v3, v43
    s_waitcnt vmcnt(4)
    v_add_f32 v0, v0, v44
    v_add_f32 v1, v1, v45
    v_add_f32 v2, v2, v46
    v_add_f32 v3, v3, v47
    s_waitcnt vmcnt(3)
    v_add_f32 v0, v0, v48
    v_add_f32 v1, v1, v49
    v_add_f32 v2, v2, v50
    v_add_f32 v3, v3, v51
    s_waitcnt vmcnt(2)
    v_add_f32 v0, v0, v52
    v_add_f32 v1, v1, v53
    v_add_f32 v2, v2, v54
    v_add_f32 v3, v3, v55
    s_waitcnt vmcnt(1)
    v_add_f32 v0, v0, v56
    v_add_f32 v1, v1, v57
    v_add_f32 v2, v2, v58
    v_add_f32 v3, v3, v59
    s_waitcnt vmcnt(0)
    v_add_f32 v0, v0, v60
    v_add_f32 v1, v1, v61
    v_add_f32 v2, v2, v62
    v_add_f32 v3, v3, v63
    ds_write_b128 v234, v[0:3] offset:36864
Lk2_kernel_nored2:
    s_waitcnt lgkmcnt(0)
    s_barrier
    s_cmp_ge_u32 s30, 4
    s_cbranch_scc1 Lk2_kernel_nob
    ds_read_b32 v0, v73 offset:36864
    ds_read_b32 v1, v75 offset:36864
    ds_read_b32 v2, v77 offset:36864
    ds_read_b32 v3, v79 offset:36864
    ds_read_b32 v4, v81 offset:36864
    ds_read_b32 v5, v83 offset:36864
    ds_read_b32 v6, v85 offset:36864
    ds_read_b32 v7, v87 offset:36864
    s_waitcnt lgkmcnt(0)
    v_cvt_pk_bf16_f32 v8, v0, v1
    v_cvt_pk_bf16_f32 v9, v2, v3
    v_cvt_pk_bf16_f32 v10, v4, v5
    v_cvt_pk_bf16_f32 v11, v6, v7
    s_lshl_b32 s59, s33, 2
    s_add_u32 s59, s59, s30
    s_lshl_b32 s59, s59, 10
    s_add_u32 s59, s59, 5455872
    buffer_store_dwordx4 v[8:11], v225, s[16:19], s59 offen sc1
    s_waitcnt vmcnt(0)
Lk2_kernel_nob:
    s_barrier
    s_cmp_lg_u32 s30, 0
    s_cbranch_scc1 Lk2_kernel_cs2
    v_lshlrev_b32 v234, 7, v226
    v_mov_b32 v235, 1
    s_lshl_b32 s59, s33, 2
    s_add_u32 s59, s59, 14483456
    s_mov_b64 exec, 0xff
    buffer_store_dword v235, v234, s[16:19], s59 offen sc1
    s_mov_b64 exec, -1
Lk2_kernel_cs2:
    s_and_b32 s32, s2, 7
    s_lshl_b32 s32, s32, 2
    s_lshr_b32 s34, s2, 4
    s_add_u32 s32, s32, s34
    s_bfe_u32 s34, s2, 0x10003
    s_lshl_b32 s34, s34, 5
    s_add_u32 s32, s32, s34
    s_cmp_ge_u32 s32, 32
    s_cselect_b32 s8, s26, s24
    s_cselect_b32 s9, s27, s25
    s_mov_b32 s10, 5308416
    s_mov_b32 s11, 0x20000
    s_and_b32 s34, s32, 31
    v_mul_u32_u24 v234, 57, v226
    v_lshrrev_b32 v234, 10, v234
    v_mul_u32_u24 v235, 18, v234
    v_sub_u32 v235, v226, v235
    v_mul_u32_u24 v236, 9216, v234
    v_lshl_add_u32 v236, v235, 4, v236
    v_mov_b32 v237, 0x40000000
    v_cmp_gt_u32 vcc, 54, v226
    s_nop 1
    v_cndmask_b32 v236, v237, v236, vcc
    s_mul_i32 s40, s30, 27648
    s_mul_i32 s41, s34, 288
    s_add_u32 s40, s40, s41
    buffer_load_dwordx4 v[0:3], v236, s[8:11], s40 offen
    s_add_u32 s40, s40, 221184
    buffer_load_dwordx4 v[4:7], v236, s[8:11], s40 offen
    s_add_u32 s40, s40, 221184
    buffer_load_dwordx4 v[8:11], v236, s[8:11], s40 offen
    s_add_u32 s40, s40, 221184
    buffer_load_dwordx4 v[12:15], v236, s[8:11], s40 offen
    s_add_u32 s40, s40, 221184
    buffer_load_dwordx4 v[16:19], v236, s[8:11], s40 offen
    s_add_u32 s40, s40, 221184
    buffer_load_dwordx4 v[20:23], v236, s[8:11], s40 offen
    s_add_u32 s40, s40, 221184
    buffer_load_dwordx4 v[24:27], v236, s[8:11], s40 offen
    s_add_u32 s40, s40, 221184
    buffer_load_dwordx4 v[28:31], v236, s[8:11], s40 offen
    s_add_u32 s40, s40, 221184
    buffer_load_dwordx4 v[32:35], v236, s[8:11], s40 offen
    s_add_u32 s40, s40, 221184
    buffer_load_dwordx4 v[36:39], v236, s[8:11], s40 offen
    s_add_u32 s40, s40, 221184
    buffer_load_dwordx4 v[40:43], v236, s[8:11], s40 offen
    s_add_u32 s40, s40, 221184
    buffer_load_dwordx4 v[44:47], v236, s[8:11], s40 offen
    s_add_u32 s40, s40, 221184
    buffer_load_dwordx4 v[48:51], v236, s[8:11], s40 offen
    s_add_u32 s40, s40, 221184
    buffer_load_dwordx4 v[52:55], v236, s[8:11], s40 offen
    s_add_u32 s40, s40, 221184
    buffer_load_dwordx4 v[56:59], v236, s[8:11], s40 offen
    s_add_u32 s40, s40, 221184
    buffer_load_dwordx4 v[60:63], v236, s[8:11], s40 offen
    s_add_u32 s40, s40, 221184
    buffer_load_dwordx4 v[64:67], v236, s[8:11], s40 offen
    s_add_u32 s40, s40, 221184
    buffer_load_dwordx4 v[68:71], v236, s[8:11], s40 offen
    s_add_u32 s40, s40, 221184
    buffer_load_dwordx4 v[72:75], v236, s[8:11], s40 offen
    s_add_u32 s40, s40, 221184
    buffer_load_dwordx4 v[76:79], v236, s[8:11], s40 offen
    s_add_u32 s40, s40, 221184
    buffer_load_dwordx4 v[80:83], v236, s[8:11], s40 offen
    s_add_u32 s40, s40, 221184
    buffer_load_dwordx4 v[84:87], v236, s[8:11], s40 offen
    s_add_u32 s40, s40, 221184
    buffer_load_dwordx4 v[88:91], v236, s[8:11], s40 offen
    s_add_u32 s40, s40, 221184
    buffer_load_dwordx4 v[92:95], v236, s[8:11], s40 offen
    s_add_u32 s40, s40, 221184
    v_mov_b32 v100, 0
    v_mov_b32 v101, 0
    v_mov_b32 v102, 0
    v_mov_b32 v103, 0
    v_mov_b32 v104, 0
    v_mov_b32 v105, 0
    v_mov_b32 v106, 0
    v_mov_b32 v107, 0
    s_waitcnt vmcnt(23)
    v_lshlrev_b32 v110, 16, v0
    v_and_b32 v111, 0xffff0000, v0
    v_add_f32 v100, v100, v110
    v_add_f32 v101, v101, v111
    v_lshlrev_b32 v112, 16, v1
    v_and_b32 v113, 0xffff0000, v1
    v_add_f32 v102, v102, v112
    v_add_f32 v103, v103, v113
    v_lshlrev_b32 v110, 16, v2
    v_and_b32 v111, 0xffff0000, v2
    v_add_f32 v104, v104, v110
    v_add_f32 v105, v105, v111
    v_lshlrev_b32 v112, 16, v3
    v_and_b32 v113, 0xffff0000, v3
    v_add_f32 v106, v106, v112
    v_add_f32 v107, v107, v113
    s_waitcnt vmcnt(22)
    v_lshlrev_b32 v110, 16, v4
    v_and_b32 v111, 0xffff0000, v4
    v_add_f32 v100, v100, v110
    v_add_f32 v101, v101, v111
    v_lshlrev_b32 v112, 16, v5
    v_and_b32 v113, 0xffff0000, v5
    v_add_f32 v102, v102, v112
    v_add_f32 v103, v103, v113
    v_lshlrev_b32 v110, 16, v6
    v_and_b32 v111, 0xffff0000, v6
    v_add_f32 v104, v104, v110
    v_add_f32 v105, v105, v111
    v_lshlrev_b32 v112, 16, v7
    v_and_b32 v113, 0xffff0000, v7
    v_add_f32 v106, v106, v112
    v_add_f32 v107, v107, v113
    s_waitcnt vmcnt(21)
    v_lshlrev_b32 v110, 16, v8
    v_and_b32 v111, 0xffff0000, v8
    v_add_f32 v100, v100, v110
    v_add_f32 v101, v101, v111
    v_lshlrev_b32 v112, 16, v9
    v_and_b32 v113, 0xffff0000, v9
    v_add_f32 v102, v102, v112
    v_add_f32 v103, v103, v113
    v_lshlrev_b32 v110, 16, v10
    v_and_b32 v111, 0xffff0000, v10
    v_add_f32 v104, v104, v110
    v_add_f32 v105, v105, v111
    v_lshlrev_b32 v112, 16, v11
    v_and_b32 v113, 0xffff0000, v11
    v_add_f32 v106, v106, v112
    v_add_f32 v107, v107, v113
    s_waitcnt vmcnt(20)
    v_lshlrev_b32 v110, 16, v12
    v_and_b32 v111, 0xffff0000, v12
    v_add_f32 v100, v100, v110
    v_add_f32 v101, v101, v111
    v_lshlrev_b32 v112, 16, v13
    v_and_b32 v113, 0xffff0000, v13
    v_add_f32 v102, v102, v112
    v_add_f32 v103, v103, v113
    v_lshlrev_b32 v110, 16, v14
    v_and_b32 v111, 0xffff0000, v14
    v_add_f32 v104, v104, v110
    v_add_f32 v105, v105, v111
    v_lshlrev_b32 v112, 16, v15
    v_and_b32 v113, 0xffff0000, v15
    v_add_f32 v106, v106, v112
    v_add_f32 v107, v107, v113
    s_waitcnt vmcnt(19)
    v_lshlrev_b32 v110, 16, v16
    v_and_b32 v111, 0xffff0000, v16
    v_add_f32 v100, v100, v110
    v_add_f32 v101, v101, v111
    v_lshlrev_b32 v112, 16, v17
    v_and_b32 v113, 0xffff0000, v17
    v_add_f32 v102, v102, v112
    v_add_f32 v103, v103, v113
    v_lshlrev_b32 v110, 16, v18
    v_and_b32 v111, 0xffff0000, v18
    v_add_f32 v104, v104, v110
    v_add_f32 v105, v105, v111
    v_lshlrev_b32 v112, 16, v19
    v_and_b32 v113, 0xffff0000, v19
    v_add_f32 v106, v106, v112
    v_add_f32 v107, v107, v113
    s_waitcnt vmcnt(18)
    v_lshlrev_b32 v110, 16, v20
    v_and_b32 v111, 0xffff0000, v20
    v_add_f32 v100, v100, v110
    v_add_f32 v101, v101, v111
    v_lshlrev_b32 v112, 16, v21
    v_and_b32 v113, 0xffff0000, v21
    v_add_f32 v102, v102, v112
    v_add_f32 v103, v103, v113
    v_lshlrev_b32 v110, 16, v22
    v_and_b32 v111, 0xffff0000, v22
    v_add_f32 v104, v104, v110
    v_add_f32 v105, v105, v111
    v_lshlrev_b32 v112, 16, v23
    v_and_b32 v113, 0xffff0000, v23
    v_add_f32 v106, v106, v112
    v_add_f32 v107, v107, v113
    s_waitcnt vmcnt(17)
    v_lshlrev_b32 v110, 16, v24
    v_and_b32 v111, 0xffff0000, v24
    v_add_f32 v100, v100, v110
    v_add_f32 v101, v101, v111
    v_lshlrev_b32 v112, 16, v25
    v_and_b32 v113, 0xffff0000, v25
    v_add_f32 v102, v102, v112
    v_add_f32 v103, v103, v113
    v_lshlrev_b32 v110, 16, v26
    v_and_b32 v111, 0xffff0000, v26
    v_add_f32 v104, v104, v110
    v_add_f32 v105, v105, v111
    v_lshlrev_b32 v112, 16, v27
    v_and_b32 v113, 0xffff0000, v27
    v_add_f32 v106, v106, v112
    v_add_f32 v107, v107, v113
    s_waitcnt vmcnt(16)
    v_lshlrev_b32 v110, 16, v28
    v_and_b32 v111, 0xffff0000, v28
    v_add_f32 v100, v100, v110
    v_add_f32 v101, v101, v111
    v_lshlrev_b32 v112, 16, v29
    v_and_b32 v113, 0xffff0000, v29
    v_add_f32 v102, v102, v112
    v_add_f32 v103, v103, v113
    v_lshlrev_b32 v110, 16, v30
    v_and_b32 v111, 0xffff0000, v30
    v_add_f32 v104, v104, v110
    v_add_f32 v105, v105, v111
    v_lshlrev_b32 v112, 16, v31
    v_and_b32 v113, 0xffff0000, v31
    v_add_f32 v106, v106, v112
    v_add_f32 v107, v107, v113
    s_waitcnt vmcnt(15)
    v_lshlrev_b32 v110, 16, v32
    v_and_b32 v111, 0xffff0000, v32
    v_add_f32 v100, v100, v110
    v_add_f32 v101, v101, v111
    v_lshlrev_b32 v112, 16, v33
    v_and_b32 v113, 0xffff0000, v33
    v_add_f32 v102, v102, v112
    v_add_f32 v103, v103, v113
    v_lshlrev_b32 v110, 16, v34
    v_and_b32 v111, 0xffff0000, v34
    v_add_f32 v104, v104, v110
    v_add_f32 v105, v105, v111
    v_lshlrev_b32 v112, 16, v35
    v_and_b32 v113, 0xffff0000, v35
    v_add_f32 v106, v106, v112
    v_add_f32 v107, v107, v113
    s_waitcnt vmcnt(14)
    v_lshlrev_b32 v110, 16, v36
    v_and_b32 v111, 0xffff0000, v36
    v_add_f32 v100, v100, v110
    v_add_f32 v101, v101, v111
    v_lshlrev_b32 v112, 16, v37
    v_and_b32 v113, 0xffff0000, v37
    v_add_f32 v102, v102, v112
    v_add_f32 v103, v103, v113
    v_lshlrev_b32 v110, 16, v38
    v_and_b32 v111, 0xffff0000, v38
    v_add_f32 v104, v104, v110
    v_add_f32 v105, v105, v111
    v_lshlrev_b32 v112, 16, v39
    v_and_b32 v113, 0xffff0000, v39
    v_add_f32 v106, v106, v112
    v_add_f32 v107, v107, v113
    s_waitcnt vmcnt(13)
    v_lshlrev_b32 v110, 16, v40
    v_and_b32 v111, 0xffff0000, v40
    v_add_f32 v100, v100, v110
    v_add_f32 v101, v101, v111
    v_lshlrev_b32 v112, 16, v41
    v_and_b32 v113, 0xffff0000, v41
    v_add_f32 v102, v102, v112
    v_add_f32 v103, v103, v113
    v_lshlrev_b32 v110, 16, v42
    v_and_b32 v111, 0xffff0000, v42
    v_add_f32 v104, v104, v110
    v_add_f32 v105, v105, v111
    v_lshlrev_b32 v112, 16, v43
    v_and_b32 v113, 0xffff0000, v43
    v_add_f32 v106, v106, v112
    v_add_f32 v107, v107, v113
    s_waitcnt vmcnt(12)
    v_lshlrev_b32 v110, 16, v44
    v_and_b32 v111, 0xffff0000, v44
    v_add_f32 v100, v100, v110
    v_add_f32 v101, v101, v111
    v_lshlrev_b32 v112, 16, v45
    v_and_b32 v113, 0xffff0000, v45
    v_add_f32 v102, v102, v112
    v_add_f32 v103, v103, v113
    v_lshlrev_b32 v110, 16, v46
    v_and_b32 v111, 0xffff0000, v46
    v_add_f32 v104, v104, v110
    v_add_f32 v105, v105, v111
    v_lshlrev_b32 v112, 16, v47
    v_and_b32 v113, 0xffff0000, v47
    v_add_f32 v106, v106, v112
    v_add_f32 v107, v107, v113
    s_waitcnt vmcnt(11)
    v_lshlrev_b32 v110, 16, v48
    v_and_b32 v111, 0xffff0000, v48
    v_add_f32 v100, v100, v110
    v_add_f32 v101, v101, v111
    v_lshlrev_b32 v112, 16, v49
    v_and_b32 v113, 0xffff0000, v49
    v_add_f32 v102, v102, v112
    v_add_f32 v103, v103, v113
    v_lshlrev_b32 v110, 16, v50
    v_and_b32 v111, 0xffff0000, v50
    v_add_f32 v104, v104, v110
    v_add_f32 v105, v105, v111
    v_lshlrev_b32 v112, 16, v51
    v_and_b32 v113, 0xffff0000, v51
    v_add_f32 v106, v106, v112
    v_add_f32 v107, v107, v113
    s_waitcnt vmcnt(10)
    v_lshlrev_b32 v110, 16, v52
    v_and_b32 v111, 0xffff0000, v52
    v_add_f32 v100, v100, v110
    v_add_f32 v101, v101, v111
    v_lshlrev_b32 v112, 16, v53
    v_and_b32 v113, 0xffff0000, v53
    v_add_f32 v102, v102, v112
    v_add_f32 v103, v103, v113
    v_lshlrev_b32 v110, 16, v54
    v_and_b32 v111, 0xffff0000, v54
    v_add_f32 v104, v104, v110
    v_add_f32 v105, v105, v111
    v_lshlrev_b32 v112, 16, v55
    v_and_b32 v113, 0xffff0000, v55
    v_add_f32 v106, v106, v112
    v_add_f32 v107, v107, v113
    s_waitcnt vmcnt(9)
    v_lshlrev_b32 v110, 16, v56
    v_and_b32 v111, 0xffff0000, v56
    v_add_f32 v100, v100, v110
    v_add_f32 v101, v101, v111
    v_lshlrev_b32 v112, 16, v57
    v_and_b32 v113, 0xffff0000, v57
    v_add_f32 v102, v102, v112
    v_add_f32 v103, v103, v113
    v_lshlrev_b32 v110, 16, v58
    v_and_b32 v111, 0xffff0000, v58
    v_add_f32 v104, v104, v110
    v_add_f32 v105, v105, v111
    v_lshlrev_b32 v112, 16, v59
    v_and_b32 v113, 0xffff0000, v59
    v_add_f32 v106, v106, v112
    v_add_f32 v107, v107, v113
    s_waitcnt vmcnt(8)
    v_lshlrev_b32 v110, 16, v60
    v_and_b32 v111, 0xffff0000, v60
    v_add_f32 v100, v100, v110
    v_add_f32 v101, v101, v111
    v_lshlrev_b32 v112, 16, v61
    v_and_b32 v113, 0xffff0000, v61
    v_add_f32 v102, v102, v112
    v_add_f32 v103, v103, v113
    v_lshlrev_b32 v110, 16, v62
    v_and_b32 v111, 0xffff0000, v62
    v_add_f32 v104, v104, v110
    v_add_f32 v105, v105, v111
    v_lshlrev_b32 v112, 16, v63
    v_and_b32 v113, 0xffff0000, v63
    v_add_f32 v106, v106, v112
    v_add_f32 v107, v107, v113
    s_waitcnt vmcnt(7)
    v_lshlrev_b32 v110, 16, v64
    v_and_b32 v111, 0xffff0000, v64
    v_add_f32 v100, v100, v110
    v_add_f32 v101, v101, v111
    v_lshlrev_b32 v112, 16, v65
    v_and_b32 v113, 0xffff0000, v65
    v_add_f32 v102, v102, v112
    v_add_f32 v103, v103, v113
    v_lshlrev_b32 v110, 16, v66
    v_and_b32 v111, 0xffff0000, v66
    v_add_f32 v104, v104, v110
    v_add_f32 v105, v105, v111
    v_lshlrev_b32 v112, 16, v67
    v_and_b32 v113, 0xffff0000, v67
    v_add_f32 v106, v106, v112
    v_add_f32 v107, v107, v113
    s_waitcnt vmcnt(6)
    v_lshlrev_b32 v110, 16, v68
    v_and_b32 v111, 0xffff0000, v68
    v_add_f32 v100, v100, v110
    v_add_f32 v101, v101, v111
    v_lshlrev_b32 v112, 16, v69
    v_and_b32 v113, 0xffff0000, v69
    v_add_f32 v102, v102, v112
    v_add_f32 v103, v103, v113
    v_lshlrev_b32 v110, 16, v70
    v_and_b32 v111, 0xffff0000, v70
    v_add_f32 v104, v104, v110
    v_add_f32 v105, v105, v111
    v_lshlrev_b32 v112, 16, v71
    v_and_b32 v113, 0xffff0000, v71
    v_add_f32 v106, v106, v112
    v_add_f32 v107, v107, v113
    s_waitcnt vmcnt(5)
    v_lshlrev_b32 v110, 16, v72
    v_and_b32 v111, 0xffff0000, v72
    v_add_f32 v100, v100, v110
    v_add_f32 v101, v101, v111
    v_lshlrev_b32 v112, 16, v73
    v_and_b32 v113, 0xffff0000, v73
    v_add_f32 v102, v102, v112
    v_add_f32 v103, v103, v113
    v_lshlrev_b32 v110, 16, v74
    v_and_b32 v111, 0xffff0000, v74
    v_add_f32 v104, v104, v110
    v_add_f32 v105, v105, v111
    v_lshlrev_b32 v112, 16, v75
    v_and_b32 v113, 0xffff0000, v75
    v_add_f32 v106, v106, v112
    v_add_f32 v107, v107, v113
    s_waitcnt vmcnt(4)
    v_lshlrev_b32 v110, 16, v76
    v_and_b32 v111, 0xffff0000, v76
    v_add_f32 v100, v100, v110
    v_add_f32 v101, v101, v111
    v_lshlrev_b32 v112, 16, v77
    v_and_b32 v113, 0xffff0000, v77
    v_add_f32 v102, v102, v112
    v_add_f32 v103, v103, v113
    v_lshlrev_b32 v110, 16, v78
    v_and_b32 v111, 0xffff0000, v78
    v_add_f32 v104, v104, v110
    v_add_f32 v105, v105, v111
    v_lshlrev_b32 v112, 16, v79
    v_and_b32 v113, 0xffff0000, v79
    v_add_f32 v106, v106, v112
    v_add_f32 v107, v107, v113
    s_waitcnt vmcnt(3)
    v_lshlrev_b32 v110, 16, v80
    v_and_b32 v111, 0xffff0000, v80
    v_add_f32 v100, v100, v110
    v_add_f32 v101, v101, v111
    v_lshlrev_b32 v112, 16, v81
    v_and_b32 v113, 0xffff0000, v81
    v_add_f32 v102, v102, v112
    v_add_f32 v103, v103, v113
    v_lshlrev_b32 v110, 16, v82
    v_and_b32 v111, 0xffff0000, v82
    v_add_f32 v104, v104, v110
    v_add_f32 v105, v105, v111
    v_lshlrev_b32 v112, 16, v83
    v_and_b32 v113, 0xffff0000, v83
    v_add_f32 v106, v106, v112
    v_add_f32 v107, v107, v113
    s_waitcnt vmcnt(2)
    v_lshlrev_b32 v110, 16, v84
    v_and_b32 v111, 0xffff0000, v84
    v_add_f32 v100, v100, v110
    v_add_f32 v101, v101, v111
    v_lshlrev_b32 v112, 16, v85
    v_and_b32 v113, 0xffff0000, v85
    v_add_f32 v102, v102, v112
    v_add_f32 v103, v103, v113
    v_lshlrev_b32 v110, 16, v86
    v_and_b32 v111, 0xffff0000, v86
    v_add_f32 v104, v104, v110
    v_add_f32 v105, v105, v111
    v_lshlrev_b32 v112, 16, v87
    v_and_b32 v113, 0xffff0000, v87
    v_add_f32 v106, v106, v112
    v_add_f32 v107, v107, v113
    s_waitcnt vmcnt(1)
    v_lshlrev_b32 v110, 16, v88
    v_and_b32 v111, 0xffff0000, v88
    v_add_f32 v100, v100, v110
    v_add_f32 v101, v101, v111
    v_lshlrev_b32 v112, 16, v89
    v_and_b32 v113, 0xffff0000, v89
    v_add_f32 v102, v102, v112
    v_add_f32 v103, v103, v113
    v_lshlrev_b32 v110, 16, v90
    v_and_b32 v111, 0xffff0000, v90
    v_add_f32 v104, v104, v110
    v_add_f32 v105, v105, v111
    v_lshlrev_b32 v112, 16, v91
    v_and_b32 v113, 0xffff0000, v91
    v_add_f32 v106, v106, v112
    v_add_f32 v107, v107, v113
    s_waitcnt vmcnt(0)
    v_lshlrev_b32 v110, 16, v92
    v_and_b32 v111, 0xffff0000, v92
    v_add_f32 v100, v100, v110
    v_add_f32 v101, v101, v111
    v_lshlrev_b32 v112, 16, v93
    v_and_b32 v113, 0xffff0000, v93
    v_add_f32 v102, v102, v112
    v_add_f32 v103, v103, v113
    v_lshlrev_b32 v110, 16, v94
    v_and_b32 v111, 0xffff0000, v94
    v_add_f32 v104, v104, v110
    v_add_f32 v105, v105, v111
    v_lshlrev_b32 v112, 16, v95
    v_and_b32 v113, 0xffff0000, v95
    v_add_f32 v106, v106, v112
    v_add_f32 v107, v107, v113
    s_mul_i32 s40, s30, 2304
    v_mul_u32_u24 v234, 576, v234
    v_lshl_add_u32 v234, v235, 5, v234
    v_add_u32 v234, s40, v234
    ds_write_b128 v234, v[100:103]
    ds_write_b128 v234, v[104:107] offset:16
    s_waitcnt lgkmcnt(0)
    s_barrier
    s_cmp_ge_u32 s30, 3
    s_cbranch_scc1 Lk2_kernel_fin
    s_lshl_b32 s40, s30, 8
    v_lshl_add_u32 v234, v226, 2, s40
    ds_read_b32 v0, v234 offset:0
    ds_read_b32 v1, v234 offset:576
    ds_read_b32 v2, v234 offset:1152
    ds_read_b32 v3, v234 offset:2304
    ds_read_b32 v4, v234 offset:2880
    ds_read_b32 v5, v234 offset:3456
    ds_read_b32 v6, v234 offset:4608
    ds_read_b32 v7, v234 offset:5184
    ds_read_b32 v8, v234 offset:5760
    ds_read_b32 v9, v234 offset:6912
    ds_read_b32 v10, v234 offset:7488
    ds_read_b32 v11, v234 offset:8064
    ds_read_b32 v12, v234 offset:9216
    ds_read_b32 v13, v234 offset:9792
    ds_read_b32 v14, v234 offset:10368
    ds_read_b32 v15, v234 offset:11520
    ds_read_b32 v16, v234 offset:12096
    ds_read_b32 v17, v234 offset:12672
    ds_read_b32 v18, v234 offset:13824
    ds_read_b32 v19, v234 offset:14400
    ds_read_b32 v20, v234 offset:14976
    ds_read_b32 v21, v234 offset:16128
    ds_read_b32 v22, v234 offset:16704
    ds_read_b32 v23, v234 offset:17280
    s_waitcnt lgkmcnt(0)
    v_add_f32 v0, v0, v1
    v_add_f32 v0, v0, v2
    v_add_f32 v0, v0, v3
    v_add_f32 v0, v0, v4
    v_add_f32 v0, v0, v5
    v_add_f32 v0, v0, v6
    v_add_f32 v0, v0, v7
    v_add_f32 v0, v0, v8
    v_add_f32 v0, v0, v9
    v_add_f32 v0, v0, v10
    v_add_f32 v0, v0, v11
    v_add_f32 v0, v0, v12
    v_add_f32 v0, v0, v13
    v_add_f32 v0, v0, v14
    v_add_f32 v0, v0, v15
    v_add_f32 v0, v0, v16
    v_add_f32 v0, v0, v17
    v_add_f32 v0, v0, v18
    v_add_f32 v0, v0, v19
    v_add_f32 v0, v0, v20
    v_add_f32 v0, v0, v21
    v_add_f32 v0, v0, v22
    v_add_f32 v0, v0, v23
    v_mov_b32 v237, 0x40000000
    v_cmp_gt_u32 vcc, 576, v234
    s_nop 1
    v_cndmask_b32 v234, v237, v234, vcc
    s_mul_i32 s40, s32, 576
    s_add_u32 s40, s40, 14155776
    buffer_store_dword v0, v234, s[16:19], s40 offen
Lk2_kernel_fin:
Lk2_kernel_end:
    s_endpgm

.globl k3_kernel
.p2align 8
.type k3_kernel,@function
k3_kernel:

    s_cmp_ge_u32 s2, 256
    s_cbranch_scc1 Lk3_kernel_end
    s_load_dwordx4 s[4:7], s[0:1], 32
    s_load_dwordx2 s[24:25], s[0:1], 72
    s_load_dwordx2 s[92:93], s[0:1], 48
    v_lshrrev_b32 v101, 6, v0
    s_nop 0
    v_readfirstlane_b32 s30, v101
    v_and_b32 v100, 63, v0
    s_and_b32 s31, s2, 7
    s_lshr_b32 s32, s2, 3
    s_and_b32 s33, s32, 7
    s_lshr_b32 s32, s32, 3
    s_lshl_b32 s34, s31, 2
    s_add_u32 s34, s34, s32
    s_and_b32 s41, s30, 3
    s_lshl_b32 s35, s33, 4
    s_lshl_b32 s36, s41, 2
    s_add_u32 s35, s35, s36
    v_lshlrev_b32 v243, 4, v100
    s_mov_b32 s36, 0xAAAB
    v_add_u32 v102, 0, v100
    v_mul_lo_u32 v103, v102, s36
    v_lshrrev_b32 v103, 20, v103
    v_mul_u32_u24 v105, 24, v103
    v_sub_u32 v104, v102, v105
    v_and_b32 v105, 6, v103
    v_xor_b32 v104, v104, v105
    v_mul_u32_u24 v105, 9216, v103
    v_lshl_add_u32 v240, v104, 4, v105
    v_add_u32 v102, 64, v100
    v_mul_lo_u32 v103, v102, s36
    v_lshrrev_b32 v103, 20, v103
    v_mul_u32_u24 v105, 24, v103
    v_sub_u32 v104, v102, v105
    v_and_b32 v105, 6, v103
    v_xor_b32 v104, v104, v105
    v_mul_u32_u24 v105, 9216, v103
    v_lshl_add_u32 v241, v104, 4, v105
    v_add_u32 v102, 128, v100
    v_mul_lo_u32 v103, v102, s36
    v_lshrrev_b32 v103, 20, v103
    v_mul_u32_u24 v105, 24, v103
    v_sub_u32 v104, v102, v105
    v_and_b32 v105, 6, v103
    v_xor_b32 v104, v104, v105
    v_mul_u32_u24 v105, 9216, v103
    v_lshl_add_u32 v242, v104, 4, v105
    v_lshrrev_b32 v102, 2, v100
    v_bfe_u32 v103, v100, 3, 2
    v_and_b32 v104, 3, v100
    v_mul_u32_u24 v102, 384, v102
    v_lshl_add_u32 v102, v104, 3, v102
    s_and_b32 s37, s34, 3
    s_add_u32 s38, s37, 0
    v_xor_b32 v105, s38, v103
    v_lshl_add_u32 v232, v105, 5, v102
    s_add_u32 s38, s37, 1
    v_xor_b32 v105, s38, v103
    v_lshl_add_u32 v233, v105, 5, v102
    s_add_u32 s38, s37, 2
    v_xor_b32 v105, s38, v103
    v_lshl_add_u32 v234, v105, 5, v102
    s_add_u32 s38, s37, 3
    v_xor_b32 v105, s38, v103
    v_lshl_add_u32 v235, v105, 5, v102
    s_waitcnt lgkmcnt(0)
    s_cmp_lt_u32 s30, 4
    s_cselect_b32 s8, s4, s6
    s_cselect_b32 s9, s5, s7
    s_mov_b32 s10, 5308416
    s_mov_b32 s11, 0x20000
    s_mov_b32 s16, s24
    s_mov_b32 s17, s25
    s_mov_b32 s18, 268435456
    s_mov_b32 s19, 0x20000
    s_mul_i32 s40, s34, 288
    s_and_b32 s40, s40, 0xffffff80
    s_mul_i32 s42, s41, 73728
    s_add_u32 s40, s40, s42
    s_mul_i32 s43, s41, 3072
    s_cmp_lt_u32 s30, 4
    s_cselect_b32 s44, 0, 12288
    s_add_u32 s43, s43, s44
    s_add_u32 s52, s35, 0
    s_mul_i32 s52, s52, 18432
    s_add_u32 s52, s52, 2359296
    s_add_u32 s53, s35, 1
    s_mul_i32 s53, s53, 18432
    s_add_u32 s53, s53, 2359296
    s_add_u32 s54, s35, 2
    s_mul_i32 s54, s54, 18432
    s_add_u32 s54, s54, 2359296
    s_add_u32 s55, s35, 3
    s_mul_i32 s55, s55, 18432
    s_add_u32 s55, s55, 2359296
    s_add_u32 m0, s43, 0
    s_nop 0
    buffer_load_dwordx4 v240, s[8:11], s40 offen lds
    s_add_u32 m0, s43, 1024
    s_nop 0
    buffer_load_dwordx4 v241, s[8:11], s40 offen lds
    s_add_u32 m0, s43, 2048
    s_nop 0
    buffer_load_dwordx4 v242, s[8:11], s40 offen lds
    s_add_u32 s40, s40, 294912
    buffer_load_dwordx4 v[160:163], v243, s[16:19], s52 offen
    s_add_u32 s52, s52, 1024
    buffer_load_dwordx4 v[164:167], v243, s[16:19], s53 offen
    s_add_u32 s53, s53, 1024
    buffer_load_dwordx4 v[168:171], v243, s[16:19], s54 offen
    s_add_u32 s54, s54, 1024
    buffer_load_dwordx4 v[172:175], v243, s[16:19], s55 offen
    s_add_u32 s55, s55, 1024
    s_cmp_lg_u32 s41, 0
    s_cbranch_scc1 Lk3_kernel_nocs
    s_mul_i32 s47, s34, 576
    s_lshr_b32 s46, s30, 2
    s_mul_i32 s48, s46, 18432
    s_add_u32 s47, s47, s48
    s_add_u32 s47, s47, 14155776
    s_mul_i32 s46, s46, 576
    s_add_u32 m0, s46, 147456
    s_mov_b32 exec_hi, 0xf
    buffer_load_dwordx4 v243, s[16:19], s47 offen lds
    s_mov_b64 exec, -1
Lk3_kernel_nocs:
    s_waitcnt vmcnt(4)
    s_barrier
    s_cmp_ge_u32 s30, 4
    s_cbranch_scc1 Lk3_kernel_half1
    ds_read_b64_tr_b16 v[208:209], v232 offset:0
    ds_read_b64_tr_b16 v[210:211], v232 offset:6144
    ds_read_b64_tr_b16 v[212:213], v232 offset:12288
    ds_read_b64_tr_b16 v[214:215], v232 offset:18432
    ds_read_b64_tr_b16 v[216:217], v233 offset:0
    ds_read_b64_tr_b16 v[218:219], v233 offset:6144
    s_waitcnt lgkmcnt(4)
    s_waitcnt vmcnt(3)
    v_mfma_f32_16x16x32_bf16 v[0:3], v[208:211], v[160:163], 0
    ds_read_b64_tr_b16 v[220:221], v233 offset:12288
    ds_read_b64_tr_b16 v[222:223], v233 offset:18432
    s_add_u32 m0, s43, 24576
    s_nop 0
    buffer_load_dwordx4 v240, s[8:11], s40 offen lds
    s_waitcnt vmcnt(3)
    v_mfma_f32_16x16x32_bf16 v[40:43], v[208:211], v[164:167], 0
    s_waitcnt vmcnt(2)
    v_mfma_f32_16x16x32_bf16 v[80:83], v[208:211], v[168:171], 0
    s_add_u32 m0, s43, 25600
    s_nop 0
    buffer_load_dwordx4 v241, s[8:11], s40 offen lds
    s_waitcnt vmcnt(2)
    v_mfma_f32_16x16x32_bf16 v[120:123], v[208:211], v[172:175], 0
    s_waitcnt lgkmcnt(4)
    v_mfma_f32_16x16x32_bf16 v[4:7], v[212:215], v[160:163], 0
    ds_read_b64_tr_b16 v[208:209], v234 offset:0
    ds_read_b64_tr_b16 v[210:211], v234 offset:6144
    s_add_u32 m0, s43, 26624
    s_nop 0
    buffer_load_dwordx4 v242, s[8:11], s40 offen lds
    s_add_u32 s40, s40, 294912
    v_mfma_f32_16x16x32_bf16 v[44:47], v[212:215], v[164:167], 0
    v_mfma_f32_16x16x32_bf16 v[84:87], v[212:215], v[168:171], 0
    buffer_load_dwordx4 v[176:179], v243, s[16:19], s52 offen
    s_add_u32 s52, s52, 1024
    v_mfma_f32_16x16x32_bf16 v[124:127], v[212:215], v[172:175], 0
    s_waitcnt lgkmcnt(4)
    v_mfma_f32_16x16x32_bf16 v[8:11], v[216:219], v[160:163], 0
    ds_read_b64_tr_b16 v[212:213], v234 offset:12288
    ds_read_b64_tr_b16 v[214:215], v234 offset:18432
    buffer_load_dwordx4 v[180:183], v243, s[16:19], s53 offen
    s_add_u32 s53, s53, 1024
    v_mfma_f32_16x16x32_bf16 v[48:51], v[216:219], v[164:167], 0
    v_mfma_f32_16x16x32_bf16 v[88:91], v[216:219], v[168:171], 0
    buffer_load_dwordx4 v[184:187], v243, s[16:19], s54 offen
    s_add_u32 s54, s54, 1024
    v_mfma_f32_16x16x32_bf16 v[128:131], v[216:219], v[172:175], 0
    s_waitcnt lgkmcnt(4)
    v_mfma_f32_16x16x32_bf16 v[12:15], v[220:223], v[160:163], 0
    ds_read_b64_tr_b16 v[216:217], v235 offset:0
    ds_read_b64_tr_b16 v[218:219], v235 offset:6144
    buffer_load_dwordx4 v[188:191], v243, s[16:19], s55 offen
    s_add_u32 s55, s55, 1024
    v_mfma_f32_16x16x32_bf16 v[52:55], v[220:223], v[164:167], 0
    v_mfma_f32_16x16x32_bf16 v[92:95], v[220:223], v[168:171], 0
    s_add_u32 m0, s43, 49152
    s_nop 0
    buffer_load_dwordx4 v240, s[8:11], s40 offen lds
    v_mfma_f32_16x16x32_bf16 v[132:135], v[220:223], v[172:175], 0
    s_waitcnt lgkmcnt(4)
    v_mfma_f32_16x16x32_bf16 v[16:19], v[208:211], v[160:163], 0
    ds_read_b64_tr_b16 v[220:221], v235 offset:12288
    ds_read_b64_tr_b16 v[222:223], v235 offset:18432
    s_add_u32 m0, s43, 50176
    s_nop 0
    buffer_load_dwordx4 v241, s[8:11], s40 offen lds
    v_mfma_f32_16x16x32_bf16 v[56:59], v[208:211], v[164:167], 0
    v_mfma_f32_16x16x32_bf16 v[96:99], v[208:211], v[168:171], 0
    s_add_u32 m0, s43, 51200
    s_nop 0
    buffer_load_dwordx4 v242, s[8:11], s40 offen lds
    s_add_u32 s40, s40, 294912
    v_mfma_f32_16x16x32_bf16 v[136:139], v[208:211], v[172:175], 0
    s_waitcnt vmcnt(7)
    s_barrier
    v_add_u32 v236, 24576, v232
    v_add_u32 v237, 24576, v233
    v_add_u32 v238, 24576, v234
    v_add_u32 v239, 24576, v235
    s_waitcnt lgkmcnt(4)
    v_mfma_f32_16x16x32_bf16 v[20:23], v[212:215], v[160:163], 0
    ds_read_b64_tr_b16 v[208:209], v232 offset:256
    ds_read_b64_tr_b16 v[210:211], v232 offset:6400
    buffer_load_dwordx4 v[192:195], v243, s[16:19], s52 offen
    s_add_u32 s52, s52, 1024
    v_mfma_f32_16x16x32_bf16 v[60:63], v[212:215], v[164:167], 0
    v_mfma_f32_16x16x32_bf16 v[100:103], v[212:215], v[168:171], 0
    buffer_load_dwordx4 v[196:199], v243, s[16:19], s53 offen
    s_add_u32 s53, s53, 1024
    v_mfma_f32_16x16x32_bf16 v[140:143], v[212:215], v[172:175], 0
    s_waitcnt lgkmcnt(4)
    v_mfma_f32_16x16x32_bf16 v[24:27], v[216:219], v[160:163], 0
    ds_read_b64_tr_b16 v[212:213], v232 offset:12544
    ds_read_b64_tr_b16 v[214:215], v232 offset:18688
    buffer_load_dwordx4 v[200:203], v243, s[16:19], s54 offen
    s_add_u32 s54, s54, 1024
    v_mfma_f32_16x16x32_bf16 v[64:67], v[216:219], v[164:167], 0
    v_mfma_f32_16x16x32_bf16 v[104:107], v[216:219], v[168:171], 0
    buffer_load_dwordx4 v[204:207], v243, s[16:19], s55 offen
    s_add_u32 s55, s55, 1024
    v_mfma_f32_16x16x32_bf16 v[144:147], v[216:219], v[172:175], 0
    s_waitcnt lgkmcnt(4)
    v_mfma_f32_16x16x32_bf16 v[28:31], v[220:223], v[160:163], 0
    ds_read_b64_tr_b16 v[216:217], v236 offset:0
    ds_read_b64_tr_b16 v[218:219], v236 offset:6144
    v_mfma_f32_16x16x32_bf16 v[68:71], v[220:223], v[164:167], 0
    v_mfma_f32_16x16x32_bf16 v[108:111], v[220:223], v[168:171], 0
    v_mfma_f32_16x16x32_bf16 v[148:151], v[220:223], v[172:175], 0
    s_waitcnt lgkmcnt(4)
    v_mfma_f32_16x16x32_bf16 v[32:35], v[208:211], v[160:163], 0
    ds_read_b64_tr_b16 v[220:221], v236 offset:12288
    ds_read_b64_tr_b16 v[222:223], v236 offset:18432
    v_mfma_f32_16x16x32_bf16 v[72:75], v[208:211], v[164:167], 0
    v_mfma_f32_16x16x32_bf16 v[112:115], v[208:211], v[168:171], 0
    v_mfma_f32_16x16x32_bf16 v[152:155], v[208:211], v[172:175], 0
    s_waitcnt lgkmcnt(4)
    v_mfma_f32_16x16x32_bf16 v[36:39], v[212:215], v[160:163], 0
    ds_read_b64_tr_b16 v[208:209], v237 offset:0
    ds_read_b64_tr_b16 v[210:211], v237 offset:6144
    v_mfma_f32_16x16x32_bf16 v[76:79], v[212:215], v[164:167], 0
    v_mfma_f32_16x16x32_bf16 v[116:119], v[212:215], v[168:171], 0
    v_mfma_f32_16x16x32_bf16 v[156:159], v[212:215], v[172:175], 0
    s_waitcnt lgkmcnt(4)
    s_waitcnt vmcnt(10)
    v_mfma_f32_16x16x32_bf16 v[0:3], v[216:219], v[176:179], v[0:3]
    ds_read_b64_tr_b16 v[212:213], v237 offset:12288
    ds_read_b64_tr_b16 v[214:215], v237 offset:18432
    buffer_load_dwordx4 v[160:163], v243, s[16:19], s52 offen
    s_add_u32 s52, s52, 1024
    s_waitcnt vmcnt(10)
    v_mfma_f32_16x16x32_bf16 v[40:43], v[216:219], v[180:183], v[40:43]
    s_waitcnt vmcnt(9)
    v_mfma_f32_16x16x32_bf16 v[80:83], v[216:219], v[184:187], v[80:83]
    s_waitcnt vmcnt(8)
    v_mfma_f32_16x16x32_bf16 v[120:123], v[216:219], v[188:191], v[120:123]
    s_waitcnt lgkmcnt(4)
    v_mfma_f32_16x16x32_bf16 v[4:7], v[220:223], v[176:179], v[4:7]
    ds_read_b64_tr_b16 v[216:217], v238 offset:0
    ds_read_b64_tr_b16 v[218:219], v238 offset:6144
    s_add_u32 m0, s43, 73728
    s_nop 0
    buffer_load_dwordx4 v240, s[8:11], s40 offen lds
    v_mfma_f32_16x16x32_bf16 v[44:47], v[220:223], v[180:183], v[44:47]
    v_mfma_f32_16x16x32_bf16 v[84:87], v[220:223], v[184:187], v[84:87]
    v_mfma_f32_16x16x32_bf16 v[124:127], v[220:223], v[188:191], v[124:127]
    s_waitcnt lgkmcnt(4)
    v_mfma_f32_16x16x32_bf16 v[8:11], v[208:211], v[176:179], v[8:11]
    ds_read_b64_tr_b16 v[220:221], v238 offset:12288
    ds_read_b64_tr_b16 v[222:223], v238 offset:18432
    buffer_load_dwordx4 v[164:167], v243, s[16:19], s53 offen
    s_add_u32 s53, s53, 1024
    v_mfma_f32_16x16x32_bf16 v[48:51], v[208:211], v[180:183], v[48:51]
    v_mfma_f32_16x16x32_bf16 v[88:91], v[208:211], v[184:187], v[88:91]
    v_mfma_f32_16x16x32_bf16 v[128:131], v[208:211], v[188:191], v[128:131]
    s_add_u32 m0, s43, 74752
    s_nop 0
    buffer_load_dwordx4 v241, s[8:11], s40 offen lds
    s_waitcnt lgkmcnt(4)
    v_mfma_f32_16x16x32_bf16 v[12:15], v[212:215], v[176:179], v[12:15]
    ds_read_b64_tr_b16 v[208:209], v239 offset:0
    ds_read_b64_tr_b16 v[210:211], v239 offset:6144
    v_mfma_f32_16x16x32_bf16 v[52:55], v[212:215], v[180:183], v[52:55]
    v_mfma_f32_16x16x32_bf16 v[92:95], v[212:215], v[184:187], v[92:95]
    v_mfma_f32_16x16x32_bf16 v[132:135], v[212:215], v[188:191], v[132:135]
    buffer_load_dwordx4 v[168:171], v243, s[16:19], s54 offen
    s_add_u32 s54, s54, 1024
    s_waitcnt lgkmcnt(4)
    v_mfma_f32_16x16x32_bf16 v[16:19], v[216:219], v[176:179], v[16:19]
    ds_read_b64_tr_b16 v[212:213], v239 offset:12288
    ds_read_b64_tr_b16 v[214:215], v239 offset:18432
    v_mfma_f32_16x16x32_bf16 v[56:59], v[216:219], v[180:183], v[56:59]
    v_mfma_f32_16x16x32_bf16 v[96:99], v[216:219], v[184:187], v[96:99]
    s_add_u32 m0, s43, 75776
    s_nop 0
    buffer_load_dwordx4 v242, s[8:11], s40 offen lds
    s_add_u32 s40, s40, 294912
    v_mfma_f32_16x16x32_bf16 v[136:139], v[216:219], v[188:191], v[136:139]
    s_waitcnt vmcnt(10)
    s_barrier
    v_add_u32 v232, 24576, v236
    v_add_u32 v233, 24576, v237
    v_add_u32 v234, 24576, v238
    v_add_u32 v235, 24576, v239
    s_waitcnt lgkmcnt(4)
    v_mfma_f32_16x16x32_bf16 v[20:23], v[220:223], v[176:179], v[20:23]
    ds_read_b64_tr_b16 v[216:217], v236 offset:256
    ds_read_b64_tr_b16 v[218:219], v236 offset:6400
    v_mfma_f32_16x16x32_bf16 v[60:63], v[220:223], v[180:183], v[60:63]
    v_mfma_f32_16x16x32_bf16 v[100:103], v[220:223], v[184:187], v[100:103]
    buffer_load_dwordx4 v[172:175], v243, s[16:19], s55 offen
    s_add_u32 s55, s55, 1024
    v_mfma_f32_16x16x32_bf16 v[140:143], v[220:223], v[188:191], v[140:143]
    s_waitcnt lgkmcnt(4)
    v_mfma_f32_16x16x32_bf16 v[24:27], v[208:211], v[176:179], v[24:27]
    ds_read_b64_tr_b16 v[220:221], v236 offset:12544
    ds_read_b64_tr_b16 v[222:223], v236 offset:18688
    v_mfma_f32_16x16x32_bf16 v[64:67], v[208:211], v[180:183], v[64:67]
    v_mfma_f32_16x16x32_bf16 v[104:107], v[208:211], v[184:187], v[104:107]
    s_add_u32 m0, s43, 98304
    s_nop 0
    buffer_load_dwordx4 v240, s[8:11], s40 offen lds
    v_mfma_f32_16x16x32_bf16 v[144:147], v[208:211], v[188:191], v[144:147]
    s_waitcnt lgkmcnt(4)
    v_mfma_f32_16x16x32_bf16 v[28:31], v[212:215], v[176:179], v[28:31]
    ds_read_b64_tr_b16 v[208:209], v232 offset:0
    ds_read_b64_tr_b16 v[210:211], v232 offset:6144
    v_mfma_f32_16x16x32_bf16 v[68:71], v[212:215], v[180:183], v[68:71]
    s_add_u32 m0, s43, 99328
    s_nop 0
    buffer_load_dwordx4 v241, s[8:11], s40 offen lds
    v_mfma_f32_16x16x32_bf16 v[108:111], v[212:215], v[184:187], v[108:111]
    v_mfma_f32_16x16x32_bf16 v[148:151], v[212:215], v[188:191], v[148:151]
    s_waitcnt lgkmcnt(4)
    v_mfma_f32_16x16x32_bf16 v[32:35], v[216:219], v[176:179], v[32:35]
    ds_read_b64_tr_b16 v[212:213], v232 offset:12288
    ds_read_b64_tr_b16 v[214:215], v232 offset:18432
    v_mfma_f32_16x16x32_bf16 v[72:75], v[216:219], v[180:183], v[72:75]
    s_add_u32 m0, s43, 100352
    s_nop 0
    buffer_load_dwordx4 v242, s[8:11], s40 offen lds
    s_add_u32 s40, s40, 294912
    v_mfma_f32_16x16x32_bf16 v[112:115], v[216:219], v[184:187], v[112:115]
    v_mfma_f32_16x16x32_bf16 v[152:155], v[216:219], v[188:191], v[152:155]
    s_waitcnt lgkmcnt(4)
    v_mfma_f32_16x16x32_bf16 v[36:39], v[220:223], v[176:179], v[36:39]
    ds_read_b64_tr_b16 v[216:217], v233 offset:0
    ds_read_b64_tr_b16 v[218:219], v233 offset:6144
    v_mfma_f32_16x16x32_bf16 v[76:79], v[220:223], v[180:183], v[76:79]
    v_mfma_f32_16x16x32_bf16 v[116:119], v[220:223], v[184:187], v[116:119]
    v_mfma_f32_16x16x32_bf16 v[156:159], v[220:223], v[188:191], v[156:159]
    s_waitcnt lgkmcnt(4)
    s_waitcnt vmcnt(13)
    v_mfma_f32_16x16x32_bf16 v[0:3], v[208:211], v[192:195], v[0:3]
    ds_read_b64_tr_b16 v[220:221], v233 offset:12288
    ds_read_b64_tr_b16 v[222:223], v233 offset:18432
    buffer_load_dwordx4 v[176:179], v243, s[16:19], s52 offen
    s_add_u32 s52, s52, 1024
    s_waitcnt vmcnt(13)
    v_mfma_f32_16x16x32_bf16 v[40:43], v[208:211], v[196:199], v[40:43]
    s_waitcnt vmcnt(12)
    v_mfma_f32_16x16x32_bf16 v[80:83], v[208:211], v[200:203], v[80:83]
    s_waitcnt vmcnt(11)
    v_mfma_f32_16x16x32_bf16 v[120:123], v[208:211], v[204:207], v[120:123]
    s_waitcnt lgkmcnt(4)
    v_mfma_f32_16x16x32_bf16 v[4:7], v[212:215], v[192:195], v[4:7]
    ds_read_b64_tr_b16 v[208:209], v234 offset:0
    ds_read_b64_tr_b16 v[210:211], v234 offset:6144
    s_add_u32 m0, s43, 122880
    s_nop 0
    buffer_load_dwordx4 v240, s[8:11], s40 offen lds
    v_mfma_f32_16x16x32_bf16 v[44:47], v[212:215], v[196:199], v[44:47]
    v_mfma_f32_16x16x32_bf16 v[84:87], v[212:215], v[200:203], v[84:87]
    v_mfma_f32_16x16x32_bf16 v[124:127], v[212:215], v[204:207], v[124:127]
    s_waitcnt lgkmcnt(4)
    v_mfma_f32_16x16x32_bf16 v[8:11], v[216:219], v[192:195], v[8:11]
    ds_read_b64_tr_b16 v[212:213], v234 offset:12288
    ds_read_b64_tr_b16 v[214:215], v234 offset:18432
    buffer_load_dwordx4 v[180:183], v243, s[16:19], s53 offen
    s_add_u32 s53, s53, 1024
    v_mfma_f32_16x16x32_bf16 v[48:51], v[216:219], v[196:199], v[48:51]
    v_mfma_f32_16x16x32_bf16 v[88:91], v[216:219], v[200:203], v[88:91]
    v_mfma_f32_16x16x32_bf16 v[128:131], v[216:219], v[204:207], v[128:131]
    s_add_u32 m0, s43, 123904
    s_nop 0
    buffer_load_dwordx4 v241, s[8:11], s40 offen lds
    s_waitcnt lgkmcnt(4)
    v_mfma_f32_16x16x32_bf16 v[12:15], v[220:223], v[192:195], v[12:15]
    ds_read_b64_tr_b16 v[216:217], v235 offset:0
    ds_read_b64_tr_b16 v[218:219], v235 offset:6144
    v_mfma_f32_16x16x32_bf16 v[52:55], v[220:223], v[196:199], v[52:55]
    v_mfma_f32_16x16x32_bf16 v[92:95], v[220:223], v[200:203], v[92:95]
    v_mfma_f32_16x16x32_bf16 v[132:135], v[220:223], v[204:207], v[132:135]
    buffer_load_dwordx4 v[184:187], v243, s[16:19], s54 offen
    s_add_u32 s54, s54, 1024
    s_waitcnt lgkmcnt(4)
    v_mfma_f32_16x16x32_bf16 v[16:19], v[208:211], v[192:195], v[16:19]
    ds_read_b64_tr_b16 v[220:221], v235 offset:12288
    ds_read_b64_tr_b16 v[222:223], v235 offset:18432
    v_mfma_f32_16x16x32_bf16 v[56:59], v[208:211], v[196:199], v[56:59]
    v_mfma_f32_16x16x32_bf16 v[96:99], v[208:211], v[200:203], v[96:99]
    s_add_u32 m0, s43, 124928
    s_nop 0
    buffer_load_dwordx4 v242, s[8:11], s40 offen lds
    s_add_u32 s40, s40, 294912
    v_mfma_f32_16x16x32_bf16 v[136:139], v[208:211], v[204:207], v[136:139]
    s_waitcnt vmcnt(10)
    s_barrier
    v_add_u32 v236, 24576, v232
    v_add_u32 v237, 24576, v233
    v_add_u32 v238, 24576, v234
    v_add_u32 v239, 24576, v235
    s_waitcnt lgkmcnt(4)
    v_mfma_f32_16x16x32_bf16 v[20:23], v[212:215], v[192:195], v[20:23]
    ds_read_b64_tr_b16 v[208:209], v232 offset:256
    ds_read_b64_tr_b16 v[210:211], v232 offset:6400
    v_mfma_f32_16x16x32_bf16 v[60:63], v[212:215], v[196:199], v[60:63]
    v_mfma_f32_16x16x32_bf16 v[100:103], v[212:215], v[200:203], v[100:103]
    buffer_load_dwordx4 v[188:191], v243, s[16:19], s55 offen
    s_add_u32 s55, s55, 1024
    v_mfma_f32_16x16x32_bf16 v[140:143], v[212:215], v[204:207], v[140:143]
    s_waitcnt lgkmcnt(4)
    v_mfma_f32_16x16x32_bf16 v[24:27], v[216:219], v[192:195], v[24:27]
    ds_read_b64_tr_b16 v[212:213], v232 offset:12544
    ds_read_b64_tr_b16 v[214:215], v232 offset:18688
    v_mfma_f32_16x16x32_bf16 v[64:67], v[216:219], v[196:199], v[64:67]
    v_mfma_f32_16x16x32_bf16 v[104:107], v[216:219], v[200:203], v[104:107]
    s_add_u32 m0, s43, 0
    s_nop 0
    buffer_load_dwordx4 v240, s[8:11], s40 offen lds
    v_mfma_f32_16x16x32_bf16 v[144:147], v[216:219], v[204:207], v[144:147]
    s_waitcnt lgkmcnt(4)
    v_mfma_f32_16x16x32_bf16 v[28:31], v[220:223], v[192:195], v[28:31]
    ds_read_b64_tr_b16 v[216:217], v236 offset:0
    ds_read_b64_tr_b16 v[218:219], v236 offset:6144
    v_mfma_f32_16x16x32_bf16 v[68:71], v[220:223], v[196:199], v[68:71]
    s_add_u32 m0, s43, 1024
    s_nop 0
    buffer_load_dwordx4 v241, s[8:11], s40 offen lds
    v_mfma_f32_16x16x32_bf16 v[108:111], v[220:223], v[200:203], v[108:111]
    v_mfma_f32_16x16x32_bf16 v[148:151], v[220:223], v[204:207], v[148:151]
    s_waitcnt lgkmcnt(4)
    v_mfma_f32_16x16x32_bf16 v[32:35], v[208:211], v[192:195], v[32:35]
    ds_read_b64_tr_b16 v[220:221], v236 offset:12288
    ds_read_b64_tr_b16 v[222:223], v236 offset:18432
    v_mfma_f32_16x16x32_bf16 v[72:75], v[208:211], v[196:199], v[72:75]
    s_add_u32 m0, s43, 2048
    s_nop 0
    buffer_load_dwordx4 v242, s[8:11], s40 offen lds
    s_add_u32 s40, s40, 294912
    v_mfma_f32_16x16x32_bf16 v[112:115], v[208:211], v[200:203], v[112:115]
    v_mfma_f32_16x16x32_bf16 v[152:155], v[208:211], v[204:207], v[152:155]
    s_waitcnt lgkmcnt(4)
    v_mfma_f32_16x16x32_bf16 v[36:39], v[212:215], v[192:195], v[36:39]
    ds_read_b64_tr_b16 v[208:209], v237 offset:0
    ds_read_b64_tr_b16 v[210:211], v237 offset:6144
    v_mfma_f32_16x16x32_bf16 v[76:79], v[212:215], v[196:199], v[76:79]
    v_mfma_f32_16x16x32_bf16 v[116:119], v[212:215], v[200:203], v[116:119]
    v_mfma_f32_16x16x32_bf16 v[156:159], v[212:215], v[204:207], v[156:159]
    s_waitcnt lgkmcnt(4)
    v_mfma_f32_16x16x32_bf16 v[0:3], v[216:219], v[160:163], v[0:3]
    ds_read_b64_tr_b16 v[212:213], v237 offset:12288
    ds_read_b64_tr_b16 v[214:215], v237 offset:18432
    v_mfma_f32_16x16x32_bf16 v[40:43], v[216:219], v[164:167], v[40:43]
    buffer_load_dwordx4 v[192:195], v243, s[16:19], s52 offen
    s_add_u32 s52, s52, 1024
    v_mfma_f32_16x16x32_bf16 v[80:83], v[216:219], v[168:171], v[80:83]
    s_waitcnt vmcnt(14)
    v_mfma_f32_16x16x32_bf16 v[120:123], v[216:219], v[172:175], v[120:123]
    s_waitcnt lgkmcnt(4)
    v_mfma_f32_16x16x32_bf16 v[4:7], v[220:223], v[160:163], v[4:7]
    ds_read_b64_tr_b16 v[216:217], v238 offset:0
    ds_read_b64_tr_b16 v[218:219], v238 offset:6144
    v_mfma_f32_16x16x32_bf16 v[44:47], v[220:223], v[164:167], v[44:47]
    v_mfma_f32_16x16x32_bf16 v[84:87], v[220:223], v[168:171], v[84:87]
    s_add_u32 m0, s43, 24576
    s_nop 0
    buffer_load_dwordx4 v240, s[8:11], s40 offen lds
    v_mfma_f32_16x16x32_bf16 v[124:127], v[220:223], v[172:175], v[124:127]
    s_waitcnt lgkmcnt(4)
    v_mfma_f32_16x16x32_bf16 v[8:11], v[208:211], v[160:163], v[8:11]
    ds_read_b64_tr_b16 v[220:221], v238 offset:12288
    ds_read_b64_tr_b16 v[222:223], v238 offset:18432
    v_mfma_f32_16x16x32_bf16 v[48:51], v[208:211], v[164:167], v[48:51]
    v_mfma_f32_16x16x32_bf16 v[88:91], v[208:211], v[168:171], v[88:91]
    v_mfma_f32_16x16x32_bf16 v[128:131], v[208:211], v[172:175], v[128:131]
    buffer_load_dwordx4 v[196:199], v243, s[16:19], s53 offen
    s_add_u32 s53, s53, 1024
    s_waitcnt lgkmcnt(4)
    v_mfma_f32_16x16x32_bf16 v[12:15], v[212:215], v[160:163], v[12:15]
    ds_read_b64_tr_b16 v[208:209], v239 offset:0
    ds_read_b64_tr_b16 v[210:211], v239 offset:6144
    v_mfma_f32_16x16x32_bf16 v[52:55], v[212:215], v[164:167], v[52:55]
    v_mfma_f32_16x16x32_bf16 v[92:95], v[212:215], v[168:171], v[92:95]
    v_mfma_f32_16x16x32_bf16 v[132:135], v[212:215], v[172:175], v[132:135]
    s_waitcnt lgkmcnt(4)
    v_mfma_f32_16x16x32_bf16 v[16:19], v[216:219], v[160:163], v[16:19]
    ds_read_b64_tr_b16 v[212:213], v239 offset:12288
    ds_read_b64_tr_b16 v[214:215], v239 offset:18432
    s_add_u32 m0, s43, 25600
    s_nop 0
    buffer_load_dwordx4 v241, s[8:11], s40 offen lds
    v_mfma_f32_16x16x32_bf16 v[56:59], v[216:219], v[164:167], v[56:59]
    v_mfma_f32_16x16x32_bf16 v[96:99], v[216:219], v[168:171], v[96:99]
    v_mfma_f32_16x16x32_bf16 v[136:139], v[216:219], v[172:175], v[136:139]
    s_waitcnt vmcnt(14)
    s_barrier
    v_add_u32 v232, 24576, v236
    v_add_u32 v233, 24576, v237
    v_add_u32 v234, 24576, v238
    v_add_u32 v235, 24576, v239
    s_waitcnt lgkmcnt(4)
    v_mfma_f32_16x16x32_bf16 v[20:23], v[220:223], v[160:163], v[20:23]
    ds_read_b64_tr_b16 v[216:217], v236 offset:256
    ds_read_b64_tr_b16 v[218:219], v236 offset:6400
    v_mfma_f32_16x16x32_bf16 v[60:63], v[220:223], v[164:167], v[60:63]
    buffer_load_dwordx4 v[200:203], v243, s[16:19], s54 offen
    s_add_u32 s54, s54, 1024
    v_mfma_f32_16x16x32_bf16 v[100:103], v[220:223], v[168:171], v[100:103]
    v_mfma_f32_16x16x32_bf16 v[140:143], v[220:223], v[172:175], v[140:143]
    s_waitcnt lgkmcnt(4)
    v_mfma_f32_16x16x32_bf16 v[24:27], v[208:211], v[160:163], v[24:27]
    ds_read_b64_tr_b16 v[220:221], v236 offset:12544
    ds_read_b64_tr_b16 v[222:223], v236 offset:18688
    v_mfma_f32_16x16x32_bf16 v[64:67], v[208:211], v[164:167], v[64:67]
    v_mfma_f32_16x16x32_bf16 v[104:107], v[208:211], v[168:171], v[104:107]
    v_mfma_f32_16x16x32_bf16 v[144:147], v[208:211], v[172:175], v[144:147]
    s_add_u32 m0, s43, 26624
    s_nop 0
    buffer_load_dwordx4 v242, s[8:11], s40 offen lds
    s_add_u32 s40, s40, 294912
    s_waitcnt lgkmcnt(4)
    v_mfma_f32_16x16x32_bf16 v[28:31], v[212:215], v[160:163], v[28:31]
    ds_read_b64_tr_b16 v[208:209], v232 offset:0
    ds_read_b64_tr_b16 v[210:211], v232 offset:6144
    v_mfma_f32_16x16x32_bf16 v[68:71], v[212:215], v[164:167], v[68:71]
    v_mfma_f32_16x16x32_bf16 v[108:111], v[212:215], v[168:171], v[108:111]
    v_mfma_f32_16x16x32_bf16 v[148:151], v[212:215], v[172:175], v[148:151]
    s_waitcnt lgkmcnt(4)
    v_mfma_f32_16x16x32_bf16 v[32:35], v[216:219], v[160:163], v[32:35]
    ds_read_b64_tr_b16 v[212:213], v232 offset:12288
    ds_read_b64_tr_b16 v[214:215], v232 offset:18432
    buffer_load_dwordx4 v[204:207], v243, s[16:19], s55 offen
    s_add_u32 s55, s55, 1024
    v_mfma_f32_16x16x32_bf16 v[72:75], v[216:219], v[164:167], v[72:75]
    v_mfma_f32_16x16x32_bf16 v[112:115], v[216:219], v[168:171], v[112:115]
    v_mfma_f32_16x16x32_bf16 v[152:155], v[216:219], v[172:175], v[152:155]
    s_waitcnt lgkmcnt(4)
    v_mfma_f32_16x16x32_bf16 v[36:39], v[220:223], v[160:163], v[36:39]
    ds_read_b64_tr_b16 v[216:217], v233 offset:0
    ds_read_b64_tr_b16 v[218:219], v233 offset:6144
    v_mfma_f32_16x16x32_bf16 v[76:79], v[220:223], v[164:167], v[76:79]
    v_mfma_f32_16x16x32_bf16 v[116:119], v[220:223], v[168:171], v[116:119]
    v_mfma_f32_16x16x32_bf16 v[156:159], v[220:223], v[172:175], v[156:159]
    s_waitcnt lgkmcnt(4)
    s_waitcnt vmcnt(16)
    v_mfma_f32_16x16x32_bf16 v[0:3], v[208:211], v[176:179], v[0:3]
    ds_read_b64_tr_b16 v[220:221], v233 offset:12288
    ds_read_b64_tr_b16 v[222:223], v233 offset:18432
    s_waitcnt vmcnt(14)
    v_mfma_f32_16x16x32_bf16 v[40:43], v[208:211], v[180:183], v[40:43]
    buffer_load_dwordx4 v[160:163], v243, s[16:19], s52 offen
    s_add_u32 s52, s52, 1024
    s_waitcnt vmcnt(13)
    v_mfma_f32_16x16x32_bf16 v[80:83], v[208:211], v[184:187], v[80:83]
    s_waitcnt vmcnt(11)
    v_mfma_f32_16x16x32_bf16 v[120:123], v[208:211], v[188:191], v[120:123]
    s_waitcnt lgkmcnt(4)
    v_mfma_f32_16x16x32_bf16 v[4:7], v[212:215], v[176:179], v[4:7]
    ds_read_b64_tr_b16 v[208:209], v234 offset:0
    ds_read_b64_tr_b16 v[210:211], v234 offset:6144
    v_mfma_f32_16x16x32_bf16 v[44:47], v[212:215], v[180:183], v[44:47]
    v_mfma_f32_16x16x32_bf16 v[84:87], v[212:215], v[184:187], v[84:87]
    s_add_u32 m0, s43, 49152
    s_nop 0
    buffer_load_dwordx4 v240, s[8:11], s40 offen lds
    v_mfma_f32_16x16x32_bf16 v[124:127], v[212:215], v[188:191], v[124:127]
    s_waitcnt lgkmcnt(4)
    v_mfma_f32_16x16x32_bf16 v[8:11], v[216:219], v[176:179], v[8:11]
    ds_read_b64_tr_b16 v[212:213], v234 offset:12288
    ds_read_b64_tr_b16 v[214:215], v234 offset:18432
    v_mfma_f32_16x16x32_bf16 v[48:51], v[216:219], v[180:183], v[48:51]
    v_mfma_f32_16x16x32_bf16 v[88:91], v[216:219], v[184:187], v[88:91]
    v_mfma_f32_16x16x32_bf16 v[128:131], v[216:219], v[188:191], v[128:131]
    buffer_load_dwordx4 v[164:167], v243, s[16:19], s53 offen
    s_add_u32 s53, s53, 1024
    s_waitcnt lgkmcnt(4)
    v_mfma_f32_16x16x32_bf16 v[12:15], v[220:223], v[176:179], v[12:15]
    ds_read_b64_tr_b16 v[216:217], v235 offset:0
    ds_read_b64_tr_b16 v[218:219], v235 offset:6144
    v_mfma_f32_16x16x32_bf16 v[52:55], v[220:223], v[180:183], v[52:55]
    v_mfma_f32_16x16x32_bf16 v[92:95], v[220:223], v[184:187], v[92:95]
    v_mfma_f32_16x16x32_bf16 v[132:135], v[220:223], v[188:191], v[132:135]
    s_waitcnt lgkmcnt(4)
    v_mfma_f32_16x16x32_bf16 v[16:19], v[208:211], v[176:179], v[16:19]
    ds_read_b64_tr_b16 v[220:221], v235 offset:12288
    ds_read_b64_tr_b16 v[222:223], v235 offset:18432
    s_add_u32 m0, s43, 50176
    s_nop 0
    buffer_load_dwordx4 v241, s[8:11], s40 offen lds
    v_mfma_f32_16x16x32_bf16 v[56:59], v[208:211], v[180:183], v[56:59]
    v_mfma_f32_16x16x32_bf16 v[96:99], v[208:211], v[184:187], v[96:99]
    v_mfma_f32_16x16x32_bf16 v[136:139], v[208:211], v[188:191], v[136:139]
    s_barrier
    v_add_u32 v236, 24576, v232
    v_add_u32 v237, 24576, v233
    v_add_u32 v238, 24576, v234
    v_add_u32 v239, 24576, v235
    s_waitcnt lgkmcnt(4)
    v_mfma_f32_16x16x32_bf16 v[20:23], v[212:215], v[176:179], v[20:23]
    ds_read_b64_tr_b16 v[208:209], v232 offset:256
    ds_read_b64_tr_b16 v[210:211], v232 offset:6400
    v_mfma_f32_16x16x32_bf16 v[60:63], v[212:215], v[180:183], v[60:63]
    buffer_load_dwordx4 v[168:171], v243, s[16:19], s54 offen
    s_add_u32 s54, s54, 1024
    v_mfma_f32_16x16x32_bf16 v[100:103], v[212:215], v[184:187], v[100:103]
    v_mfma_f32_16x16x32_bf16 v[140:143], v[212:215], v[188:191], v[140:143]
    s_waitcnt lgkmcnt(4)
    v_mfma_f32_16x16x32_bf16 v[24:27], v[216:219], v[176:179], v[24:27]
    ds_read_b64_tr_b16 v[212:213], v232 offset:12544
    ds_read_b64_tr_b16 v[214:215], v232 offset:18688
    v_mfma_f32_16x16x32_bf16 v[64:67], v[216:219], v[180:183], v[64:67]
    v_mfma_f32_16x16x32_bf16 v[104:107], v[216:219], v[184:187], v[104:107]
    v_mfma_f32_16x16x32_bf16 v[144:147], v[216:219], v[188:191], v[144:147]
    s_add_u32 m0, s43, 51200
    s_nop 0
    buffer_load_dwordx4 v242, s[8:11], s40 offen lds
    s_add_u32 s40, s40, 294912
    s_waitcnt lgkmcnt(4)
    v_mfma_f32_16x16x32_bf16 v[28:31], v[220:223], v[176:179], v[28:31]
    ds_read_b64_tr_b16 v[216:217], v236 offset:0
    ds_read_b64_tr_b16 v[218:219], v236 offset:6144
    v_mfma_f32_16x16x32_bf16 v[68:71], v[220:223], v[180:183], v[68:71]
    v_mfma_f32_16x16x32_bf16 v[108:111], v[220:223], v[184:187], v[108:111]
    v_mfma_f32_16x16x32_bf16 v[148:151], v[220:223], v[188:191], v[148:151]
    s_waitcnt lgkmcnt(4)
    v_mfma_f32_16x16x32_bf16 v[32:35], v[208:211], v[176:179], v[32:35]
    ds_read_b64_tr_b16 v[220:221], v236 offset:12288
    ds_read_b64_tr_b16 v[222:223], v236 offset:18432
    buffer_load_dwordx4 v[172:175], v243, s[16:19], s55 offen
    s_add_u32 s55, s55, 1024
    v_mfma_f32_16x16x32_bf16 v[72:75], v[208:211], v[180:183], v[72:75]
    v_mfma_f32_16x16x32_bf16 v[112:115], v[208:211], v[184:187], v[112:115]
    v_mfma_f32_16x16x32_bf16 v[152:155], v[208:211], v[188:191], v[152:155]
    s_waitcnt lgkmcnt(4)
    v_mfma_f32_16x16x32_bf16 v[36:39], v[212:215], v[176:179], v[36:39]
    ds_read_b64_tr_b16 v[208:209], v237 offset:0
    ds_read_b64_tr_b16 v[210:211], v237 offset:6144
    v_mfma_f32_16x16x32_bf16 v[76:79], v[212:215], v[180:183], v[76:79]
    v_mfma_f32_16x16x32_bf16 v[116:119], v[212:215], v[184:187], v[116:119]
    v_mfma_f32_16x16x32_bf16 v[156:159], v[212:215], v[188:191], v[156:159]
    s_waitcnt lgkmcnt(4)
    s_waitcnt vmcnt(13)
    v_mfma_f32_16x16x32_bf16 v[0:3], v[216:219], v[192:195], v[0:3]
    ds_read_b64_tr_b16 v[212:213], v237 offset:12288
    ds_read_b64_tr_b16 v[214:215], v237 offset:18432
    s_waitcnt vmcnt(11)
    v_mfma_f32_16x16x32_bf16 v[40:43], v[216:219], v[196:199], v[40:43]
    buffer_load_dwordx4 v[176:179], v243, s[16:19], s52 offen
    s_add_u32 s52, s52, 1024
    s_waitcnt vmcnt(10)
    v_mfma_f32_16x16x32_bf16 v[80:83], v[216:219], v[200:203], v[80:83]
    s_waitcnt vmcnt(8)
    v_mfma_f32_16x16x32_bf16 v[120:123], v[216:219], v[204:207], v[120:123]
    s_waitcnt lgkmcnt(4)
    v_mfma_f32_16x16x32_bf16 v[4:7], v[220:223], v[192:195], v[4:7]
    ds_read_b64_tr_b16 v[216:217], v238 offset:0
    ds_read_b64_tr_b16 v[218:219], v238 offset:6144
    v_mfma_f32_16x16x32_bf16 v[44:47], v[220:223], v[196:199], v[44:47]
    v_mfma_f32_16x16x32_bf16 v[84:87], v[220:223], v[200:203], v[84:87]
    s_add_u32 m0, s43, 73728
    s_nop 0
    buffer_load_dwordx4 v240, s[8:11], s40 offen lds
    v_mfma_f32_16x16x32_bf16 v[124:127], v[220:223], v[204:207], v[124:127]
    s_waitcnt lgkmcnt(4)
    v_mfma_f32_16x16x32_bf16 v[8:11], v[208:211], v[192:195], v[8:11]
    ds_read_b64_tr_b16 v[220:221], v238 offset:12288
    ds_read_b64_tr_b16 v[222:223], v238 offset:18432
    v_mfma_f32_16x16x32_bf16 v[48:51], v[208:211], v[196:199], v[48:51]
    v_mfma_f32_16x16x32_bf16 v[88:91], v[208:211], v[200:203], v[88:91]
    v_mfma_f32_16x16x32_bf16 v[128:131], v[208:211], v[204:207], v[128:131]
    buffer_load_dwordx4 v[180:183], v243, s[16:19], s53 offen
    s_add_u32 s53, s53, 1024
    s_waitcnt lgkmcnt(4)
    v_mfma_f32_16x16x32_bf16 v[12:15], v[212:215], v[192:195], v[12:15]
    ds_read_b64_tr_b16 v[208:209], v239 offset:0
    ds_read_b64_tr_b16 v[210:211], v239 offset:6144
    v_mfma_f32_16x16x32_bf16 v[52:55], v[212:215], v[196:199], v[52:55]
    v_mfma_f32_16x16x32_bf16 v[92:95], v[212:215], v[200:203], v[92:95]
    v_mfma_f32_16x16x32_bf16 v[132:135], v[212:215], v[204:207], v[132:135]
    s_waitcnt lgkmcnt(4)
    v_mfma_f32_16x16x32_bf16 v[16:19], v[216:219], v[192:195], v[16:19]
    ds_read_b64_tr_b16 v[212:213], v239 offset:12288
    ds_read_b64_tr_b16 v[214:215], v239 offset:18432
    s_add_u32 m0, s43, 74752
    s_nop 0
    buffer_load_dwordx4 v241, s[8:11], s40 offen lds
    v_mfma_f32_16x16x32_bf16 v[56:59], v[216:219], v[196:199], v[56:59]
    v_mfma_f32_16x16x32_bf16 v[96:99], v[216:219], v[200:203], v[96:99]
    v_mfma_f32_16x16x32_bf16 v[136:139], v[216:219], v[204:207], v[136:139]
    s_barrier
    v_add_u32 v232, -122880, v236
    v_add_u32 v233, -122880, v237
    v_add_u32 v234, -122880, v238
    v_add_u32 v235, -122880, v239
    s_waitcnt lgkmcnt(4)
    v_mfma_f32_16x16x32_bf16 v[20:23], v[220:223], v[192:195], v[20:23]
    ds_read_b64_tr_b16 v[216:217], v236 offset:256
    ds_read_b64_tr_b16 v[218:219], v236 offset:6400
    v_mfma_f32_16x16x32_bf16 v[60:63], v[220:223], v[196:199], v[60:63]
    buffer_load_dwordx4 v[184:187], v243, s[16:19], s54 offen
    s_add_u32 s54, s54, 1024
    v_mfma_f32_16x16x32_bf16 v[100:103], v[220:223], v[200:203], v[100:103]
    v_mfma_f32_16x16x32_bf16 v[140:143], v[220:223], v[204:207], v[140:143]
    s_waitcnt lgkmcnt(4)
    v_mfma_f32_16x16x32_bf16 v[24:27], v[208:211], v[192:195], v[24:27]
    ds_read_b64_tr_b16 v[220:221], v236 offset:12544
    ds_read_b64_tr_b16 v[222:223], v236 offset:18688
    v_mfma_f32_16x16x32_bf16 v[64:67], v[208:211], v[196:199], v[64:67]
    v_mfma_f32_16x16x32_bf16 v[104:107], v[208:211], v[200:203], v[104:107]
    v_mfma_f32_16x16x32_bf16 v[144:147], v[208:211], v[204:207], v[144:147]
    s_add_u32 m0, s43, 75776
    s_nop 0
    buffer_load_dwordx4 v242, s[8:11], s40 offen lds
    s_add_u32 s40, s40, 294912
    s_waitcnt lgkmcnt(4)
    v_mfma_f32_16x16x32_bf16 v[28:31], v[212:215], v[192:195], v[28:31]
    ds_read_b64_tr_b16 v[208:209], v232 offset:0
    ds_read_b64_tr_b16 v[210:211], v232 offset:6144
    v_mfma_f32_16x16x32_bf16 v[68:71], v[212:215], v[196:199], v[68:71]
    v_mfma_f32_16x16x32_bf16 v[108:111], v[212:215], v[200:203], v[108:111]
    v_mfma_f32_16x16x32_bf16 v[148:151], v[212:215], v[204:207], v[148:151]
    s_waitcnt lgkmcnt(4)
    v_mfma_f32_16x16x32_bf16 v[32:35], v[216:219], v[192:195], v[32:35]
    ds_read_b64_tr_b16 v[212:213], v232 offset:12288
    ds_read_b64_tr_b16 v[214:215], v232 offset:18432
    buffer_load_dwordx4 v[188:191], v243, s[16:19], s55 offen
    s_add_u32 s55, s55, 1024
    v_mfma_f32_16x16x32_bf16 v[72:75], v[216:219], v[196:199], v[72:75]
    v_mfma_f32_16x16x32_bf16 v[112:115], v[216:219], v[200:203], v[112:115]
    v_mfma_f32_16x16x32_bf16 v[152:155], v[216:219], v[204:207], v[152:155]
    s_waitcnt lgkmcnt(4)
    v_mfma_f32_16x16x32_bf16 v[36:39], v[220:223], v[192:195], v[36:39]
    ds_read_b64_tr_b16 v[216:217], v233 offset:0
    ds_read_b64_tr_b16 v[218:219], v233 offset:6144
    v_mfma_f32_16x16x32_bf16 v[76:79], v[220:223], v[196:199], v[76:79]
    v_mfma_f32_16x16x32_bf16 v[116:119], v[220:223], v[200:203], v[116:119]
    v_mfma_f32_16x16x32_bf16 v[156:159], v[220:223], v[204:207], v[156:159]
    s_waitcnt lgkmcnt(4)
    s_waitcnt vmcnt(13)
    v_mfma_f32_16x16x32_bf16 v[0:3], v[208:211], v[160:163], v[0:3]
    ds_read_b64_tr_b16 v[220:221], v233 offset:12288
    ds_read_b64_tr_b16 v[222:223], v233 offset:18432
    s_waitcnt vmcnt(11)
    v_mfma_f32_16x16x32_bf16 v[40:43], v[208:211], v[164:167], v[40:43]
    buffer_load_dwordx4 v[192:195], v243, s[16:19], s52 offen
    s_add_u32 s52, s52, 1024
    s_waitcnt vmcnt(10)
    v_mfma_f32_16x16x32_bf16 v[80:83], v[208:211], v[168:171], v[80:83]
    s_waitcnt vmcnt(8)
    v_mfma_f32_16x16x32_bf16 v[120:123], v[208:211], v[172:175], v[120:123]
    s_waitcnt lgkmcnt(4)
    v_mfma_f32_16x16x32_bf16 v[4:7], v[212:215], v[160:163], v[4:7]
    ds_read_b64_tr_b16 v[208:209], v234 offset:0
    ds_read_b64_tr_b16 v[210:211], v234 offset:6144
    v_mfma_f32_16x16x32_bf16 v[44:47], v[212:215], v[164:167], v[44:47]
    v_mfma_f32_16x16x32_bf16 v[84:87], v[212:215], v[168:171], v[84:87]
    s_add_u32 m0, s43, 98304
    s_nop 0
    buffer_load_dwordx4 v240, s[8:11], s40 offen lds
    v_mfma_f32_16x16x32_bf16 v[124:127], v[212:215], v[172:175], v[124:127]
    s_waitcnt lgkmcnt(4)
    v_mfma_f32_16x16x32_bf16 v[8:11], v[216:219], v[160:163], v[8:11]
    ds_read_b64_tr_b16 v[212:213], v234 offset:12288
    ds_read_b64_tr_b16 v[214:215], v234 offset:18432
    v_mfma_f32_16x16x32_bf16 v[48:51], v[216:219], v[164:167], v[48:51]
    v_mfma_f32_16x16x32_bf16 v[88:91], v[216:219], v[168:171], v[88:91]
    v_mfma_f32_16x16x32_bf16 v[128:131], v[216:219], v[172:175], v[128:131]
    buffer_load_dwordx4 v[196:199], v243, s[16:19], s53 offen
    s_add_u32 s53, s53, 1024
    s_waitcnt lgkmcnt(4)
    v_mfma_f32_16x16x32_bf16 v[12:15], v[220:223], v[160:163], v[12:15]
    ds_read_b64_tr_b16 v[216:217], v235 offset:0
    ds_read_b64_tr_b16 v[218:219], v235 offset:6144
    v_mfma_f32_16x16x32_bf16 v[52:55], v[220:223], v[164:167], v[52:55]
    v_mfma_f32_16x16x32_bf16 v[92:95], v[220:223], v[168:171], v[92:95]
    v_mfma_f32_16x16x32_bf16 v[132:135], v[220:223], v[172:175], v[132:135]
    s_waitcnt lgkmcnt(4)
    v_mfma_f32_16x16x32_bf16 v[16:19], v[208:211], v[160:163], v[16:19]
    ds_read_b64_tr_b16 v[220:221], v235 offset:12288
    ds_read_b64_tr_b16 v[222:223], v235 offset:18432
    s_add_u32 m0, s43, 99328
    s_nop 0
    buffer_load_dwordx4 v241, s[8:11], s40 offen lds
    v_mfma_f32_16x16x32_bf16 v[56:59], v[208:211], v[164:167], v[56:59]
    v_mfma_f32_16x16x32_bf16 v[96:99], v[208:211], v[168:171], v[96:99]
    v_mfma_f32_16x16x32_bf16 v[136:139], v[208:211], v[172:175], v[136:139]
    s_barrier
    v_add_u32 v236, 24576, v232
    v_add_u32 v237, 24576, v233
    v_add_u32 v238, 24576, v234
    v_add_u32 v239, 24576, v235
    s_waitcnt lgkmcnt(4)
    v_mfma_f32_16x16x32_bf16 v[20:23], v[212:215], v[160:163], v[20:23]
    ds_read_b64_tr_b16 v[208:209], v232 offset:256
    ds_read_b64_tr_b16 v[210:211], v232 offset:6400
    v_mfma_f32_16x16x32_bf16 v[60:63], v[212:215], v[164:167], v[60:63]
    buffer_load_dwordx4 v[200:203], v243, s[16:19], s54 offen
    s_add_u32 s54, s54, 1024
    v_mfma_f32_16x16x32_bf16 v[100:103], v[212:215], v[168:171], v[100:103]
    v_mfma_f32_16x16x32_bf16 v[140:143], v[212:215], v[172:175], v[140:143]
    s_waitcnt lgkmcnt(4)
    v_mfma_f32_16x16x32_bf16 v[24:27], v[216:219], v[160:163], v[24:27]
    ds_read_b64_tr_b16 v[212:213], v232 offset:12544
    ds_read_b64_tr_b16 v[214:215], v232 offset:18688
    v_mfma_f32_16x16x32_bf16 v[64:67], v[216:219], v[164:167], v[64:67]
    v_mfma_f32_16x16x32_bf16 v[104:107], v[216:219], v[168:171], v[104:107]
    v_mfma_f32_16x16x32_bf16 v[144:147], v[216:219], v[172:175], v[144:147]
    s_add_u32 m0, s43, 100352
    s_nop 0
    buffer_load_dwordx4 v242, s[8:11], s40 offen lds
    s_add_u32 s40, s40, 294912
    s_waitcnt lgkmcnt(4)
    v_mfma_f32_16x16x32_bf16 v[28:31], v[220:223], v[160:163], v[28:31]
    ds_read_b64_tr_b16 v[216:217], v236 offset:0
    ds_read_b64_tr_b16 v[218:219], v236 offset:6144
    v_mfma_f32_16x16x32_bf16 v[68:71], v[220:223], v[164:167], v[68:71]
    v_mfma_f32_16x16x32_bf16 v[108:111], v[220:223], v[168:171], v[108:111]
    v_mfma_f32_16x16x32_bf16 v[148:151], v[220:223], v[172:175], v[148:151]
    s_waitcnt lgkmcnt(4)
    v_mfma_f32_16x16x32_bf16 v[32:35], v[208:211], v[160:163], v[32:35]
    ds_read_b64_tr_b16 v[220:221], v236 offset:12288
    ds_read_b64_tr_b16 v[222:223], v236 offset:18432
    buffer_load_dwordx4 v[204:207], v243, s[16:19], s55 offen
    s_add_u32 s55, s55, 1024
    v_mfma_f32_16x16x32_bf16 v[72:75], v[208:211], v[164:167], v[72:75]
    v_mfma_f32_16x16x32_bf16 v[112:115], v[208:211], v[168:171], v[112:115]
    v_mfma_f32_16x16x32_bf16 v[152:155], v[208:211], v[172:175], v[152:155]
    s_waitcnt lgkmcnt(4)
    v_mfma_f32_16x16x32_bf16 v[36:39], v[212:215], v[160:163], v[36:39]
    ds_read_b64_tr_b16 v[208:209], v237 offset:0
    ds_read_b64_tr_b16 v[210:211], v237 offset:6144
    v_mfma_f32_16x16x32_bf16 v[76:79], v[212:215], v[164:167], v[76:79]
    v_mfma_f32_16x16x32_bf16 v[116:119], v[212:215], v[168:171], v[116:119]
    v_mfma_f32_16x16x32_bf16 v[156:159], v[212:215], v[172:175], v[156:159]
    s_waitcnt lgkmcnt(4)
    s_waitcnt vmcnt(13)
    v_mfma_f32_16x16x32_bf16 v[0:3], v[216:219], v[176:179], v[0:3]
    ds_read_b64_tr_b16 v[212:213], v237 offset:12288
    ds_read_b64_tr_b16 v[214:215], v237 offset:18432
    s_waitcnt vmcnt(11)
    v_mfma_f32_16x16x32_bf16 v[40:43], v[216:219], v[180:183], v[40:43]
    buffer_load_dwordx4 v[160:163], v243, s[16:19], s52 offen
    s_add_u32 s52, s52, 1024
    s_waitcnt vmcnt(10)
    v_mfma_f32_16x16x32_bf16 v[80:83], v[216:219], v[184:187], v[80:83]
    s_waitcnt vmcnt(8)
    v_mfma_f32_16x16x32_bf16 v[120:123], v[216:219], v[188:191], v[120:123]
    s_waitcnt lgkmcnt(4)
    v_mfma_f32_16x16x32_bf16 v[4:7], v[220:223], v[176:179], v[4:7]
    ds_read_b64_tr_b16 v[216:217], v238 offset:0
    ds_read_b64_tr_b16 v[218:219], v238 offset:6144
    v_mfma_f32_16x16x32_bf16 v[44:47], v[220:223], v[180:183], v[44:47]
    v_mfma_f32_16x16x32_bf16 v[84:87], v[220:223], v[184:187], v[84:87]
    s_add_u32 m0, s43, 122880
    s_nop 0
    buffer_load_dwordx4 v240, s[8:11], s40 offen lds
    v_mfma_f32_16x16x32_bf16 v[124:127], v[220:223], v[188:191], v[124:127]
    s_waitcnt lgkmcnt(4)
    v_mfma_f32_16x16x32_bf16 v[8:11], v[208:211], v[176:179], v[8:11]
    ds_read_b64_tr_b16 v[220:221], v238 offset:12288
    ds_read_b64_tr_b16 v[222:223], v238 offset:18432
    v_mfma_f32_16x16x32_bf16 v[48:51], v[208:211], v[180:183], v[48:51]
    v_mfma_f32_16x16x32_bf16 v[88:91], v[208:211], v[184:187], v[88:91]
    v_mfma_f32_16x16x32_bf16 v[128:131], v[208:211], v[188:191], v[128:131]
    buffer_load_dwordx4 v[164:167], v243, s[16:19], s53 offen
    s_add_u32 s53, s53, 1024
    s_waitcnt lgkmcnt(4)
    v_mfma_f32_16x16x32_bf16 v[12:15], v[212:215], v[176:179], v[12:15]
    ds_read_b64_tr_b16 v[208:209], v239 offset:0
    ds_read_b64_tr_b16 v[210:211], v239 offset:6144
    v_mfma_f32_16x16x32_bf16 v[52:55], v[212:215], v[180:183], v[52:55]
    v_mfma_f32_16x16x32_bf16 v[92:95], v[212:215], v[184:187], v[92:95]
    v_mfma_f32_16x16x32_bf16 v[132:135], v[212:215], v[188:191], v[132:135]
    s_waitcnt lgkmcnt(4)
    v_mfma_f32_16x16x32_bf16 v[16:19], v[216:219], v[176:179], v[16:19]
    ds_read_b64_tr_b16 v[212:213], v239 offset:12288
    ds_read_b64_tr_b16 v[214:215], v239 offset:18432
    s_add_u32 m0, s43, 123904
    s_nop 0
    buffer_load_dwordx4 v241, s[8:11], s40 offen lds
    v_mfma_f32_16x16x32_bf16 v[56:59], v[216:219], v[180:183], v[56:59]
    v_mfma_f32_16x16x32_bf16 v[96:99], v[216:219], v[184:187], v[96:99]
    v_mfma_f32_16x16x32_bf16 v[136:139], v[216:219], v[188:191], v[136:139]
    s_barrier
    v_add_u32 v232, 24576, v236
    v_add_u32 v233, 24576, v237
    v_add_u32 v234, 24576, v238
    v_add_u32 v235, 24576, v239
    s_waitcnt lgkmcnt(4)
    v_mfma_f32_16x16x32_bf16 v[20:23], v[220:223], v[176:179], v[20:23]
    ds_read_b64_tr_b16 v[216:217], v236 offset:256
    ds_read_b64_tr_b16 v[218:219], v236 offset:6400
    v_mfma_f32_16x16x32_bf16 v[60:63], v[220:223], v[180:183], v[60:63]
    buffer_load_dwordx4 v[168:171], v243, s[16:19], s54 offen
    s_add_u32 s54, s54, 1024
    v_mfma_f32_16x16x32_bf16 v[100:103], v[220:223], v[184:187], v[100:103]
    v_mfma_f32_16x16x32_bf16 v[140:143], v[220:223], v[188:191], v[140:143]
    s_waitcnt lgkmcnt(4)
    v_mfma_f32_16x16x32_bf16 v[24:27], v[208:211], v[176:179], v[24:27]
    ds_read_b64_tr_b16 v[220:221], v236 offset:12544
    ds_read_b64_tr_b16 v[222:223], v236 offset:18688
    v_mfma_f32_16x16x32_bf16 v[64:67], v[208:211], v[180:183], v[64:67]
    v_mfma_f32_16x16x32_bf16 v[104:107], v[208:211], v[184:187], v[104:107]
    v_mfma_f32_16x16x32_bf16 v[144:147], v[208:211], v[188:191], v[144:147]
    s_add_u32 m0, s43, 124928
    s_nop 0
    buffer_load_dwordx4 v242, s[8:11], s40 offen lds
    s_add_u32 s40, s40, 294912
    s_waitcnt lgkmcnt(4)
    v_mfma_f32_16x16x32_bf16 v[28:31], v[212:215], v[176:179], v[28:31]
    ds_read_b64_tr_b16 v[208:209], v232 offset:0
    ds_read_b64_tr_b16 v[210:211], v232 offset:6144
    v_mfma_f32_16x16x32_bf16 v[68:71], v[212:215], v[180:183], v[68:71]
    v_mfma_f32_16x16x32_bf16 v[108:111], v[212:215], v[184:187], v[108:111]
    v_mfma_f32_16x16x32_bf16 v[148:151], v[212:215], v[188:191], v[148:151]
    s_waitcnt lgkmcnt(4)
    v_mfma_f32_16x16x32_bf16 v[32:35], v[216:219], v[176:179], v[32:35]
    ds_read_b64_tr_b16 v[212:213], v232 offset:12288
    ds_read_b64_tr_b16 v[214:215], v232 offset:18432
    buffer_load_dwordx4 v[172:175], v243, s[16:19], s55 offen
    s_add_u32 s55, s55, 1024
    v_mfma_f32_16x16x32_bf16 v[72:75], v[216:219], v[180:183], v[72:75]
    v_mfma_f32_16x16x32_bf16 v[112:115], v[216:219], v[184:187], v[112:115]
    v_mfma_f32_16x16x32_bf16 v[152:155], v[216:219], v[188:191], v[152:155]
    s_waitcnt lgkmcnt(4)
    v_mfma_f32_16x16x32_bf16 v[36:39], v[220:223], v[176:179], v[36:39]
    ds_read_b64_tr_b16 v[216:217], v233 offset:0
    ds_read_b64_tr_b16 v[218:219], v233 offset:6144
    v_mfma_f32_16x16x32_bf16 v[76:79], v[220:223], v[180:183], v[76:79]
    v_mfma_f32_16x16x32_bf16 v[116:119], v[220:223], v[184:187], v[116:119]
    v_mfma_f32_16x16x32_bf16 v[156:159], v[220:223], v[188:191], v[156:159]
    s_waitcnt lgkmcnt(4)
    s_waitcnt vmcnt(13)
    v_mfma_f32_16x16x32_bf16 v[0:3], v[208:211], v[192:195], v[0:3]
    ds_read_b64_tr_b16 v[220:221], v233 offset:12288
    ds_read_b64_tr_b16 v[222:223], v233 offset:18432
    s_waitcnt vmcnt(11)
    v_mfma_f32_16x16x32_bf16 v[40:43], v[208:211], v[196:199], v[40:43]
    buffer_load_dwordx4 v[176:179], v243, s[16:19], s52 offen
    s_add_u32 s52, s52, 1024
    s_waitcnt vmcnt(10)
    v_mfma_f32_16x16x32_bf16 v[80:83], v[208:211], v[200:203], v[80:83]
    s_waitcnt vmcnt(8)
    v_mfma_f32_16x16x32_bf16 v[120:123], v[208:211], v[204:207], v[120:123]
    s_waitcnt lgkmcnt(4)
    v_mfma_f32_16x16x32_bf16 v[4:7], v[212:215], v[192:195], v[4:7]
    ds_read_b64_tr_b16 v[208:209], v234 offset:0
    ds_read_b64_tr_b16 v[210:211], v234 offset:6144
    v_mfma_f32_16x16x32_bf16 v[44:47], v[212:215], v[196:199], v[44:47]
    v_mfma_f32_16x16x32_bf16 v[84:87], v[212:215], v[200:203], v[84:87]
    s_add_u32 m0, s43, 0
    s_nop 0
    buffer_load_dwordx4 v240, s[8:11], s40 offen lds
    v_mfma_f32_16x16x32_bf16 v[124:127], v[212:215], v[204:207], v[124:127]
    s_waitcnt lgkmcnt(4)
    v_mfma_f32_16x16x32_bf16 v[8:11], v[216:219], v[192:195], v[8:11]
    ds_read_b64_tr_b16 v[212:213], v234 offset:12288
    ds_read_b64_tr_b16 v[214:215], v234 offset:18432
    v_mfma_f32_16x16x32_bf16 v[48:51], v[216:219], v[196:199], v[48:51]
    v_mfma_f32_16x16x32_bf16 v[88:91], v[216:219], v[200:203], v[88:91]
    v_mfma_f32_16x16x32_bf16 v[128:131], v[216:219], v[204:207], v[128:131]
    buffer_load_dwordx4 v[180:183], v243, s[16:19], s53 offen
    s_add_u32 s53, s53, 1024
    s_waitcnt lgkmcnt(4)
    v_mfma_f32_16x16x32_bf16 v[12:15], v[220:223], v[192:195], v[12:15]
    ds_read_b64_tr_b16 v[216:217], v235 offset:0
    ds_read_b64_tr_b16 v[218:219], v235 offset:6144
    v_mfma_f32_16x16x32_bf16 v[52:55], v[220:223], v[196:199], v[52:55]
    v_mfma_f32_16x16x32_bf16 v[92:95], v[220:223], v[200:203], v[92:95]
    v_mfma_f32_16x16x32_bf16 v[132:135], v[220:223], v[204:207], v[132:135]
    s_waitcnt lgkmcnt(4)
    v_mfma_f32_16x16x32_bf16 v[16:19], v[208:211], v[192:195], v[16:19]
    ds_read_b64_tr_b16 v[220:221], v235 offset:12288
    ds_read_b64_tr_b16 v[222:223], v235 offset:18432
    s_add_u32 m0, s43, 1024
    s_nop 0
    buffer_load_dwordx4 v241, s[8:11], s40 offen lds
    v_mfma_f32_16x16x32_bf16 v[56:59], v[208:211], v[196:199], v[56:59]
    v_mfma_f32_16x16x32_bf16 v[96:99], v[208:211], v[200:203], v[96:99]
    v_mfma_f32_16x16x32_bf16 v[136:139], v[208:211], v[204:207], v[136:139]
    s_barrier
    v_add_u32 v236, 24576, v232
    v_add_u32 v237, 24576, v233
    v_add_u32 v238, 24576, v234
    v_add_u32 v239, 24576, v235
    s_waitcnt lgkmcnt(4)
    v_mfma_f32_16x16x32_bf16 v[20:23], v[212:215], v[192:195], v[20:23]
    ds_read_b64_tr_b16 v[208:209], v232 offset:256
    ds_read_b64_tr_b16 v[210:211], v232 offset:6400
    v_mfma_f32_16x16x32_bf16 v[60:63], v[212:215], v[196:199], v[60:63]
    buffer_load_dwordx4 v[184:187], v243, s[16:19], s54 offen
    s_add_u32 s54, s54, 1024
    v_mfma_f32_16x16x32_bf16 v[100:103], v[212:215], v[200:203], v[100:103]
    v_mfma_f32_16x16x32_bf16 v[140:143], v[212:215], v[204:207], v[140:143]
    s_waitcnt lgkmcnt(4)
    v_mfma_f32_16x16x32_bf16 v[24:27], v[216:219], v[192:195], v[24:27]
    ds_read_b64_tr_b16 v[212:213], v232 offset:12544
    ds_read_b64_tr_b16 v[214:215], v232 offset:18688
    v_mfma_f32_16x16x32_bf16 v[64:67], v[216:219], v[196:199], v[64:67]
    v_mfma_f32_16x16x32_bf16 v[104:107], v[216:219], v[200:203], v[104:107]
    v_mfma_f32_16x16x32_bf16 v[144:147], v[216:219], v[204:207], v[144:147]
    s_add_u32 m0, s43, 2048
    s_nop 0
    buffer_load_dwordx4 v242, s[8:11], s40 offen lds
    s_add_u32 s40, s40, 294912
    s_waitcnt lgkmcnt(4)
    v_mfma_f32_16x16x32_bf16 v[28:31], v[220:223], v[192:195], v[28:31]
    ds_read_b64_tr_b16 v[216:217], v236 offset:0
    ds_read_b64_tr_b16 v[218:219], v236 offset:6144
    v_mfma_f32_16x16x32_bf16 v[68:71], v[220:223], v[196:199], v[68:71]
    v_mfma_f32_16x16x32_bf16 v[108:111], v[220:223], v[200:203], v[108:111]
    v_mfma_f32_16x16x32_bf16 v[148:151], v[220:223], v[204:207], v[148:151]
    s_waitcnt lgkmcnt(4)
    v_mfma_f32_16x16x32_bf16 v[32:35], v[208:211], v[192:195], v[32:35]
    ds_read_b64_tr_b16 v[220:221], v236 offset:12288
    ds_read_b64_tr_b16 v[222:223], v236 offset:18432
    buffer_load_dwordx4 v[188:191], v243, s[16:19], s55 offen
    s_add_u32 s55, s55, 1024
    v_mfma_f32_16x16x32_bf16 v[72:75], v[208:211], v[196:199], v[72:75]
    v_mfma_f32_16x16x32_bf16 v[112:115], v[208:211], v[200:203], v[112:115]
    v_mfma_f32_16x16x32_bf16 v[152:155], v[208:211], v[204:207], v[152:155]
    s_waitcnt lgkmcnt(4)
    v_mfma_f32_16x16x32_bf16 v[36:39], v[212:215], v[192:195], v[36:39]
    ds_read_b64_tr_b16 v[208:209], v237 offset:0
    ds_read_b64_tr_b16 v[210:211], v237 offset:6144
    v_mfma_f32_16x16x32_bf16 v[76:79], v[212:215], v[196:199], v[76:79]
    v_mfma_f32_16x16x32_bf16 v[116:119], v[212:215], v[200:203], v[116:119]
    v_mfma_f32_16x16x32_bf16 v[156:159], v[212:215], v[204:207], v[156:159]
    s_waitcnt lgkmcnt(4)
    s_waitcnt vmcnt(13)
    v_mfma_f32_16x16x32_bf16 v[0:3], v[216:219], v[160:163], v[0:3]
    ds_read_b64_tr_b16 v[212:213], v237 offset:12288
    ds_read_b64_tr_b16 v[214:215], v237 offset:18432
    s_waitcnt vmcnt(11)
    v_mfma_f32_16x16x32_bf16 v[40:43], v[216:219], v[164:167], v[40:43]
    buffer_load_dwordx4 v[192:195], v243, s[16:19], s52 offen
    s_add_u32 s52, s52, 1024
    s_waitcnt vmcnt(10)
    v_mfma_f32_16x16x32_bf16 v[80:83], v[216:219], v[168:171], v[80:83]
    s_waitcnt vmcnt(8)
    v_mfma_f32_16x16x32_bf16 v[120:123], v[216:219], v[172:175], v[120:123]
    s_waitcnt lgkmcnt(4)
    v_mfma_f32_16x16x32_bf16 v[4:7], v[220:223], v[160:163], v[4:7]
    ds_read_b64_tr_b16 v[216:217], v238 offset:0
    ds_read_b64_tr_b16 v[218:219], v238 offset:6144
    v_mfma_f32_16x16x32_bf16 v[44:47], v[220:223], v[164:167], v[44:47]
    v_mfma_f32_16x16x32_bf16 v[84:87], v[220:223], v[168:171], v[84:87]
    s_add_u32 m0, s43, 24576
    s_nop 0
    buffer_load_dwordx4 v240, s[8:11], s40 offen lds
    v_mfma_f32_16x16x32_bf16 v[124:127], v[220:223], v[172:175], v[124:127]
    s_waitcnt lgkmcnt(4)
    v_mfma_f32_16x16x32_bf16 v[8:11], v[208:211], v[160:163], v[8:11]
    ds_read_b64_tr_b16 v[220:221], v238 offset:12288
    ds_read_b64_tr_b16 v[222:223], v238 offset:18432
    v_mfma_f32_16x16x32_bf16 v[48:51], v[208:211], v[164:167], v[48:51]
    v_mfma_f32_16x16x32_bf16 v[88:91], v[208:211], v[168:171], v[88:91]
    v_mfma_f32_16x16x32_bf16 v[128:131], v[208:211], v[172:175], v[128:131]
    buffer_load_dwordx4 v[196:199], v243, s[16:19], s53 offen
    s_add_u32 s53, s53, 1024
    s_waitcnt lgkmcnt(4)
    v_mfma_f32_16x16x32_bf16 v[12:15], v[212:215], v[160:163], v[12:15]
    ds_read_b64_tr_b16 v[208:209], v239 offset:0
    ds_read_b64_tr_b16 v[210:211], v239 offset:6144
    v_mfma_f32_16x16x32_bf16 v[52:55], v[212:215], v[164:167], v[52:55]
    v_mfma_f32_16x16x32_bf16 v[92:95], v[212:215], v[168:171], v[92:95]
    v_mfma_f32_16x16x32_bf16 v[132:135], v[212:215], v[172:175], v[132:135]
    s_waitcnt lgkmcnt(4)
    v_mfma_f32_16x16x32_bf16 v[16:19], v[216:219], v[160:163], v[16:19]
    ds_read_b64_tr_b16 v[212:213], v239 offset:12288
    ds_read_b64_tr_b16 v[214:215], v239 offset:18432
    s_add_u32 m0, s43, 25600
    s_nop 0
    buffer_load_dwordx4 v241, s[8:11], s40 offen lds
    v_mfma_f32_16x16x32_bf16 v[56:59], v[216:219], v[164:167], v[56:59]
    v_mfma_f32_16x16x32_bf16 v[96:99], v[216:219], v[168:171], v[96:99]
    v_mfma_f32_16x16x32_bf16 v[136:139], v[216:219], v[172:175], v[136:139]
    s_barrier
    v_add_u32 v232, 24576, v236
    v_add_u32 v233, 24576, v237
    v_add_u32 v234, 24576, v238
    v_add_u32 v235, 24576, v239
    s_waitcnt lgkmcnt(4)
    v_mfma_f32_16x16x32_bf16 v[20:23], v[220:223], v[160:163], v[20:23]
    ds_read_b64_tr_b16 v[216:217], v236 offset:256
    ds_read_b64_tr_b16 v[218:219], v236 offset:6400
    v_mfma_f32_16x16x32_bf16 v[60:63], v[220:223], v[164:167], v[60:63]
    buffer_load_dwordx4 v[200:203], v243, s[16:19], s54 offen
    s_add_u32 s54, s54, 1024
    v_mfma_f32_16x16x32_bf16 v[100:103], v[220:223], v[168:171], v[100:103]
    v_mfma_f32_16x16x32_bf16 v[140:143], v[220:223], v[172:175], v[140:143]
    s_waitcnt lgkmcnt(4)
    v_mfma_f32_16x16x32_bf16 v[24:27], v[208:211], v[160:163], v[24:27]
    ds_read_b64_tr_b16 v[220:221], v236 offset:12544
    ds_read_b64_tr_b16 v[222:223], v236 offset:18688
    v_mfma_f32_16x16x32_bf16 v[64:67], v[208:211], v[164:167], v[64:67]
    v_mfma_f32_16x16x32_bf16 v[104:107], v[208:211], v[168:171], v[104:107]
    v_mfma_f32_16x16x32_bf16 v[144:147], v[208:211], v[172:175], v[144:147]
    s_add_u32 m0, s43, 26624
    s_nop 0
    buffer_load_dwordx4 v242, s[8:11], s40 offen lds
    s_add_u32 s40, s40, 294912
    s_waitcnt lgkmcnt(4)
    v_mfma_f32_16x16x32_bf16 v[28:31], v[212:215], v[160:163], v[28:31]
    ds_read_b64_tr_b16 v[208:209], v232 offset:0
    ds_read_b64_tr_b16 v[210:211], v232 offset:6144
    v_mfma_f32_16x16x32_bf16 v[68:71], v[212:215], v[164:167], v[68:71]
    v_mfma_f32_16x16x32_bf16 v[108:111], v[212:215], v[168:171], v[108:111]
    v_mfma_f32_16x16x32_bf16 v[148:151], v[212:215], v[172:175], v[148:151]
    s_waitcnt lgkmcnt(4)
    v_mfma_f32_16x16x32_bf16 v[32:35], v[216:219], v[160:163], v[32:35]
    ds_read_b64_tr_b16 v[212:213], v232 offset:12288
    ds_read_b64_tr_b16 v[214:215], v232 offset:18432
    buffer_load_dwordx4 v[204:207], v243, s[16:19], s55 offen
    s_add_u32 s55, s55, 1024
    v_mfma_f32_16x16x32_bf16 v[72:75], v[216:219], v[164:167], v[72:75]
    v_mfma_f32_16x16x32_bf16 v[112:115], v[216:219], v[168:171], v[112:115]
    v_mfma_f32_16x16x32_bf16 v[152:155], v[216:219], v[172:175], v[152:155]
    s_waitcnt lgkmcnt(4)
    v_mfma_f32_16x16x32_bf16 v[36:39], v[220:223], v[160:163], v[36:39]
    ds_read_b64_tr_b16 v[216:217], v233 offset:0
    ds_read_b64_tr_b16 v[218:219], v233 offset:6144
    v_mfma_f32_16x16x32_bf16 v[76:79], v[220:223], v[164:167], v[76:79]
    v_mfma_f32_16x16x32_bf16 v[116:119], v[220:223], v[168:171], v[116:119]
    v_mfma_f32_16x16x32_bf16 v[156:159], v[220:223], v[172:175], v[156:159]
    s_waitcnt lgkmcnt(4)
    s_waitcnt vmcnt(13)
    v_mfma_f32_16x16x32_bf16 v[0:3], v[208:211], v[176:179], v[0:3]
    ds_read_b64_tr_b16 v[220:221], v233 offset:12288
    ds_read_b64_tr_b16 v[222:223], v233 offset:18432
    s_waitcnt vmcnt(11)
    v_mfma_f32_16x16x32_bf16 v[40:43], v[208:211], v[180:183], v[40:43]
    buffer_load_dwordx4 v[160:163], v243, s[16:19], s52 offen
    s_add_u32 s52, s52, 1024
    s_waitcnt vmcnt(10)
    v_mfma_f32_16x16x32_bf16 v[80:83], v[208:211], v[184:187], v[80:83]
    s_waitcnt vmcnt(8)
    v_mfma_f32_16x16x32_bf16 v[120:123], v[208:211], v[188:191], v[120:123]
    s_waitcnt lgkmcnt(4)
    v_mfma_f32_16x16x32_bf16 v[4:7], v[212:215], v[176:179], v[4:7]
    ds_read_b64_tr_b16 v[208:209], v234 offset:0
    ds_read_b64_tr_b16 v[210:211], v234 offset:6144
    v_mfma_f32_16x16x32_bf16 v[44:47], v[212:215], v[180:183], v[44:47]
    v_mfma_f32_16x16x32_bf16 v[84:87], v[212:215], v[184:187], v[84:87]
    s_add_u32 m0, s43, 49152
    s_nop 0
    buffer_load_dwordx4 v240, s[8:11], s40 offen lds
    v_mfma_f32_16x16x32_bf16 v[124:127], v[212:215], v[188:191], v[124:127]
    s_waitcnt lgkmcnt(4)
    v_mfma_f32_16x16x32_bf16 v[8:11], v[216:219], v[176:179], v[8:11]
    ds_read_b64_tr_b16 v[212:213], v234 offset:12288
    ds_read_b64_tr_b16 v[214:215], v234 offset:18432
    v_mfma_f32_16x16x32_bf16 v[48:51], v[216:219], v[180:183], v[48:51]
    v_mfma_f32_16x16x32_bf16 v[88:91], v[216:219], v[184:187], v[88:91]
    v_mfma_f32_16x16x32_bf16 v[128:131], v[216:219], v[188:191], v[128:131]
    buffer_load_dwordx4 v[164:167], v243, s[16:19], s53 offen
    s_add_u32 s53, s53, 1024
    s_waitcnt lgkmcnt(4)
    v_mfma_f32_16x16x32_bf16 v[12:15], v[220:223], v[176:179], v[12:15]
    ds_read_b64_tr_b16 v[216:217], v235 offset:0
    ds_read_b64_tr_b16 v[218:219], v235 offset:6144
    v_mfma_f32_16x16x32_bf16 v[52:55], v[220:223], v[180:183], v[52:55]
    v_mfma_f32_16x16x32_bf16 v[92:95], v[220:223], v[184:187], v[92:95]
    v_mfma_f32_16x16x32_bf16 v[132:135], v[220:223], v[188:191], v[132:135]
    s_waitcnt lgkmcnt(4)
    v_mfma_f32_16x16x32_bf16 v[16:19], v[208:211], v[176:179], v[16:19]
    ds_read_b64_tr_b16 v[220:221], v235 offset:12288
    ds_read_b64_tr_b16 v[222:223], v235 offset:18432
    s_add_u32 m0, s43, 50176
    s_nop 0
    buffer_load_dwordx4 v241, s[8:11], s40 offen lds
    v_mfma_f32_16x16x32_bf16 v[56:59], v[208:211], v[180:183], v[56:59]
    v_mfma_f32_16x16x32_bf16 v[96:99], v[208:211], v[184:187], v[96:99]
    v_mfma_f32_16x16x32_bf16 v[136:139], v[208:211], v[188:191], v[136:139]
    s_barrier
    v_add_u32 v236, 24576, v232
    v_add_u32 v237, 24576, v233
    v_add_u32 v238, 24576, v234
    v_add_u32 v239, 24576, v235
    s_waitcnt lgkmcnt(4)
    v_mfma_f32_16x16x32_bf16 v[20:23], v[212:215], v[176:179], v[20:23]
    ds_read_b64_tr_b16 v[208:209], v232 offset:256
    ds_read_b64_tr_b16 v[210:211], v232 offset:6400
    v_mfma_f32_16x16x32_bf16 v[60:63], v[212:215], v[180:183], v[60:63]
    buffer_load_dwordx4 v[168:171], v243, s[16:19], s54 offen
    s_add_u32 s54, s54, 1024
    v_mfma_f32_16x16x32_bf16 v[100:103], v[212:215], v[184:187], v[100:103]
    v_mfma_f32_16x16x32_bf16 v[140:143], v[212:215], v[188:191], v[140:143]
    s_waitcnt lgkmcnt(4)
    v_mfma_f32_16x16x32_bf16 v[24:27], v[216:219], v[176:179], v[24:27]
    ds_read_b64_tr_b16 v[212:213], v232 offset:12544
    ds_read_b64_tr_b16 v[214:215], v232 offset:18688
    v_mfma_f32_16x16x32_bf16 v[64:67], v[216:219], v[180:183], v[64:67]
    v_mfma_f32_16x16x32_bf16 v[104:107], v[216:219], v[184:187], v[104:107]
    v_mfma_f32_16x16x32_bf16 v[144:147], v[216:219], v[188:191], v[144:147]
    s_add_u32 m0, s43, 51200
    s_nop 0
    buffer_load_dwordx4 v242, s[8:11], s40 offen lds
    s_add_u32 s40, s40, 294912
    s_waitcnt lgkmcnt(4)
    v_mfma_f32_16x16x32_bf16 v[28:31], v[220:223], v[176:179], v[28:31]
    ds_read_b64_tr_b16 v[216:217], v236 offset:0
    ds_read_b64_tr_b16 v[218:219], v236 offset:6144
    v_mfma_f32_16x16x32_bf16 v[68:71], v[220:223], v[180:183], v[68:71]
    v_mfma_f32_16x16x32_bf16 v[108:111], v[220:223], v[184:187], v[108:111]
    v_mfma_f32_16x16x32_bf16 v[148:151], v[220:223], v[188:191], v[148:151]
    s_waitcnt lgkmcnt(4)
    v_mfma_f32_16x16x32_bf16 v[32:35], v[208:211], v[176:179], v[32:35]
    ds_read_b64_tr_b16 v[220:221], v236 offset:12288
    ds_read_b64_tr_b16 v[222:223], v236 offset:18432
    buffer_load_dwordx4 v[172:175], v243, s[16:19], s55 offen
    s_add_u32 s55, s55, 1024
    v_mfma_f32_16x16x32_bf16 v[72:75], v[208:211], v[180:183], v[72:75]
    v_mfma_f32_16x16x32_bf16 v[112:115], v[208:211], v[184:187], v[112:115]
    v_mfma_f32_16x16x32_bf16 v[152:155], v[208:211], v[188:191], v[152:155]
    s_waitcnt lgkmcnt(4)
    v_mfma_f32_16x16x32_bf16 v[36:39], v[212:215], v[176:179], v[36:39]
    ds_read_b64_tr_b16 v[208:209], v237 offset:0
    ds_read_b64_tr_b16 v[210:211], v237 offset:6144
    v_mfma_f32_16x16x32_bf16 v[76:79], v[212:215], v[180:183], v[76:79]
    v_mfma_f32_16x16x32_bf16 v[116:119], v[212:215], v[184:187], v[116:119]
    v_mfma_f32_16x16x32_bf16 v[156:159], v[212:215], v[188:191], v[156:159]
    s_waitcnt lgkmcnt(4)
    s_waitcnt vmcnt(13)
    v_mfma_f32_16x16x32_bf16 v[0:3], v[216:219], v[192:195], v[0:3]
    ds_read_b64_tr_b16 v[212:213], v237 offset:12288
    ds_read_b64_tr_b16 v[214:215], v237 offset:18432
    s_waitcnt vmcnt(11)
    v_mfma_f32_16x16x32_bf16 v[40:43], v[216:219], v[196:199], v[40:43]
    buffer_load_dwordx4 v[176:179], v243, s[16:19], s52 offen
    s_add_u32 s52, s52, 1024
    s_waitcnt vmcnt(10)
    v_mfma_f32_16x16x32_bf16 v[80:83], v[216:219], v[200:203], v[80:83]
    s_waitcnt vmcnt(8)
    v_mfma_f32_16x16x32_bf16 v[120:123], v[216:219], v[204:207], v[120:123]
    s_waitcnt lgkmcnt(4)
    v_mfma_f32_16x16x32_bf16 v[4:7], v[220:223], v[192:195], v[4:7]
    ds_read_b64_tr_b16 v[216:217], v238 offset:0
    ds_read_b64_tr_b16 v[218:219], v238 offset:6144
    v_mfma_f32_16x16x32_bf16 v[44:47], v[220:223], v[196:199], v[44:47]
    v_mfma_f32_16x16x32_bf16 v[84:87], v[220:223], v[200:203], v[84:87]
    s_add_u32 m0, s43, 73728
    s_nop 0
    buffer_load_dwordx4 v240, s[8:11], s40 offen lds
    v_mfma_f32_16x16x32_bf16 v[124:127], v[220:223], v[204:207], v[124:127]
    s_waitcnt lgkmcnt(4)
    v_mfma_f32_16x16x32_bf16 v[8:11], v[208:211], v[192:195], v[8:11]
    ds_read_b64_tr_b16 v[220:221], v238 offset:12288
    ds_read_b64_tr_b16 v[222:223], v238 offset:18432
    v_mfma_f32_16x16x32_bf16 v[48:51], v[208:211], v[196:199], v[48:51]
    v_mfma_f32_16x16x32_bf16 v[88:91], v[208:211], v[200:203], v[88:91]
    v_mfma_f32_16x16x32_bf16 v[128:131], v[208:211], v[204:207], v[128:131]
    buffer_load_dwordx4 v[180:183], v243, s[16:19], s53 offen
    s_add_u32 s53, s53, 1024
    s_waitcnt lgkmcnt(4)
    v_mfma_f32_16x16x32_bf16 v[12:15], v[212:215], v[192:195], v[12:15]
    ds_read_b64_tr_b16 v[208:209], v239 offset:0
    ds_read_b64_tr_b16 v[210:211], v239 offset:6144
    v_mfma_f32_16x16x32_bf16 v[52:55], v[212:215], v[196:199], v[52:55]
    v_mfma_f32_16x16x32_bf16 v[92:95], v[212:215], v[200:203], v[92:95]
    v_mfma_f32_16x16x32_bf16 v[132:135], v[212:215], v[204:207], v[132:135]
    s_waitcnt lgkmcnt(4)
    v_mfma_f32_16x16x32_bf16 v[16:19], v[216:219], v[192:195], v[16:19]
    ds_read_b64_tr_b16 v[212:213], v239 offset:12288
    ds_read_b64_tr_b16 v[214:215], v239 offset:18432
    s_add_u32 m0, s43, 74752
    s_nop 0
    buffer_load_dwordx4 v241, s[8:11], s40 offen lds
    v_mfma_f32_16x16x32_bf16 v[56:59], v[216:219], v[196:199], v[56:59]
    v_mfma_f32_16x16x32_bf16 v[96:99], v[216:219], v[200:203], v[96:99]
    v_mfma_f32_16x16x32_bf16 v[136:139], v[216:219], v[204:207], v[136:139]
    s_barrier
    v_add_u32 v232, -122880, v236
    v_add_u32 v233, -122880, v237
    v_add_u32 v234, -122880, v238
    v_add_u32 v235, -122880, v239
    s_waitcnt lgkmcnt(4)
    v_mfma_f32_16x16x32_bf16 v[20:23], v[220:223], v[192:195], v[20:23]
    ds_read_b64_tr_b16 v[216:217], v236 offset:256
    ds_read_b64_tr_b16 v[218:219], v236 offset:6400
    v_mfma_f32_16x16x32_bf16 v[60:63], v[220:223], v[196:199], v[60:63]
    buffer_load_dwordx4 v[184:187], v243, s[16:19], s54 offen
    s_add_u32 s54, s54, 1024
    v_mfma_f32_16x16x32_bf16 v[100:103], v[220:223], v[200:203], v[100:103]
    v_mfma_f32_16x16x32_bf16 v[140:143], v[220:223], v[204:207], v[140:143]
    s_waitcnt lgkmcnt(4)
    v_mfma_f32_16x16x32_bf16 v[24:27], v[208:211], v[192:195], v[24:27]
    ds_read_b64_tr_b16 v[220:221], v236 offset:12544
    ds_read_b64_tr_b16 v[222:223], v236 offset:18688
    v_mfma_f32_16x16x32_bf16 v[64:67], v[208:211], v[196:199], v[64:67]
    v_mfma_f32_16x16x32_bf16 v[104:107], v[208:211], v[200:203], v[104:107]
    v_mfma_f32_16x16x32_bf16 v[144:147], v[208:211], v[204:207], v[144:147]
    s_add_u32 m0, s43, 75776
    s_nop 0
    buffer_load_dwordx4 v242, s[8:11], s40 offen lds
    s_add_u32 s40, s40, 294912
    s_waitcnt lgkmcnt(4)
    v_mfma_f32_16x16x32_bf16 v[28:31], v[212:215], v[192:195], v[28:31]
    ds_read_b64_tr_b16 v[208:209], v232 offset:0
    ds_read_b64_tr_b16 v[210:211], v232 offset:6144
    v_mfma_f32_16x16x32_bf16 v[68:71], v[212:215], v[196:199], v[68:71]
    v_mfma_f32_16x16x32_bf16 v[108:111], v[212:215], v[200:203], v[108:111]
    v_mfma_f32_16x16x32_bf16 v[148:151], v[212:215], v[204:207], v[148:151]
    s_waitcnt lgkmcnt(4)
    v_mfma_f32_16x16x32_bf16 v[32:35], v[216:219], v[192:195], v[32:35]
    ds_read_b64_tr_b16 v[212:213], v232 offset:12288
    ds_read_b64_tr_b16 v[214:215], v232 offset:18432
    buffer_load_dwordx4 v[188:191], v243, s[16:19], s55 offen
    s_add_u32 s55, s55, 1024
    v_mfma_f32_16x16x32_bf16 v[72:75], v[216:219], v[196:199], v[72:75]
    v_mfma_f32_16x16x32_bf16 v[112:115], v[216:219], v[200:203], v[112:115]
    v_mfma_f32_16x16x32_bf16 v[152:155], v[216:219], v[204:207], v[152:155]
    s_waitcnt lgkmcnt(4)
    v_mfma_f32_16x16x32_bf16 v[36:39], v[220:223], v[192:195], v[36:39]
    ds_read_b64_tr_b16 v[216:217], v233 offset:0
    ds_read_b64_tr_b16 v[218:219], v233 offset:6144
    v_mfma_f32_16x16x32_bf16 v[76:79], v[220:223], v[196:199], v[76:79]
    v_mfma_f32_16x16x32_bf16 v[116:119], v[220:223], v[200:203], v[116:119]
    v_mfma_f32_16x16x32_bf16 v[156:159], v[220:223], v[204:207], v[156:159]
    s_waitcnt lgkmcnt(4)
    s_waitcnt vmcnt(13)
    v_mfma_f32_16x16x32_bf16 v[0:3], v[208:211], v[160:163], v[0:3]
    ds_read_b64_tr_b16 v[220:221], v233 offset:12288
    ds_read_b64_tr_b16 v[222:223], v233 offset:18432
    s_waitcnt vmcnt(11)
    v_mfma_f32_16x16x32_bf16 v[40:43], v[208:211], v[164:167], v[40:43]
    buffer_load_dwordx4 v[192:195], v243, s[16:19], s52 offen
    s_add_u32 s52, s52, 1024
    s_waitcnt vmcnt(10)
    v_mfma_f32_16x16x32_bf16 v[80:83], v[208:211], v[168:171], v[80:83]
    s_waitcnt vmcnt(8)
    v_mfma_f32_16x16x32_bf16 v[120:123], v[208:211], v[172:175], v[120:123]
    s_waitcnt lgkmcnt(4)
    v_mfma_f32_16x16x32_bf16 v[4:7], v[212:215], v[160:163], v[4:7]
    ds_read_b64_tr_b16 v[208:209], v234 offset:0
    ds_read_b64_tr_b16 v[210:211], v234 offset:6144
    v_mfma_f32_16x16x32_bf16 v[44:47], v[212:215], v[164:167], v[44:47]
    v_mfma_f32_16x16x32_bf16 v[84:87], v[212:215], v[168:171], v[84:87]
    s_add_u32 m0, s43, 98304
    s_nop 0
    buffer_load_dwordx4 v240, s[8:11], s40 offen lds
    v_mfma_f32_16x16x32_bf16 v[124:127], v[212:215], v[172:175], v[124:127]
    v_lshrrev_b32 v253, 1, v243
    s_mul_i32 s47, s35, 768
    s_add_u32 s47, s47, 13631488
    v_mov_b32 v224, 0
    v_mov_b32 v225, 0
    v_mov_b32 v226, 0
    v_mov_b32 v227, 0
    v_mov_b32 v228, 0
    v_mov_b32 v229, 0
    v_mov_b32 v230, 0
    v_mov_b32 v231, 0
    buffer_load_dwordx2 v[224:225], v253, s[16:19], s47 offen offset:0
    buffer_load_dwordx2 v[228:229], v253, s[16:19], s47 offen offset:768
    s_mov_b32 exec_hi, 0
    buffer_load_dwordx2 v[226:227], v253, s[16:19], s47 offen offset:512
    buffer_load_dwordx2 v[230:231], v253, s[16:19], s47 offen offset:1280
    s_mov_b64 exec, -1
    s_waitcnt lgkmcnt(4)
    v_mfma_f32_16x16x32_bf16 v[8:11], v[216:219], v[160:163], v[8:11]
    ds_read_b64_tr_b16 v[212:213], v234 offset:12288
    ds_read_b64_tr_b16 v[214:215], v234 offset:18432
    v_mfma_f32_16x16x32_bf16 v[48:51], v[216:219], v[164:167], v[48:51]
    v_mfma_f32_16x16x32_bf16 v[88:91], v[216:219], v[168:171], v[88:91]
    v_mfma_f32_16x16x32_bf16 v[128:131], v[216:219], v[172:175], v[128:131]
    buffer_load_dwordx4 v[196:199], v243, s[16:19], s53 offen
    s_add_u32 s53, s53, 1024
    s_waitcnt lgkmcnt(4)
    v_mfma_f32_16x16x32_bf16 v[12:15], v[220:223], v[160:163], v[12:15]
    ds_read_b64_tr_b16 v[216:217], v235 offset:0
    ds_read_b64_tr_b16 v[218:219], v235 offset:6144
    v_mfma_f32_16x16x32_bf16 v[52:55], v[220:223], v[164:167], v[52:55]
    v_mfma_f32_16x16x32_bf16 v[92:95], v[220:223], v[168:171], v[92:95]
    v_mfma_f32_16x16x32_bf16 v[132:135], v[220:223], v[172:175], v[132:135]
    s_waitcnt lgkmcnt(4)
    v_mfma_f32_16x16x32_bf16 v[16:19], v[208:211], v[160:163], v[16:19]
    ds_read_b64_tr_b16 v[220:221], v235 offset:12288
    ds_read_b64_tr_b16 v[222:223], v235 offset:18432
    s_add_u32 m0, s43, 99328
    s_nop 0
    buffer_load_dwordx4 v241, s[8:11], s40 offen lds
    v_mfma_f32_16x16x32_bf16 v[56:59], v[208:211], v[164:167], v[56:59]
    v_mfma_f32_16x16x32_bf16 v[96:99], v[208:211], v[168:171], v[96:99]
    v_mfma_f32_16x16x32_bf16 v[136:139], v[208:211], v[172:175], v[136:139]
    s_barrier
    v_add_u32 v236, 24576, v232
    v_add_u32 v237, 24576, v233
    v_add_u32 v238, 24576, v234
    v_add_u32 v239, 24576, v235
    s_waitcnt lgkmcnt(4)
    v_mfma_f32_16x16x32_bf16 v[20:23], v[212:215], v[160:163], v[20:23]
    ds_read_b64_tr_b16 v[208:209], v232 offset:256
    ds_read_b64_tr_b16 v[210:211], v232 offset:6400
    v_mfma_f32_16x16x32_bf16 v[60:63], v[212:215], v[164:167], v[60:63]
    buffer_load_dwordx4 v[200:203], v243, s[16:19], s54 offen
    s_add_u32 s54, s54, 1024
    v_mfma_f32_16x16x32_bf16 v[100:103], v[212:215], v[168:171], v[100:103]
    v_mfma_f32_16x16x32_bf16 v[140:143], v[212:215], v[172:175], v[140:143]
    s_waitcnt lgkmcnt(4)
    v_mfma_f32_16x16x32_bf16 v[24:27], v[216:219], v[160:163], v[24:27]
    ds_read_b64_tr_b16 v[212:213], v232 offset:12544
    ds_read_b64_tr_b16 v[214:215], v232 offset:18688
    v_mfma_f32_16x16x32_bf16 v[64:67], v[216:219], v[164:167], v[64:67]
    v_mfma_f32_16x16x32_bf16 v[104:107], v[216:219], v[168:171], v[104:107]
    v_mfma_f32_16x16x32_bf16 v[144:147], v[216:219], v[172:175], v[144:147]
    s_add_u32 m0, s43, 100352
    s_nop 0
    buffer_load_dwordx4 v242, s[8:11], s40 offen lds
    s_add_u32 s40, s40, 294912
    s_waitcnt lgkmcnt(4)
    v_mfma_f32_16x16x32_bf16 v[28:31], v[220:223], v[160:163], v[28:31]
    ds_read_b64_tr_b16 v[216:217], v236 offset:0
    ds_read_b64_tr_b16 v[218:219], v236 offset:6144
    v_mfma_f32_16x16x32_bf16 v[68:71], v[220:223], v[164:167], v[68:71]
    v_mfma_f32_16x16x32_bf16 v[108:111], v[220:223], v[168:171], v[108:111]
    v_mfma_f32_16x16x32_bf16 v[148:151], v[220:223], v[172:175], v[148:151]
    s_waitcnt lgkmcnt(4)
    v_mfma_f32_16x16x32_bf16 v[32:35], v[208:211], v[160:163], v[32:35]
    ds_read_b64_tr_b16 v[220:221], v236 offset:12288
    ds_read_b64_tr_b16 v[222:223], v236 offset:18432
    buffer_load_dwordx4 v[204:207], v243, s[16:19], s55 offen
    s_add_u32 s55, s55, 1024
    v_mfma_f32_16x16x32_bf16 v[72:75], v[208:211], v[164:167], v[72:75]
    v_mfma_f32_16x16x32_bf16 v[112:115], v[208:211], v[168:171], v[112:115]
    v_mfma_f32_16x16x32_bf16 v[152:155], v[208:211], v[172:175], v[152:155]
    s_waitcnt lgkmcnt(4)
    v_mfma_f32_16x16x32_bf16 v[36:39], v[212:215], v[160:163], v[36:39]
    ds_read_b64_tr_b16 v[208:209], v237 offset:0
    ds_read_b64_tr_b16 v[210:211], v237 offset:6144
    v_mfma_f32_16x16x32_bf16 v[76:79], v[212:215], v[164:167], v[76:79]
    v_mfma_f32_16x16x32_bf16 v[116:119], v[212:215], v[168:171], v[116:119]
    v_mfma_f32_16x16x32_bf16 v[156:159], v[212:215], v[172:175], v[156:159]
    s_waitcnt lgkmcnt(4)
    s_waitcnt vmcnt(17)
    v_mfma_f32_16x16x32_bf16 v[0:3], v[216:219], v[176:179], v[0:3]
    ds_read_b64_tr_b16 v[212:213], v237 offset:12288
    ds_read_b64_tr_b16 v[214:215], v237 offset:18432
    s_waitcnt vmcnt(15)
    v_mfma_f32_16x16x32_bf16 v[40:43], v[216:219], v[180:183], v[40:43]
    buffer_load_dwordx4 v[160:163], v243, s[16:19], s52 offen
    s_add_u32 s52, s52, 1024
    s_waitcnt vmcnt(14)
    v_mfma_f32_16x16x32_bf16 v[80:83], v[216:219], v[184:187], v[80:83]
    s_waitcnt vmcnt(12)
    v_mfma_f32_16x16x32_bf16 v[120:123], v[216:219], v[188:191], v[120:123]
    s_waitcnt lgkmcnt(4)
    v_mfma_f32_16x16x32_bf16 v[4:7], v[220:223], v[176:179], v[4:7]
    ds_read_b64_tr_b16 v[216:217], v238 offset:0
    ds_read_b64_tr_b16 v[218:219], v238 offset:6144
    v_mfma_f32_16x16x32_bf16 v[44:47], v[220:223], v[180:183], v[44:47]
    v_mfma_f32_16x16x32_bf16 v[84:87], v[220:223], v[184:187], v[84:87]
    s_add_u32 m0, s43, 122880
    s_nop 0
    buffer_load_dwordx4 v240, s[8:11], s40 offen lds
    v_mfma_f32_16x16x32_bf16 v[124:127], v[220:223], v[188:191], v[124:127]
    s_waitcnt lgkmcnt(4)
    v_mfma_f32_16x16x32_bf16 v[8:11], v[208:211], v[176:179], v[8:11]
    ds_read_b64_tr_b16 v[220:221], v238 offset:12288
    ds_read_b64_tr_b16 v[222:223], v238 offset:18432
    v_mfma_f32_16x16x32_bf16 v[48:51], v[208:211], v[180:183], v[48:51]
    v_mfma_f32_16x16x32_bf16 v[88:91], v[208:211], v[184:187], v[88:91]
    v_mfma_f32_16x16x32_bf16 v[128:131], v[208:211], v[188:191], v[128:131]
    buffer_load_dwordx4 v[164:167], v243, s[16:19], s53 offen
    s_add_u32 s53, s53, 1024
    s_waitcnt lgkmcnt(4)
    v_mfma_f32_16x16x32_bf16 v[12:15], v[212:215], v[176:179], v[12:15]
    ds_read_b64_tr_b16 v[208:209], v239 offset:0
    ds_read_b64_tr_b16 v[210:211], v239 offset:6144
    v_mfma_f32_16x16x32_bf16 v[52:55], v[212:215], v[180:183], v[52:55]
    v_mfma_f32_16x16x32_bf16 v[92:95], v[212:215], v[184:187], v[92:95]
    v_mfma_f32_16x16x32_bf16 v[132:135], v[212:215], v[188:191], v[132:135]
    s_waitcnt lgkmcnt(4)
    v_mfma_f32_16x16x32_bf16 v[16:19], v[216:219], v[176:179], v[16:19]
    ds_read_b64_tr_b16 v[212:213], v239 offset:12288
    ds_read_b64_tr_b16 v[214:215], v239 offset:18432
    s_add_u32 m0, s43, 123904
    s_nop 0
    buffer_load_dwordx4 v241, s[8:11], s40 offen lds
    v_mfma_f32_16x16x32_bf16 v[56:59], v[216:219], v[180:183], v[56:59]
    v_mfma_f32_16x16x32_bf16 v[96:99], v[216:219], v[184:187], v[96:99]
    v_mfma_f32_16x16x32_bf16 v[136:139], v[216:219], v[188:191], v[136:139]
    s_barrier
    v_add_u32 v232, 24576, v236
    v_add_u32 v233, 24576, v237
    v_add_u32 v234, 24576, v238
    v_add_u32 v235, 24576, v239
    s_waitcnt lgkmcnt(4)
    v_mfma_f32_16x16x32_bf16 v[20:23], v[220:223], v[176:179], v[20:23]
    ds_read_b64_tr_b16 v[216:217], v236 offset:256
    ds_read_b64_tr_b16 v[218:219], v236 offset:6400
    v_mfma_f32_16x16x32_bf16 v[60:63], v[220:223], v[180:183], v[60:63]
    buffer_load_dwordx4 v[168:171], v243, s[16:19], s54 offen
    s_add_u32 s54, s54, 1024
    v_mfma_f32_16x16x32_bf16 v[100:103], v[220:223], v[184:187], v[100:103]
    v_mfma_f32_16x16x32_bf16 v[140:143], v[220:223], v[188:191], v[140:143]
    s_waitcnt lgkmcnt(4)
    v_mfma_f32_16x16x32_bf16 v[24:27], v[208:211], v[176:179], v[24:27]
    ds_read_b64_tr_b16 v[220:221], v236 offset:12544
    ds_read_b64_tr_b16 v[222:223], v236 offset:18688
    v_mfma_f32_16x16x32_bf16 v[64:67], v[208:211], v[180:183], v[64:67]
    v_mfma_f32_16x16x32_bf16 v[104:107], v[208:211], v[184:187], v[104:107]
    v_mfma_f32_16x16x32_bf16 v[144:147], v[208:211], v[188:191], v[144:147]
    s_add_u32 m0, s43, 124928
    s_nop 0
    buffer_load_dwordx4 v242, s[8:11], s40 offen lds
    s_add_u32 s40, s40, 294912
    s_waitcnt lgkmcnt(4)
    v_mfma_f32_16x16x32_bf16 v[28:31], v[212:215], v[176:179], v[28:31]
    ds_read_b64_tr_b16 v[208:209], v232 offset:0
    ds_read_b64_tr_b16 v[210:211], v232 offset:6144
    v_mfma_f32_16x16x32_bf16 v[68:71], v[212:215], v[180:183], v[68:71]
    v_mfma_f32_16x16x32_bf16 v[108:111], v[212:215], v[184:187], v[108:111]
    v_mfma_f32_16x16x32_bf16 v[148:151], v[212:215], v[188:191], v[148:151]
    s_waitcnt lgkmcnt(4)
    v_mfma_f32_16x16x32_bf16 v[32:35], v[216:219], v[176:179], v[32:35]
    ds_read_b64_tr_b16 v[212:213], v232 offset:12288
    ds_read_b64_tr_b16 v[214:215], v232 offset:18432
    buffer_load_dwordx4 v[172:175], v243, s[16:19], s55 offen
    s_add_u32 s55, s55, 1024
    v_mfma_f32_16x16x32_bf16 v[72:75], v[216:219], v[180:183], v[72:75]
    v_mfma_f32_16x16x32_bf16 v[112:115], v[216:219], v[184:187], v[112:115]
    v_mfma_f32_16x16x32_bf16 v[152:155], v[216:219], v[188:191], v[152:155]
    s_waitcnt lgkmcnt(4)
    v_mfma_f32_16x16x32_bf16 v[36:39], v[220:223], v[176:179], v[36:39]
    ds_read_b64_tr_b16 v[216:217], v233 offset:0
    ds_read_b64_tr_b16 v[218:219], v233 offset:6144
    v_mfma_f32_16x16x32_bf16 v[76:79], v[220:223], v[180:183], v[76:79]
    v_mfma_f32_16x16x32_bf16 v[116:119], v[220:223], v[184:187], v[116:119]
    v_mfma_f32_16x16x32_bf16 v[156:159], v[220:223], v[188:191], v[156:159]
    s_waitcnt lgkmcnt(4)
    s_waitcnt vmcnt(17)
    v_mfma_f32_16x16x32_bf16 v[0:3], v[208:211], v[192:195], v[0:3]
    ds_read_b64_tr_b16 v[220:221], v233 offset:12288
    ds_read_b64_tr_b16 v[222:223], v233 offset:18432
    s_waitcnt vmcnt(11)
    v_mfma_f32_16x16x32_bf16 v[40:43], v[208:211], v[196:199], v[40:43]
    s_waitcnt vmcnt(9)
    v_mfma_f32_16x16x32_bf16 v[80:83], v[208:211], v[200:203], v[80:83]
    buffer_load_dwordx4 v[176:179], v243, s[16:19], s52 offen
    s_add_u32 s52, s52, 1024
    s_waitcnt vmcnt(8)
    v_mfma_f32_16x16x32_bf16 v[120:123], v[208:211], v[204:207], v[120:123]
    s_mov_b32 s49, 0x3AE38E39
    v_add_f32 v224, v224, v226
    v_add_f32 v225, v225, v227
    v_add_f32 v228, v228, v230
    v_add_f32 v229, v229, v231
    v_mov_b32 v226, v224
    v_mov_b32 v227, v225
    v_mov_b32 v230, v228
    v_mov_b32 v231, v229
    v_permlane16_swap_b32 v224, v226
    v_permlane16_swap_b32 v225, v227
    v_permlane16_swap_b32 v228, v230
    v_permlane16_swap_b32 v229, v231
    s_nop 1
    v_add_f32 v224, v224, v226
    v_add_f32 v225, v225, v227
    v_add_f32 v228, v228, v230
    v_add_f32 v229, v229, v231
    v_mov_b32 v226, v224
    v_mov_b32 v227, v225
    v_mov_b32 v230, v228
    v_mov_b32 v231, v229
    v_permlane32_swap_b32 v224, v226
    v_permlane32_swap_b32 v225, v227
    v_permlane32_swap_b32 v228, v230
    v_permlane32_swap_b32 v229, v231
    s_nop 1
    v_add_f32 v224, v224, v226
    v_add_f32 v225, v225, v227
    v_add_f32 v228, v228, v230
    v_add_f32 v229, v229, v231
    v_mul_f32 v224, s49, v224
    v_mul_f32 v225, s49, v225
    v_fma_f32 v225, -v224, v224, v225
    v_max_f32 v225, 0, v225
    v_add_f32 v240, 0x3727c5ac, v225
    v_rsq_f32 v245, v240
    v_sub_f32 v244, 0, v224
    v_mul_f32 v245, 0xbfb8aa3b, v245
    v_mul_f32 v228, s49, v228
    v_mul_f32 v229, s49, v229
    v_fma_f32 v229, -v228, v228, v229
    v_max_f32 v229, 0, v229
    v_add_f32 v241, 0x3727c5ac, v229
    v_rsq_f32 v247, v241
    v_sub_f32 v246, 0, v228
    v_mul_f32 v247, 0xbfb8aa3b, v247
    v_lshrrev_b32 v253, 1, v243
    s_mul_i32 s47, s35, 768
    s_add_u32 s47, s47, 13631488
    v_mov_b32 v224, 0
    v_mov_b32 v225, 0
    v_mov_b32 v226, 0
    v_mov_b32 v227, 0
    v_mov_b32 v228, 0
    v_mov_b32 v229, 0
    v_mov_b32 v230, 0
    v_mov_b32 v231, 0
    buffer_load_dwordx2 v[224:225], v253, s[16:19], s47 offen offset:1536
    buffer_load_dwordx2 v[228:229], v253, s[16:19], s47 offen offset:2304
    s_mov_b32 exec_hi, 0
    buffer_load_dwordx2 v[226:227], v253, s[16:19], s47 offen offset:2048
    buffer_load_dwordx2 v[230:231], v253, s[16:19], s47 offen offset:2816
    s_mov_b64 exec, -1
    s_waitcnt lgkmcnt(4)
    v_mfma_f32_16x16x32_bf16 v[4:7], v[212:215], v[192:195], v[4:7]
    ds_read_b64_tr_b16 v[208:209], v234 offset:0
    ds_read_b64_tr_b16 v[210:211], v234 offset:6144
    v_mfma_f32_16x16x32_bf16 v[44:47], v[212:215], v[196:199], v[44:47]
    v_mfma_f32_16x16x32_bf16 v[84:87], v[212:215], v[200:203], v[84:87]
    v_mfma_f32_16x16x32_bf16 v[124:127], v[212:215], v[204:207], v[124:127]
    s_waitcnt lgkmcnt(4)
    v_mfma_f32_16x16x32_bf16 v[8:11], v[216:219], v[192:195], v[8:11]
    ds_read_b64_tr_b16 v[212:213], v234 offset:12288
    ds_read_b64_tr_b16 v[214:215], v234 offset:18432
    v_mfma_f32_16x16x32_bf16 v[48:51], v[216:219], v[196:199], v[48:51]
    v_mfma_f32_16x16x32_bf16 v[88:91], v[216:219], v[200:203], v[88:91]
    v_mfma_f32_16x16x32_bf16 v[128:131], v[216:219], v[204:207], v[128:131]
    buffer_load_dwordx4 v[180:183], v243, s[16:19], s53 offen
    s_add_u32 s53, s53, 1024
    s_waitcnt lgkmcnt(4)
    v_mfma_f32_16x16x32_bf16 v[12:15], v[220:223], v[192:195], v[12:15]
    ds_read_b64_tr_b16 v[216:217], v235 offset:0
    ds_read_b64_tr_b16 v[218:219], v235 offset:6144
    v_mfma_f32_16x16x32_bf16 v[52:55], v[220:223], v[196:199], v[52:55]
    v_mfma_f32_16x16x32_bf16 v[92:95], v[220:223], v[200:203], v[92:95]
    v_mfma_f32_16x16x32_bf16 v[132:135], v[220:223], v[204:207], v[132:135]
    s_waitcnt lgkmcnt(4)
    v_mfma_f32_16x16x32_bf16 v[16:19], v[208:211], v[192:195], v[16:19]
    ds_read_b64_tr_b16 v[220:221], v235 offset:12288
    ds_read_b64_tr_b16 v[222:223], v235 offset:18432
    v_mfma_f32_16x16x32_bf16 v[56:59], v[208:211], v[196:199], v[56:59]
    v_mfma_f32_16x16x32_bf16 v[96:99], v[208:211], v[200:203], v[96:99]
    v_mfma_f32_16x16x32_bf16 v[136:139], v[208:211], v[204:207], v[136:139]
    s_waitcnt vmcnt(7)
    s_barrier
    v_add_u32 v236, 24576, v232
    v_add_u32 v237, 24576, v233
    v_add_u32 v238, 24576, v234
    v_add_u32 v239, 24576, v235
    s_waitcnt lgkmcnt(4)
    v_mfma_f32_16x16x32_bf16 v[20:23], v[212:215], v[192:195], v[20:23]
    ds_read_b64_tr_b16 v[208:209], v232 offset:256
    ds_read_b64_tr_b16 v[210:211], v232 offset:6400
    buffer_load_dwordx4 v[184:187], v243, s[16:19], s54 offen
    s_add_u32 s54, s54, 1024
    v_mfma_f32_16x16x32_bf16 v[60:63], v[212:215], v[196:199], v[60:63]
    v_mfma_f32_16x16x32_bf16 v[100:103], v[212:215], v[200:203], v[100:103]
    v_mfma_f32_16x16x32_bf16 v[140:143], v[212:215], v[204:207], v[140:143]
    s_waitcnt lgkmcnt(4)
    v_mfma_f32_16x16x32_bf16 v[24:27], v[216:219], v[192:195], v[24:27]
    ds_read_b64_tr_b16 v[212:213], v232 offset:12544
    ds_read_b64_tr_b16 v[214:215], v232 offset:18688
    v_mfma_f32_16x16x32_bf16 v[64:67], v[216:219], v[196:199], v[64:67]
    v_mfma_f32_16x16x32_bf16 v[104:107], v[216:219], v[200:203], v[104:107]
    v_mfma_f32_16x16x32_bf16 v[144:147], v[216:219], v[204:207], v[144:147]
    s_waitcnt lgkmcnt(4)
    v_mfma_f32_16x16x32_bf16 v[28:31], v[220:223], v[192:195], v[28:31]
    ds_read_b64_tr_b16 v[216:217], v236 offset:0
    ds_read_b64_tr_b16 v[218:219], v236 offset:6144
    v_mfma_f32_16x16x32_bf16 v[68:71], v[220:223], v[196:199], v[68:71]
    buffer_load_dwordx4 v[188:191], v243, s[16:19], s55 offen
    s_add_u32 s55, s55, 1024
    v_mfma_f32_16x16x32_bf16 v[108:111], v[220:223], v[200:203], v[108:111]
    v_mfma_f32_16x16x32_bf16 v[148:151], v[220:223], v[204:207], v[148:151]
    s_waitcnt lgkmcnt(4)
    v_mfma_f32_16x16x32_bf16 v[32:35], v[208:211], v[192:195], v[32:35]
    ds_read_b64_tr_b16 v[220:221], v236 offset:12288
    ds_read_b64_tr_b16 v[222:223], v236 offset:18432
    v_mfma_f32_16x16x32_bf16 v[72:75], v[208:211], v[196:199], v[72:75]
    v_mfma_f32_16x16x32_bf16 v[112:115], v[208:211], v[200:203], v[112:115]
    v_mfma_f32_16x16x32_bf16 v[152:155], v[208:211], v[204:207], v[152:155]
    s_waitcnt lgkmcnt(4)
    v_mfma_f32_16x16x32_bf16 v[36:39], v[212:215], v[192:195], v[36:39]
    ds_read_b64_tr_b16 v[208:209], v236 offset:24576
    ds_read_b64_tr_b16 v[210:211], v236 offset:30720
    v_mfma_f32_16x16x32_bf16 v[76:79], v[212:215], v[196:199], v[76:79]
    v_mfma_f32_16x16x32_bf16 v[116:119], v[212:215], v[200:203], v[116:119]
    v_mfma_f32_16x16x32_bf16 v[156:159], v[212:215], v[204:207], v[156:159]
    buffer_load_dwordx4 v[192:195], v243, s[16:19], s52 offen
    s_add_u32 s52, s52, 1024
    buffer_load_dwordx4 v[196:199], v243, s[16:19], s53 offen
    s_add_u32 s53, s53, 1024
    buffer_load_dwordx4 v[200:203], v243, s[16:19], s54 offen
    s_add_u32 s54, s54, 1024
    buffer_load_dwordx4 v[204:207], v243, s[16:19], s55 offen
    s_add_u32 s55, s55, 1024
    s_waitcnt vmcnt(7)
    s_mov_b32 s49, 0x3AE38E39
    v_add_f32 v224, v224, v226
    v_add_f32 v225, v225, v227
    v_add_f32 v228, v228, v230
    v_add_f32 v229, v229, v231
    v_mov_b32 v226, v224
    v_mov_b32 v227, v225
    v_mov_b32 v230, v228
    v_mov_b32 v231, v229
    v_permlane16_swap_b32 v224, v226
    v_permlane16_swap_b32 v225, v227
    v_permlane16_swap_b32 v228, v230
    v_permlane16_swap_b32 v229, v231
    s_nop 1
    v_add_f32 v224, v224, v226
    v_add_f32 v225, v225, v227
    v_add_f32 v228, v228, v230
    v_add_f32 v229, v229, v231
    v_mov_b32 v226, v224
    v_mov_b32 v227, v225
    v_mov_b32 v230, v228
    v_mov_b32 v231, v229
    v_permlane32_swap_b32 v224, v226
    v_permlane32_swap_b32 v225, v227
    v_permlane32_swap_b32 v228, v230
    v_permlane32_swap_b32 v229, v231
    s_nop 1
    v_add_f32 v224, v224, v226
    v_add_f32 v225, v225, v227
    v_add_f32 v228, v228, v230
    v_add_f32 v229, v229, v231
    v_mul_f32 v224, s49, v224
    v_mul_f32 v225, s49, v225
    v_fma_f32 v225, -v224, v224, v225
    v_max_f32 v225, 0, v225
    v_add_f32 v242, 0x3727c5ac, v225
    v_rsq_f32 v249, v242
    v_sub_f32 v248, 0, v224
    v_mul_f32 v249, 0xbfb8aa3b, v249
    v_mul_f32 v228, s49, v228
    v_mul_f32 v229, s49, v229
    v_fma_f32 v229, -v228, v228, v229
    v_max_f32 v229, 0, v229
    v_add_f32 v255, 0x3727c5ac, v229
    v_rsq_f32 v251, v255
    v_sub_f32 v250, 0, v228
    v_mul_f32 v251, 0xbfb8aa3b, v251
    v_add_u32 v232, 49152, v236
    v_add_u32 v233, 49152, v237
    v_add_u32 v234, 49152, v238
    v_add_u32 v235, 49152, v239
    s_mov_b32 s49, 0xbfb8aa3b
    s_lshr_b32 s56, s34, 1
    s_mul_i32 s56, s56, 9
    s_and_b32 s58, s34, 1
    s_lshl_b32 s59, s58, 2
    s_add_u32 s59, s59, s56
    s_lshl_b32 s59, s59, 10
    s_add_u32 s56, s56, 8
    s_lshl_b32 s56, s56, 10
    s_lshl_b32 s58, s58, 3
    s_add_u32 s56, s56, s58
    v_lshrrev_b32 v252, 8, v243
    v_lshlrev_b32 v252, 4, v252
    v_add_u32 v252, 147456, v252
    s_add_u32 s84, s35, 0
    s_mul_i32 s84, s84, 147456
    s_add_u32 s84, s84, 14680064
    s_add_u32 s85, s35, 1
    s_mul_i32 s85, s85, 147456
    s_add_u32 s85, s85, 14680064
    s_add_u32 s86, s35, 2
    s_mul_i32 s86, s86, 147456
    s_add_u32 s86, s86, 14680064
    s_add_u32 s87, s35, 3
    s_mul_i32 s87, s87, 147456
    s_add_u32 s87, s87, 14680064
    s_waitcnt lgkmcnt(4)
    v_mfma_f32_16x16x32_bf16 v[0:3], v[216:219], v[160:163], v[0:3]
    ds_read_b64_tr_b16 v[212:213], v236 offset:36864
    ds_read_b64_tr_b16 v[214:215], v236 offset:43008
    v_mfma_f32_16x16x32_bf16 v[40:43], v[216:219], v[164:167], v[40:43]
    v_mfma_f32_16x16x32_bf16 v[80:83], v[216:219], v[168:171], v[80:83]
    v_mfma_f32_16x16x32_bf16 v[120:123], v[216:219], v[172:175], v[120:123]
    s_waitcnt lgkmcnt(4)
    v_mfma_f32_16x16x32_bf16 v[4:7], v[220:223], v[160:163], v[4:7]
    ds_read_b64_tr_b16 v[216:217], v232 offset:0
    ds_read_b64_tr_b16 v[218:219], v232 offset:6144
    v_mfma_f32_16x16x32_bf16 v[44:47], v[220:223], v[164:167], v[44:47]
    v_mfma_f32_16x16x32_bf16 v[84:87], v[220:223], v[168:171], v[84:87]
    v_mfma_f32_16x16x32_bf16 v[124:127], v[220:223], v[172:175], v[124:127]
    s_waitcnt lgkmcnt(4)
    v_mfma_f32_16x16x32_bf16 v[0:3], v[208:211], v[176:179], v[0:3]
    ds_read_b64_tr_b16 v[220:221], v232 offset:12288
    ds_read_b64_tr_b16 v[222:223], v232 offset:18432
    s_waitcnt vmcnt(6)
    v_mfma_f32_16x16x32_bf16 v[40:43], v[208:211], v[180:183], v[40:43]
    s_waitcnt vmcnt(5)
    v_mfma_f32_16x16x32_bf16 v[80:83], v[208:211], v[184:187], v[80:83]
    s_waitcnt vmcnt(4)
    v_mfma_f32_16x16x32_bf16 v[120:123], v[208:211], v[188:191], v[120:123]
    s_waitcnt lgkmcnt(4)
    v_mfma_f32_16x16x32_bf16 v[4:7], v[212:215], v[176:179], v[4:7]
    ds_read_b64_tr_b16 v[208:209], v237 offset:0
    ds_read_b64_tr_b16 v[210:211], v237 offset:6144
    v_mfma_f32_16x16x32_bf16 v[44:47], v[212:215], v[180:183], v[44:47]
    v_mfma_f32_16x16x32_bf16 v[84:87], v[212:215], v[184:187], v[84:87]
    v_mfma_f32_16x16x32_bf16 v[124:127], v[212:215], v[188:191], v[124:127]
    s_waitcnt lgkmcnt(4)
    s_waitcnt vmcnt(3)
    v_mfma_f32_16x16x32_bf16 v[0:3], v[216:219], v[192:195], v[0:3]
    ds_read_b64_tr_b16 v[212:213], v237 offset:12288
    ds_read_b64_tr_b16 v[214:215], v237 offset:18432
    s_waitcnt vmcnt(2)
    v_mfma_f32_16x16x32_bf16 v[40:43], v[216:219], v[196:199], v[40:43]
    s_waitcnt vmcnt(1)
    v_mfma_f32_16x16x32_bf16 v[80:83], v[216:219], v[200:203], v[80:83]
    s_waitcnt vmcnt(0)
    v_mfma_f32_16x16x32_bf16 v[120:123], v[216:219], v[204:207], v[120:123]
    s_waitcnt lgkmcnt(4)
    v_mfma_f32_16x16x32_bf16 v[4:7], v[220:223], v[192:195], v[4:7]
    ds_read_b64_tr_b16 v[216:217], v237 offset:24576
    ds_read_b64_tr_b16 v[218:219], v237 offset:30720
    v_mfma_f32_16x16x32_bf16 v[44:47], v[220:223], v[196:199], v[44:47]
    v_mfma_f32_16x16x32_bf16 v[84:87], v[220:223], v[200:203], v[84:87]
    v_mfma_f32_16x16x32_bf16 v[124:127], v[220:223], v[204:207], v[124:127]
    s_lshr_b32 s46, s2, 3
    s_lshl_b32 s46, s46, 3
    s_add_u32 s46, s46, s30
    s_mul_i32 s46, s46, 23
    v_lshrrev_b32 v254, 4, v243
    v_add_u32 v254, s46, v254
    v_min_u32 v254, 5759, v254
    s_mov_b32 s48, 0xCCCD
    v_mul_lo_u32 v253, v254, s48
    v_lshrrev_b32 v253, 18, v253
    v_lshlrev_b32 v254, 7, v254
    v_mul_u32_u24 v253, 512, v253
    v_add_u32 v254, v254, v253
    s_lshr_b32 s48, s31, 1
    s_mul_i32 s48, s48, 1327104
    s_and_b32 s46, s31, 1
    s_lshl_b32 s46, s46, 9
    s_add_u32 s48, s48, s46
    s_mov_b32 s24, s92
    s_mov_b32 s25, s93
    s_mov_b32 s26, 0x510000
    s_mov_b32 s27, 0x20000
    s_mov_b32 exec_hi, 0
    s_mov_b32 exec_lo, 0x7fffff
    buffer_load_dword v253, v254, s[24:27], s48 offen
    s_mov_b64 exec, -1
    s_waitcnt lgkmcnt(4)
    v_mfma_f32_16x16x32_bf16 v[8:11], v[208:211], v[160:163], v[8:11]
    ds_read_b64_tr_b16 v[220:221], v237 offset:36864
    ds_read_b64_tr_b16 v[222:223], v237 offset:43008
    ds_read_b128 v[224:227], v252 offset:0
    ds_read_b128 v[228:231], v252 offset:576
    s_waitcnt lgkmcnt(0)
    v_fmac_f32 v0, v244, v224
    v_fmac_f32 v1, v244, v225
    v_fmac_f32 v2, v244, v226
    v_mfma_f32_16x16x32_bf16 v[48:51], v[208:211], v[164:167], v[48:51]
    v_fmac_f32 v3, v244, v227
    v_fmac_f32 v4, v244, v228
    v_fmac_f32 v5, v244, v229
    v_fmac_f32 v6, v244, v230
    v_fmac_f32 v7, v244, v231
    v_mul_f32 v4, v0, v4
    v_mfma_f32_16x16x32_bf16 v[88:91], v[208:211], v[168:171], v[88:91]
    v_mul_f32 v5, v1, v5
    v_mul_f32 v6, v2, v6
    v_mul_f32 v7, v3, v7
    v_mul_f32 v0, v245, v0
    v_mul_f32 v1, v245, v1
    v_mul_f32 v2, v245, v2
    v_mfma_f32_16x16x32_bf16 v[128:131], v[208:211], v[172:175], v[128:131]
    v_mul_f32 v3, v245, v3
    v_exp_f32 v0, v0
    v_exp_f32 v1, v1
    v_exp_f32 v2, v2
    v_exp_f32 v3, v3
    v_fma_f32 v0, v0, v240, v240
    v_mfma_f32_16x16x32_bf16 v[12:15], v[212:215], v[160:163], v[12:15]
    ds_read_b64_tr_b16 v[208:209], v233 offset:0
    ds_read_b64_tr_b16 v[210:211], v233 offset:6144
    v_fma_f32 v1, v1, v240, v240
    v_fma_f32 v2, v2, v240, v240
    v_fma_f32 v3, v3, v240, v240
    v_rcp_f32 v0, v0
    v_rcp_f32 v1, v1
    v_mfma_f32_16x16x32_bf16 v[52:55], v[212:215], v[164:167], v[52:55]
    v_rcp_f32 v2, v2
    v_rcp_f32 v3, v3
    v_mul_f32 v4, v4, v0
    v_mul_f32 v5, v5, v1
    v_mul_f32 v6, v6, v2
    v_mul_f32 v7, v7, v3
    v_mfma_f32_16x16x32_bf16 v[92:95], v[212:215], v[168:171], v[92:95]
    v_cvt_pk_bf16_f32 v0, v4, v5
    v_cvt_pk_bf16_f32 v1, v6, v7
    v_fmac_f32 v40, v246, v224
    v_fmac_f32 v41, v246, v225
    v_fmac_f32 v42, v246, v226
    v_fmac_f32 v43, v246, v227
    v_mfma_f32_16x16x32_bf16 v[132:135], v[212:215], v[172:175], v[132:135]
    v_fmac_f32 v44, v246, v228
    v_fmac_f32 v45, v246, v229
    v_fmac_f32 v46, v246, v230
    v_fmac_f32 v47, v246, v231
    v_mul_f32 v44, v40, v44
    v_mul_f32 v45, v41, v45
    v_mfma_f32_16x16x32_bf16 v[8:11], v[216:219], v[176:179], v[8:11]
    ds_read_b64_tr_b16 v[212:213], v233 offset:12288
    ds_read_b64_tr_b16 v[214:215], v233 offset:18432
    v_mul_f32 v46, v42, v46
    v_mul_f32 v47, v43, v47
    v_mul_f32 v40, v247, v40
    v_mul_f32 v41, v247, v41
    v_mul_f32 v42, v247, v42
    v_mfma_f32_16x16x32_bf16 v[48:51], v[216:219], v[180:183], v[48:51]
    v_mul_f32 v43, v247, v43
    v_exp_f32 v40, v40
    v_exp_f32 v41, v41
    v_exp_f32 v42, v42
    v_exp_f32 v43, v43
    v_fma_f32 v40, v40, v241, v241
    v_mfma_f32_16x16x32_bf16 v[88:91], v[216:219], v[184:187], v[88:91]
    v_fma_f32 v41, v41, v241, v241
    v_fma_f32 v42, v42, v241, v241
    v_fma_f32 v43, v43, v241, v241
    v_rcp_f32 v40, v40
    v_rcp_f32 v41, v41
    v_rcp_f32 v42, v42
    v_mfma_f32_16x16x32_bf16 v[128:131], v[216:219], v[188:191], v[128:131]
    v_rcp_f32 v43, v43
    v_mul_f32 v44, v44, v40
    v_mul_f32 v45, v45, v41
    v_mul_f32 v46, v46, v42
    v_mul_f32 v47, v47, v43
    v_cvt_pk_bf16_f32 v40, v44, v45
    v_mfma_f32_16x16x32_bf16 v[12:15], v[220:223], v[176:179], v[12:15]
    ds_read_b64_tr_b16 v[216:217], v238 offset:0
    ds_read_b64_tr_b16 v[218:219], v238 offset:6144
    v_cvt_pk_bf16_f32 v41, v46, v47
    v_fmac_f32 v80, v248, v224
    v_fmac_f32 v81, v248, v225
    v_fmac_f32 v82, v248, v226
    v_fmac_f32 v83, v248, v227
    v_mfma_f32_16x16x32_bf16 v[52:55], v[220:223], v[180:183], v[52:55]
    v_fmac_f32 v84, v248, v228
    v_fmac_f32 v85, v248, v229
    v_fmac_f32 v86, v248, v230
    v_fmac_f32 v87, v248, v231
    v_mul_f32 v84, v80, v84
    v_mul_f32 v85, v81, v85
    v_mfma_f32_16x16x32_bf16 v[92:95], v[220:223], v[184:187], v[92:95]
    v_mul_f32 v86, v82, v86
    v_mul_f32 v87, v83, v87
    v_mul_f32 v80, v249, v80
    v_mul_f32 v81, v249, v81
    v_mul_f32 v82, v249, v82
    v_mul_f32 v83, v249, v83
    v_mfma_f32_16x16x32_bf16 v[132:135], v[220:223], v[188:191], v[132:135]
    v_exp_f32 v80, v80
    v_exp_f32 v81, v81
    v_exp_f32 v82, v82
    v_exp_f32 v83, v83
    v_fma_f32 v80, v80, v242, v242
    v_fma_f32 v81, v81, v242, v242
    s_waitcnt lgkmcnt(4)
    v_mfma_f32_16x16x32_bf16 v[8:11], v[208:211], v[192:195], v[8:11]
    ds_read_b64_tr_b16 v[220:221], v238 offset:12288
    ds_read_b64_tr_b16 v[222:223], v238 offset:18432
    v_fma_f32 v82, v82, v242, v242
    v_fma_f32 v83, v83, v242, v242
    v_rcp_f32 v80, v80
    v_rcp_f32 v81, v81
    v_rcp_f32 v82, v82
    v_mfma_f32_16x16x32_bf16 v[48:51], v[208:211], v[196:199], v[48:51]
    v_rcp_f32 v83, v83
    v_mul_f32 v84, v84, v80
    v_mul_f32 v85, v85, v81
    v_mul_f32 v86, v86, v82
    v_mul_f32 v87, v87, v83
    v_cvt_pk_bf16_f32 v80, v84, v85
    v_mfma_f32_16x16x32_bf16 v[88:91], v[208:211], v[200:203], v[88:91]
    v_cvt_pk_bf16_f32 v81, v86, v87
    v_fmac_f32 v120, v250, v224
    v_fmac_f32 v121, v250, v225
    v_fmac_f32 v122, v250, v226
    v_fmac_f32 v123, v250, v227
    v_fmac_f32 v124, v250, v228
    v_mfma_f32_16x16x32_bf16 v[128:131], v[208:211], v[204:207], v[128:131]
    v_fmac_f32 v125, v250, v229
    v_fmac_f32 v126, v250, v230
    v_fmac_f32 v127, v250, v231
    v_mul_f32 v124, v120, v124
    v_mul_f32 v125, v121, v125
    v_mul_f32 v126, v122, v126
    s_waitcnt lgkmcnt(4)
    v_mfma_f32_16x16x32_bf16 v[12:15], v[212:215], v[192:195], v[12:15]
    ds_read_b64_tr_b16 v[208:209], v238 offset:24576
    ds_read_b64_tr_b16 v[210:211], v238 offset:30720
    v_mul_f32 v127, v123, v127
    v_mul_f32 v120, v251, v120
    v_mul_f32 v121, v251, v121
    v_mul_f32 v122, v251, v122
    v_mul_f32 v123, v251, v123
    v_mfma_f32_16x16x32_bf16 v[52:55], v[212:215], v[196:199], v[52:55]
    v_exp_f32 v120, v120
    v_exp_f32 v121, v121
    v_exp_f32 v122, v122
    v_exp_f32 v123, v123
    v_fma_f32 v120, v120, v255, v255
    v_fma_f32 v121, v121, v255, v255
    v_mfma_f32_16x16x32_bf16 v[92:95], v[212:215], v[200:203], v[92:95]
    v_fma_f32 v122, v122, v255, v255
    v_fma_f32 v123, v123, v255, v255
    v_rcp_f32 v120, v120
    v_rcp_f32 v121, v121
    v_rcp_f32 v122, v122
    v_rcp_f32 v123, v123
    v_mfma_f32_16x16x32_bf16 v[132:135], v[212:215], v[204:207], v[132:135]
    v_mul_f32 v124, v124, v120
    v_mul_f32 v125, v125, v121
    v_mul_f32 v126, v126, v122
    v_mul_f32 v127, v127, v123
    v_cvt_pk_bf16_f32 v120, v124, v125
    v_cvt_pk_bf16_f32 v121, v126, v127
    s_waitcnt lgkmcnt(4)
    v_mfma_f32_16x16x32_bf16 v[16:19], v[216:219], v[160:163], v[16:19]
    ds_read_b64_tr_b16 v[212:213], v238 offset:36864
    ds_read_b64_tr_b16 v[214:215], v238 offset:43008
    ds_read_b128 v[224:227], v252 offset:64
    ds_read_b128 v[228:231], v252 offset:640
    s_waitcnt lgkmcnt(0)
    v_fmac_f32 v8, v244, v224
    v_fmac_f32 v9, v244, v225
    v_fmac_f32 v10, v244, v226
    v_fmac_f32 v11, v244, v227
    v_mfma_f32_16x16x32_bf16 v[56:59], v[216:219], v[164:167], v[56:59]
    v_fmac_f32 v12, v244, v228
    v_fmac_f32 v13, v244, v229
    v_fmac_f32 v14, v244, v230
    v_fmac_f32 v15, v244, v231
    v_mul_f32 v12, v8, v12
    v_mul_f32 v13, v9, v13
    v_mfma_f32_16x16x32_bf16 v[96:99], v[216:219], v[168:171], v[96:99]
    v_mul_f32 v14, v10, v14
    v_mul_f32 v15, v11, v15
    v_mul_f32 v8, v245, v8
    v_mul_f32 v9, v245, v9
    v_mul_f32 v10, v245, v10
    v_mul_f32 v11, v245, v11
    v_mfma_f32_16x16x32_bf16 v[136:139], v[216:219], v[172:175], v[136:139]
    v_exp_f32 v8, v8
    v_exp_f32 v9, v9
    v_exp_f32 v10, v10
    v_exp_f32 v11, v11
    v_fma_f32 v8, v8, v240, v240
    v_fma_f32 v9, v9, v240, v240
    v_mfma_f32_16x16x32_bf16 v[20:23], v[220:223], v[160:163], v[20:23]
    ds_read_b64_tr_b16 v[216:217], v234 offset:0
    ds_read_b64_tr_b16 v[218:219], v234 offset:6144
    v_fma_f32 v10, v10, v240, v240
    v_fma_f32 v11, v11, v240, v240
    v_rcp_f32 v8, v8
    v_rcp_f32 v9, v9
    v_rcp_f32 v10, v10
    v_rcp_f32 v11, v11
    v_mfma_f32_16x16x32_bf16 v[60:63], v[220:223], v[164:167], v[60:63]
    v_mul_f32 v12, v12, v8
    v_mul_f32 v13, v13, v9
    v_mul_f32 v14, v14, v10
    v_mul_f32 v15, v15, v11
    v_cvt_pk_bf16_f32 v2, v12, v13
    v_cvt_pk_bf16_f32 v3, v14, v15
    v_mfma_f32_16x16x32_bf16 v[100:103], v[220:223], v[168:171], v[100:103]
    s_add_u32 s57, s59, s84
    buffer_store_dwordx4 v[0:3], v243, s[16:19], s57 offen offset:0 sc1
    v_fmac_f32 v48, v246, v224
    v_fmac_f32 v49, v246, v225
    v_fmac_f32 v50, v246, v226
    v_fmac_f32 v51, v246, v227
    v_mfma_f32_16x16x32_bf16 v[140:143], v[220:223], v[172:175], v[140:143]
    v_fmac_f32 v52, v246, v228
    v_fmac_f32 v53, v246, v229
    v_fmac_f32 v54, v246, v230
    v_fmac_f32 v55, v246, v231
    v_mul_f32 v52, v48, v52
    v_mul_f32 v53, v49, v53
    v_mfma_f32_16x16x32_bf16 v[16:19], v[208:211], v[176:179], v[16:19]
    ds_read_b64_tr_b16 v[220:221], v234 offset:12288
    ds_read_b64_tr_b16 v[222:223], v234 offset:18432
    v_mul_f32 v54, v50, v54
    v_mul_f32 v55, v51, v55
    v_mul_f32 v48, v247, v48
    v_mul_f32 v49, v247, v49
    v_mul_f32 v50, v247, v50
    v_mul_f32 v51, v247, v51
    v_mfma_f32_16x16x32_bf16 v[56:59], v[208:211], v[180:183], v[56:59]
    v_exp_f32 v48, v48
    v_exp_f32 v49, v49
    v_exp_f32 v50, v50
    v_exp_f32 v51, v51
    v_fma_f32 v48, v48, v241, v241
    v_fma_f32 v49, v49, v241, v241
    v_mfma_f32_16x16x32_bf16 v[96:99], v[208:211], v[184:187], v[96:99]
    v_fma_f32 v50, v50, v241, v241
    v_fma_f32 v51, v51, v241, v241
    v_rcp_f32 v48, v48
    v_rcp_f32 v49, v49
    v_rcp_f32 v50, v50
    v_rcp_f32 v51, v51
    v_mfma_f32_16x16x32_bf16 v[136:139], v[208:211], v[188:191], v[136:139]
    v_mul_f32 v52, v52, v48
    v_mul_f32 v53, v53, v49
    v_mul_f32 v54, v54, v50
    v_mul_f32 v55, v55, v51
    v_cvt_pk_bf16_f32 v42, v52, v53
    v_cvt_pk_bf16_f32 v43, v54, v55
    s_add_u32 s57, s59, s85
    v_mfma_f32_16x16x32_bf16 v[20:23], v[212:215], v[176:179], v[20:23]
    ds_read_b64_tr_b16 v[208:209], v239 offset:0
    ds_read_b64_tr_b16 v[210:211], v239 offset:6144
    buffer_store_dwordx4 v[40:43], v243, s[16:19], s57 offen offset:0 sc1
    v_fmac_f32 v88, v248, v224
    v_fmac_f32 v89, v248, v225
    v_fmac_f32 v90, v248, v226
    v_fmac_f32 v91, v248, v227
    v_fmac_f32 v92, v248, v228
    v_mfma_f32_16x16x32_bf16 v[60:63], v[212:215], v[180:183], v[60:63]
    v_fmac_f32 v93, v248, v229
    v_fmac_f32 v94, v248, v230
    v_fmac_f32 v95, v248, v231
    v_mul_f32 v92, v88, v92
    v_mul_f32 v93, v89, v93
    v_mul_f32 v94, v90, v94
    v_mfma_f32_16x16x32_bf16 v[100:103], v[212:215], v[184:187], v[100:103]
    v_mul_f32 v95, v91, v95
    v_mul_f32 v88, v249, v88
    v_mul_f32 v89, v249, v89
    v_mul_f32 v90, v249, v90
    v_mul_f32 v91, v249, v91
    v_exp_f32 v88, v88
    v_mfma_f32_16x16x32_bf16 v[140:143], v[212:215], v[188:191], v[140:143]
    v_exp_f32 v89, v89
    v_exp_f32 v90, v90
    v_exp_f32 v91, v91
    v_fma_f32 v88, v88, v242, v242
    v_fma_f32 v89, v89, v242, v242
    v_fma_f32 v90, v90, v242, v242
    s_waitcnt lgkmcnt(4)
    v_mfma_f32_16x16x32_bf16 v[16:19], v[216:219], v[192:195], v[16:19]
    ds_read_b64_tr_b16 v[212:213], v239 offset:12288
    ds_read_b64_tr_b16 v[214:215], v239 offset:18432
    v_fma_f32 v91, v91, v242, v242
    v_rcp_f32 v88, v88
    v_rcp_f32 v89, v89
    v_rcp_f32 v90, v90
    v_rcp_f32 v91, v91
    v_mul_f32 v92, v92, v88
    v_mfma_f32_16x16x32_bf16 v[56:59], v[216:219], v[196:199], v[56:59]
    v_mul_f32 v93, v93, v89
    v_mul_f32 v94, v94, v90
    v_mul_f32 v95, v95, v91
    v_cvt_pk_bf16_f32 v82, v92, v93
    v_cvt_pk_bf16_f32 v83, v94, v95
    s_add_u32 s57, s59, s86
    v_mfma_f32_16x16x32_bf16 v[96:99], v[216:219], v[200:203], v[96:99]
    buffer_store_dwordx4 v[80:83], v243, s[16:19], s57 offen offset:0 sc1
    v_fmac_f32 v128, v250, v224
    v_fmac_f32 v129, v250, v225
    v_fmac_f32 v130, v250, v226
    v_fmac_f32 v131, v250, v227
    v_fmac_f32 v132, v250, v228
    v_mfma_f32_16x16x32_bf16 v[136:139], v[216:219], v[204:207], v[136:139]
    v_fmac_f32 v133, v250, v229
    v_fmac_f32 v134, v250, v230
    v_fmac_f32 v135, v250, v231
    v_mul_f32 v132, v128, v132
    v_mul_f32 v133, v129, v133
    v_mul_f32 v134, v130, v134
    s_waitcnt lgkmcnt(4)
    v_mfma_f32_16x16x32_bf16 v[20:23], v[220:223], v[192:195], v[20:23]
    ds_read_b64_tr_b16 v[216:217], v239 offset:24576
    ds_read_b64_tr_b16 v[218:219], v239 offset:30720
    v_mul_f32 v135, v131, v135
    v_mul_f32 v128, v251, v128
    v_mul_f32 v129, v251, v129
    v_mul_f32 v130, v251, v130
    v_mul_f32 v131, v251, v131
    v_exp_f32 v128, v128
    v_mfma_f32_16x16x32_bf16 v[60:63], v[220:223], v[196:199], v[60:63]
    v_exp_f32 v129, v129
    v_exp_f32 v130, v130
    v_exp_f32 v131, v131
    v_fma_f32 v128, v128, v255, v255
    v_fma_f32 v129, v129, v255, v255
    v_fma_f32 v130, v130, v255, v255
    v_mfma_f32_16x16x32_bf16 v[100:103], v[220:223], v[200:203], v[100:103]
    v_fma_f32 v131, v131, v255, v255
    v_rcp_f32 v128, v128
    v_rcp_f32 v129, v129
    v_rcp_f32 v130, v130
    v_rcp_f32 v131, v131
    v_mul_f32 v132, v132, v128
    v_mfma_f32_16x16x32_bf16 v[140:143], v[220:223], v[204:207], v[140:143]
    v_mul_f32 v133, v133, v129
    v_mul_f32 v134, v134, v130
    v_mul_f32 v135, v135, v131
    v_cvt_pk_bf16_f32 v122, v132, v133
    v_cvt_pk_bf16_f32 v123, v134, v135
    s_add_u32 s57, s59, s87
    buffer_store_dwordx4 v[120:123], v243, s[16:19], s57 offen offset:0 sc1
    s_waitcnt lgkmcnt(4)
    v_mfma_f32_16x16x32_bf16 v[24:27], v[208:211], v[160:163], v[24:27]
    ds_read_b64_tr_b16 v[220:221], v239 offset:36864
    ds_read_b64_tr_b16 v[222:223], v239 offset:43008
    ds_read_b128 v[224:227], v252 offset:128
    ds_read_b128 v[228:231], v252 offset:704
    s_waitcnt lgkmcnt(0)
    v_fmac_f32 v16, v244, v224
    v_fmac_f32 v17, v244, v225
    v_fmac_f32 v18, v244, v226
    v_mfma_f32_16x16x32_bf16 v[64:67], v[208:211], v[164:167], v[64:67]
    v_fmac_f32 v19, v244, v227
    v_fmac_f32 v20, v244, v228
    v_fmac_f32 v21, v244, v229
    v_fmac_f32 v22, v244, v230
    v_fmac_f32 v23, v244, v231
    v_mul_f32 v20, v16, v20
    v_mfma_f32_16x16x32_bf16 v[104:107], v[208:211], v[168:171], v[104:107]
    v_mul_f32 v21, v17, v21
    v_mul_f32 v22, v18, v22
    v_mul_f32 v23, v19, v23
    v_mul_f32 v16, v245, v16
    v_mul_f32 v17, v245, v17
    v_mul_f32 v18, v245, v18
    v_mfma_f32_16x16x32_bf16 v[144:147], v[208:211], v[172:175], v[144:147]
    v_mul_f32 v19, v245, v19
    v_exp_f32 v16, v16
    v_exp_f32 v17, v17
    v_exp_f32 v18, v18
    v_exp_f32 v19, v19
    v_fma_f32 v16, v16, v240, v240
    v_mfma_f32_16x16x32_bf16 v[28:31], v[212:215], v[160:163], v[28:31]
    ds_read_b64_tr_b16 v[208:209], v235 offset:0
    ds_read_b64_tr_b16 v[210:211], v235 offset:6144
    v_fma_f32 v17, v17, v240, v240
    v_fma_f32 v18, v18, v240, v240
    v_fma_f32 v19, v19, v240, v240
    v_rcp_f32 v16, v16
    v_rcp_f32 v17, v17
    v_mfma_f32_16x16x32_bf16 v[68:71], v[212:215], v[164:167], v[68:71]
    v_rcp_f32 v18, v18
    v_rcp_f32 v19, v19
    v_mul_f32 v20, v20, v16
    v_mul_f32 v21, v21, v17
    v_mul_f32 v22, v22, v18
    v_mul_f32 v23, v23, v19
    v_mfma_f32_16x16x32_bf16 v[108:111], v[212:215], v[168:171], v[108:111]
    v_cvt_pk_bf16_f32 v16, v20, v21
    v_cvt_pk_bf16_f32 v17, v22, v23
    v_fmac_f32 v56, v246, v224
    v_fmac_f32 v57, v246, v225
    v_fmac_f32 v58, v246, v226
    v_fmac_f32 v59, v246, v227
    v_mfma_f32_16x16x32_bf16 v[148:151], v[212:215], v[172:175], v[148:151]
    v_fmac_f32 v60, v246, v228
    v_fmac_f32 v61, v246, v229
    v_fmac_f32 v62, v246, v230
    v_fmac_f32 v63, v246, v231
    v_mul_f32 v60, v56, v60
    v_mul_f32 v61, v57, v61
    v_mfma_f32_16x16x32_bf16 v[24:27], v[216:219], v[176:179], v[24:27]
    ds_read_b64_tr_b16 v[212:213], v235 offset:12288
    ds_read_b64_tr_b16 v[214:215], v235 offset:18432
    v_mul_f32 v62, v58, v62
    v_mul_f32 v63, v59, v63
    v_mul_f32 v56, v247, v56
    v_mul_f32 v57, v247, v57
    v_mul_f32 v58, v247, v58
    v_mfma_f32_16x16x32_bf16 v[64:67], v[216:219], v[180:183], v[64:67]
    v_mul_f32 v59, v247, v59
    v_exp_f32 v56, v56
    v_exp_f32 v57, v57
    v_exp_f32 v58, v58
    v_exp_f32 v59, v59
    v_fma_f32 v56, v56, v241, v241
    v_mfma_f32_16x16x32_bf16 v[104:107], v[216:219], v[184:187], v[104:107]
    v_fma_f32 v57, v57, v241, v241
    v_fma_f32 v58, v58, v241, v241
    v_fma_f32 v59, v59, v241, v241
    v_rcp_f32 v56, v56
    v_rcp_f32 v57, v57
    v_rcp_f32 v58, v58
    v_mfma_f32_16x16x32_bf16 v[144:147], v[216:219], v[188:191], v[144:147]
    v_rcp_f32 v59, v59
    v_mul_f32 v60, v60, v56
    v_mul_f32 v61, v61, v57
    v_mul_f32 v62, v62, v58
    v_mul_f32 v63, v63, v59
    v_cvt_pk_bf16_f32 v56, v60, v61
    v_mfma_f32_16x16x32_bf16 v[28:31], v[220:223], v[176:179], v[28:31]
    ds_read_b64_tr_b16 v[216:217], v236 offset:256
    ds_read_b64_tr_b16 v[218:219], v236 offset:6400
    v_cvt_pk_bf16_f32 v57, v62, v63
    v_fmac_f32 v96, v248, v224
    v_fmac_f32 v97, v248, v225
    v_fmac_f32 v98, v248, v226
    v_fmac_f32 v99, v248, v227
    v_mfma_f32_16x16x32_bf16 v[68:71], v[220:223], v[180:183], v[68:71]
    v_fmac_f32 v100, v248, v228
    v_fmac_f32 v101, v248, v229
    v_fmac_f32 v102, v248, v230
    v_fmac_f32 v103, v248, v231
    v_mul_f32 v100, v96, v100
    v_mul_f32 v101, v97, v101
    v_mfma_f32_16x16x32_bf16 v[108:111], v[220:223], v[184:187], v[108:111]
    v_mul_f32 v102, v98, v102
    v_mul_f32 v103, v99, v103
    v_mul_f32 v96, v249, v96
    v_mul_f32 v97, v249, v97
    v_mul_f32 v98, v249, v98
    v_mul_f32 v99, v249, v99
    v_mfma_f32_16x16x32_bf16 v[148:151], v[220:223], v[188:191], v[148:151]
    v_exp_f32 v96, v96
    v_exp_f32 v97, v97
    v_exp_f32 v98, v98
    v_exp_f32 v99, v99
    v_fma_f32 v96, v96, v242, v242
    v_fma_f32 v97, v97, v242, v242
    s_waitcnt lgkmcnt(4)
    v_mfma_f32_16x16x32_bf16 v[24:27], v[208:211], v[192:195], v[24:27]
    ds_read_b64_tr_b16 v[220:221], v236 offset:12544
    ds_read_b64_tr_b16 v[222:223], v236 offset:18688
    v_fma_f32 v98, v98, v242, v242
    v_fma_f32 v99, v99, v242, v242
    v_rcp_f32 v96, v96
    v_rcp_f32 v97, v97
    v_rcp_f32 v98, v98
    v_mfma_f32_16x16x32_bf16 v[64:67], v[208:211], v[196:199], v[64:67]
    v_rcp_f32 v99, v99
    v_mul_f32 v100, v100, v96
    v_mul_f32 v101, v101, v97
    v_mul_f32 v102, v102, v98
    v_mul_f32 v103, v103, v99
    v_cvt_pk_bf16_f32 v96, v100, v101
    v_mfma_f32_16x16x32_bf16 v[104:107], v[208:211], v[200:203], v[104:107]
    v_cvt_pk_bf16_f32 v97, v102, v103
    v_fmac_f32 v136, v250, v224
    v_fmac_f32 v137, v250, v225
    v_fmac_f32 v138, v250, v226
    v_fmac_f32 v139, v250, v227
    v_fmac_f32 v140, v250, v228
    v_mfma_f32_16x16x32_bf16 v[144:147], v[208:211], v[204:207], v[144:147]
    v_fmac_f32 v141, v250, v229
    v_fmac_f32 v142, v250, v230
    v_fmac_f32 v143, v250, v231
    v_mul_f32 v140, v136, v140
    v_mul_f32 v141, v137, v141
    v_mul_f32 v142, v138, v142
    s_waitcnt lgkmcnt(4)
    v_mfma_f32_16x16x32_bf16 v[28:31], v[212:215], v[192:195], v[28:31]
    ds_read_b64_tr_b16 v[208:209], v236 offset:24832
    ds_read_b64_tr_b16 v[210:211], v236 offset:30976
    v_mul_f32 v143, v139, v143
    v_mul_f32 v136, v251, v136
    v_mul_f32 v137, v251, v137
    v_mul_f32 v138, v251, v138
    v_mul_f32 v139, v251, v139
    v_mfma_f32_16x16x32_bf16 v[68:71], v[212:215], v[196:199], v[68:71]
    v_exp_f32 v136, v136
    v_exp_f32 v137, v137
    v_exp_f32 v138, v138
    v_exp_f32 v139, v139
    v_fma_f32 v136, v136, v255, v255
    v_fma_f32 v137, v137, v255, v255
    v_mfma_f32_16x16x32_bf16 v[108:111], v[212:215], v[200:203], v[108:111]
    v_fma_f32 v138, v138, v255, v255
    v_fma_f32 v139, v139, v255, v255
    v_rcp_f32 v136, v136
    v_rcp_f32 v137, v137
    v_rcp_f32 v138, v138
    v_rcp_f32 v139, v139
    v_mfma_f32_16x16x32_bf16 v[148:151], v[212:215], v[204:207], v[148:151]
    v_mul_f32 v140, v140, v136
    v_mul_f32 v141, v141, v137
    v_mul_f32 v142, v142, v138
    v_mul_f32 v143, v143, v139
    v_cvt_pk_bf16_f32 v136, v140, v141
    v_cvt_pk_bf16_f32 v137, v142, v143
    s_waitcnt lgkmcnt(4)
    v_mfma_f32_16x16x32_bf16 v[32:35], v[216:219], v[160:163], v[32:35]
    ds_read_b64_tr_b16 v[212:213], v236 offset:37120
    ds_read_b64_tr_b16 v[214:215], v236 offset:43264
    ds_read_b128 v[224:227], v252 offset:192
    ds_read_b128 v[228:231], v252 offset:768
    s_waitcnt lgkmcnt(0)
    v_fmac_f32 v24, v244, v224
    v_fmac_f32 v25, v244, v225
    v_fmac_f32 v26, v244, v226
    v_fmac_f32 v27, v244, v227
    v_mfma_f32_16x16x32_bf16 v[72:75], v[216:219], v[164:167], v[72:75]
    v_fmac_f32 v28, v244, v228
    v_fmac_f32 v29, v244, v229
    v_fmac_f32 v30, v244, v230
    v_fmac_f32 v31, v244, v231
    v_mul_f32 v28, v24, v28
    v_mul_f32 v29, v25, v29
    v_mfma_f32_16x16x32_bf16 v[112:115], v[216:219], v[168:171], v[112:115]
    v_mul_f32 v30, v26, v30
    v_mul_f32 v31, v27, v31
    v_mul_f32 v24, v245, v24
    v_mul_f32 v25, v245, v25
    v_mul_f32 v26, v245, v26
    v_mul_f32 v27, v245, v27
    v_mfma_f32_16x16x32_bf16 v[152:155], v[216:219], v[172:175], v[152:155]
    v_exp_f32 v24, v24
    v_exp_f32 v25, v25
    v_exp_f32 v26, v26
    v_exp_f32 v27, v27
    v_fma_f32 v24, v24, v240, v240
    v_fma_f32 v25, v25, v240, v240
    v_mfma_f32_16x16x32_bf16 v[36:39], v[220:223], v[160:163], v[36:39]
    ds_read_b64_tr_b16 v[216:217], v232 offset:256
    ds_read_b64_tr_b16 v[218:219], v232 offset:6400
    v_fma_f32 v26, v26, v240, v240
    v_fma_f32 v27, v27, v240, v240
    v_rcp_f32 v24, v24
    v_rcp_f32 v25, v25
    v_rcp_f32 v26, v26
    v_rcp_f32 v27, v27
    v_mfma_f32_16x16x32_bf16 v[76:79], v[220:223], v[164:167], v[76:79]
    v_mul_f32 v28, v28, v24
    v_mul_f32 v29, v29, v25
    v_mul_f32 v30, v30, v26
    v_mul_f32 v31, v31, v27
    v_cvt_pk_bf16_f32 v18, v28, v29
    v_cvt_pk_bf16_f32 v19, v30, v31
    v_mfma_f32_16x16x32_bf16 v[116:119], v[220:223], v[168:171], v[116:119]
    s_add_u32 s57, s59, s84
    buffer_store_dwordx4 v[16:19], v243, s[16:19], s57 offen offset:1024 sc1
    v_fmac_f32 v64, v246, v224
    v_fmac_f32 v65, v246, v225
    v_fmac_f32 v66, v246, v226
    v_fmac_f32 v67, v246, v227
    v_mfma_f32_16x16x32_bf16 v[156:159], v[220:223], v[172:175], v[156:159]
    v_fmac_f32 v68, v246, v228
    v_fmac_f32 v69, v246, v229
    v_fmac_f32 v70, v246, v230
    v_fmac_f32 v71, v246, v231
    v_mul_f32 v68, v64, v68
    v_mul_f32 v69, v65, v69
    v_mfma_f32_16x16x32_bf16 v[32:35], v[208:211], v[176:179], v[32:35]
    ds_read_b64_tr_b16 v[220:221], v232 offset:12544
    ds_read_b64_tr_b16 v[222:223], v232 offset:18688
    v_mul_f32 v70, v66, v70
    v_mul_f32 v71, v67, v71
    v_mul_f32 v64, v247, v64
    v_mul_f32 v65, v247, v65
    v_mul_f32 v66, v247, v66
    v_mul_f32 v67, v247, v67
    v_mfma_f32_16x16x32_bf16 v[72:75], v[208:211], v[180:183], v[72:75]
    v_exp_f32 v64, v64
    v_exp_f32 v65, v65
    v_exp_f32 v66, v66
    v_exp_f32 v67, v67
    v_fma_f32 v64, v64, v241, v241
    v_fma_f32 v65, v65, v241, v241
    v_mfma_f32_16x16x32_bf16 v[112:115], v[208:211], v[184:187], v[112:115]
    v_fma_f32 v66, v66, v241, v241
    v_fma_f32 v67, v67, v241, v241
    v_rcp_f32 v64, v64
    v_rcp_f32 v65, v65
    v_rcp_f32 v66, v66
    v_rcp_f32 v67, v67
    v_mfma_f32_16x16x32_bf16 v[152:155], v[208:211], v[188:191], v[152:155]
    v_mul_f32 v68, v68, v64
    v_mul_f32 v69, v69, v65
    v_mul_f32 v70, v70, v66
    v_mul_f32 v71, v71, v67
    v_cvt_pk_bf16_f32 v58, v68, v69
    v_cvt_pk_bf16_f32 v59, v70, v71
    s_add_u32 s57, s59, s85
    v_mfma_f32_16x16x32_bf16 v[36:39], v[212:215], v[176:179], v[36:39]
    buffer_store_dwordx4 v[56:59], v243, s[16:19], s57 offen offset:1024 sc1
    v_fmac_f32 v104, v248, v224
    v_fmac_f32 v105, v248, v225
    v_fmac_f32 v106, v248, v226
    v_fmac_f32 v107, v248, v227
    v_fmac_f32 v108, v248, v228
    v_mfma_f32_16x16x32_bf16 v[76:79], v[212:215], v[180:183], v[76:79]
    v_fmac_f32 v109, v248, v229
    v_fmac_f32 v110, v248, v230
    v_fmac_f32 v111, v248, v231
    v_mul_f32 v108, v104, v108
    v_mul_f32 v109, v105, v109
    v_mul_f32 v110, v106, v110
    v_mfma_f32_16x16x32_bf16 v[116:119], v[212:215], v[184:187], v[116:119]
    v_mul_f32 v111, v107, v111
    v_mul_f32 v104, v249, v104
    v_mul_f32 v105, v249, v105
    v_mul_f32 v106, v249, v106
    v_mul_f32 v107, v249, v107
    v_exp_f32 v104, v104
    v_mfma_f32_16x16x32_bf16 v[156:159], v[212:215], v[188:191], v[156:159]
    v_exp_f32 v105, v105
    v_exp_f32 v106, v106
    v_exp_f32 v107, v107
    v_fma_f32 v104, v104, v242, v242
    v_fma_f32 v105, v105, v242, v242
    v_fma_f32 v106, v106, v242, v242
    s_waitcnt lgkmcnt(2)
    v_mfma_f32_16x16x32_bf16 v[32:35], v[216:219], v[192:195], v[32:35]
    v_fma_f32 v107, v107, v242, v242
    v_rcp_f32 v104, v104
    v_rcp_f32 v105, v105
    v_rcp_f32 v106, v106
    v_rcp_f32 v107, v107
    v_mul_f32 v108, v108, v104
    v_mfma_f32_16x16x32_bf16 v[72:75], v[216:219], v[196:199], v[72:75]
    v_mul_f32 v109, v109, v105
    v_mul_f32 v110, v110, v106
    v_mul_f32 v111, v111, v107
    v_cvt_pk_bf16_f32 v98, v108, v109
    v_cvt_pk_bf16_f32 v99, v110, v111
    s_add_u32 s57, s59, s86
    v_mfma_f32_16x16x32_bf16 v[112:115], v[216:219], v[200:203], v[112:115]
    buffer_store_dwordx4 v[96:99], v243, s[16:19], s57 offen offset:1024 sc1
    v_fmac_f32 v144, v250, v224
    v_fmac_f32 v145, v250, v225
    v_fmac_f32 v146, v250, v226
    v_fmac_f32 v147, v250, v227
    v_fmac_f32 v148, v250, v228
    v_mfma_f32_16x16x32_bf16 v[152:155], v[216:219], v[204:207], v[152:155]
    v_fmac_f32 v149, v250, v229
    v_fmac_f32 v150, v250, v230
    v_fmac_f32 v151, v250, v231
    v_mul_f32 v148, v144, v148
    v_mul_f32 v149, v145, v149
    v_mul_f32 v150, v146, v150
    s_waitcnt lgkmcnt(0)
    v_mfma_f32_16x16x32_bf16 v[36:39], v[220:223], v[192:195], v[36:39]
    v_mul_f32 v151, v147, v151
    v_mul_f32 v144, v251, v144
    v_mul_f32 v145, v251, v145
    v_mul_f32 v146, v251, v146
    v_mul_f32 v147, v251, v147
    v_exp_f32 v144, v144
    v_mfma_f32_16x16x32_bf16 v[76:79], v[220:223], v[196:199], v[76:79]
    v_exp_f32 v145, v145
    v_exp_f32 v146, v146
    v_exp_f32 v147, v147
    v_fma_f32 v144, v144, v255, v255
    v_fma_f32 v145, v145, v255, v255
    v_fma_f32 v146, v146, v255, v255
    v_mfma_f32_16x16x32_bf16 v[116:119], v[220:223], v[200:203], v[116:119]
    v_fma_f32 v147, v147, v255, v255
    v_rcp_f32 v144, v144
    v_rcp_f32 v145, v145
    v_rcp_f32 v146, v146
    v_rcp_f32 v147, v147
    v_mul_f32 v148, v148, v144
    v_mfma_f32_16x16x32_bf16 v[156:159], v[220:223], v[204:207], v[156:159]
    v_mul_f32 v149, v149, v145
    v_mul_f32 v150, v150, v146
    v_mul_f32 v151, v151, v147
    v_cvt_pk_bf16_f32 v138, v148, v149
    v_cvt_pk_bf16_f32 v139, v150, v151
    s_add_u32 s57, s59, s87
    buffer_store_dwordx4 v[136:139], v243, s[16:19], s57 offen offset:1024 sc1
    ds_read_b128 v[224:227], v252 offset:512
    ds_read_b128 v[228:231], v252 offset:1088
    s_waitcnt lgkmcnt(0)
    v_fmac_f32 v32, v244, v224
    v_fmac_f32 v33, v244, v225
    v_fmac_f32 v34, v244, v226
    v_fmac_f32 v35, v244, v227
    v_fmac_f32 v36, v244, v228
    v_fmac_f32 v37, v244, v229
    v_fmac_f32 v38, v244, v230
    v_fmac_f32 v39, v244, v231
    v_mul_f32 v36, v32, v36
    v_mul_f32 v37, v33, v37
    v_mul_f32 v38, v34, v38
    v_mul_f32 v39, v35, v39
    v_mul_f32 v32, v245, v32
    v_mul_f32 v33, v245, v33
    v_mul_f32 v34, v245, v34
    v_mul_f32 v35, v245, v35
    v_exp_f32 v32, v32
    v_exp_f32 v33, v33
    v_exp_f32 v34, v34
    v_exp_f32 v35, v35
    v_fma_f32 v32, v32, v240, v240
    v_fma_f32 v33, v33, v240, v240
    v_fma_f32 v34, v34, v240, v240
    v_fma_f32 v35, v35, v240, v240
    v_rcp_f32 v32, v32
    v_rcp_f32 v33, v33
    v_rcp_f32 v34, v34
    v_rcp_f32 v35, v35
    v_mul_f32 v36, v36, v32
    v_mul_f32 v37, v37, v33
    v_mul_f32 v38, v38, v34
    v_mul_f32 v39, v39, v35
    v_cvt_pk_bf16_f32 v32, v36, v37
    v_cvt_pk_bf16_f32 v33, v38, v39
    s_add_u32 s57, s56, s84
    buffer_store_dwordx2 v[32:33], v243, s[16:19], s57 offen
    v_fmac_f32 v72, v246, v224
    v_fmac_f32 v73, v246, v225
    v_fmac_f32 v74, v246, v226
    v_fmac_f32 v75, v246, v227
    v_fmac_f32 v76, v246, v228
    v_fmac_f32 v77, v246, v229
    v_fmac_f32 v78, v246, v230
    v_fmac_f32 v79, v246, v231
    v_mul_f32 v76, v72, v76
    v_mul_f32 v77, v73, v77
    v_mul_f32 v78, v74, v78
    v_mul_f32 v79, v75, v79
    v_mul_f32 v72, v247, v72
    v_mul_f32 v73, v247, v73
    v_mul_f32 v74, v247, v74
    v_mul_f32 v75, v247, v75
    v_exp_f32 v72, v72
    v_exp_f32 v73, v73
    v_exp_f32 v74, v74
    v_exp_f32 v75, v75
    v_fma_f32 v72, v72, v241, v241
    v_fma_f32 v73, v73, v241, v241
    v_fma_f32 v74, v74, v241, v241
    v_fma_f32 v75, v75, v241, v241
    v_rcp_f32 v72, v72
    v_rcp_f32 v73, v73
    v_rcp_f32 v74, v74
    v_rcp_f32 v75, v75
    v_mul_f32 v76, v76, v72
    v_mul_f32 v77, v77, v73
    v_mul_f32 v78, v78, v74
    v_mul_f32 v79, v79, v75
    v_cvt_pk_bf16_f32 v72, v76, v77
    v_cvt_pk_bf16_f32 v73, v78, v79
    s_add_u32 s57, s56, s85
    buffer_store_dwordx2 v[72:73], v243, s[16:19], s57 offen
    v_fmac_f32 v112, v248, v224
    v_fmac_f32 v113, v248, v225
    v_fmac_f32 v114, v248, v226
    v_fmac_f32 v115, v248, v227
    v_fmac_f32 v116, v248, v228
    v_fmac_f32 v117, v248, v229
    v_fmac_f32 v118, v248, v230
    v_fmac_f32 v119, v248, v231
    v_mul_f32 v116, v112, v116
    v_mul_f32 v117, v113, v117
    v_mul_f32 v118, v114, v118
    v_mul_f32 v119, v115, v119
    v_mul_f32 v112, v249, v112
    v_mul_f32 v113, v249, v113
    v_mul_f32 v114, v249, v114
    v_mul_f32 v115, v249, v115
    v_exp_f32 v112, v112
    v_exp_f32 v113, v113
    v_exp_f32 v114, v114
    v_exp_f32 v115, v115
    v_fma_f32 v112, v112, v242, v242
    v_fma_f32 v113, v113, v242, v242
    v_fma_f32 v114, v114, v242, v242
    v_fma_f32 v115, v115, v242, v242
    v_rcp_f32 v112, v112
    v_rcp_f32 v113, v113
    v_rcp_f32 v114, v114
    v_rcp_f32 v115, v115
    v_mul_f32 v116, v116, v112
    v_mul_f32 v117, v117, v113
    v_mul_f32 v118, v118, v114
    v_mul_f32 v119, v119, v115
    v_cvt_pk_bf16_f32 v112, v116, v117
    v_cvt_pk_bf16_f32 v113, v118, v119
    s_add_u32 s57, s56, s86
    buffer_store_dwordx2 v[112:113], v243, s[16:19], s57 offen
    v_fmac_f32 v152, v250, v224
    v_fmac_f32 v153, v250, v225
    v_fmac_f32 v154, v250, v226
    v_fmac_f32 v155, v250, v227
    v_fmac_f32 v156, v250, v228
    v_fmac_f32 v157, v250, v229
    v_fmac_f32 v158, v250, v230
    v_fmac_f32 v159, v250, v231
    v_mul_f32 v156, v152, v156
    v_mul_f32 v157, v153, v157
    v_mul_f32 v158, v154, v158
    v_mul_f32 v159, v155, v159
    v_mul_f32 v152, v251, v152
    v_mul_f32 v153, v251, v153
    v_mul_f32 v154, v251, v154
    v_mul_f32 v155, v251, v155
    v_exp_f32 v152, v152
    v_exp_f32 v153, v153
    v_exp_f32 v154, v154
    v_exp_f32 v155, v155
    v_fma_f32 v152, v152, v255, v255
    v_fma_f32 v153, v153, v255, v255
    v_fma_f32 v154, v154, v255, v255
    v_fma_f32 v155, v155, v255, v255
    v_rcp_f32 v152, v152
    v_rcp_f32 v153, v153
    v_rcp_f32 v154, v154
    v_rcp_f32 v155, v155
    v_mul_f32 v156, v156, v152
    v_mul_f32 v157, v157, v153
    v_mul_f32 v158, v158, v154
    v_mul_f32 v159, v159, v155
    v_cvt_pk_bf16_f32 v152, v156, v157
    v_cvt_pk_bf16_f32 v153, v158, v159
    s_add_u32 s57, s56, s87
    buffer_store_dwordx2 v[152:153], v243, s[16:19], s57 offen
    s_endpgm
Lk3_kernel_half1:
    ds_read_b64_tr_b16 v[208:209], v232 offset:128
    ds_read_b64_tr_b16 v[210:211], v232 offset:6272
    ds_read_b64_tr_b16 v[212:213], v232 offset:12416
    ds_read_b64_tr_b16 v[214:215], v232 offset:18560
    ds_read_b64_tr_b16 v[216:217], v233 offset:128
    ds_read_b64_tr_b16 v[218:219], v233 offset:6272
    s_waitcnt lgkmcnt(4)
    s_waitcnt vmcnt(3)
    v_mfma_f32_16x16x32_bf16 v[0:3], v[208:211], v[160:163], 0
    ds_read_b64_tr_b16 v[220:221], v233 offset:12416
    ds_read_b64_tr_b16 v[222:223], v233 offset:18560
    s_add_u32 m0, s43, 24576
    s_nop 0
    buffer_load_dwordx4 v240, s[8:11], s40 offen lds
    s_waitcnt vmcnt(3)
    v_mfma_f32_16x16x32_bf16 v[32:35], v[208:211], v[164:167], 0
    s_waitcnt vmcnt(2)
    v_mfma_f32_16x16x32_bf16 v[64:67], v[208:211], v[168:171], 0
    s_add_u32 m0, s43, 25600
    s_nop 0
    buffer_load_dwordx4 v241, s[8:11], s40 offen lds
    s_waitcnt vmcnt(2)
    v_mfma_f32_16x16x32_bf16 v[96:99], v[208:211], v[172:175], 0
    s_waitcnt lgkmcnt(4)
    v_mfma_f32_16x16x32_bf16 v[4:7], v[212:215], v[160:163], 0
    ds_read_b64_tr_b16 v[208:209], v234 offset:128
    ds_read_b64_tr_b16 v[210:211], v234 offset:6272
    s_add_u32 m0, s43, 26624
    s_nop 0
    buffer_load_dwordx4 v242, s[8:11], s40 offen lds
    s_add_u32 s40, s40, 294912
    v_mfma_f32_16x16x32_bf16 v[36:39], v[212:215], v[164:167], 0
    v_mfma_f32_16x16x32_bf16 v[68:71], v[212:215], v[168:171], 0
    buffer_load_dwordx4 v[176:179], v243, s[16:19], s52 offen
    s_add_u32 s52, s52, 1024
    v_mfma_f32_16x16x32_bf16 v[100:103], v[212:215], v[172:175], 0
    s_waitcnt lgkmcnt(4)
    v_mfma_f32_16x16x32_bf16 v[8:11], v[216:219], v[160:163], 0
    ds_read_b64_tr_b16 v[212:213], v234 offset:12416
    ds_read_b64_tr_b16 v[214:215], v234 offset:18560
    buffer_load_dwordx4 v[180:183], v243, s[16:19], s53 offen
    s_add_u32 s53, s53, 1024
    v_mfma_f32_16x16x32_bf16 v[40:43], v[216:219], v[164:167], 0
    v_mfma_f32_16x16x32_bf16 v[72:75], v[216:219], v[168:171], 0
    buffer_load_dwordx4 v[184:187], v243, s[16:19], s54 offen
    s_add_u32 s54, s54, 1024
    v_mfma_f32_16x16x32_bf16 v[104:107], v[216:219], v[172:175], 0
    s_waitcnt lgkmcnt(4)
    v_mfma_f32_16x16x32_bf16 v[12:15], v[220:223], v[160:163], 0
    ds_read_b64_tr_b16 v[216:217], v235 offset:128
    ds_read_b64_tr_b16 v[218:219], v235 offset:6272
    buffer_load_dwordx4 v[188:191], v243, s[16:19], s55 offen
    s_add_u32 s55, s55, 1024
    v_mfma_f32_16x16x32_bf16 v[44:47], v[220:223], v[164:167], 0
    v_mfma_f32_16x16x32_bf16 v[76:79], v[220:223], v[168:171], 0
    s_add_u32 m0, s43, 49152
    s_nop 0
    buffer_load_dwordx4 v240, s[8:11], s40 offen lds
    v_mfma_f32_16x16x32_bf16 v[108:111], v[220:223], v[172:175], 0
    s_waitcnt vmcnt(5)
    s_barrier
    v_add_u32 v236, 24576, v232
    v_add_u32 v237, 24576, v233
    v_add_u32 v238, 24576, v234
    v_add_u32 v239, 24576, v235
    s_waitcnt lgkmcnt(4)
    v_mfma_f32_16x16x32_bf16 v[16:19], v[208:211], v[160:163], 0
    ds_read_b64_tr_b16 v[220:221], v235 offset:12416
    ds_read_b64_tr_b16 v[222:223], v235 offset:18560
    s_add_u32 m0, s43, 50176
    s_nop 0
    buffer_load_dwordx4 v241, s[8:11], s40 offen lds
    v_mfma_f32_16x16x32_bf16 v[48:51], v[208:211], v[164:167], 0
    v_mfma_f32_16x16x32_bf16 v[80:83], v[208:211], v[168:171], 0
    s_add_u32 m0, s43, 51200
    s_nop 0
    buffer_load_dwordx4 v242, s[8:11], s40 offen lds
    s_add_u32 s40, s40, 294912
    v_mfma_f32_16x16x32_bf16 v[112:115], v[208:211], v[172:175], 0
    s_waitcnt lgkmcnt(4)
    v_mfma_f32_16x16x32_bf16 v[20:23], v[212:215], v[160:163], 0
    ds_read_b64_tr_b16 v[208:209], v236 offset:128
    ds_read_b64_tr_b16 v[210:211], v236 offset:6272
    buffer_load_dwordx4 v[192:195], v243, s[16:19], s52 offen
    s_add_u32 s52, s52, 1024
    v_mfma_f32_16x16x32_bf16 v[52:55], v[212:215], v[164:167], 0
    v_mfma_f32_16x16x32_bf16 v[84:87], v[212:215], v[168:171], 0
    buffer_load_dwordx4 v[196:199], v243, s[16:19], s53 offen
    s_add_u32 s53, s53, 1024
    v_mfma_f32_16x16x32_bf16 v[116:119], v[212:215], v[172:175], 0
    s_waitcnt lgkmcnt(4)
    v_mfma_f32_16x16x32_bf16 v[24:27], v[216:219], v[160:163], 0
    ds_read_b64_tr_b16 v[212:213], v236 offset:12416
    ds_read_b64_tr_b16 v[214:215], v236 offset:18560
    buffer_load_dwordx4 v[200:203], v243, s[16:19], s54 offen
    s_add_u32 s54, s54, 1024
    v_mfma_f32_16x16x32_bf16 v[56:59], v[216:219], v[164:167], 0
    v_mfma_f32_16x16x32_bf16 v[88:91], v[216:219], v[168:171], 0
    buffer_load_dwordx4 v[204:207], v243, s[16:19], s55 offen
    s_add_u32 s55, s55, 1024
    v_mfma_f32_16x16x32_bf16 v[120:123], v[216:219], v[172:175], 0
    s_waitcnt lgkmcnt(4)
    v_mfma_f32_16x16x32_bf16 v[28:31], v[220:223], v[160:163], 0
    ds_read_b64_tr_b16 v[216:217], v237 offset:128
    ds_read_b64_tr_b16 v[218:219], v237 offset:6272
    v_mfma_f32_16x16x32_bf16 v[60:63], v[220:223], v[164:167], 0
    v_mfma_f32_16x16x32_bf16 v[92:95], v[220:223], v[168:171], 0
    v_mfma_f32_16x16x32_bf16 v[124:127], v[220:223], v[172:175], 0
    s_waitcnt lgkmcnt(4)
    s_waitcnt vmcnt(10)
    v_mfma_f32_16x16x32_bf16 v[0:3], v[208:211], v[176:179], v[0:3]
    ds_read_b64_tr_b16 v[220:221], v237 offset:12416
    ds_read_b64_tr_b16 v[222:223], v237 offset:18560
    s_waitcnt vmcnt(9)
    v_mfma_f32_16x16x32_bf16 v[32:35], v[208:211], v[180:183], v[32:35]
    s_waitcnt vmcnt(8)
    v_mfma_f32_16x16x32_bf16 v[64:67], v[208:211], v[184:187], v[64:67]
    buffer_load_dwordx4 v[160:163], v243, s[16:19], s52 offen
    s_add_u32 s52, s52, 1024
    s_waitcnt vmcnt(8)
    v_mfma_f32_16x16x32_bf16 v[96:99], v[208:211], v[188:191], v[96:99]
    s_waitcnt lgkmcnt(4)
    v_mfma_f32_16x16x32_bf16 v[4:7], v[212:215], v[176:179], v[4:7]
    ds_read_b64_tr_b16 v[208:209], v238 offset:128
    ds_read_b64_tr_b16 v[210:211], v238 offset:6272
    s_add_u32 m0, s43, 73728
    s_nop 0
    buffer_load_dwordx4 v240, s[8:11], s40 offen lds
    v_mfma_f32_16x16x32_bf16 v[36:39], v[212:215], v[180:183], v[36:39]
    v_mfma_f32_16x16x32_bf16 v[68:71], v[212:215], v[184:187], v[68:71]
    v_mfma_f32_16x16x32_bf16 v[100:103], v[212:215], v[188:191], v[100:103]
    buffer_load_dwordx4 v[164:167], v243, s[16:19], s53 offen
    s_add_u32 s53, s53, 1024
    s_waitcnt lgkmcnt(4)
    v_mfma_f32_16x16x32_bf16 v[8:11], v[216:219], v[176:179], v[8:11]
    ds_read_b64_tr_b16 v[212:213], v238 offset:12416
    ds_read_b64_tr_b16 v[214:215], v238 offset:18560
    v_mfma_f32_16x16x32_bf16 v[40:43], v[216:219], v[180:183], v[40:43]
    v_mfma_f32_16x16x32_bf16 v[72:75], v[216:219], v[184:187], v[72:75]
    s_add_u32 m0, s43, 74752
    s_nop 0
    buffer_load_dwordx4 v241, s[8:11], s40 offen lds
    v_mfma_f32_16x16x32_bf16 v[104:107], v[216:219], v[188:191], v[104:107]
    s_waitcnt lgkmcnt(4)
    v_mfma_f32_16x16x32_bf16 v[12:15], v[220:223], v[176:179], v[12:15]
    ds_read_b64_tr_b16 v[216:217], v239 offset:128
    ds_read_b64_tr_b16 v[218:219], v239 offset:6272
    v_mfma_f32_16x16x32_bf16 v[44:47], v[220:223], v[180:183], v[44:47]
    buffer_load_dwordx4 v[168:171], v243, s[16:19], s54 offen
    s_add_u32 s54, s54, 1024
    v_mfma_f32_16x16x32_bf16 v[76:79], v[220:223], v[184:187], v[76:79]
    v_mfma_f32_16x16x32_bf16 v[108:111], v[220:223], v[188:191], v[108:111]
    s_waitcnt vmcnt(9)
    s_barrier
    v_add_u32 v232, 24576, v236
    v_add_u32 v233, 24576, v237
    v_add_u32 v234, 24576, v238
    v_add_u32 v235, 24576, v239
    s_waitcnt lgkmcnt(4)
    v_mfma_f32_16x16x32_bf16 v[16:19], v[208:211], v[176:179], v[16:19]
    ds_read_b64_tr_b16 v[220:221], v239 offset:12416
    ds_read_b64_tr_b16 v[222:223], v239 offset:18560
    s_add_u32 m0, s43, 75776
    s_nop 0
    buffer_load_dwordx4 v242, s[8:11], s40 offen lds
    s_add_u32 s40, s40, 294912
    v_mfma_f32_16x16x32_bf16 v[48:51], v[208:211], v[180:183], v[48:51]
    v_mfma_f32_16x16x32_bf16 v[80:83], v[208:211], v[184:187], v[80:83]
    buffer_load_dwordx4 v[172:175], v243, s[16:19], s55 offen
    s_add_u32 s55, s55, 1024
    v_mfma_f32_16x16x32_bf16 v[112:115], v[208:211], v[188:191], v[112:115]
    s_waitcnt lgkmcnt(4)
    v_mfma_f32_16x16x32_bf16 v[20:23], v[212:215], v[176:179], v[20:23]
    ds_read_b64_tr_b16 v[208:209], v232 offset:128
    ds_read_b64_tr_b16 v[210:211], v232 offset:6272
    v_mfma_f32_16x16x32_bf16 v[52:55], v[212:215], v[180:183], v[52:55]
    s_add_u32 m0, s43, 98304
    s_nop 0
    buffer_load_dwordx4 v240, s[8:11], s40 offen lds
    v_mfma_f32_16x16x32_bf16 v[84:87], v[212:215], v[184:187], v[84:87]
    v_mfma_f32_16x16x32_bf16 v[116:119], v[212:215], v[188:191], v[116:119]
    s_waitcnt lgkmcnt(4)
    v_mfma_f32_16x16x32_bf16 v[24:27], v[216:219], v[176:179], v[24:27]
    ds_read_b64_tr_b16 v[212:213], v232 offset:12416
    ds_read_b64_tr_b16 v[214:215], v232 offset:18560
    s_add_u32 m0, s43, 99328
    s_nop 0
    buffer_load_dwordx4 v241, s[8:11], s40 offen lds
    v_mfma_f32_16x16x32_bf16 v[56:59], v[216:219], v[180:183], v[56:59]
    v_mfma_f32_16x16x32_bf16 v[88:91], v[216:219], v[184:187], v[88:91]
    v_mfma_f32_16x16x32_bf16 v[120:123], v[216:219], v[188:191], v[120:123]
    s_add_u32 m0, s43, 100352
    s_nop 0
    buffer_load_dwordx4 v242, s[8:11], s40 offen lds
    s_add_u32 s40, s40, 294912
    s_waitcnt lgkmcnt(4)
    v_mfma_f32_16x16x32_bf16 v[28:31], v[220:223], v[176:179], v[28:31]
    ds_read_b64_tr_b16 v[216:217], v233 offset:128
    ds_read_b64_tr_b16 v[218:219], v233 offset:6272
    v_mfma_f32_16x16x32_bf16 v[60:63], v[220:223], v[180:183], v[60:63]
    v_mfma_f32_16x16x32_bf16 v[92:95], v[220:223], v[184:187], v[92:95]
    v_mfma_f32_16x16x32_bf16 v[124:127], v[220:223], v[188:191], v[124:127]
    s_waitcnt lgkmcnt(4)
    s_waitcnt vmcnt(13)
    v_mfma_f32_16x16x32_bf16 v[0:3], v[208:211], v[192:195], v[0:3]
    ds_read_b64_tr_b16 v[220:221], v233 offset:12416
    ds_read_b64_tr_b16 v[222:223], v233 offset:18560
    s_waitcnt vmcnt(12)
    v_mfma_f32_16x16x32_bf16 v[32:35], v[208:211], v[196:199], v[32:35]
    s_waitcnt vmcnt(11)
    v_mfma_f32_16x16x32_bf16 v[64:67], v[208:211], v[200:203], v[64:67]
    buffer_load_dwordx4 v[176:179], v243, s[16:19], s52 offen
    s_add_u32 s52, s52, 1024
    s_waitcnt vmcnt(11)
    v_mfma_f32_16x16x32_bf16 v[96:99], v[208:211], v[204:207], v[96:99]
    s_waitcnt lgkmcnt(4)
    v_mfma_f32_16x16x32_bf16 v[4:7], v[212:215], v[192:195], v[4:7]
    ds_read_b64_tr_b16 v[208:209], v234 offset:128
    ds_read_b64_tr_b16 v[210:211], v234 offset:6272
    s_add_u32 m0, s43, 122880
    s_nop 0
    buffer_load_dwordx4 v240, s[8:11], s40 offen lds
    v_mfma_f32_16x16x32_bf16 v[36:39], v[212:215], v[196:199], v[36:39]
    v_mfma_f32_16x16x32_bf16 v[68:71], v[212:215], v[200:203], v[68:71]
    v_mfma_f32_16x16x32_bf16 v[100:103], v[212:215], v[204:207], v[100:103]
    buffer_load_dwordx4 v[180:183], v243, s[16:19], s53 offen
    s_add_u32 s53, s53, 1024
    s_waitcnt lgkmcnt(4)
    v_mfma_f32_16x16x32_bf16 v[8:11], v[216:219], v[192:195], v[8:11]
    ds_read_b64_tr_b16 v[212:213], v234 offset:12416
    ds_read_b64_tr_b16 v[214:215], v234 offset:18560
    v_mfma_f32_16x16x32_bf16 v[40:43], v[216:219], v[196:199], v[40:43]
    v_mfma_f32_16x16x32_bf16 v[72:75], v[216:219], v[200:203], v[72:75]
    s_add_u32 m0, s43, 123904
    s_nop 0
    buffer_load_dwordx4 v241, s[8:11], s40 offen lds
    v_mfma_f32_16x16x32_bf16 v[104:107], v[216:219], v[204:207], v[104:107]
    s_waitcnt lgkmcnt(4)
    v_mfma_f32_16x16x32_bf16 v[12:15], v[220:223], v[192:195], v[12:15]
    ds_read_b64_tr_b16 v[216:217], v235 offset:128
    ds_read_b64_tr_b16 v[218:219], v235 offset:6272
    v_mfma_f32_16x16x32_bf16 v[44:47], v[220:223], v[196:199], v[44:47]
    buffer_load_dwordx4 v[184:187], v243, s[16:19], s54 offen
    s_add_u32 s54, s54, 1024
    v_mfma_f32_16x16x32_bf16 v[76:79], v[220:223], v[200:203], v[76:79]
    v_mfma_f32_16x16x32_bf16 v[108:111], v[220:223], v[204:207], v[108:111]
    s_waitcnt vmcnt(9)
    s_barrier
    v_add_u32 v236, 24576, v232
    v_add_u32 v237, 24576, v233
    v_add_u32 v238, 24576, v234
    v_add_u32 v239, 24576, v235
    s_waitcnt lgkmcnt(4)
    v_mfma_f32_16x16x32_bf16 v[16:19], v[208:211], v[192:195], v[16:19]
    ds_read_b64_tr_b16 v[220:221], v235 offset:12416
    ds_read_b64_tr_b16 v[222:223], v235 offset:18560
    s_add_u32 m0, s43, 124928
    s_nop 0
    buffer_load_dwordx4 v242, s[8:11], s40 offen lds
    s_add_u32 s40, s40, 294912
    v_mfma_f32_16x16x32_bf16 v[48:51], v[208:211], v[196:199], v[48:51]
    v_mfma_f32_16x16x32_bf16 v[80:83], v[208:211], v[200:203], v[80:83]
    buffer_load_dwordx4 v[188:191], v243, s[16:19], s55 offen
    s_add_u32 s55, s55, 1024
    v_mfma_f32_16x16x32_bf16 v[112:115], v[208:211], v[204:207], v[112:115]
    s_waitcnt lgkmcnt(4)
    v_mfma_f32_16x16x32_bf16 v[20:23], v[212:215], v[192:195], v[20:23]
    ds_read_b64_tr_b16 v[208:209], v236 offset:128
    ds_read_b64_tr_b16 v[210:211], v236 offset:6272
    v_mfma_f32_16x16x32_bf16 v[52:55], v[212:215], v[196:199], v[52:55]
    s_add_u32 m0, s43, 0
    s_nop 0
    buffer_load_dwordx4 v240, s[8:11], s40 offen lds
    v_mfma_f32_16x16x32_bf16 v[84:87], v[212:215], v[200:203], v[84:87]
    v_mfma_f32_16x16x32_bf16 v[116:119], v[212:215], v[204:207], v[116:119]
    s_waitcnt lgkmcnt(4)
    v_mfma_f32_16x16x32_bf16 v[24:27], v[216:219], v[192:195], v[24:27]
    ds_read_b64_tr_b16 v[212:213], v236 offset:12416
    ds_read_b64_tr_b16 v[214:215], v236 offset:18560
    s_add_u32 m0, s43, 1024
    s_nop 0
    buffer_load_dwordx4 v241, s[8:11], s40 offen lds
    v_mfma_f32_16x16x32_bf16 v[56:59], v[216:219], v[196:199], v[56:59]
    v_mfma_f32_16x16x32_bf16 v[88:91], v[216:219], v[200:203], v[88:91]
    v_mfma_f32_16x16x32_bf16 v[120:123], v[216:219], v[204:207], v[120:123]
    s_add_u32 m0, s43, 2048
    s_nop 0
    buffer_load_dwordx4 v242, s[8:11], s40 offen lds
    s_add_u32 s40, s40, 294912
    s_waitcnt lgkmcnt(4)
    v_mfma_f32_16x16x32_bf16 v[28:31], v[220:223], v[192:195], v[28:31]
    ds_read_b64_tr_b16 v[216:217], v237 offset:128
    ds_read_b64_tr_b16 v[218:219], v237 offset:6272
    v_mfma_f32_16x16x32_bf16 v[60:63], v[220:223], v[196:199], v[60:63]
    v_mfma_f32_16x16x32_bf16 v[92:95], v[220:223], v[200:203], v[92:95]
    v_mfma_f32_16x16x32_bf16 v[124:127], v[220:223], v[204:207], v[124:127]
    s_waitcnt lgkmcnt(4)
    v_mfma_f32_16x16x32_bf16 v[0:3], v[208:211], v[160:163], v[0:3]
    ds_read_b64_tr_b16 v[220:221], v237 offset:12416
    ds_read_b64_tr_b16 v[222:223], v237 offset:18560
    v_mfma_f32_16x16x32_bf16 v[32:35], v[208:211], v[164:167], v[32:35]
    v_mfma_f32_16x16x32_bf16 v[64:67], v[208:211], v[168:171], v[64:67]
    s_waitcnt vmcnt(13)
    v_mfma_f32_16x16x32_bf16 v[96:99], v[208:211], v[172:175], v[96:99]
    buffer_load_dwordx4 v[192:195], v243, s[16:19], s52 offen
    s_add_u32 s52, s52, 1024
    s_waitcnt lgkmcnt(4)
    v_mfma_f32_16x16x32_bf16 v[4:7], v[212:215], v[160:163], v[4:7]
    ds_read_b64_tr_b16 v[208:209], v238 offset:128
    ds_read_b64_tr_b16 v[210:211], v238 offset:6272
    v_mfma_f32_16x16x32_bf16 v[36:39], v[212:215], v[164:167], v[36:39]
    v_mfma_f32_16x16x32_bf16 v[68:71], v[212:215], v[168:171], v[68:71]
    v_mfma_f32_16x16x32_bf16 v[100:103], v[212:215], v[172:175], v[100:103]
    s_add_u32 m0, s43, 24576
    s_nop 0
    buffer_load_dwordx4 v240, s[8:11], s40 offen lds
    s_waitcnt lgkmcnt(4)
    v_mfma_f32_16x16x32_bf16 v[8:11], v[216:219], v[160:163], v[8:11]
    ds_read_b64_tr_b16 v[212:213], v238 offset:12416
    ds_read_b64_tr_b16 v[214:215], v238 offset:18560
    v_mfma_f32_16x16x32_bf16 v[40:43], v[216:219], v[164:167], v[40:43]
    v_mfma_f32_16x16x32_bf16 v[72:75], v[216:219], v[168:171], v[72:75]
    v_mfma_f32_16x16x32_bf16 v[104:107], v[216:219], v[172:175], v[104:107]
    buffer_load_dwordx4 v[196:199], v243, s[16:19], s53 offen
    s_add_u32 s53, s53, 1024
    s_waitcnt lgkmcnt(4)
    v_mfma_f32_16x16x32_bf16 v[12:15], v[220:223], v[160:163], v[12:15]
    ds_read_b64_tr_b16 v[216:217], v239 offset:128
    ds_read_b64_tr_b16 v[218:219], v239 offset:6272
    v_mfma_f32_16x16x32_bf16 v[44:47], v[220:223], v[164:167], v[44:47]
    v_mfma_f32_16x16x32_bf16 v[76:79], v[220:223], v[168:171], v[76:79]
    v_mfma_f32_16x16x32_bf16 v[108:111], v[220:223], v[172:175], v[108:111]
    s_add_u32 m0, s43, 25600
    s_nop 0
    buffer_load_dwordx4 v241, s[8:11], s40 offen lds
    s_waitcnt vmcnt(14)
    s_barrier
    v_add_u32 v232, 24576, v236
    v_add_u32 v233, 24576, v237
    v_add_u32 v234, 24576, v238
    v_add_u32 v235, 24576, v239
    s_waitcnt lgkmcnt(4)
    v_mfma_f32_16x16x32_bf16 v[16:19], v[208:211], v[160:163], v[16:19]
    ds_read_b64_tr_b16 v[220:221], v239 offset:12416
    ds_read_b64_tr_b16 v[222:223], v239 offset:18560
    v_mfma_f32_16x16x32_bf16 v[48:51], v[208:211], v[164:167], v[48:51]
    v_mfma_f32_16x16x32_bf16 v[80:83], v[208:211], v[168:171], v[80:83]
    v_mfma_f32_16x16x32_bf16 v[112:115], v[208:211], v[172:175], v[112:115]
    buffer_load_dwordx4 v[200:203], v243, s[16:19], s54 offen
    s_add_u32 s54, s54, 1024
    s_waitcnt lgkmcnt(4)
    v_mfma_f32_16x16x32_bf16 v[20:23], v[212:215], v[160:163], v[20:23]
    ds_read_b64_tr_b16 v[208:209], v232 offset:128
    ds_read_b64_tr_b16 v[210:211], v232 offset:6272
    v_mfma_f32_16x16x32_bf16 v[52:55], v[212:215], v[164:167], v[52:55]
    v_mfma_f32_16x16x32_bf16 v[84:87], v[212:215], v[168:171], v[84:87]
    v_mfma_f32_16x16x32_bf16 v[116:119], v[212:215], v[172:175], v[116:119]
    s_add_u32 m0, s43, 26624
    s_nop 0
    buffer_load_dwordx4 v242, s[8:11], s40 offen lds
    s_add_u32 s40, s40, 294912
    s_waitcnt lgkmcnt(4)
    v_mfma_f32_16x16x32_bf16 v[24:27], v[216:219], v[160:163], v[24:27]
    ds_read_b64_tr_b16 v[212:213], v232 offset:12416
    ds_read_b64_tr_b16 v[214:215], v232 offset:18560
    v_mfma_f32_16x16x32_bf16 v[56:59], v[216:219], v[164:167], v[56:59]
    v_mfma_f32_16x16x32_bf16 v[88:91], v[216:219], v[168:171], v[88:91]
    v_mfma_f32_16x16x32_bf16 v[120:123], v[216:219], v[172:175], v[120:123]
    buffer_load_dwordx4 v[204:207], v243, s[16:19], s55 offen
    s_add_u32 s55, s55, 1024
    s_waitcnt lgkmcnt(4)
    v_mfma_f32_16x16x32_bf16 v[28:31], v[220:223], v[160:163], v[28:31]
    ds_read_b64_tr_b16 v[216:217], v233 offset:128
    ds_read_b64_tr_b16 v[218:219], v233 offset:6272
    v_mfma_f32_16x16x32_bf16 v[60:63], v[220:223], v[164:167], v[60:63]
    v_mfma_f32_16x16x32_bf16 v[92:95], v[220:223], v[168:171], v[92:95]
    v_mfma_f32_16x16x32_bf16 v[124:127], v[220:223], v[172:175], v[124:127]
    s_waitcnt lgkmcnt(4)
    s_waitcnt vmcnt(16)
    v_mfma_f32_16x16x32_bf16 v[0:3], v[208:211], v[176:179], v[0:3]
    ds_read_b64_tr_b16 v[220:221], v233 offset:12416
    ds_read_b64_tr_b16 v[222:223], v233 offset:18560
    s_waitcnt vmcnt(14)
    v_mfma_f32_16x16x32_bf16 v[32:35], v[208:211], v[180:183], v[32:35]
    s_waitcnt vmcnt(12)
    v_mfma_f32_16x16x32_bf16 v[64:67], v[208:211], v[184:187], v[64:67]
    s_waitcnt vmcnt(10)
    v_mfma_f32_16x16x32_bf16 v[96:99], v[208:211], v[188:191], v[96:99]
    buffer_load_dwordx4 v[160:163], v243, s[16:19], s52 offen
    s_add_u32 s52, s52, 1024
    s_waitcnt lgkmcnt(4)
    v_mfma_f32_16x16x32_bf16 v[4:7], v[212:215], v[176:179], v[4:7]
    ds_read_b64_tr_b16 v[208:209], v234 offset:128
    ds_read_b64_tr_b16 v[210:211], v234 offset:6272
    v_mfma_f32_16x16x32_bf16 v[36:39], v[212:215], v[180:183], v[36:39]
    v_mfma_f32_16x16x32_bf16 v[68:71], v[212:215], v[184:187], v[68:71]
    v_mfma_f32_16x16x32_bf16 v[100:103], v[212:215], v[188:191], v[100:103]
    s_add_u32 m0, s43, 49152
    s_nop 0
    buffer_load_dwordx4 v240, s[8:11], s40 offen lds
    s_waitcnt lgkmcnt(4)
    v_mfma_f32_16x16x32_bf16 v[8:11], v[216:219], v[176:179], v[8:11]
    ds_read_b64_tr_b16 v[212:213], v234 offset:12416
    ds_read_b64_tr_b16 v[214:215], v234 offset:18560
    v_mfma_f32_16x16x32_bf16 v[40:43], v[216:219], v[180:183], v[40:43]
    v_mfma_f32_16x16x32_bf16 v[72:75], v[216:219], v[184:187], v[72:75]
    v_mfma_f32_16x16x32_bf16 v[104:107], v[216:219], v[188:191], v[104:107]
    buffer_load_dwordx4 v[164:167], v243, s[16:19], s53 offen
    s_add_u32 s53, s53, 1024
    s_waitcnt lgkmcnt(4)
    v_mfma_f32_16x16x32_bf16 v[12:15], v[220:223], v[176:179], v[12:15]
    ds_read_b64_tr_b16 v[216:217], v235 offset:128
    ds_read_b64_tr_b16 v[218:219], v235 offset:6272
    v_mfma_f32_16x16x32_bf16 v[44:47], v[220:223], v[180:183], v[44:47]
    v_mfma_f32_16x16x32_bf16 v[76:79], v[220:223], v[184:187], v[76:79]
    v_mfma_f32_16x16x32_bf16 v[108:111], v[220:223], v[188:191], v[108:111]
    s_add_u32 m0, s43, 50176
    s_nop 0
    buffer_load_dwordx4 v241, s[8:11], s40 offen lds
    s_barrier
    v_add_u32 v236, 24576, v232
    v_add_u32 v237, 24576, v233
    v_add_u32 v238, 24576, v234
    v_add_u32 v239, 24576, v235
    s_waitcnt lgkmcnt(4)
    v_mfma_f32_16x16x32_bf16 v[16:19], v[208:211], v[176:179], v[16:19]
    ds_read_b64_tr_b16 v[220:221], v235 offset:12416
    ds_read_b64_tr_b16 v[222:223], v235 offset:18560
    v_mfma_f32_16x16x32_bf16 v[48:51], v[208:211], v[180:183], v[48:51]
    v_mfma_f32_16x16x32_bf16 v[80:83], v[208:211], v[184:187], v[80:83]
    v_mfma_f32_16x16x32_bf16 v[112:115], v[208:211], v[188:191], v[112:115]
    buffer_load_dwordx4 v[168:171], v243, s[16:19], s54 offen
    s_add_u32 s54, s54, 1024
    s_waitcnt lgkmcnt(4)
    v_mfma_f32_16x16x32_bf16 v[20:23], v[212:215], v[176:179], v[20:23]
    ds_read_b64_tr_b16 v[208:209], v236 offset:128
    ds_read_b64_tr_b16 v[210:211], v236 offset:6272
    v_mfma_f32_16x16x32_bf16 v[52:55], v[212:215], v[180:183], v[52:55]
    v_mfma_f32_16x16x32_bf16 v[84:87], v[212:215], v[184:187], v[84:87]
    v_mfma_f32_16x16x32_bf16 v[116:119], v[212:215], v[188:191], v[116:119]
    s_add_u32 m0, s43, 51200
    s_nop 0
    buffer_load_dwordx4 v242, s[8:11], s40 offen lds
    s_add_u32 s40, s40, 294912
    s_waitcnt lgkmcnt(4)
    v_mfma_f32_16x16x32_bf16 v[24:27], v[216:219], v[176:179], v[24:27]
    ds_read_b64_tr_b16 v[212:213], v236 offset:12416
    ds_read_b64_tr_b16 v[214:215], v236 offset:18560
    v_mfma_f32_16x16x32_bf16 v[56:59], v[216:219], v[180:183], v[56:59]
    v_mfma_f32_16x16x32_bf16 v[88:91], v[216:219], v[184:187], v[88:91]
    v_mfma_f32_16x16x32_bf16 v[120:123], v[216:219], v[188:191], v[120:123]
    buffer_load_dwordx4 v[172:175], v243, s[16:19], s55 offen
    s_add_u32 s55, s55, 1024
    s_waitcnt lgkmcnt(4)
    v_mfma_f32_16x16x32_bf16 v[28:31], v[220:223], v[176:179], v[28:31]
    ds_read_b64_tr_b16 v[216:217], v237 offset:128
    ds_read_b64_tr_b16 v[218:219], v237 offset:6272
    v_mfma_f32_16x16x32_bf16 v[60:63], v[220:223], v[180:183], v[60:63]
    v_mfma_f32_16x16x32_bf16 v[92:95], v[220:223], v[184:187], v[92:95]
    v_mfma_f32_16x16x32_bf16 v[124:127], v[220:223], v[188:191], v[124:127]
    s_waitcnt lgkmcnt(4)
    s_waitcnt vmcnt(13)
    v_mfma_f32_16x16x32_bf16 v[0:3], v[208:211], v[192:195], v[0:3]
    ds_read_b64_tr_b16 v[220:221], v237 offset:12416
    ds_read_b64_tr_b16 v[222:223], v237 offset:18560
    s_waitcnt vmcnt(11)
    v_mfma_f32_16x16x32_bf16 v[32:35], v[208:211], v[196:199], v[32:35]
    s_waitcnt vmcnt(9)
    v_mfma_f32_16x16x32_bf16 v[64:67], v[208:211], v[200:203], v[64:67]
    s_waitcnt vmcnt(7)
    v_mfma_f32_16x16x32_bf16 v[96:99], v[208:211], v[204:207], v[96:99]
    buffer_load_dwordx4 v[176:179], v243, s[16:19], s52 offen
    s_add_u32 s52, s52, 1024
    s_waitcnt lgkmcnt(4)
    v_mfma_f32_16x16x32_bf16 v[4:7], v[212:215], v[192:195], v[4:7]
    ds_read_b64_tr_b16 v[208:209], v238 offset:128
    ds_read_b64_tr_b16 v[210:211], v238 offset:6272
    v_mfma_f32_16x16x32_bf16 v[36:39], v[212:215], v[196:199], v[36:39]
    v_mfma_f32_16x16x32_bf16 v[68:71], v[212:215], v[200:203], v[68:71]
    v_mfma_f32_16x16x32_bf16 v[100:103], v[212:215], v[204:207], v[100:103]
    s_add_u32 m0, s43, 73728
    s_nop 0
    buffer_load_dwordx4 v240, s[8:11], s40 offen lds
    s_waitcnt lgkmcnt(4)
    v_mfma_f32_16x16x32_bf16 v[8:11], v[216:219], v[192:195], v[8:11]
    ds_read_b64_tr_b16 v[212:213], v238 offset:12416
    ds_read_b64_tr_b16 v[214:215], v238 offset:18560
    v_mfma_f32_16x16x32_bf16 v[40:43], v[216:219], v[196:199], v[40:43]
    v_mfma_f32_16x16x32_bf16 v[72:75], v[216:219], v[200:203], v[72:75]
    v_mfma_f32_16x16x32_bf16 v[104:107], v[216:219], v[204:207], v[104:107]
    buffer_load_dwordx4 v[180:183], v243, s[16:19], s53 offen
    s_add_u32 s53, s53, 1024
    s_waitcnt lgkmcnt(4)
    v_mfma_f32_16x16x32_bf16 v[12:15], v[220:223], v[192:195], v[12:15]
    ds_read_b64_tr_b16 v[216:217], v239 offset:128
    ds_read_b64_tr_b16 v[218:219], v239 offset:6272
    v_mfma_f32_16x16x32_bf16 v[44:47], v[220:223], v[196:199], v[44:47]
    v_mfma_f32_16x16x32_bf16 v[76:79], v[220:223], v[200:203], v[76:79]
    v_mfma_f32_16x16x32_bf16 v[108:111], v[220:223], v[204:207], v[108:111]
    s_add_u32 m0, s43, 74752
    s_nop 0
    buffer_load_dwordx4 v241, s[8:11], s40 offen lds
    s_barrier
    v_add_u32 v232, -122880, v236
    v_add_u32 v233, -122880, v237
    v_add_u32 v234, -122880, v238
    v_add_u32 v235, -122880, v239
    s_waitcnt lgkmcnt(4)
    v_mfma_f32_16x16x32_bf16 v[16:19], v[208:211], v[192:195], v[16:19]
    ds_read_b64_tr_b16 v[220:221], v239 offset:12416
    ds_read_b64_tr_b16 v[222:223], v239 offset:18560
    v_mfma_f32_16x16x32_bf16 v[48:51], v[208:211], v[196:199], v[48:51]
    v_mfma_f32_16x16x32_bf16 v[80:83], v[208:211], v[200:203], v[80:83]
    v_mfma_f32_16x16x32_bf16 v[112:115], v[208:211], v[204:207], v[112:115]
    buffer_load_dwordx4 v[184:187], v243, s[16:19], s54 offen
    s_add_u32 s54, s54, 1024
    s_waitcnt lgkmcnt(4)
    v_mfma_f32_16x16x32_bf16 v[20:23], v[212:215], v[192:195], v[20:23]
    ds_read_b64_tr_b16 v[208:209], v232 offset:128
    ds_read_b64_tr_b16 v[210:211], v232 offset:6272
    v_mfma_f32_16x16x32_bf16 v[52:55], v[212:215], v[196:199], v[52:55]
    v_mfma_f32_16x16x32_bf16 v[84:87], v[212:215], v[200:203], v[84:87]
    v_mfma_f32_16x16x32_bf16 v[116:119], v[212:215], v[204:207], v[116:119]
    s_add_u32 m0, s43, 75776
    s_nop 0
    buffer_load_dwordx4 v242, s[8:11], s40 offen lds
    s_add_u32 s40, s40, 294912
    s_waitcnt lgkmcnt(4)
    v_mfma_f32_16x16x32_bf16 v[24:27], v[216:219], v[192:195], v[24:27]
    ds_read_b64_tr_b16 v[212:213], v232 offset:12416
    ds_read_b64_tr_b16 v[214:215], v232 offset:18560
    v_mfma_f32_16x16x32_bf16 v[56:59], v[216:219], v[196:199], v[56:59]
    v_mfma_f32_16x16x32_bf16 v[88:91], v[216:219], v[200:203], v[88:91]
    v_mfma_f32_16x16x32_bf16 v[120:123], v[216:219], v[204:207], v[120:123]
    buffer_load_dwordx4 v[188:191], v243, s[16:19], s55 offen
    s_add_u32 s55, s55, 1024
    s_waitcnt lgkmcnt(4)
    v_mfma_f32_16x16x32_bf16 v[28:31], v[220:223], v[192:195], v[28:31]
    ds_read_b64_tr_b16 v[216:217], v233 offset:128
    ds_read_b64_tr_b16 v[218:219], v233 offset:6272
    v_mfma_f32_16x16x32_bf16 v[60:63], v[220:223], v[196:199], v[60:63]
    v_mfma_f32_16x16x32_bf16 v[92:95], v[220:223], v[200:203], v[92:95]
    v_mfma_f32_16x16x32_bf16 v[124:127], v[220:223], v[204:207], v[124:127]
    s_waitcnt lgkmcnt(4)
    s_waitcnt vmcnt(13)
    v_mfma_f32_16x16x32_bf16 v[0:3], v[208:211], v[160:163], v[0:3]
    ds_read_b64_tr_b16 v[220:221], v233 offset:12416
    ds_read_b64_tr_b16 v[222:223], v233 offset:18560
    s_waitcnt vmcnt(11)
    v_mfma_f32_16x16x32_bf16 v[32:35], v[208:211], v[164:167], v[32:35]
    s_waitcnt vmcnt(9)
    v_mfma_f32_16x16x32_bf16 v[64:67], v[208:211], v[168:171], v[64:67]
    s_waitcnt vmcnt(7)
    v_mfma_f32_16x16x32_bf16 v[96:99], v[208:211], v[172:175], v[96:99]
    buffer_load_dwordx4 v[192:195], v243, s[16:19], s52 offen
    s_add_u32 s52, s52, 1024
    s_waitcnt lgkmcnt(4)
    v_mfma_f32_16x16x32_bf16 v[4:7], v[212:215], v[160:163], v[4:7]
    ds_read_b64_tr_b16 v[208:209], v234 offset:128
    ds_read_b64_tr_b16 v[210:211], v234 offset:6272
    v_mfma_f32_16x16x32_bf16 v[36:39], v[212:215], v[164:167], v[36:39]
    v_mfma_f32_16x16x32_bf16 v[68:71], v[212:215], v[168:171], v[68:71]
    v_mfma_f32_16x16x32_bf16 v[100:103], v[212:215], v[172:175], v[100:103]
    s_add_u32 m0, s43, 98304
    s_nop 0
    buffer_load_dwordx4 v240, s[8:11], s40 offen lds
    s_waitcnt lgkmcnt(4)
    v_mfma_f32_16x16x32_bf16 v[8:11], v[216:219], v[160:163], v[8:11]
    ds_read_b64_tr_b16 v[212:213], v234 offset:12416
    ds_read_b64_tr_b16 v[214:215], v234 offset:18560
    v_mfma_f32_16x16x32_bf16 v[40:43], v[216:219], v[164:167], v[40:43]
    v_mfma_f32_16x16x32_bf16 v[72:75], v[216:219], v[168:171], v[72:75]
    v_mfma_f32_16x16x32_bf16 v[104:107], v[216:219], v[172:175], v[104:107]
    buffer_load_dwordx4 v[196:199], v243, s[16:19], s53 offen
    s_add_u32 s53, s53, 1024
    s_waitcnt lgkmcnt(4)
    v_mfma_f32_16x16x32_bf16 v[12:15], v[220:223], v[160:163], v[12:15]
    ds_read_b64_tr_b16 v[216:217], v235 offset:128
    ds_read_b64_tr_b16 v[218:219], v235 offset:6272
    v_mfma_f32_16x16x32_bf16 v[44:47], v[220:223], v[164:167], v[44:47]
    v_mfma_f32_16x16x32_bf16 v[76:79], v[220:223], v[168:171], v[76:79]
    v_mfma_f32_16x16x32_bf16 v[108:111], v[220:223], v[172:175], v[108:111]
    s_add_u32 m0, s43, 99328
    s_nop 0
    buffer_load_dwordx4 v241, s[8:11], s40 offen lds
    s_barrier
    v_add_u32 v236, 24576, v232
    v_add_u32 v237, 24576, v233
    v_add_u32 v238, 24576, v234
    v_add_u32 v239, 24576, v235
    s_waitcnt lgkmcnt(4)
    v_mfma_f32_16x16x32_bf16 v[16:19], v[208:211], v[160:163], v[16:19]
    ds_read_b64_tr_b16 v[220:221], v235 offset:12416
    ds_read_b64_tr_b16 v[222:223], v235 offset:18560
    v_mfma_f32_16x16x32_bf16 v[48:51], v[208:211], v[164:167], v[48:51]
    v_mfma_f32_16x16x32_bf16 v[80:83], v[208:211], v[168:171], v[80:83]
    v_mfma_f32_16x16x32_bf16 v[112:115], v[208:211], v[172:175], v[112:115]
    buffer_load_dwordx4 v[200:203], v243, s[16:19], s54 offen
    s_add_u32 s54, s54, 1024
    s_waitcnt lgkmcnt(4)
    v_mfma_f32_16x16x32_bf16 v[20:23], v[212:215], v[160:163], v[20:23]
    ds_read_b64_tr_b16 v[208:209], v236 offset:128
    ds_read_b64_tr_b16 v[210:211], v236 offset:6272
    v_mfma_f32_16x16x32_bf16 v[52:55], v[212:215], v[164:167], v[52:55]
    v_mfma_f32_16x16x32_bf16 v[84:87], v[212:215], v[168:171], v[84:87]
    v_mfma_f32_16x16x32_bf16 v[116:119], v[212:215], v[172:175], v[116:119]
    s_add_u32 m0, s43, 100352
    s_nop 0
    buffer_load_dwordx4 v242, s[8:11], s40 offen lds
    s_add_u32 s40, s40, 294912
    s_waitcnt lgkmcnt(4)
    v_mfma_f32_16x16x32_bf16 v[24:27], v[216:219], v[160:163], v[24:27]
    ds_read_b64_tr_b16 v[212:213], v236 offset:12416
    ds_read_b64_tr_b16 v[214:215], v236 offset:18560
    v_mfma_f32_16x16x32_bf16 v[56:59], v[216:219], v[164:167], v[56:59]
    v_mfma_f32_16x16x32_bf16 v[88:91], v[216:219], v[168:171], v[88:91]
    v_mfma_f32_16x16x32_bf16 v[120:123], v[216:219], v[172:175], v[120:123]
    buffer_load_dwordx4 v[204:207], v243, s[16:19], s55 offen
    s_add_u32 s55, s55, 1024
    s_waitcnt lgkmcnt(4)
    v_mfma_f32_16x16x32_bf16 v[28:31], v[220:223], v[160:163], v[28:31]
    ds_read_b64_tr_b16 v[216:217], v237 offset:128
    ds_read_b64_tr_b16 v[218:219], v237 offset:6272
    v_mfma_f32_16x16x32_bf16 v[60:63], v[220:223], v[164:167], v[60:63]
    v_mfma_f32_16x16x32_bf16 v[92:95], v[220:223], v[168:171], v[92:95]
    v_mfma_f32_16x16x32_bf16 v[124:127], v[220:223], v[172:175], v[124:127]
    s_waitcnt lgkmcnt(4)
    s_waitcnt vmcnt(13)
    v_mfma_f32_16x16x32_bf16 v[0:3], v[208:211], v[176:179], v[0:3]
    ds_read_b64_tr_b16 v[220:221], v237 offset:12416
    ds_read_b64_tr_b16 v[222:223], v237 offset:18560
    s_waitcnt vmcnt(11)
    v_mfma_f32_16x16x32_bf16 v[32:35], v[208:211], v[180:183], v[32:35]
    s_waitcnt vmcnt(9)
    v_mfma_f32_16x16x32_bf16 v[64:67], v[208:211], v[184:187], v[64:67]
    s_waitcnt vmcnt(7)
    v_mfma_f32_16x16x32_bf16 v[96:99], v[208:211], v[188:191], v[96:99]
    buffer_load_dwordx4 v[160:163], v243, s[16:19], s52 offen
    s_add_u32 s52, s52, 1024
    s_waitcnt lgkmcnt(4)
    v_mfma_f32_16x16x32_bf16 v[4:7], v[212:215], v[176:179], v[4:7]
    ds_read_b64_tr_b16 v[208:209], v238 offset:128
    ds_read_b64_tr_b16 v[210:211], v238 offset:6272
    v_mfma_f32_16x16x32_bf16 v[36:39], v[212:215], v[180:183], v[36:39]
    v_mfma_f32_16x16x32_bf16 v[68:71], v[212:215], v[184:187], v[68:71]
    v_mfma_f32_16x16x32_bf16 v[100:103], v[212:215], v[188:191], v[100:103]
    s_add_u32 m0, s43, 122880
    s_nop 0
    buffer_load_dwordx4 v240, s[8:11], s40 offen lds
    s_waitcnt lgkmcnt(4)
    v_mfma_f32_16x16x32_bf16 v[8:11], v[216:219], v[176:179], v[8:11]
    ds_read_b64_tr_b16 v[212:213], v238 offset:12416
    ds_read_b64_tr_b16 v[214:215], v238 offset:18560
    v_mfma_f32_16x16x32_bf16 v[40:43], v[216:219], v[180:183], v[40:43]
    v_mfma_f32_16x16x32_bf16 v[72:75], v[216:219], v[184:187], v[72:75]
    v_mfma_f32_16x16x32_bf16 v[104:107], v[216:219], v[188:191], v[104:107]
    buffer_load_dwordx4 v[164:167], v243, s[16:19], s53 offen
    s_add_u32 s53, s53, 1024
    s_waitcnt lgkmcnt(4)
    v_mfma_f32_16x16x32_bf16 v[12:15], v[220:223], v[176:179], v[12:15]
    ds_read_b64_tr_b16 v[216:217], v239 offset:128
    ds_read_b64_tr_b16 v[218:219], v239 offset:6272
    v_mfma_f32_16x16x32_bf16 v[44:47], v[220:223], v[180:183], v[44:47]
    v_mfma_f32_16x16x32_bf16 v[76:79], v[220:223], v[184:187], v[76:79]
    v_mfma_f32_16x16x32_bf16 v[108:111], v[220:223], v[188:191], v[108:111]
    s_add_u32 m0, s43, 123904
    s_nop 0
    buffer_load_dwordx4 v241, s[8:11], s40 offen lds
    s_barrier
    v_add_u32 v232, 24576, v236
    v_add_u32 v233, 24576, v237
    v_add_u32 v234, 24576, v238
    v_add_u32 v235, 24576, v239
    s_waitcnt lgkmcnt(4)
    v_mfma_f32_16x16x32_bf16 v[16:19], v[208:211], v[176:179], v[16:19]
    ds_read_b64_tr_b16 v[220:221], v239 offset:12416
    ds_read_b64_tr_b16 v[222:223], v239 offset:18560
    v_mfma_f32_16x16x32_bf16 v[48:51], v[208:211], v[180:183], v[48:51]
    v_mfma_f32_16x16x32_bf16 v[80:83], v[208:211], v[184:187], v[80:83]
    v_mfma_f32_16x16x32_bf16 v[112:115], v[208:211], v[188:191], v[112:115]
    buffer_load_dwordx4 v[168:171], v243, s[16:19], s54 offen
    s_add_u32 s54, s54, 1024
    s_waitcnt lgkmcnt(4)
    v_mfma_f32_16x16x32_bf16 v[20:23], v[212:215], v[176:179], v[20:23]
    ds_read_b64_tr_b16 v[208:209], v232 offset:128
    ds_read_b64_tr_b16 v[210:211], v232 offset:6272
    v_mfma_f32_16x16x32_bf16 v[52:55], v[212:215], v[180:183], v[52:55]
    v_mfma_f32_16x16x32_bf16 v[84:87], v[212:215], v[184:187], v[84:87]
    v_mfma_f32_16x16x32_bf16 v[116:119], v[212:215], v[188:191], v[116:119]
    s_add_u32 m0, s43, 124928
    s_nop 0
    buffer_load_dwordx4 v242, s[8:11], s40 offen lds
    s_add_u32 s40, s40, 294912
    s_waitcnt lgkmcnt(4)
    v_mfma_f32_16x16x32_bf16 v[24:27], v[216:219], v[176:179], v[24:27]
    ds_read_b64_tr_b16 v[212:213], v232 offset:12416
    ds_read_b64_tr_b16 v[214:215], v232 offset:18560
    v_mfma_f32_16x16x32_bf16 v[56:59], v[216:219], v[180:183], v[56:59]
    v_mfma_f32_16x16x32_bf16 v[88:91], v[216:219], v[184:187], v[88:91]
    v_mfma_f32_16x16x32_bf16 v[120:123], v[216:219], v[188:191], v[120:123]
    buffer_load_dwordx4 v[172:175], v243, s[16:19], s55 offen
    s_add_u32 s55, s55, 1024
    s_waitcnt lgkmcnt(4)
    v_mfma_f32_16x16x32_bf16 v[28:31], v[220:223], v[176:179], v[28:31]
    ds_read_b64_tr_b16 v[216:217], v233 offset:128
    ds_read_b64_tr_b16 v[218:219], v233 offset:6272
    v_mfma_f32_16x16x32_bf16 v[60:63], v[220:223], v[180:183], v[60:63]
    v_mfma_f32_16x16x32_bf16 v[92:95], v[220:223], v[184:187], v[92:95]
    v_mfma_f32_16x16x32_bf16 v[124:127], v[220:223], v[188:191], v[124:127]
    s_waitcnt lgkmcnt(4)
    s_waitcnt vmcnt(13)
    v_mfma_f32_16x16x32_bf16 v[0:3], v[208:211], v[192:195], v[0:3]
    ds_read_b64_tr_b16 v[220:221], v233 offset:12416
    ds_read_b64_tr_b16 v[222:223], v233 offset:18560
    s_waitcnt vmcnt(11)
    v_mfma_f32_16x16x32_bf16 v[32:35], v[208:211], v[196:199], v[32:35]
    s_waitcnt vmcnt(9)
    v_mfma_f32_16x16x32_bf16 v[64:67], v[208:211], v[200:203], v[64:67]
    s_waitcnt vmcnt(7)
    v_mfma_f32_16x16x32_bf16 v[96:99], v[208:211], v[204:207], v[96:99]
    buffer_load_dwordx4 v[176:179], v243, s[16:19], s52 offen
    s_add_u32 s52, s52, 1024
    s_waitcnt lgkmcnt(4)
    v_mfma_f32_16x16x32_bf16 v[4:7], v[212:215], v[192:195], v[4:7]
    ds_read_b64_tr_b16 v[208:209], v234 offset:128
    ds_read_b64_tr_b16 v[210:211], v234 offset:6272
    v_mfma_f32_16x16x32_bf16 v[36:39], v[212:215], v[196:199], v[36:39]
    v_mfma_f32_16x16x32_bf16 v[68:71], v[212:215], v[200:203], v[68:71]
    v_mfma_f32_16x16x32_bf16 v[100:103], v[212:215], v[204:207], v[100:103]
    s_add_u32 m0, s43, 0
    s_nop 0
    buffer_load_dwordx4 v240, s[8:11], s40 offen lds
    s_waitcnt lgkmcnt(4)
    v_mfma_f32_16x16x32_bf16 v[8:11], v[216:219], v[192:195], v[8:11]
    ds_read_b64_tr_b16 v[212:213], v234 offset:12416
    ds_read_b64_tr_b16 v[214:215], v234 offset:18560
    v_mfma_f32_16x16x32_bf16 v[40:43], v[216:219], v[196:199], v[40:43]
    v_mfma_f32_16x16x32_bf16 v[72:75], v[216:219], v[200:203], v[72:75]
    v_mfma_f32_16x16x32_bf16 v[104:107], v[216:219], v[204:207], v[104:107]
    buffer_load_dwordx4 v[180:183], v243, s[16:19], s53 offen
    s_add_u32 s53, s53, 1024
    s_waitcnt lgkmcnt(4)
    v_mfma_f32_16x16x32_bf16 v[12:15], v[220:223], v[192:195], v[12:15]
    ds_read_b64_tr_b16 v[216:217], v235 offset:128
    ds_read_b64_tr_b16 v[218:219], v235 offset:6272
    v_mfma_f32_16x16x32_bf16 v[44:47], v[220:223], v[196:199], v[44:47]
    v_mfma_f32_16x16x32_bf16 v[76:79], v[220:223], v[200:203], v[76:79]
    v_mfma_f32_16x16x32_bf16 v[108:111], v[220:223], v[204:207], v[108:111]
    s_add_u32 m0, s43, 1024
    s_nop 0
    buffer_load_dwordx4 v241, s[8:11], s40 offen lds
    s_barrier
    v_add_u32 v236, 24576, v232
    v_add_u32 v237, 24576, v233
    v_add_u32 v238, 24576, v234
    v_add_u32 v239, 24576, v235
    s_waitcnt lgkmcnt(4)
    v_mfma_f32_16x16x32_bf16 v[16:19], v[208:211], v[192:195], v[16:19]
    ds_read_b64_tr_b16 v[220:221], v235 offset:12416
    ds_read_b64_tr_b16 v[222:223], v235 offset:18560
    v_mfma_f32_16x16x32_bf16 v[48:51], v[208:211], v[196:199], v[48:51]
    v_mfma_f32_16x16x32_bf16 v[80:83], v[208:211], v[200:203], v[80:83]
    v_mfma_f32_16x16x32_bf16 v[112:115], v[208:211], v[204:207], v[112:115]
    buffer_load_dwordx4 v[184:187], v243, s[16:19], s54 offen
    s_add_u32 s54, s54, 1024
    s_waitcnt lgkmcnt(4)
    v_mfma_f32_16x16x32_bf16 v[20:23], v[212:215], v[192:195], v[20:23]
    ds_read_b64_tr_b16 v[208:209], v236 offset:128
    ds_read_b64_tr_b16 v[210:211], v236 offset:6272
    v_mfma_f32_16x16x32_bf16 v[52:55], v[212:215], v[196:199], v[52:55]
    v_mfma_f32_16x16x32_bf16 v[84:87], v[212:215], v[200:203], v[84:87]
    v_mfma_f32_16x16x32_bf16 v[116:119], v[212:215], v[204:207], v[116:119]
    s_add_u32 m0, s43, 2048
    s_nop 0
    buffer_load_dwordx4 v242, s[8:11], s40 offen lds
    s_add_u32 s40, s40, 294912
    s_waitcnt lgkmcnt(4)
    v_mfma_f32_16x16x32_bf16 v[24:27], v[216:219], v[192:195], v[24:27]
    ds_read_b64_tr_b16 v[212:213], v236 offset:12416
    ds_read_b64_tr_b16 v[214:215], v236 offset:18560
    v_mfma_f32_16x16x32_bf16 v[56:59], v[216:219], v[196:199], v[56:59]
    v_mfma_f32_16x16x32_bf16 v[88:91], v[216:219], v[200:203], v[88:91]
    v_mfma_f32_16x16x32_bf16 v[120:123], v[216:219], v[204:207], v[120:123]
    buffer_load_dwordx4 v[188:191], v243, s[16:19], s55 offen
    s_add_u32 s55, s55, 1024
    s_waitcnt lgkmcnt(4)
    v_mfma_f32_16x16x32_bf16 v[28:31], v[220:223], v[192:195], v[28:31]
    ds_read_b64_tr_b16 v[216:217], v237 offset:128
    ds_read_b64_tr_b16 v[218:219], v237 offset:6272
    v_mfma_f32_16x16x32_bf16 v[60:63], v[220:223], v[196:199], v[60:63]
    v_mfma_f32_16x16x32_bf16 v[92:95], v[220:223], v[200:203], v[92:95]
    v_mfma_f32_16x16x32_bf16 v[124:127], v[220:223], v[204:207], v[124:127]
    s_waitcnt lgkmcnt(4)
    s_waitcnt vmcnt(13)
    v_mfma_f32_16x16x32_bf16 v[0:3], v[208:211], v[160:163], v[0:3]
    ds_read_b64_tr_b16 v[220:221], v237 offset:12416
    ds_read_b64_tr_b16 v[222:223], v237 offset:18560
    s_waitcnt vmcnt(11)
    v_mfma_f32_16x16x32_bf16 v[32:35], v[208:211], v[164:167], v[32:35]
    s_waitcnt vmcnt(9)
    v_mfma_f32_16x16x32_bf16 v[64:67], v[208:211], v[168:171], v[64:67]
    s_waitcnt vmcnt(7)
    v_mfma_f32_16x16x32_bf16 v[96:99], v[208:211], v[172:175], v[96:99]
    buffer_load_dwordx4 v[192:195], v243, s[16:19], s52 offen
    s_add_u32 s52, s52, 1024
    s_waitcnt lgkmcnt(4)
    v_mfma_f32_16x16x32_bf16 v[4:7], v[212:215], v[160:163], v[4:7]
    ds_read_b64_tr_b16 v[208:209], v238 offset:128
    ds_read_b64_tr_b16 v[210:211], v238 offset:6272
    v_mfma_f32_16x16x32_bf16 v[36:39], v[212:215], v[164:167], v[36:39]
    v_mfma_f32_16x16x32_bf16 v[68:71], v[212:215], v[168:171], v[68:71]
    v_mfma_f32_16x16x32_bf16 v[100:103], v[212:215], v[172:175], v[100:103]
    s_add_u32 m0, s43, 24576
    s_nop 0
    buffer_load_dwordx4 v240, s[8:11], s40 offen lds
    s_waitcnt lgkmcnt(4)
    v_mfma_f32_16x16x32_bf16 v[8:11], v[216:219], v[160:163], v[8:11]
    ds_read_b64_tr_b16 v[212:213], v238 offset:12416
    ds_read_b64_tr_b16 v[214:215], v238 offset:18560
    v_mfma_f32_16x16x32_bf16 v[40:43], v[216:219], v[164:167], v[40:43]
    v_mfma_f32_16x16x32_bf16 v[72:75], v[216:219], v[168:171], v[72:75]
    v_mfma_f32_16x16x32_bf16 v[104:107], v[216:219], v[172:175], v[104:107]
    buffer_load_dwordx4 v[196:199], v243, s[16:19], s53 offen
    s_add_u32 s53, s53, 1024
    s_waitcnt lgkmcnt(4)
    v_mfma_f32_16x16x32_bf16 v[12:15], v[220:223], v[160:163], v[12:15]
    ds_read_b64_tr_b16 v[216:217], v239 offset:128
    ds_read_b64_tr_b16 v[218:219], v239 offset:6272
    v_mfma_f32_16x16x32_bf16 v[44:47], v[220:223], v[164:167], v[44:47]
    v_mfma_f32_16x16x32_bf16 v[76:79], v[220:223], v[168:171], v[76:79]
    v_mfma_f32_16x16x32_bf16 v[108:111], v[220:223], v[172:175], v[108:111]
    s_add_u32 m0, s43, 25600
    s_nop 0
    buffer_load_dwordx4 v241, s[8:11], s40 offen lds
    s_barrier
    v_add_u32 v232, 24576, v236
    v_add_u32 v233, 24576, v237
    v_add_u32 v234, 24576, v238
    v_add_u32 v235, 24576, v239
    s_waitcnt lgkmcnt(4)
    v_mfma_f32_16x16x32_bf16 v[16:19], v[208:211], v[160:163], v[16:19]
    ds_read_b64_tr_b16 v[220:221], v239 offset:12416
    ds_read_b64_tr_b16 v[222:223], v239 offset:18560
    v_mfma_f32_16x16x32_bf16 v[48:51], v[208:211], v[164:167], v[48:51]
    v_mfma_f32_16x16x32_bf16 v[80:83], v[208:211], v[168:171], v[80:83]
    v_mfma_f32_16x16x32_bf16 v[112:115], v[208:211], v[172:175], v[112:115]
    buffer_load_dwordx4 v[200:203], v243, s[16:19], s54 offen
    s_add_u32 s54, s54, 1024
    s_waitcnt lgkmcnt(4)
    v_mfma_f32_16x16x32_bf16 v[20:23], v[212:215], v[160:163], v[20:23]
    ds_read_b64_tr_b16 v[208:209], v232 offset:128
    ds_read_b64_tr_b16 v[210:211], v232 offset:6272
    v_mfma_f32_16x16x32_bf16 v[52:55], v[212:215], v[164:167], v[52:55]
    v_mfma_f32_16x16x32_bf16 v[84:87], v[212:215], v[168:171], v[84:87]
    v_mfma_f32_16x16x32_bf16 v[116:119], v[212:215], v[172:175], v[116:119]
    s_add_u32 m0, s43, 26624
    s_nop 0
    buffer_load_dwordx4 v242, s[8:11], s40 offen lds
    s_add_u32 s40, s40, 294912
    s_waitcnt lgkmcnt(4)
    v_mfma_f32_16x16x32_bf16 v[24:27], v[216:219], v[160:163], v[24:27]
    ds_read_b64_tr_b16 v[212:213], v232 offset:12416
    ds_read_b64_tr_b16 v[214:215], v232 offset:18560
    v_mfma_f32_16x16x32_bf16 v[56:59], v[216:219], v[164:167], v[56:59]
    v_mfma_f32_16x16x32_bf16 v[88:91], v[216:219], v[168:171], v[88:91]
    v_mfma_f32_16x16x32_bf16 v[120:123], v[216:219], v[172:175], v[120:123]
    buffer_load_dwordx4 v[204:207], v243, s[16:19], s55 offen
    s_add_u32 s55, s55, 1024
    s_waitcnt lgkmcnt(4)
    v_mfma_f32_16x16x32_bf16 v[28:31], v[220:223], v[160:163], v[28:31]
    ds_read_b64_tr_b16 v[216:217], v233 offset:128
    ds_read_b64_tr_b16 v[218:219], v233 offset:6272
    v_mfma_f32_16x16x32_bf16 v[60:63], v[220:223], v[164:167], v[60:63]
    v_mfma_f32_16x16x32_bf16 v[92:95], v[220:223], v[168:171], v[92:95]
    v_mfma_f32_16x16x32_bf16 v[124:127], v[220:223], v[172:175], v[124:127]
    s_waitcnt lgkmcnt(4)
    s_waitcnt vmcnt(13)
    v_mfma_f32_16x16x32_bf16 v[0:3], v[208:211], v[176:179], v[0:3]
    ds_read_b64_tr_b16 v[220:221], v233 offset:12416
    ds_read_b64_tr_b16 v[222:223], v233 offset:18560
    s_waitcnt vmcnt(11)
    v_mfma_f32_16x16x32_bf16 v[32:35], v[208:211], v[180:183], v[32:35]
    s_waitcnt vmcnt(9)
    v_mfma_f32_16x16x32_bf16 v[64:67], v[208:211], v[184:187], v[64:67]
    s_waitcnt vmcnt(7)
    v_mfma_f32_16x16x32_bf16 v[96:99], v[208:211], v[188:191], v[96:99]
    buffer_load_dwordx4 v[160:163], v243, s[16:19], s52 offen
    s_add_u32 s52, s52, 1024
    s_waitcnt lgkmcnt(4)
    v_mfma_f32_16x16x32_bf16 v[4:7], v[212:215], v[176:179], v[4:7]
    ds_read_b64_tr_b16 v[208:209], v234 offset:128
    ds_read_b64_tr_b16 v[210:211], v234 offset:6272
    v_mfma_f32_16x16x32_bf16 v[36:39], v[212:215], v[180:183], v[36:39]
    v_mfma_f32_16x16x32_bf16 v[68:71], v[212:215], v[184:187], v[68:71]
    v_mfma_f32_16x16x32_bf16 v[100:103], v[212:215], v[188:191], v[100:103]
    s_add_u32 m0, s43, 49152
    s_nop 0
    buffer_load_dwordx4 v240, s[8:11], s40 offen lds
    s_waitcnt lgkmcnt(4)
    v_mfma_f32_16x16x32_bf16 v[8:11], v[216:219], v[176:179], v[8:11]
    ds_read_b64_tr_b16 v[212:213], v234 offset:12416
    ds_read_b64_tr_b16 v[214:215], v234 offset:18560
    v_mfma_f32_16x16x32_bf16 v[40:43], v[216:219], v[180:183], v[40:43]
    v_mfma_f32_16x16x32_bf16 v[72:75], v[216:219], v[184:187], v[72:75]
    v_mfma_f32_16x16x32_bf16 v[104:107], v[216:219], v[188:191], v[104:107]
    buffer_load_dwordx4 v[164:167], v243, s[16:19], s53 offen
    s_add_u32 s53, s53, 1024
    s_waitcnt lgkmcnt(4)
    v_mfma_f32_16x16x32_bf16 v[12:15], v[220:223], v[176:179], v[12:15]
    ds_read_b64_tr_b16 v[216:217], v235 offset:128
    ds_read_b64_tr_b16 v[218:219], v235 offset:6272
    v_mfma_f32_16x16x32_bf16 v[44:47], v[220:223], v[180:183], v[44:47]
    v_mfma_f32_16x16x32_bf16 v[76:79], v[220:223], v[184:187], v[76:79]
    v_mfma_f32_16x16x32_bf16 v[108:111], v[220:223], v[188:191], v[108:111]
    s_add_u32 m0, s43, 50176
    s_nop 0
    buffer_load_dwordx4 v241, s[8:11], s40 offen lds
    s_barrier
    v_add_u32 v236, 24576, v232
    v_add_u32 v237, 24576, v233
    v_add_u32 v238, 24576, v234
    v_add_u32 v239, 24576, v235
    s_waitcnt lgkmcnt(4)
    v_mfma_f32_16x16x32_bf16 v[16:19], v[208:211], v[176:179], v[16:19]
    ds_read_b64_tr_b16 v[220:221], v235 offset:12416
    ds_read_b64_tr_b16 v[222:223], v235 offset:18560
    v_mfma_f32_16x16x32_bf16 v[48:51], v[208:211], v[180:183], v[48:51]
    v_mfma_f32_16x16x32_bf16 v[80:83], v[208:211], v[184:187], v[80:83]
    v_mfma_f32_16x16x32_bf16 v[112:115], v[208:211], v[188:191], v[112:115]
    buffer_load_dwordx4 v[168:171], v243, s[16:19], s54 offen
    s_add_u32 s54, s54, 1024
    s_waitcnt lgkmcnt(4)
    v_mfma_f32_16x16x32_bf16 v[20:23], v[212:215], v[176:179], v[20:23]
    ds_read_b64_tr_b16 v[208:209], v236 offset:128
    ds_read_b64_tr_b16 v[210:211], v236 offset:6272
    v_mfma_f32_16x16x32_bf16 v[52:55], v[212:215], v[180:183], v[52:55]
    v_mfma_f32_16x16x32_bf16 v[84:87], v[212:215], v[184:187], v[84:87]
    v_mfma_f32_16x16x32_bf16 v[116:119], v[212:215], v[188:191], v[116:119]
    s_add_u32 m0, s43, 51200
    s_nop 0
    buffer_load_dwordx4 v242, s[8:11], s40 offen lds
    s_add_u32 s40, s40, 294912
    s_waitcnt lgkmcnt(4)
    v_mfma_f32_16x16x32_bf16 v[24:27], v[216:219], v[176:179], v[24:27]
    ds_read_b64_tr_b16 v[212:213], v236 offset:12416
    ds_read_b64_tr_b16 v[214:215], v236 offset:18560
    v_mfma_f32_16x16x32_bf16 v[56:59], v[216:219], v[180:183], v[56:59]
    v_mfma_f32_16x16x32_bf16 v[88:91], v[216:219], v[184:187], v[88:91]
    v_mfma_f32_16x16x32_bf16 v[120:123], v[216:219], v[188:191], v[120:123]
    buffer_load_dwordx4 v[172:175], v243, s[16:19], s55 offen
    s_add_u32 s55, s55, 1024
    s_waitcnt lgkmcnt(4)
    v_mfma_f32_16x16x32_bf16 v[28:31], v[220:223], v[176:179], v[28:31]
    ds_read_b64_tr_b16 v[216:217], v237 offset:128
    ds_read_b64_tr_b16 v[218:219], v237 offset:6272
    v_mfma_f32_16x16x32_bf16 v[60:63], v[220:223], v[180:183], v[60:63]
    v_mfma_f32_16x16x32_bf16 v[92:95], v[220:223], v[184:187], v[92:95]
    v_mfma_f32_16x16x32_bf16 v[124:127], v[220:223], v[188:191], v[124:127]
    s_waitcnt lgkmcnt(4)
    s_waitcnt vmcnt(13)
    v_mfma_f32_16x16x32_bf16 v[0:3], v[208:211], v[192:195], v[0:3]
    ds_read_b64_tr_b16 v[220:221], v237 offset:12416
    ds_read_b64_tr_b16 v[222:223], v237 offset:18560
    s_waitcnt vmcnt(11)
    v_mfma_f32_16x16x32_bf16 v[32:35], v[208:211], v[196:199], v[32:35]
    s_waitcnt vmcnt(9)
    v_mfma_f32_16x16x32_bf16 v[64:67], v[208:211], v[200:203], v[64:67]
    s_waitcnt vmcnt(7)
    v_mfma_f32_16x16x32_bf16 v[96:99], v[208:211], v[204:207], v[96:99]
    buffer_load_dwordx4 v[176:179], v243, s[16:19], s52 offen
    s_add_u32 s52, s52, 1024
    s_waitcnt lgkmcnt(4)
    v_mfma_f32_16x16x32_bf16 v[4:7], v[212:215], v[192:195], v[4:7]
    ds_read_b64_tr_b16 v[208:209], v238 offset:128
    ds_read_b64_tr_b16 v[210:211], v238 offset:6272
    v_mfma_f32_16x16x32_bf16 v[36:39], v[212:215], v[196:199], v[36:39]
    v_mfma_f32_16x16x32_bf16 v[68:71], v[212:215], v[200:203], v[68:71]
    v_mfma_f32_16x16x32_bf16 v[100:103], v[212:215], v[204:207], v[100:103]
    s_add_u32 m0, s43, 73728
    s_nop 0
    buffer_load_dwordx4 v240, s[8:11], s40 offen lds
    s_waitcnt lgkmcnt(4)
    v_mfma_f32_16x16x32_bf16 v[8:11], v[216:219], v[192:195], v[8:11]
    ds_read_b64_tr_b16 v[212:213], v238 offset:12416
    ds_read_b64_tr_b16 v[214:215], v238 offset:18560
    v_mfma_f32_16x16x32_bf16 v[40:43], v[216:219], v[196:199], v[40:43]
    v_mfma_f32_16x16x32_bf16 v[72:75], v[216:219], v[200:203], v[72:75]
    v_mfma_f32_16x16x32_bf16 v[104:107], v[216:219], v[204:207], v[104:107]
    buffer_load_dwordx4 v[180:183], v243, s[16:19], s53 offen
    s_add_u32 s53, s53, 1024
    s_waitcnt lgkmcnt(4)
    v_mfma_f32_16x16x32_bf16 v[12:15], v[220:223], v[192:195], v[12:15]
    ds_read_b64_tr_b16 v[216:217], v239 offset:128
    ds_read_b64_tr_b16 v[218:219], v239 offset:6272
    v_mfma_f32_16x16x32_bf16 v[44:47], v[220:223], v[196:199], v[44:47]
    v_mfma_f32_16x16x32_bf16 v[76:79], v[220:223], v[200:203], v[76:79]
    v_mfma_f32_16x16x32_bf16 v[108:111], v[220:223], v[204:207], v[108:111]
    s_add_u32 m0, s43, 74752
    s_nop 0
    buffer_load_dwordx4 v241, s[8:11], s40 offen lds
    s_barrier
    v_add_u32 v232, -122880, v236
    v_add_u32 v233, -122880, v237
    v_add_u32 v234, -122880, v238
    v_add_u32 v235, -122880, v239
    s_waitcnt lgkmcnt(4)
    v_mfma_f32_16x16x32_bf16 v[16:19], v[208:211], v[192:195], v[16:19]
    ds_read_b64_tr_b16 v[220:221], v239 offset:12416
    ds_read_b64_tr_b16 v[222:223], v239 offset:18560
    v_mfma_f32_16x16x32_bf16 v[48:51], v[208:211], v[196:199], v[48:51]
    v_mfma_f32_16x16x32_bf16 v[80:83], v[208:211], v[200:203], v[80:83]
    v_mfma_f32_16x16x32_bf16 v[112:115], v[208:211], v[204:207], v[112:115]
    buffer_load_dwordx4 v[184:187], v243, s[16:19], s54 offen
    s_add_u32 s54, s54, 1024
    s_waitcnt lgkmcnt(4)
    v_mfma_f32_16x16x32_bf16 v[20:23], v[212:215], v[192:195], v[20:23]
    ds_read_b64_tr_b16 v[208:209], v232 offset:128
    ds_read_b64_tr_b16 v[210:211], v232 offset:6272
    v_mfma_f32_16x16x32_bf16 v[52:55], v[212:215], v[196:199], v[52:55]
    v_mfma_f32_16x16x32_bf16 v[84:87], v[212:215], v[200:203], v[84:87]
    v_mfma_f32_16x16x32_bf16 v[116:119], v[212:215], v[204:207], v[116:119]
    s_add_u32 m0, s43, 75776
    s_nop 0
    buffer_load_dwordx4 v242, s[8:11], s40 offen lds
    s_add_u32 s40, s40, 294912
    s_waitcnt lgkmcnt(4)
    v_mfma_f32_16x16x32_bf16 v[24:27], v[216:219], v[192:195], v[24:27]
    ds_read_b64_tr_b16 v[212:213], v232 offset:12416
    ds_read_b64_tr_b16 v[214:215], v232 offset:18560
    v_mfma_f32_16x16x32_bf16 v[56:59], v[216:219], v[196:199], v[56:59]
    v_mfma_f32_16x16x32_bf16 v[88:91], v[216:219], v[200:203], v[88:91]
    v_mfma_f32_16x16x32_bf16 v[120:123], v[216:219], v[204:207], v[120:123]
    buffer_load_dwordx4 v[188:191], v243, s[16:19], s55 offen
    s_add_u32 s55, s55, 1024
    s_waitcnt lgkmcnt(4)
    v_mfma_f32_16x16x32_bf16 v[28:31], v[220:223], v[192:195], v[28:31]
    ds_read_b64_tr_b16 v[216:217], v233 offset:128
    ds_read_b64_tr_b16 v[218:219], v233 offset:6272
    v_mfma_f32_16x16x32_bf16 v[60:63], v[220:223], v[196:199], v[60:63]
    v_mfma_f32_16x16x32_bf16 v[92:95], v[220:223], v[200:203], v[92:95]
    v_mfma_f32_16x16x32_bf16 v[124:127], v[220:223], v[204:207], v[124:127]
    s_waitcnt lgkmcnt(4)
    s_waitcnt vmcnt(13)
    v_mfma_f32_16x16x32_bf16 v[0:3], v[208:211], v[160:163], v[0:3]
    ds_read_b64_tr_b16 v[220:221], v233 offset:12416
    ds_read_b64_tr_b16 v[222:223], v233 offset:18560
    s_waitcnt vmcnt(11)
    v_mfma_f32_16x16x32_bf16 v[32:35], v[208:211], v[164:167], v[32:35]
    s_waitcnt vmcnt(9)
    v_mfma_f32_16x16x32_bf16 v[64:67], v[208:211], v[168:171], v[64:67]
    s_waitcnt vmcnt(7)
    v_mfma_f32_16x16x32_bf16 v[96:99], v[208:211], v[172:175], v[96:99]
    buffer_load_dwordx4 v[192:195], v243, s[16:19], s52 offen
    s_add_u32 s52, s52, 1024
    s_waitcnt lgkmcnt(4)
    v_mfma_f32_16x16x32_bf16 v[4:7], v[212:215], v[160:163], v[4:7]
    ds_read_b64_tr_b16 v[208:209], v234 offset:128
    ds_read_b64_tr_b16 v[210:211], v234 offset:6272
    v_mfma_f32_16x16x32_bf16 v[36:39], v[212:215], v[164:167], v[36:39]
    v_mfma_f32_16x16x32_bf16 v[68:71], v[212:215], v[168:171], v[68:71]
    v_mfma_f32_16x16x32_bf16 v[100:103], v[212:215], v[172:175], v[100:103]
    s_add_u32 m0, s43, 98304
    s_nop 0
    buffer_load_dwordx4 v240, s[8:11], s40 offen lds
    v_lshrrev_b32 v253, 1, v243
    s_mul_i32 s47, s35, 768
    s_add_u32 s47, s47, 13631488
    v_mov_b32 v224, 0
    v_mov_b32 v225, 0
    v_mov_b32 v226, 0
    v_mov_b32 v227, 0
    v_mov_b32 v228, 0
    v_mov_b32 v229, 0
    v_mov_b32 v230, 0
    v_mov_b32 v231, 0
    buffer_load_dwordx2 v[224:225], v253, s[16:19], s47 offen offset:0
    buffer_load_dwordx2 v[228:229], v253, s[16:19], s47 offen offset:768
    s_mov_b32 exec_hi, 0
    buffer_load_dwordx2 v[226:227], v253, s[16:19], s47 offen offset:512
    buffer_load_dwordx2 v[230:231], v253, s[16:19], s47 offen offset:1280
    s_mov_b64 exec, -1
    s_waitcnt lgkmcnt(4)
    v_mfma_f32_16x16x32_bf16 v[8:11], v[216:219], v[160:163], v[8:11]
    ds_read_b64_tr_b16 v[212:213], v234 offset:12416
    ds_read_b64_tr_b16 v[214:215], v234 offset:18560
    v_mfma_f32_16x16x32_bf16 v[40:43], v[216:219], v[164:167], v[40:43]
    v_mfma_f32_16x16x32_bf16 v[72:75], v[216:219], v[168:171], v[72:75]
    v_mfma_f32_16x16x32_bf16 v[104:107], v[216:219], v[172:175], v[104:107]
    buffer_load_dwordx4 v[196:199], v243, s[16:19], s53 offen
    s_add_u32 s53, s53, 1024
    s_waitcnt lgkmcnt(4)
    v_mfma_f32_16x16x32_bf16 v[12:15], v[220:223], v[160:163], v[12:15]
    ds_read_b64_tr_b16 v[216:217], v235 offset:128
    ds_read_b64_tr_b16 v[218:219], v235 offset:6272
    v_mfma_f32_16x16x32_bf16 v[44:47], v[220:223], v[164:167], v[44:47]
    v_mfma_f32_16x16x32_bf16 v[76:79], v[220:223], v[168:171], v[76:79]
    v_mfma_f32_16x16x32_bf16 v[108:111], v[220:223], v[172:175], v[108:111]
    s_add_u32 m0, s43, 99328
    s_nop 0
    buffer_load_dwordx4 v241, s[8:11], s40 offen lds
    s_barrier
    v_add_u32 v236, 24576, v232
    v_add_u32 v237, 24576, v233
    v_add_u32 v238, 24576, v234
    v_add_u32 v239, 24576, v235
    s_waitcnt lgkmcnt(4)
    v_mfma_f32_16x16x32_bf16 v[16:19], v[208:211], v[160:163], v[16:19]
    ds_read_b64_tr_b16 v[220:221], v235 offset:12416
    ds_read_b64_tr_b16 v[222:223], v235 offset:18560
    v_mfma_f32_16x16x32_bf16 v[48:51], v[208:211], v[164:167], v[48:51]
    v_mfma_f32_16x16x32_bf16 v[80:83], v[208:211], v[168:171], v[80:83]
    v_mfma_f32_16x16x32_bf16 v[112:115], v[208:211], v[172:175], v[112:115]
    buffer_load_dwordx4 v[200:203], v243, s[16:19], s54 offen
    s_add_u32 s54, s54, 1024
    s_waitcnt lgkmcnt(4)
    v_mfma_f32_16x16x32_bf16 v[20:23], v[212:215], v[160:163], v[20:23]
    ds_read_b64_tr_b16 v[208:209], v236 offset:128
    ds_read_b64_tr_b16 v[210:211], v236 offset:6272
    v_mfma_f32_16x16x32_bf16 v[52:55], v[212:215], v[164:167], v[52:55]
    v_mfma_f32_16x16x32_bf16 v[84:87], v[212:215], v[168:171], v[84:87]
    v_mfma_f32_16x16x32_bf16 v[116:119], v[212:215], v[172:175], v[116:119]
    s_add_u32 m0, s43, 100352
    s_nop 0
    buffer_load_dwordx4 v242, s[8:11], s40 offen lds
    s_add_u32 s40, s40, 294912
    s_waitcnt lgkmcnt(4)
    v_mfma_f32_16x16x32_bf16 v[24:27], v[216:219], v[160:163], v[24:27]
    ds_read_b64_tr_b16 v[212:213], v236 offset:12416
    ds_read_b64_tr_b16 v[214:215], v236 offset:18560
    v_mfma_f32_16x16x32_bf16 v[56:59], v[216:219], v[164:167], v[56:59]
    v_mfma_f32_16x16x32_bf16 v[88:91], v[216:219], v[168:171], v[88:91]
    v_mfma_f32_16x16x32_bf16 v[120:123], v[216:219], v[172:175], v[120:123]
    buffer_load_dwordx4 v[204:207], v243, s[16:19], s55 offen
    s_add_u32 s55, s55, 1024
    s_waitcnt lgkmcnt(4)
    v_mfma_f32_16x16x32_bf16 v[28:31], v[220:223], v[160:163], v[28:31]
    ds_read_b64_tr_b16 v[216:217], v237 offset:128
    ds_read_b64_tr_b16 v[218:219], v237 offset:6272
    v_mfma_f32_16x16x32_bf16 v[60:63], v[220:223], v[164:167], v[60:63]
    v_mfma_f32_16x16x32_bf16 v[92:95], v[220:223], v[168:171], v[92:95]
    v_mfma_f32_16x16x32_bf16 v[124:127], v[220:223], v[172:175], v[124:127]
    s_waitcnt lgkmcnt(4)
    s_waitcnt vmcnt(17)
    v_mfma_f32_16x16x32_bf16 v[0:3], v[208:211], v[176:179], v[0:3]
    ds_read_b64_tr_b16 v[220:221], v237 offset:12416
    ds_read_b64_tr_b16 v[222:223], v237 offset:18560
    s_waitcnt vmcnt(15)
    v_mfma_f32_16x16x32_bf16 v[32:35], v[208:211], v[180:183], v[32:35]
    s_waitcnt vmcnt(13)
    v_mfma_f32_16x16x32_bf16 v[64:67], v[208:211], v[184:187], v[64:67]
    s_waitcnt vmcnt(11)
    v_mfma_f32_16x16x32_bf16 v[96:99], v[208:211], v[188:191], v[96:99]
    buffer_load_dwordx4 v[160:163], v243, s[16:19], s52 offen
    s_add_u32 s52, s52, 1024
    s_waitcnt lgkmcnt(4)
    v_mfma_f32_16x16x32_bf16 v[4:7], v[212:215], v[176:179], v[4:7]
    ds_read_b64_tr_b16 v[208:209], v238 offset:128
    ds_read_b64_tr_b16 v[210:211], v238 offset:6272
    v_mfma_f32_16x16x32_bf16 v[36:39], v[212:215], v[180:183], v[36:39]
    v_mfma_f32_16x16x32_bf16 v[68:71], v[212:215], v[184:187], v[68:71]
    v_mfma_f32_16x16x32_bf16 v[100:103], v[212:215], v[188:191], v[100:103]
    s_add_u32 m0, s43, 122880
    s_nop 0
    buffer_load_dwordx4 v240, s[8:11], s40 offen lds
    s_waitcnt lgkmcnt(4)
    v_mfma_f32_16x16x32_bf16 v[8:11], v[216:219], v[176:179], v[8:11]
    ds_read_b64_tr_b16 v[212:213], v238 offset:12416
    ds_read_b64_tr_b16 v[214:215], v238 offset:18560
    v_mfma_f32_16x16x32_bf16 v[40:43], v[216:219], v[180:183], v[40:43]
    v_mfma_f32_16x16x32_bf16 v[72:75], v[216:219], v[184:187], v[72:75]
    v_mfma_f32_16x16x32_bf16 v[104:107], v[216:219], v[188:191], v[104:107]
    buffer_load_dwordx4 v[164:167], v243, s[16:19], s53 offen
    s_add_u32 s53, s53, 1024
    s_waitcnt lgkmcnt(4)
    v_mfma_f32_16x16x32_bf16 v[12:15], v[220:223], v[176:179], v[12:15]
    ds_read_b64_tr_b16 v[216:217], v239 offset:128
    ds_read_b64_tr_b16 v[218:219], v239 offset:6272
    v_mfma_f32_16x16x32_bf16 v[44:47], v[220:223], v[180:183], v[44:47]
    v_mfma_f32_16x16x32_bf16 v[76:79], v[220:223], v[184:187], v[76:79]
    v_mfma_f32_16x16x32_bf16 v[108:111], v[220:223], v[188:191], v[108:111]
    s_add_u32 m0, s43, 123904
    s_nop 0
    buffer_load_dwordx4 v241, s[8:11], s40 offen lds
    s_barrier
    v_add_u32 v232, 24576, v236
    v_add_u32 v233, 24576, v237
    v_add_u32 v234, 24576, v238
    v_add_u32 v235, 24576, v239
    s_waitcnt lgkmcnt(4)
    v_mfma_f32_16x16x32_bf16 v[16:19], v[208:211], v[176:179], v[16:19]
    ds_read_b64_tr_b16 v[220:221], v239 offset:12416
    ds_read_b64_tr_b16 v[222:223], v239 offset:18560
    v_mfma_f32_16x16x32_bf16 v[48:51], v[208:211], v[180:183], v[48:51]
    v_mfma_f32_16x16x32_bf16 v[80:83], v[208:211], v[184:187], v[80:83]
    v_mfma_f32_16x16x32_bf16 v[112:115], v[208:211], v[188:191], v[112:115]
    buffer_load_dwordx4 v[168:171], v243, s[16:19], s54 offen
    s_add_u32 s54, s54, 1024
    s_waitcnt lgkmcnt(4)
    v_mfma_f32_16x16x32_bf16 v[20:23], v[212:215], v[176:179], v[20:23]
    ds_read_b64_tr_b16 v[208:209], v232 offset:128
    ds_read_b64_tr_b16 v[210:211], v232 offset:6272
    v_mfma_f32_16x16x32_bf16 v[52:55], v[212:215], v[180:183], v[52:55]
    v_mfma_f32_16x16x32_bf16 v[84:87], v[212:215], v[184:187], v[84:87]
    v_mfma_f32_16x16x32_bf16 v[116:119], v[212:215], v[188:191], v[116:119]
    s_add_u32 m0, s43, 124928
    s_nop 0
    buffer_load_dwordx4 v242, s[8:11], s40 offen lds
    s_add_u32 s40, s40, 294912
    s_waitcnt lgkmcnt(4)
    v_mfma_f32_16x16x32_bf16 v[24:27], v[216:219], v[176:179], v[24:27]
    ds_read_b64_tr_b16 v[212:213], v232 offset:12416
    ds_read_b64_tr_b16 v[214:215], v232 offset:18560
    v_mfma_f32_16x16x32_bf16 v[56:59], v[216:219], v[180:183], v[56:59]
    v_mfma_f32_16x16x32_bf16 v[88:91], v[216:219], v[184:187], v[88:91]
    v_mfma_f32_16x16x32_bf16 v[120:123], v[216:219], v[188:191], v[120:123]
    buffer_load_dwordx4 v[172:175], v243, s[16:19], s55 offen
    s_add_u32 s55, s55, 1024
    s_waitcnt lgkmcnt(4)
    v_mfma_f32_16x16x32_bf16 v[28:31], v[220:223], v[176:179], v[28:31]
    ds_read_b64_tr_b16 v[216:217], v233 offset:128
    ds_read_b64_tr_b16 v[218:219], v233 offset:6272
    v_mfma_f32_16x16x32_bf16 v[60:63], v[220:223], v[180:183], v[60:63]
    v_mfma_f32_16x16x32_bf16 v[92:95], v[220:223], v[184:187], v[92:95]
    v_mfma_f32_16x16x32_bf16 v[124:127], v[220:223], v[188:191], v[124:127]
    s_waitcnt lgkmcnt(4)
    s_waitcnt vmcnt(17)
    v_mfma_f32_16x16x32_bf16 v[0:3], v[208:211], v[192:195], v[0:3]
    ds_read_b64_tr_b16 v[220:221], v233 offset:12416
    ds_read_b64_tr_b16 v[222:223], v233 offset:18560
    s_waitcnt vmcnt(11)
    v_mfma_f32_16x16x32_bf16 v[32:35], v[208:211], v[196:199], v[32:35]
    s_waitcnt vmcnt(9)
    v_mfma_f32_16x16x32_bf16 v[64:67], v[208:211], v[200:203], v[64:67]
    s_waitcnt vmcnt(7)
    v_mfma_f32_16x16x32_bf16 v[96:99], v[208:211], v[204:207], v[96:99]
    s_mov_b32 s49, 0x3AE38E39
    v_add_f32 v224, v224, v226
    v_add_f32 v225, v225, v227
    v_add_f32 v228, v228, v230
    v_add_f32 v229, v229, v231
    v_mov_b32 v226, v224
    v_mov_b32 v227, v225
    v_mov_b32 v230, v228
    v_mov_b32 v231, v229
    v_permlane16_swap_b32 v224, v226
    v_permlane16_swap_b32 v225, v227
    v_permlane16_swap_b32 v228, v230
    v_permlane16_swap_b32 v229, v231
    s_nop 1
    v_add_f32 v224, v224, v226
    v_add_f32 v225, v225, v227
    v_add_f32 v228, v228, v230
    v_add_f32 v229, v229, v231
    v_mov_b32 v226, v224
    v_mov_b32 v227, v225
    v_mov_b32 v230, v228
    v_mov_b32 v231, v229
    v_permlane32_swap_b32 v224, v226
    v_permlane32_swap_b32 v225, v227
    v_permlane32_swap_b32 v228, v230
    v_permlane32_swap_b32 v229, v231
    s_nop 1
    v_add_f32 v224, v224, v226
    v_add_f32 v225, v225, v227
    v_add_f32 v228, v228, v230
    v_add_f32 v229, v229, v231
    v_mul_f32 v224, s49, v224
    v_mul_f32 v225, s49, v225
    v_fma_f32 v225, -v224, v224, v225
    v_max_f32 v225, 0, v225
    v_add_f32 v240, 0x3727c5ac, v225
    v_rsq_f32 v245, v240
    v_sub_f32 v244, 0, v224
    v_mul_f32 v245, 0xbfb8aa3b, v245
    v_mul_f32 v228, s49, v228
    v_mul_f32 v229, s49, v229
    v_fma_f32 v229, -v228, v228, v229
    v_max_f32 v229, 0, v229
    v_add_f32 v241, 0x3727c5ac, v229
    v_rsq_f32 v247, v241
    v_sub_f32 v246, 0, v228
    v_mul_f32 v247, 0xbfb8aa3b, v247
    v_lshrrev_b32 v253, 1, v243
    s_mul_i32 s47, s35, 768
    s_add_u32 s47, s47, 13631488
    v_mov_b32 v224, 0
    v_mov_b32 v225, 0
    v_mov_b32 v226, 0
    v_mov_b32 v227, 0
    v_mov_b32 v228, 0
    v_mov_b32 v229, 0
    v_mov_b32 v230, 0
    v_mov_b32 v231, 0
    buffer_load_dwordx2 v[224:225], v253, s[16:19], s47 offen offset:1536
    buffer_load_dwordx2 v[228:229], v253, s[16:19], s47 offen offset:2304
    s_mov_b32 exec_hi, 0
    buffer_load_dwordx2 v[226:227], v253, s[16:19], s47 offen offset:2048
    buffer_load_dwordx2 v[230:231], v253, s[16:19], s47 offen offset:2816
    s_mov_b64 exec, -1
    s_waitcnt lgkmcnt(4)
    v_mfma_f32_16x16x32_bf16 v[4:7], v[212:215], v[192:195], v[4:7]
    ds_read_b64_tr_b16 v[208:209], v234 offset:128
    ds_read_b64_tr_b16 v[210:211], v234 offset:6272
    v_mfma_f32_16x16x32_bf16 v[36:39], v[212:215], v[196:199], v[36:39]
    buffer_load_dwordx4 v[176:179], v243, s[16:19], s52 offen
    s_add_u32 s52, s52, 1024
    v_mfma_f32_16x16x32_bf16 v[68:71], v[212:215], v[200:203], v[68:71]
    v_mfma_f32_16x16x32_bf16 v[100:103], v[212:215], v[204:207], v[100:103]
    s_waitcnt lgkmcnt(4)
    v_mfma_f32_16x16x32_bf16 v[8:11], v[216:219], v[192:195], v[8:11]
    ds_read_b64_tr_b16 v[212:213], v234 offset:12416
    ds_read_b64_tr_b16 v[214:215], v234 offset:18560
    v_mfma_f32_16x16x32_bf16 v[40:43], v[216:219], v[196:199], v[40:43]
    v_mfma_f32_16x16x32_bf16 v[72:75], v[216:219], v[200:203], v[72:75]
    v_mfma_f32_16x16x32_bf16 v[104:107], v[216:219], v[204:207], v[104:107]
    s_waitcnt lgkmcnt(4)
    v_mfma_f32_16x16x32_bf16 v[12:15], v[220:223], v[192:195], v[12:15]
    ds_read_b64_tr_b16 v[216:217], v235 offset:128
    ds_read_b64_tr_b16 v[218:219], v235 offset:6272
    buffer_load_dwordx4 v[180:183], v243, s[16:19], s53 offen
    s_add_u32 s53, s53, 1024
    v_mfma_f32_16x16x32_bf16 v[44:47], v[220:223], v[196:199], v[44:47]
    v_mfma_f32_16x16x32_bf16 v[76:79], v[220:223], v[200:203], v[76:79]
    v_mfma_f32_16x16x32_bf16 v[108:111], v[220:223], v[204:207], v[108:111]
    s_waitcnt vmcnt(7)
    s_barrier
    v_add_u32 v236, 24576, v232
    v_add_u32 v237, 24576, v233
    v_add_u32 v238, 24576, v234
    v_add_u32 v239, 24576, v235
    s_waitcnt lgkmcnt(4)
    v_mfma_f32_16x16x32_bf16 v[16:19], v[208:211], v[192:195], v[16:19]
    ds_read_b64_tr_b16 v[220:221], v235 offset:12416
    ds_read_b64_tr_b16 v[222:223], v235 offset:18560
    v_mfma_f32_16x16x32_bf16 v[48:51], v[208:211], v[196:199], v[48:51]
    v_mfma_f32_16x16x32_bf16 v[80:83], v[208:211], v[200:203], v[80:83]
    v_mfma_f32_16x16x32_bf16 v[112:115], v[208:211], v[204:207], v[112:115]
    buffer_load_dwordx4 v[184:187], v243, s[16:19], s54 offen
    s_add_u32 s54, s54, 1024
    s_waitcnt lgkmcnt(4)
    v_mfma_f32_16x16x32_bf16 v[20:23], v[212:215], v[192:195], v[20:23]
    ds_read_b64_tr_b16 v[208:209], v236 offset:128
    ds_read_b64_tr_b16 v[210:211], v236 offset:6272
    v_mfma_f32_16x16x32_bf16 v[52:55], v[212:215], v[196:199], v[52:55]
    v_mfma_f32_16x16x32_bf16 v[84:87], v[212:215], v[200:203], v[84:87]
    v_mfma_f32_16x16x32_bf16 v[116:119], v[212:215], v[204:207], v[116:119]
    s_waitcnt lgkmcnt(4)
    v_mfma_f32_16x16x32_bf16 v[24:27], v[216:219], v[192:195], v[24:27]
    ds_read_b64_tr_b16 v[212:213], v236 offset:12416
    ds_read_b64_tr_b16 v[214:215], v236 offset:18560
    v_mfma_f32_16x16x32_bf16 v[56:59], v[216:219], v[196:199], v[56:59]
    v_mfma_f32_16x16x32_bf16 v[88:91], v[216:219], v[200:203], v[88:91]
    buffer_load_dwordx4 v[188:191], v243, s[16:19], s55 offen
    s_add_u32 s55, s55, 1024
    v_mfma_f32_16x16x32_bf16 v[120:123], v[216:219], v[204:207], v[120:123]
    s_waitcnt lgkmcnt(4)
    v_mfma_f32_16x16x32_bf16 v[28:31], v[220:223], v[192:195], v[28:31]
    ds_read_b64_tr_b16 v[216:217], v236 offset:24704
    ds_read_b64_tr_b16 v[218:219], v236 offset:30848
    v_mfma_f32_16x16x32_bf16 v[60:63], v[220:223], v[196:199], v[60:63]
    v_mfma_f32_16x16x32_bf16 v[92:95], v[220:223], v[200:203], v[92:95]
    v_mfma_f32_16x16x32_bf16 v[124:127], v[220:223], v[204:207], v[124:127]
    buffer_load_dwordx4 v[192:195], v243, s[16:19], s52 offen
    s_add_u32 s52, s52, 1024
    buffer_load_dwordx4 v[196:199], v243, s[16:19], s53 offen
    s_add_u32 s53, s53, 1024
    buffer_load_dwordx4 v[200:203], v243, s[16:19], s54 offen
    s_add_u32 s54, s54, 1024
    buffer_load_dwordx4 v[204:207], v243, s[16:19], s55 offen
    s_add_u32 s55, s55, 1024
    s_waitcnt vmcnt(8)
    s_mov_b32 s49, 0x3AE38E39
    v_add_f32 v224, v224, v226
    v_add_f32 v225, v225, v227
    v_add_f32 v228, v228, v230
    v_add_f32 v229, v229, v231
    v_mov_b32 v226, v224
    v_mov_b32 v227, v225
    v_mov_b32 v230, v228
    v_mov_b32 v231, v229
    v_permlane16_swap_b32 v224, v226
    v_permlane16_swap_b32 v225, v227
    v_permlane16_swap_b32 v228, v230
    v_permlane16_swap_b32 v229, v231
    s_nop 1
    v_add_f32 v224, v224, v226
    v_add_f32 v225, v225, v227
    v_add_f32 v228, v228, v230
    v_add_f32 v229, v229, v231
    v_mov_b32 v226, v224
    v_mov_b32 v227, v225
    v_mov_b32 v230, v228
    v_mov_b32 v231, v229
    v_permlane32_swap_b32 v224, v226
    v_permlane32_swap_b32 v225, v227
    v_permlane32_swap_b32 v228, v230
    v_permlane32_swap_b32 v229, v231
    s_nop 1
    v_add_f32 v224, v224, v226
    v_add_f32 v225, v225, v227
    v_add_f32 v228, v228, v230
    v_add_f32 v229, v229, v231
    v_mul_f32 v224, s49, v224
    v_mul_f32 v225, s49, v225
    v_fma_f32 v225, -v224, v224, v225
    v_max_f32 v225, 0, v225
    v_add_f32 v242, 0x3727c5ac, v225
    v_rsq_f32 v249, v242
    v_sub_f32 v248, 0, v224
    v_mul_f32 v249, 0xbfb8aa3b, v249
    v_mul_f32 v228, s49, v228
    v_mul_f32 v229, s49, v229
    v_fma_f32 v229, -v228, v228, v229
    v_max_f32 v229, 0, v229
    v_add_f32 v255, 0x3727c5ac, v229
    v_rsq_f32 v251, v255
    v_sub_f32 v250, 0, v228
    v_mul_f32 v251, 0xbfb8aa3b, v251
    v_add_u32 v232, 49152, v236
    v_add_u32 v233, 49152, v237
    v_add_u32 v234, 49152, v238
    v_add_u32 v235, 49152, v239
    s_mov_b32 s49, 0xbfb8aa3b
    s_lshr_b32 s56, s34, 1
    s_mul_i32 s56, s56, 9
    s_and_b32 s58, s34, 1
    s_lshl_b32 s59, s58, 2
    s_add_u32 s59, s59, s56
    s_lshl_b32 s59, s59, 10
    s_add_u32 s56, s56, 8
    s_lshl_b32 s56, s56, 10
    s_lshl_b32 s58, s58, 3
    s_add_u32 s56, s56, s58
    v_lshrrev_b32 v252, 8, v243
    v_lshlrev_b32 v252, 4, v252
    v_add_u32 v252, 147456, v252
    s_add_u32 s84, s35, 0
    s_mul_i32 s84, s84, 147456
    s_add_u32 s84, s84, 14680064
    s_add_u32 s85, s35, 1
    s_mul_i32 s85, s85, 147456
    s_add_u32 s85, s85, 14680064
    s_add_u32 s86, s35, 2
    s_mul_i32 s86, s86, 147456
    s_add_u32 s86, s86, 14680064
    s_add_u32 s87, s35, 3
    s_mul_i32 s87, s87, 147456
    s_add_u32 s87, s87, 14680064
    s_waitcnt lgkmcnt(4)
    v_mfma_f32_16x16x32_bf16 v[0:3], v[208:211], v[160:163], v[0:3]
    ds_read_b64_tr_b16 v[220:221], v236 offset:36992
    ds_read_b64_tr_b16 v[222:223], v236 offset:43136
    v_mfma_f32_16x16x32_bf16 v[32:35], v[208:211], v[164:167], v[32:35]
    v_mfma_f32_16x16x32_bf16 v[64:67], v[208:211], v[168:171], v[64:67]
    v_mfma_f32_16x16x32_bf16 v[96:99], v[208:211], v[172:175], v[96:99]
    s_waitcnt lgkmcnt(4)
    v_mfma_f32_16x16x32_bf16 v[4:7], v[212:215], v[160:163], v[4:7]
    ds_read_b64_tr_b16 v[208:209], v232 offset:128
    ds_read_b64_tr_b16 v[210:211], v232 offset:6272
    v_mfma_f32_16x16x32_bf16 v[36:39], v[212:215], v[164:167], v[36:39]
    v_mfma_f32_16x16x32_bf16 v[68:71], v[212:215], v[168:171], v[68:71]
    v_mfma_f32_16x16x32_bf16 v[100:103], v[212:215], v[172:175], v[100:103]
    s_waitcnt lgkmcnt(4)
    s_waitcnt vmcnt(7)
    v_mfma_f32_16x16x32_bf16 v[0:3], v[216:219], v[176:179], v[0:3]
    ds_read_b64_tr_b16 v[212:213], v232 offset:12416
    ds_read_b64_tr_b16 v[214:215], v232 offset:18560
    s_waitcnt vmcnt(6)
    v_mfma_f32_16x16x32_bf16 v[32:35], v[216:219], v[180:183], v[32:35]
    s_waitcnt vmcnt(5)
    v_mfma_f32_16x16x32_bf16 v[64:67], v[216:219], v[184:187], v[64:67]
    s_waitcnt vmcnt(4)
    v_mfma_f32_16x16x32_bf16 v[96:99], v[216:219], v[188:191], v[96:99]
    s_waitcnt lgkmcnt(4)
    v_mfma_f32_16x16x32_bf16 v[4:7], v[220:223], v[176:179], v[4:7]
    ds_read_b64_tr_b16 v[216:217], v237 offset:128
    ds_read_b64_tr_b16 v[218:219], v237 offset:6272
    v_mfma_f32_16x16x32_bf16 v[36:39], v[220:223], v[180:183], v[36:39]
    v_mfma_f32_16x16x32_bf16 v[68:71], v[220:223], v[184:187], v[68:71]
    v_mfma_f32_16x16x32_bf16 v[100:103], v[220:223], v[188:191], v[100:103]
    s_waitcnt lgkmcnt(4)
    s_waitcnt vmcnt(3)
    v_mfma_f32_16x16x32_bf16 v[0:3], v[208:211], v[192:195], v[0:3]
    ds_read_b64_tr_b16 v[220:221], v237 offset:12416
    ds_read_b64_tr_b16 v[222:223], v237 offset:18560
    s_waitcnt vmcnt(2)
    v_mfma_f32_16x16x32_bf16 v[32:35], v[208:211], v[196:199], v[32:35]
    s_waitcnt vmcnt(1)
    v_mfma_f32_16x16x32_bf16 v[64:67], v[208:211], v[200:203], v[64:67]
    s_waitcnt vmcnt(0)
    v_mfma_f32_16x16x32_bf16 v[96:99], v[208:211], v[204:207], v[96:99]
    s_waitcnt lgkmcnt(4)
    v_mfma_f32_16x16x32_bf16 v[4:7], v[212:215], v[192:195], v[4:7]
    ds_read_b64_tr_b16 v[208:209], v237 offset:24704
    ds_read_b64_tr_b16 v[210:211], v237 offset:30848
    v_mfma_f32_16x16x32_bf16 v[36:39], v[212:215], v[196:199], v[36:39]
    v_mfma_f32_16x16x32_bf16 v[68:71], v[212:215], v[200:203], v[68:71]
    v_mfma_f32_16x16x32_bf16 v[100:103], v[212:215], v[204:207], v[100:103]
    s_lshr_b32 s46, s2, 3
    s_lshl_b32 s46, s46, 3
    s_add_u32 s46, s46, s30
    s_mul_i32 s46, s46, 23
    v_lshrrev_b32 v254, 4, v243
    v_add_u32 v254, s46, v254
    v_min_u32 v254, 5759, v254
    s_mov_b32 s48, 0xCCCD
    v_mul_lo_u32 v253, v254, s48
    v_lshrrev_b32 v253, 18, v253
    v_lshlrev_b32 v254, 7, v254
    v_mul_u32_u24 v253, 512, v253
    v_add_u32 v254, v254, v253
    s_lshr_b32 s48, s31, 1
    s_mul_i32 s48, s48, 1327104
    s_and_b32 s46, s31, 1
    s_lshl_b32 s46, s46, 9
    s_add_u32 s48, s48, s46
    s_mov_b32 s24, s92
    s_mov_b32 s25, s93
    s_mov_b32 s26, 0x510000
    s_mov_b32 s27, 0x20000
    s_mov_b32 exec_hi, 0
    s_mov_b32 exec_lo, 0x7fffff
    buffer_load_dword v253, v254, s[24:27], s48 offen
    s_mov_b64 exec, -1
    s_waitcnt lgkmcnt(4)
    v_mfma_f32_16x16x32_bf16 v[8:11], v[216:219], v[160:163], v[8:11]
    ds_read_b64_tr_b16 v[212:213], v237 offset:36992
    ds_read_b64_tr_b16 v[214:215], v237 offset:43136
    ds_read_b128 v[224:227], v252 offset:256
    ds_read_b128 v[228:231], v252 offset:832
    s_waitcnt lgkmcnt(0)
    v_fmac_f32 v0, v244, v224
    v_fmac_f32 v1, v244, v225
    v_fmac_f32 v2, v244, v226
    v_mfma_f32_16x16x32_bf16 v[40:43], v[216:219], v[164:167], v[40:43]
    v_fmac_f32 v3, v244, v227
    v_fmac_f32 v4, v244, v228
    v_fmac_f32 v5, v244, v229
    v_fmac_f32 v6, v244, v230
    v_fmac_f32 v7, v244, v231
    v_mul_f32 v4, v0, v4
    v_mfma_f32_16x16x32_bf16 v[72:75], v[216:219], v[168:171], v[72:75]
    v_mul_f32 v5, v1, v5
    v_mul_f32 v6, v2, v6
    v_mul_f32 v7, v3, v7
    v_mul_f32 v0, v245, v0
    v_mul_f32 v1, v245, v1
    v_mul_f32 v2, v245, v2
    v_mfma_f32_16x16x32_bf16 v[104:107], v[216:219], v[172:175], v[104:107]
    v_mul_f32 v3, v245, v3
    v_exp_f32 v0, v0
    v_exp_f32 v1, v1
    v_exp_f32 v2, v2
    v_exp_f32 v3, v3
    v_fma_f32 v0, v0, v240, v240
    v_mfma_f32_16x16x32_bf16 v[12:15], v[220:223], v[160:163], v[12:15]
    ds_read_b64_tr_b16 v[216:217], v233 offset:128
    ds_read_b64_tr_b16 v[218:219], v233 offset:6272
    v_fma_f32 v1, v1, v240, v240
    v_fma_f32 v2, v2, v240, v240
    v_fma_f32 v3, v3, v240, v240
    v_rcp_f32 v0, v0
    v_rcp_f32 v1, v1
    v_mfma_f32_16x16x32_bf16 v[44:47], v[220:223], v[164:167], v[44:47]
    v_rcp_f32 v2, v2
    v_rcp_f32 v3, v3
    v_mul_f32 v4, v4, v0
    v_mul_f32 v5, v5, v1
    v_mul_f32 v6, v6, v2
    v_mul_f32 v7, v7, v3
    v_mfma_f32_16x16x32_bf16 v[76:79], v[220:223], v[168:171], v[76:79]
    v_cvt_pk_bf16_f32 v0, v4, v5
    v_cvt_pk_bf16_f32 v1, v6, v7
    v_fmac_f32 v32, v246, v224
    v_fmac_f32 v33, v246, v225
    v_fmac_f32 v34, v246, v226
    v_fmac_f32 v35, v246, v227
    v_mfma_f32_16x16x32_bf16 v[108:111], v[220:223], v[172:175], v[108:111]
    v_fmac_f32 v36, v246, v228
    v_fmac_f32 v37, v246, v229
    v_fmac_f32 v38, v246, v230
    v_fmac_f32 v39, v246, v231
    v_mul_f32 v36, v32, v36
    v_mul_f32 v37, v33, v37
    v_mfma_f32_16x16x32_bf16 v[8:11], v[208:211], v[176:179], v[8:11]
    ds_read_b64_tr_b16 v[220:221], v233 offset:12416
    ds_read_b64_tr_b16 v[222:223], v233 offset:18560
    v_mul_f32 v38, v34, v38
    v_mul_f32 v39, v35, v39
    v_mul_f32 v32, v247, v32
    v_mul_f32 v33, v247, v33
    v_mul_f32 v34, v247, v34
    v_mfma_f32_16x16x32_bf16 v[40:43], v[208:211], v[180:183], v[40:43]
    v_mul_f32 v35, v247, v35
    v_exp_f32 v32, v32
    v_exp_f32 v33, v33
    v_exp_f32 v34, v34
    v_exp_f32 v35, v35
    v_fma_f32 v32, v32, v241, v241
    v_mfma_f32_16x16x32_bf16 v[72:75], v[208:211], v[184:187], v[72:75]
    v_fma_f32 v33, v33, v241, v241
    v_fma_f32 v34, v34, v241, v241
    v_fma_f32 v35, v35, v241, v241
    v_rcp_f32 v32, v32
    v_rcp_f32 v33, v33
    v_rcp_f32 v34, v34
    v_mfma_f32_16x16x32_bf16 v[104:107], v[208:211], v[188:191], v[104:107]
    v_rcp_f32 v35, v35
    v_mul_f32 v36, v36, v32
    v_mul_f32 v37, v37, v33
    v_mul_f32 v38, v38, v34
    v_mul_f32 v39, v39, v35
    v_cvt_pk_bf16_f32 v32, v36, v37
    v_mfma_f32_16x16x32_bf16 v[12:15], v[212:215], v[176:179], v[12:15]
    ds_read_b64_tr_b16 v[208:209], v238 offset:128
    ds_read_b64_tr_b16 v[210:211], v238 offset:6272
    v_cvt_pk_bf16_f32 v33, v38, v39
    v_fmac_f32 v64, v248, v224
    v_fmac_f32 v65, v248, v225
    v_fmac_f32 v66, v248, v226
    v_fmac_f32 v67, v248, v227
    v_mfma_f32_16x16x32_bf16 v[44:47], v[212:215], v[180:183], v[44:47]
    v_fmac_f32 v68, v248, v228
    v_fmac_f32 v69, v248, v229
    v_fmac_f32 v70, v248, v230
    v_fmac_f32 v71, v248, v231
    v_mul_f32 v68, v64, v68
    v_mul_f32 v69, v65, v69
    v_mfma_f32_16x16x32_bf16 v[76:79], v[212:215], v[184:187], v[76:79]
    v_mul_f32 v70, v66, v70
    v_mul_f32 v71, v67, v71
    v_mul_f32 v64, v249, v64
    v_mul_f32 v65, v249, v65
    v_mul_f32 v66, v249, v66
    v_mul_f32 v67, v249, v67
    v_mfma_f32_16x16x32_bf16 v[108:111], v[212:215], v[188:191], v[108:111]
    v_exp_f32 v64, v64
    v_exp_f32 v65, v65
    v_exp_f32 v66, v66
    v_exp_f32 v67, v67
    v_fma_f32 v64, v64, v242, v242
    v_fma_f32 v65, v65, v242, v242
    s_waitcnt lgkmcnt(4)
    v_mfma_f32_16x16x32_bf16 v[8:11], v[216:219], v[192:195], v[8:11]
    ds_read_b64_tr_b16 v[212:213], v238 offset:12416
    ds_read_b64_tr_b16 v[214:215], v238 offset:18560
    v_fma_f32 v66, v66, v242, v242
    v_fma_f32 v67, v67, v242, v242
    v_rcp_f32 v64, v64
    v_rcp_f32 v65, v65
    v_rcp_f32 v66, v66
    v_mfma_f32_16x16x32_bf16 v[40:43], v[216:219], v[196:199], v[40:43]
    v_rcp_f32 v67, v67
    v_mul_f32 v68, v68, v64
    v_mul_f32 v69, v69, v65
    v_mul_f32 v70, v70, v66
    v_mul_f32 v71, v71, v67
    v_cvt_pk_bf16_f32 v64, v68, v69
    v_mfma_f32_16x16x32_bf16 v[72:75], v[216:219], v[200:203], v[72:75]
    v_cvt_pk_bf16_f32 v65, v70, v71
    v_fmac_f32 v96, v250, v224
    v_fmac_f32 v97, v250, v225
    v_fmac_f32 v98, v250, v226
    v_fmac_f32 v99, v250, v227
    v_fmac_f32 v100, v250, v228
    v_mfma_f32_16x16x32_bf16 v[104:107], v[216:219], v[204:207], v[104:107]
    v_fmac_f32 v101, v250, v229
    v_fmac_f32 v102, v250, v230
    v_fmac_f32 v103, v250, v231
    v_mul_f32 v100, v96, v100
    v_mul_f32 v101, v97, v101
    v_mul_f32 v102, v98, v102
    s_waitcnt lgkmcnt(4)
    v_mfma_f32_16x16x32_bf16 v[12:15], v[220:223], v[192:195], v[12:15]
    ds_read_b64_tr_b16 v[216:217], v238 offset:24704
    ds_read_b64_tr_b16 v[218:219], v238 offset:30848
    v_mul_f32 v103, v99, v103
    v_mul_f32 v96, v251, v96
    v_mul_f32 v97, v251, v97
    v_mul_f32 v98, v251, v98
    v_mul_f32 v99, v251, v99
    v_mfma_f32_16x16x32_bf16 v[44:47], v[220:223], v[196:199], v[44:47]
    v_exp_f32 v96, v96
    v_exp_f32 v97, v97
    v_exp_f32 v98, v98
    v_exp_f32 v99, v99
    v_fma_f32 v96, v96, v255, v255
    v_fma_f32 v97, v97, v255, v255
    v_mfma_f32_16x16x32_bf16 v[76:79], v[220:223], v[200:203], v[76:79]
    v_fma_f32 v98, v98, v255, v255
    v_fma_f32 v99, v99, v255, v255
    v_rcp_f32 v96, v96
    v_rcp_f32 v97, v97
    v_rcp_f32 v98, v98
    v_rcp_f32 v99, v99
    v_mfma_f32_16x16x32_bf16 v[108:111], v[220:223], v[204:207], v[108:111]
    v_mul_f32 v100, v100, v96
    v_mul_f32 v101, v101, v97
    v_mul_f32 v102, v102, v98
    v_mul_f32 v103, v103, v99
    v_cvt_pk_bf16_f32 v96, v100, v101
    v_cvt_pk_bf16_f32 v97, v102, v103
    s_waitcnt lgkmcnt(4)
    v_mfma_f32_16x16x32_bf16 v[16:19], v[208:211], v[160:163], v[16:19]
    ds_read_b64_tr_b16 v[220:221], v238 offset:36992
    ds_read_b64_tr_b16 v[222:223], v238 offset:43136
    ds_read_b128 v[224:227], v252 offset:320
    ds_read_b128 v[228:231], v252 offset:896
    s_waitcnt lgkmcnt(0)
    v_fmac_f32 v8, v244, v224
    v_fmac_f32 v9, v244, v225
    v_fmac_f32 v10, v244, v226
    v_fmac_f32 v11, v244, v227
    v_mfma_f32_16x16x32_bf16 v[48:51], v[208:211], v[164:167], v[48:51]
    v_fmac_f32 v12, v244, v228
    v_fmac_f32 v13, v244, v229
    v_fmac_f32 v14, v244, v230
    v_fmac_f32 v15, v244, v231
    v_mul_f32 v12, v8, v12
    v_mul_f32 v13, v9, v13
    v_mfma_f32_16x16x32_bf16 v[80:83], v[208:211], v[168:171], v[80:83]
    v_mul_f32 v14, v10, v14
    v_mul_f32 v15, v11, v15
    v_mul_f32 v8, v245, v8
    v_mul_f32 v9, v245, v9
    v_mul_f32 v10, v245, v10
    v_mul_f32 v11, v245, v11
    v_mfma_f32_16x16x32_bf16 v[112:115], v[208:211], v[172:175], v[112:115]
    v_exp_f32 v8, v8
    v_exp_f32 v9, v9
    v_exp_f32 v10, v10
    v_exp_f32 v11, v11
    v_fma_f32 v8, v8, v240, v240
    v_fma_f32 v9, v9, v240, v240
    v_mfma_f32_16x16x32_bf16 v[20:23], v[212:215], v[160:163], v[20:23]
    ds_read_b64_tr_b16 v[208:209], v234 offset:128
    ds_read_b64_tr_b16 v[210:211], v234 offset:6272
    v_fma_f32 v10, v10, v240, v240
    v_fma_f32 v11, v11, v240, v240
    v_rcp_f32 v8, v8
    v_rcp_f32 v9, v9
    v_rcp_f32 v10, v10
    v_rcp_f32 v11, v11
    v_mfma_f32_16x16x32_bf16 v[52:55], v[212:215], v[164:167], v[52:55]
    v_mul_f32 v12, v12, v8
    v_mul_f32 v13, v13, v9
    v_mul_f32 v14, v14, v10
    v_mul_f32 v15, v15, v11
    v_cvt_pk_bf16_f32 v2, v12, v13
    v_cvt_pk_bf16_f32 v3, v14, v15
    v_mfma_f32_16x16x32_bf16 v[84:87], v[212:215], v[168:171], v[84:87]
    s_add_u32 s57, s59, s84
    buffer_store_dwordx4 v[0:3], v243, s[16:19], s57 offen offset:2048 sc1
    v_fmac_f32 v40, v246, v224
    v_fmac_f32 v41, v246, v225
    v_fmac_f32 v42, v246, v226
    v_fmac_f32 v43, v246, v227
    v_mfma_f32_16x16x32_bf16 v[116:119], v[212:215], v[172:175], v[116:119]
    v_fmac_f32 v44, v246, v228
    v_fmac_f32 v45, v246, v229
    v_fmac_f32 v46, v246, v230
    v_fmac_f32 v47, v246, v231
    v_mul_f32 v44, v40, v44
    v_mul_f32 v45, v41, v45
    v_mfma_f32_16x16x32_bf16 v[16:19], v[216:219], v[176:179], v[16:19]
    ds_read_b64_tr_b16 v[212:213], v234 offset:12416
    ds_read_b64_tr_b16 v[214:215], v234 offset:18560
    v_mul_f32 v46, v42, v46
    v_mul_f32 v47, v43, v47
    v_mul_f32 v40, v247, v40
    v_mul_f32 v41, v247, v41
    v_mul_f32 v42, v247, v42
    v_mul_f32 v43, v247, v43
    v_mfma_f32_16x16x32_bf16 v[48:51], v[216:219], v[180:183], v[48:51]
    v_exp_f32 v40, v40
    v_exp_f32 v41, v41
    v_exp_f32 v42, v42
    v_exp_f32 v43, v43
    v_fma_f32 v40, v40, v241, v241
    v_fma_f32 v41, v41, v241, v241
    v_mfma_f32_16x16x32_bf16 v[80:83], v[216:219], v[184:187], v[80:83]
    v_fma_f32 v42, v42, v241, v241
    v_fma_f32 v43, v43, v241, v241
    v_rcp_f32 v40, v40
    v_rcp_f32 v41, v41
    v_rcp_f32 v42, v42
    v_rcp_f32 v43, v43
    v_mfma_f32_16x16x32_bf16 v[112:115], v[216:219], v[188:191], v[112:115]
    v_mul_f32 v44, v44, v40
    v_mul_f32 v45, v45, v41
    v_mul_f32 v46, v46, v42
    v_mul_f32 v47, v47, v43
    v_cvt_pk_bf16_f32 v34, v44, v45
    v_cvt_pk_bf16_f32 v35, v46, v47
    s_add_u32 s57, s59, s85
    v_mfma_f32_16x16x32_bf16 v[20:23], v[220:223], v[176:179], v[20:23]
    ds_read_b64_tr_b16 v[216:217], v239 offset:128
    ds_read_b64_tr_b16 v[218:219], v239 offset:6272
    buffer_store_dwordx4 v[32:35], v243, s[16:19], s57 offen offset:2048 sc1
    v_fmac_f32 v72, v248, v224
    v_fmac_f32 v73, v248, v225
    v_fmac_f32 v74, v248, v226
    v_fmac_f32 v75, v248, v227
    v_fmac_f32 v76, v248, v228
    v_mfma_f32_16x16x32_bf16 v[52:55], v[220:223], v[180:183], v[52:55]
    v_fmac_f32 v77, v248, v229
    v_fmac_f32 v78, v248, v230
    v_fmac_f32 v79, v248, v231
    v_mul_f32 v76, v72, v76
    v_mul_f32 v77, v73, v77
    v_mul_f32 v78, v74, v78
    v_mfma_f32_16x16x32_bf16 v[84:87], v[220:223], v[184:187], v[84:87]
    v_mul_f32 v79, v75, v79
    v_mul_f32 v72, v249, v72
    v_mul_f32 v73, v249, v73
    v_mul_f32 v74, v249, v74
    v_mul_f32 v75, v249, v75
    v_exp_f32 v72, v72
    v_mfma_f32_16x16x32_bf16 v[116:119], v[220:223], v[188:191], v[116:119]
    v_exp_f32 v73, v73
    v_exp_f32 v74, v74
    v_exp_f32 v75, v75
    v_fma_f32 v72, v72, v242, v242
    v_fma_f32 v73, v73, v242, v242
    v_fma_f32 v74, v74, v242, v242
    s_waitcnt lgkmcnt(4)
    v_mfma_f32_16x16x32_bf16 v[16:19], v[208:211], v[192:195], v[16:19]
    ds_read_b64_tr_b16 v[220:221], v239 offset:12416
    ds_read_b64_tr_b16 v[222:223], v239 offset:18560
    v_fma_f32 v75, v75, v242, v242
    v_rcp_f32 v72, v72
    v_rcp_f32 v73, v73
    v_rcp_f32 v74, v74
    v_rcp_f32 v75, v75
    v_mul_f32 v76, v76, v72
    v_mfma_f32_16x16x32_bf16 v[48:51], v[208:211], v[196:199], v[48:51]
    v_mul_f32 v77, v77, v73
    v_mul_f32 v78, v78, v74
    v_mul_f32 v79, v79, v75
    v_cvt_pk_bf16_f32 v66, v76, v77
    v_cvt_pk_bf16_f32 v67, v78, v79
    s_add_u32 s57, s59, s86
    v_mfma_f32_16x16x32_bf16 v[80:83], v[208:211], v[200:203], v[80:83]
    buffer_store_dwordx4 v[64:67], v243, s[16:19], s57 offen offset:2048 sc1
    v_fmac_f32 v104, v250, v224
    v_fmac_f32 v105, v250, v225
    v_fmac_f32 v106, v250, v226
    v_fmac_f32 v107, v250, v227
    v_fmac_f32 v108, v250, v228
    v_mfma_f32_16x16x32_bf16 v[112:115], v[208:211], v[204:207], v[112:115]
    v_fmac_f32 v109, v250, v229
    v_fmac_f32 v110, v250, v230
    v_fmac_f32 v111, v250, v231
    v_mul_f32 v108, v104, v108
    v_mul_f32 v109, v105, v109
    v_mul_f32 v110, v106, v110
    s_waitcnt lgkmcnt(4)
    v_mfma_f32_16x16x32_bf16 v[20:23], v[212:215], v[192:195], v[20:23]
    ds_read_b64_tr_b16 v[208:209], v239 offset:24704
    ds_read_b64_tr_b16 v[210:211], v239 offset:30848
    v_mul_f32 v111, v107, v111
    v_mul_f32 v104, v251, v104
    v_mul_f32 v105, v251, v105
    v_mul_f32 v106, v251, v106
    v_mul_f32 v107, v251, v107
    v_exp_f32 v104, v104
    v_mfma_f32_16x16x32_bf16 v[52:55], v[212:215], v[196:199], v[52:55]
    v_exp_f32 v105, v105
    v_exp_f32 v106, v106
    v_exp_f32 v107, v107
    v_fma_f32 v104, v104, v255, v255
    v_fma_f32 v105, v105, v255, v255
    v_fma_f32 v106, v106, v255, v255
    v_mfma_f32_16x16x32_bf16 v[84:87], v[212:215], v[200:203], v[84:87]
    v_fma_f32 v107, v107, v255, v255
    v_rcp_f32 v104, v104
    v_rcp_f32 v105, v105
    v_rcp_f32 v106, v106
    v_rcp_f32 v107, v107
    v_mul_f32 v108, v108, v104
    v_mfma_f32_16x16x32_bf16 v[116:119], v[212:215], v[204:207], v[116:119]
    v_mul_f32 v109, v109, v105
    v_mul_f32 v110, v110, v106
    v_mul_f32 v111, v111, v107
    v_cvt_pk_bf16_f32 v98, v108, v109
    v_cvt_pk_bf16_f32 v99, v110, v111
    s_add_u32 s57, s59, s87
    buffer_store_dwordx4 v[96:99], v243, s[16:19], s57 offen offset:2048 sc1
    s_waitcnt lgkmcnt(4)
    v_mfma_f32_16x16x32_bf16 v[24:27], v[216:219], v[160:163], v[24:27]
    ds_read_b64_tr_b16 v[212:213], v239 offset:36992
    ds_read_b64_tr_b16 v[214:215], v239 offset:43136
    ds_read_b128 v[224:227], v252 offset:384
    ds_read_b128 v[228:231], v252 offset:960
    s_waitcnt lgkmcnt(0)
    v_fmac_f32 v16, v244, v224
    v_fmac_f32 v17, v244, v225
    v_fmac_f32 v18, v244, v226
    v_mfma_f32_16x16x32_bf16 v[56:59], v[216:219], v[164:167], v[56:59]
    v_fmac_f32 v19, v244, v227
    v_fmac_f32 v20, v244, v228
    v_fmac_f32 v21, v244, v229
    v_fmac_f32 v22, v244, v230
    v_fmac_f32 v23, v244, v231
    v_mul_f32 v20, v16, v20
    v_mfma_f32_16x16x32_bf16 v[88:91], v[216:219], v[168:171], v[88:91]
    v_mul_f32 v21, v17, v21
    v_mul_f32 v22, v18, v22
    v_mul_f32 v23, v19, v23
    v_mul_f32 v16, v245, v16
    v_mul_f32 v17, v245, v17
    v_mul_f32 v18, v245, v18
    v_mfma_f32_16x16x32_bf16 v[120:123], v[216:219], v[172:175], v[120:123]
    v_mul_f32 v19, v245, v19
    v_exp_f32 v16, v16
    v_exp_f32 v17, v17
    v_exp_f32 v18, v18
    v_exp_f32 v19, v19
    v_fma_f32 v16, v16, v240, v240
    v_mfma_f32_16x16x32_bf16 v[28:31], v[220:223], v[160:163], v[28:31]
    ds_read_b64_tr_b16 v[216:217], v235 offset:128
    ds_read_b64_tr_b16 v[218:219], v235 offset:6272
    v_fma_f32 v17, v17, v240, v240
    v_fma_f32 v18, v18, v240, v240
    v_fma_f32 v19, v19, v240, v240
    v_rcp_f32 v16, v16
    v_rcp_f32 v17, v17
    v_mfma_f32_16x16x32_bf16 v[60:63], v[220:223], v[164:167], v[60:63]
    v_rcp_f32 v18, v18
    v_rcp_f32 v19, v19
    v_mul_f32 v20, v20, v16
    v_mul_f32 v21, v21, v17
    v_mul_f32 v22, v22, v18
    v_mul_f32 v23, v23, v19
    v_mfma_f32_16x16x32_bf16 v[92:95], v[220:223], v[168:171], v[92:95]
    v_cvt_pk_bf16_f32 v16, v20, v21
    v_cvt_pk_bf16_f32 v17, v22, v23
    v_fmac_f32 v48, v246, v224
    v_fmac_f32 v49, v246, v225
    v_fmac_f32 v50, v246, v226
    v_fmac_f32 v51, v246, v227
    v_mfma_f32_16x16x32_bf16 v[124:127], v[220:223], v[172:175], v[124:127]
    v_fmac_f32 v52, v246, v228
    v_fmac_f32 v53, v246, v229
    v_fmac_f32 v54, v246, v230
    v_fmac_f32 v55, v246, v231
    v_mul_f32 v52, v48, v52
    v_mul_f32 v53, v49, v53
    v_mfma_f32_16x16x32_bf16 v[24:27], v[208:211], v[176:179], v[24:27]
    ds_read_b64_tr_b16 v[220:221], v235 offset:12416
    ds_read_b64_tr_b16 v[222:223], v235 offset:18560
    v_mul_f32 v54, v50, v54
    v_mul_f32 v55, v51, v55
    v_mul_f32 v48, v247, v48
    v_mul_f32 v49, v247, v49
    v_mul_f32 v50, v247, v50
    v_mfma_f32_16x16x32_bf16 v[56:59], v[208:211], v[180:183], v[56:59]
    v_mul_f32 v51, v247, v51
    v_exp_f32 v48, v48
    v_exp_f32 v49, v49
    v_exp_f32 v50, v50
    v_exp_f32 v51, v51
    v_fma_f32 v48, v48, v241, v241
    v_mfma_f32_16x16x32_bf16 v[88:91], v[208:211], v[184:187], v[88:91]
    v_fma_f32 v49, v49, v241, v241
    v_fma_f32 v50, v50, v241, v241
    v_fma_f32 v51, v51, v241, v241
    v_rcp_f32 v48, v48
    v_rcp_f32 v49, v49
    v_rcp_f32 v50, v50
    v_mfma_f32_16x16x32_bf16 v[120:123], v[208:211], v[188:191], v[120:123]
    v_rcp_f32 v51, v51
    v_mul_f32 v52, v52, v48
    v_mul_f32 v53, v53, v49
    v_mul_f32 v54, v54, v50
    v_mul_f32 v55, v55, v51
    v_cvt_pk_bf16_f32 v48, v52, v53
    v_mfma_f32_16x16x32_bf16 v[28:31], v[212:215], v[176:179], v[28:31]
    v_cvt_pk_bf16_f32 v49, v54, v55
    v_fmac_f32 v80, v248, v224
    v_fmac_f32 v81, v248, v225
    v_fmac_f32 v82, v248, v226
    v_fmac_f32 v83, v248, v227
    v_mfma_f32_16x16x32_bf16 v[60:63], v[212:215], v[180:183], v[60:63]
    v_fmac_f32 v84, v248, v228
    v_fmac_f32 v85, v248, v229
    v_fmac_f32 v86, v248, v230
    v_fmac_f32 v87, v248, v231
    v_mul_f32 v84, v80, v84
    v_mul_f32 v85, v81, v85
    v_mfma_f32_16x16x32_bf16 v[92:95], v[212:215], v[184:187], v[92:95]
    v_mul_f32 v86, v82, v86
    v_mul_f32 v87, v83, v87
    v_mul_f32 v80, v249, v80
    v_mul_f32 v81, v249, v81
    v_mul_f32 v82, v249, v82
    v_mul_f32 v83, v249, v83
    v_mfma_f32_16x16x32_bf16 v[124:127], v[212:215], v[188:191], v[124:127]
    v_exp_f32 v80, v80
    v_exp_f32 v81, v81
    v_exp_f32 v82, v82
    v_exp_f32 v83, v83
    v_fma_f32 v80, v80, v242, v242
    v_fma_f32 v81, v81, v242, v242
    s_waitcnt lgkmcnt(2)
    v_mfma_f32_16x16x32_bf16 v[24:27], v[216:219], v[192:195], v[24:27]
    v_fma_f32 v82, v82, v242, v242
    v_fma_f32 v83, v83, v242, v242
    v_rcp_f32 v80, v80
    v_rcp_f32 v81, v81
    v_rcp_f32 v82, v82
    v_mfma_f32_16x16x32_bf16 v[56:59], v[216:219], v[196:199], v[56:59]
    v_rcp_f32 v83, v83
    v_mul_f32 v84, v84, v80
    v_mul_f32 v85, v85, v81
    v_mul_f32 v86, v86, v82
    v_mul_f32 v87, v87, v83
    v_cvt_pk_bf16_f32 v80, v84, v85
    v_mfma_f32_16x16x32_bf16 v[88:91], v[216:219], v[200:203], v[88:91]
    v_cvt_pk_bf16_f32 v81, v86, v87
    v_fmac_f32 v112, v250, v224
    v_fmac_f32 v113, v250, v225
    v_fmac_f32 v114, v250, v226
    v_fmac_f32 v115, v250, v227
    v_fmac_f32 v116, v250, v228
    v_mfma_f32_16x16x32_bf16 v[120:123], v[216:219], v[204:207], v[120:123]
    v_fmac_f32 v117, v250, v229
    v_fmac_f32 v118, v250, v230
    v_fmac_f32 v119, v250, v231
    v_mul_f32 v116, v112, v116
    v_mul_f32 v117, v113, v117
    v_mul_f32 v118, v114, v118
    s_waitcnt lgkmcnt(0)
    v_mfma_f32_16x16x32_bf16 v[28:31], v[220:223], v[192:195], v[28:31]
    v_mul_f32 v119, v115, v119
    v_mul_f32 v112, v251, v112
    v_mul_f32 v113, v251, v113
    v_mul_f32 v114, v251, v114
    v_mul_f32 v115, v251, v115
    v_mfma_f32_16x16x32_bf16 v[60:63], v[220:223], v[196:199], v[60:63]
    v_exp_f32 v112, v112
    v_exp_f32 v113, v113
    v_exp_f32 v114, v114
    v_exp_f32 v115, v115
    v_fma_f32 v112, v112, v255, v255
    v_fma_f32 v113, v113, v255, v255
    v_mfma_f32_16x16x32_bf16 v[92:95], v[220:223], v[200:203], v[92:95]
    v_fma_f32 v114, v114, v255, v255
    v_fma_f32 v115, v115, v255, v255
    v_rcp_f32 v112, v112
    v_rcp_f32 v113, v113
    v_rcp_f32 v114, v114
    v_rcp_f32 v115, v115
    v_mfma_f32_16x16x32_bf16 v[124:127], v[220:223], v[204:207], v[124:127]
    v_mul_f32 v116, v116, v112
    v_mul_f32 v117, v117, v113
    v_mul_f32 v118, v118, v114
    v_mul_f32 v119, v119, v115
    v_cvt_pk_bf16_f32 v112, v116, v117
    v_cvt_pk_bf16_f32 v113, v118, v119
    ds_read_b128 v[224:227], v252 offset:448
    ds_read_b128 v[228:231], v252 offset:1024
    s_waitcnt lgkmcnt(0)
    v_fmac_f32 v24, v244, v224
    v_fmac_f32 v25, v244, v225
    v_fmac_f32 v26, v244, v226
    v_fmac_f32 v27, v244, v227
    v_fmac_f32 v28, v244, v228
    v_fmac_f32 v29, v244, v229
    v_fmac_f32 v30, v244, v230
    v_fmac_f32 v31, v244, v231
    v_mul_f32 v28, v24, v28
    v_mul_f32 v29, v25, v29
    v_mul_f32 v30, v26, v30
    v_mul_f32 v31, v27, v31
    v_mul_f32 v24, v245, v24
    v_mul_f32 v25, v245, v25
    v_mul_f32 v26, v245, v26
    v_mul_f32 v27, v245, v27
    v_exp_f32 v24, v24
    v_exp_f32 v25, v25
    v_exp_f32 v26, v26
    v_exp_f32 v27, v27
    v_fma_f32 v24, v24, v240, v240
    v_fma_f32 v25, v25, v240, v240
    v_fma_f32 v26, v26, v240, v240
    v_fma_f32 v27, v27, v240, v240
    v_rcp_f32 v24, v24
    v_rcp_f32 v25, v25
    v_rcp_f32 v26, v26
    v_rcp_f32 v27, v27
    v_mul_f32 v28, v28, v24
    v_mul_f32 v29, v29, v25
    v_mul_f32 v30, v30, v26
    v_mul_f32 v31, v31, v27
    v_cvt_pk_bf16_f32 v18, v28, v29
    v_cvt_pk_bf16_f32 v19, v30, v31
    s_add_u32 s57, s59, s84
    buffer_store_dwordx4 v[16:19], v243, s[16:19], s57 offen offset:3072 sc1
    v_fmac_f32 v56, v246, v224
    v_fmac_f32 v57, v246, v225
    v_fmac_f32 v58, v246, v226
    v_fmac_f32 v59, v246, v227
    v_fmac_f32 v60, v246, v228
    v_fmac_f32 v61, v246, v229
    v_fmac_f32 v62, v246, v230
    v_fmac_f32 v63, v246, v231
    v_mul_f32 v60, v56, v60
    v_mul_f32 v61, v57, v61
    v_mul_f32 v62, v58, v62
    v_mul_f32 v63, v59, v63
    v_mul_f32 v56, v247, v56
    v_mul_f32 v57, v247, v57
    v_mul_f32 v58, v247, v58
    v_mul_f32 v59, v247, v59
    v_exp_f32 v56, v56
    v_exp_f32 v57, v57
    v_exp_f32 v58, v58
    v_exp_f32 v59, v59
    v_fma_f32 v56, v56, v241, v241
    v_fma_f32 v57, v57, v241, v241
    v_fma_f32 v58, v58, v241, v241
    v_fma_f32 v59, v59, v241, v241
    v_rcp_f32 v56, v56
    v_rcp_f32 v57, v57
    v_rcp_f32 v58, v58
    v_rcp_f32 v59, v59
    v_mul_f32 v60, v60, v56
    v_mul_f32 v61, v61, v57
    v_mul_f32 v62, v62, v58
    v_mul_f32 v63, v63, v59
    v_cvt_pk_bf16_f32 v50, v60, v61
    v_cvt_pk_bf16_f32 v51, v62, v63
    s_add_u32 s57, s59, s85
    buffer_store_dwordx4 v[48:51], v243, s[16:19], s57 offen offset:3072 sc1
    v_fmac_f32 v88, v248, v224
    v_fmac_f32 v89, v248, v225
    v_fmac_f32 v90, v248, v226
    v_fmac_f32 v91, v248, v227
    v_fmac_f32 v92, v248, v228
    v_fmac_f32 v93, v248, v229
    v_fmac_f32 v94, v248, v230
    v_fmac_f32 v95, v248, v231
    v_mul_f32 v92, v88, v92
    v_mul_f32 v93, v89, v93
    v_mul_f32 v94, v90, v94
    v_mul_f32 v95, v91, v95
    v_mul_f32 v88, v249, v88
    v_mul_f32 v89, v249, v89
    v_mul_f32 v90, v249, v90
    v_mul_f32 v91, v249, v91
    v_exp_f32 v88, v88
    v_exp_f32 v89, v89
    v_exp_f32 v90, v90
    v_exp_f32 v91, v91
    v_fma_f32 v88, v88, v242, v242
    v_fma_f32 v89, v89, v242, v242
    v_fma_f32 v90, v90, v242, v242
    v_fma_f32 v91, v91, v242, v242
    v_rcp_f32 v88, v88
    v_rcp_f32 v89, v89
    v_rcp_f32 v90, v90
    v_rcp_f32 v91, v91
    v_mul_f32 v92, v92, v88
    v_mul_f32 v93, v93, v89
    v_mul_f32 v94, v94, v90
    v_mul_f32 v95, v95, v91
    v_cvt_pk_bf16_f32 v82, v92, v93
    v_cvt_pk_bf16_f32 v83, v94, v95
    s_add_u32 s57, s59, s86
    buffer_store_dwordx4 v[80:83], v243, s[16:19], s57 offen offset:3072 sc1
    v_fmac_f32 v120, v250, v224
    v_fmac_f32 v121, v250, v225
    v_fmac_f32 v122, v250, v226
    v_fmac_f32 v123, v250, v227
    v_fmac_f32 v124, v250, v228
    v_fmac_f32 v125, v250, v229
    v_fmac_f32 v126, v250, v230
    v_fmac_f32 v127, v250, v231
    v_mul_f32 v124, v120, v124
    v_mul_f32 v125, v121, v125
    v_mul_f32 v126, v122, v126
    v_mul_f32 v127, v123, v127
    v_mul_f32 v120, v251, v120
    v_mul_f32 v121, v251, v121
    v_mul_f32 v122, v251, v122
    v_mul_f32 v123, v251, v123
    v_exp_f32 v120, v120
    v_exp_f32 v121, v121
    v_exp_f32 v122, v122
    v_exp_f32 v123, v123
    v_fma_f32 v120, v120, v255, v255
    v_fma_f32 v121, v121, v255, v255
    v_fma_f32 v122, v122, v255, v255
    v_fma_f32 v123, v123, v255, v255
    v_rcp_f32 v120, v120
    v_rcp_f32 v121, v121
    v_rcp_f32 v122, v122
    v_rcp_f32 v123, v123
    v_mul_f32 v124, v124, v120
    v_mul_f32 v125, v125, v121
    v_mul_f32 v126, v126, v122
    v_mul_f32 v127, v127, v123
    v_cvt_pk_bf16_f32 v114, v124, v125
    v_cvt_pk_bf16_f32 v115, v126, v127
    s_add_u32 s57, s59, s87
    buffer_store_dwordx4 v[112:115], v243, s[16:19], s57 offen offset:3072 sc1
Lk3_kernel_end:
    s_endpgm

.globl k4_kernel
.p2align 8
.type k4_kernel,@function
k4_kernel:

    s_cmp_ge_u32 s2, 256
    s_cbranch_scc1 Lk4_kernel_end
    s_load_dwordx2 s[4:5], s[0:1], 48
    s_load_dwordx4 s[20:23], s[0:1], 56
    s_load_dwordx2 s[24:25], s[0:1], 72
    v_lshrrev_b32 v209, 6, v0
    s_nop 0
    v_readfirstlane_b32 s30, v209
    v_and_b32 v208, 63, v0
    s_and_b32 s31, s2, 7
    s_lshr_b32 s32, s2, 3
    s_lshr_b32 s33, s31, 1
    s_and_b32 s34, s31, 1
    s_lshl_b32 s34, s34, 1
    s_and_b32 s36, s32, 1
    s_add_u32 s34, s34, s36
    s_lshr_b32 s32, s32, 1
    s_and_b32 s41, s30, 3
    s_lshr_b32 s39, s30, 2
    s_lshl_b32 s35, s32, 3
    s_lshl_b32 s36, s41, 1
    s_add_u32 s35, s35, s36
    v_lshlrev_b32 v207, 4, v208
    s_mov_b32 s36, 0xAAAB
    v_add_u32 v210, 0, v208
    v_mul_lo_u32 v211, v210, s36
    v_lshrrev_b32 v211, 20, v211
    v_mul_u32_u24 v213, 24, v211
    v_sub_u32 v212, v210, v213
    v_and_b32 v213, 6, v211
    v_xor_b32 v212, v212, v213
    v_mul_u32_u24 v213, 1152, v211
    v_lshl_add_u32 v152, v212, 4, v213
    v_add_u32 v210, 64, v208
    v_mul_lo_u32 v211, v210, s36
    v_lshrrev_b32 v211, 20, v211
    v_mul_u32_u24 v213, 24, v211
    v_sub_u32 v212, v210, v213
    v_and_b32 v213, 6, v211
    v_xor_b32 v212, v212, v213
    v_mul_u32_u24 v213, 1152, v211
    v_lshl_add_u32 v153, v212, 4, v213
    v_add_u32 v210, 128, v208
    v_mul_lo_u32 v211, v210, s36
    v_lshrrev_b32 v211, 20, v211
    v_mul_u32_u24 v213, 24, v211
    v_sub_u32 v212, v210, v213
    v_and_b32 v213, 6, v211
    v_xor_b32 v212, v212, v213
    v_mul_u32_u24 v213, 1152, v211
    v_lshl_add_u32 v154, v212, 4, v213
    s_mul_i32 s40, s33, 1152
    s_mul_i32 s42, s39, 576
    s_add_u32 s40, s40, s42
    s_lshl_b32 s42, s41, 3
    s_add_u32 s40, s40, s42
    s_mul_i32 s40, s40, 1152
    s_lshr_b32 s45, s41, 1
    s_mul_i32 s45, s45, 147456
    s_lshl_b32 s42, s34, 8
    s_add_u32 s40, s40, s42
    s_mul_i32 s43, s41, 3072
    s_mul_i32 s44, s39, 12288
    s_add_u32 s43, s43, s44
    s_mul_i32 s46, s33, 36
    s_mul_i32 s47, s39, 18
    s_add_u32 s46, s46, s47
    s_xor_b32 s52, s39, 0
    s_add_u32 s52, s52, s35
    s_mul_i32 s52, s52, 144
    s_add_u32 s52, s52, s46
    s_lshl_b32 s52, s52, 10
    s_add_u32 s52, s52, 14680064
    s_xor_b32 s53, s39, 1
    s_add_u32 s53, s53, s35
    s_mul_i32 s53, s53, 144
    s_add_u32 s53, s53, s46
    s_lshl_b32 s53, s53, 10
    s_add_u32 s53, s53, 14680064
    s_waitcnt lgkmcnt(0)
    s_mov_b32 s8, s4
    s_mov_b32 s9, s5
    s_mov_b32 s10, 5308416
    s_mov_b32 s11, 0x20000
    s_mov_b32 s16, s24
    s_mov_b32 s17, s25
    s_mov_b32 s18, 268435456
    s_mov_b32 s19, 0x20000
    s_add_u32 m0, s43, 0
    s_add_u32 s37, s40, 0
    buffer_load_dwordx4 v152, s[8:11], s37 offen lds
    s_add_u32 m0, s43, 1024
    s_add_u32 s37, s40, 0
    buffer_load_dwordx4 v153, s[8:11], s37 offen lds
    s_add_u32 m0, s43, 2048
    s_add_u32 s37, s40, 0
    buffer_load_dwordx4 v154, s[8:11], s37 offen lds
    buffer_load_dwordx4 v[72:75], v207, s[16:19], s52 offen
    s_add_u32 s52, s52, 1024
    buffer_load_dwordx4 v[76:79], v207, s[16:19], s53 offen
    s_add_u32 s53, s53, 1024
    s_add_u32 m0, s43, 24576
    s_add_u32 s37, s40, 36864
    buffer_load_dwordx4 v152, s[8:11], s37 offen lds
    s_add_u32 m0, s43, 25600
    s_add_u32 s37, s40, 36864
    buffer_load_dwordx4 v153, s[8:11], s37 offen lds
    s_add_u32 m0, s43, 26624
    s_add_u32 s37, s40, 36864
    buffer_load_dwordx4 v154, s[8:11], s37 offen lds
    buffer_load_dwordx4 v[80:83], v207, s[16:19], s52 offen
    s_add_u32 s52, s52, 1024
    buffer_load_dwordx4 v[84:87], v207, s[16:19], s53 offen
    s_add_u32 s53, s53, 1024
    s_mov_b32 s12, s20
    s_mov_b32 s13, s21
    s_mov_b32 s14, 2359296
    s_mov_b32 s15, 0x20000
    v_lshrrev_b32 v210, 2, v208
    v_bfe_u32 v211, v208, 3, 2
    v_and_b32 v212, 3, v208
    v_mul_u32_u24 v210, 384, v210
    v_lshl_add_u32 v210, v212, 3, v210
    s_mul_i32 s38, s39, 12288
    v_add_u32 v210, s38, v210
    s_add_u32 s38, s34, 0
    v_xor_b32 v213, s38, v211
    v_lshl_add_u32 v144, v213, 5, v210
    s_add_u32 s38, s34, 1
    v_xor_b32 v213, s38, v211
    v_lshl_add_u32 v145, v213, 5, v210
    s_add_u32 s38, s34, 2
    v_xor_b32 v213, s38, v211
    v_lshl_add_u32 v146, v213, 5, v210
    s_add_u32 s38, s34, 3
    v_xor_b32 v213, s38, v211
    v_lshl_add_u32 v147, v213, 5, v210
    s_waitcnt vmcnt(7)
    s_barrier
    ds_read_b64_tr_b16 v[120:121], v144 offset:0
    ds_read_b64_tr_b16 v[122:123], v144 offset:6144
    ds_read_b64_tr_b16 v[124:125], v145 offset:0
    ds_read_b64_tr_b16 v[126:127], v145 offset:6144
    ds_read_b64_tr_b16 v[128:129], v146 offset:0
    ds_read_b64_tr_b16 v[130:131], v146 offset:6144
    ds_read_b64_tr_b16 v[132:133], v147 offset:0
    ds_read_b64_tr_b16 v[134:135], v147 offset:6144
    s_waitcnt lgkmcnt(6)
    s_waitcnt vmcnt(6)
    v_mfma_f32_16x16x32_bf16 v[0:3], v[120:123], v[72:75], 0
    ds_read_b64_tr_b16 v[136:137], v144 offset:128
    ds_read_b64_tr_b16 v[138:139], v144 offset:6272
    s_add_u32 m0, s43, 49152
    s_add_u32 s37, s40, 73728
    buffer_load_dwordx4 v152, s[8:11], s37 offen lds
    s_waitcnt vmcnt(6)
    v_mfma_f32_16x16x32_bf16 v[36:39], v[120:123], v[76:79], 0
    s_waitcnt lgkmcnt(6)
    v_mfma_f32_16x16x32_bf16 v[4:7], v[124:127], v[72:75], 0
    ds_read_b64_tr_b16 v[140:141], v145 offset:128
    ds_read_b64_tr_b16 v[142:143], v145 offset:6272
    buffer_load_dwordx4 v[88:91], v207, s[16:19], s52 offen
    s_add_u32 s52, s52, 1024
    v_mfma_f32_16x16x32_bf16 v[40:43], v[124:127], v[76:79], 0
    s_waitcnt lgkmcnt(6)
    v_mfma_f32_16x16x32_bf16 v[8:11], v[128:131], v[72:75], 0
    ds_read_b64_tr_b16 v[120:121], v146 offset:128
    ds_read_b64_tr_b16 v[122:123], v146 offset:6272
    s_add_u32 m0, s43, 50176
    s_add_u32 s37, s40, 73728
    buffer_load_dwordx4 v153, s[8:11], s37 offen lds
    v_mfma_f32_16x16x32_bf16 v[44:47], v[128:131], v[76:79], 0
    s_waitcnt lgkmcnt(6)
    v_mfma_f32_16x16x32_bf16 v[12:15], v[132:135], v[72:75], 0
    ds_read_b64_tr_b16 v[124:125], v147 offset:128
    ds_read_b64_tr_b16 v[126:127], v147 offset:6272
    buffer_load_dwordx4 v[92:95], v207, s[16:19], s53 offen
    s_add_u32 s53, s53, 1024
    v_mfma_f32_16x16x32_bf16 v[48:51], v[132:135], v[76:79], 0
    s_waitcnt vmcnt(6)
    s_barrier
    v_add_u32 v148, 24576, v144
    v_add_u32 v149, 24576, v145
    v_add_u32 v150, 24576, v146
    v_add_u32 v151, 24576, v147
    s_waitcnt lgkmcnt(6)
    v_mfma_f32_16x16x32_bf16 v[16:19], v[136:139], v[72:75], 0
    ds_read_b64_tr_b16 v[128:129], v144 offset:256
    ds_read_b64_tr_b16 v[130:131], v144 offset:6400
    s_add_u32 m0, s43, 51200
    s_add_u32 s37, s40, 73728
    buffer_load_dwordx4 v154, s[8:11], s37 offen lds
    v_mfma_f32_16x16x32_bf16 v[52:55], v[136:139], v[76:79], 0
    buffer_load_dwordx4 v[96:99], v207, s[16:19], s52 offen
    s_add_u32 s52, s52, 1024
    s_waitcnt lgkmcnt(6)
    v_mfma_f32_16x16x32_bf16 v[20:23], v[140:143], v[72:75], 0
    ds_read_b64_tr_b16 v[132:133], v148 offset:0
    ds_read_b64_tr_b16 v[134:135], v148 offset:6144
    v_mfma_f32_16x16x32_bf16 v[56:59], v[140:143], v[76:79], 0
    s_add_u32 m0, s43, 73728
    s_add_u32 s37, s40, 110592
    buffer_load_dwordx4 v152, s[8:11], s37 offen lds
    s_waitcnt lgkmcnt(6)
    v_mfma_f32_16x16x32_bf16 v[24:27], v[120:123], v[72:75], 0
    ds_read_b64_tr_b16 v[136:137], v149 offset:0
    ds_read_b64_tr_b16 v[138:139], v149 offset:6144
    v_mfma_f32_16x16x32_bf16 v[60:63], v[120:123], v[76:79], 0
    buffer_load_dwordx4 v[100:103], v207, s[16:19], s53 offen
    s_add_u32 s53, s53, 1024
    s_waitcnt lgkmcnt(6)
    v_mfma_f32_16x16x32_bf16 v[28:31], v[124:127], v[72:75], 0
    ds_read_b64_tr_b16 v[140:141], v150 offset:0
    ds_read_b64_tr_b16 v[142:143], v150 offset:6144
    v_mfma_f32_16x16x32_bf16 v[64:67], v[124:127], v[76:79], 0
    s_add_u32 m0, s43, 74752
    s_add_u32 s37, s40, 110592
    buffer_load_dwordx4 v153, s[8:11], s37 offen lds
    s_waitcnt lgkmcnt(6)
    v_mfma_f32_16x16x32_bf16 v[32:35], v[128:131], v[72:75], 0
    ds_read_b64_tr_b16 v[120:121], v151 offset:0
    ds_read_b64_tr_b16 v[122:123], v151 offset:6144
    v_mfma_f32_16x16x32_bf16 v[68:71], v[128:131], v[76:79], 0
    s_add_u32 m0, s43, 75776
    s_add_u32 s37, s40, 110592
    buffer_load_dwordx4 v154, s[8:11], s37 offen lds
    s_waitcnt lgkmcnt(6)
    s_waitcnt vmcnt(11)
    v_mfma_f32_16x16x32_bf16 v[0:3], v[132:135], v[80:83], v[0:3]
    ds_read_b64_tr_b16 v[124:125], v148 offset:128
    ds_read_b64_tr_b16 v[126:127], v148 offset:6272
    s_add_u32 m0, s43, 98304
    s_add_u32 s37, s40, 165888
    buffer_load_dwordx4 v152, s[8:11], s37 offen lds
    s_waitcnt vmcnt(11)
    v_mfma_f32_16x16x32_bf16 v[36:39], v[132:135], v[84:87], v[36:39]
    s_waitcnt lgkmcnt(6)
    v_mfma_f32_16x16x32_bf16 v[4:7], v[136:139], v[80:83], v[4:7]
    ds_read_b64_tr_b16 v[128:129], v149 offset:128
    ds_read_b64_tr_b16 v[130:131], v149 offset:6272
    buffer_load_dwordx4 v[104:107], v207, s[16:19], s52 offen
    s_add_u32 s52, s52, 1024
    v_mfma_f32_16x16x32_bf16 v[40:43], v[136:139], v[84:87], v[40:43]
    s_waitcnt lgkmcnt(6)
    v_mfma_f32_16x16x32_bf16 v[8:11], v[140:143], v[80:83], v[8:11]
    ds_read_b64_tr_b16 v[132:133], v150 offset:128
    ds_read_b64_tr_b16 v[134:135], v150 offset:6272
    s_add_u32 m0, s43, 99328
    s_add_u32 s37, s40, 165888
    buffer_load_dwordx4 v153, s[8:11], s37 offen lds
    v_mfma_f32_16x16x32_bf16 v[44:47], v[140:143], v[84:87], v[44:47]
    s_waitcnt lgkmcnt(6)
    v_mfma_f32_16x16x32_bf16 v[12:15], v[120:123], v[80:83], v[12:15]
    ds_read_b64_tr_b16 v[136:137], v151 offset:128
    ds_read_b64_tr_b16 v[138:139], v151 offset:6272
    buffer_load_dwordx4 v[108:111], v207, s[16:19], s53 offen
    s_add_u32 s53, s53, 1024
    v_mfma_f32_16x16x32_bf16 v[48:51], v[120:123], v[84:87], v[48:51]
    s_waitcnt vmcnt(9)
    s_barrier
    v_add_u32 v144, 24576, v148
    v_add_u32 v145, 24576, v149
    v_add_u32 v146, 24576, v150
    v_add_u32 v147, 24576, v151
    s_waitcnt lgkmcnt(6)
    v_mfma_f32_16x16x32_bf16 v[16:19], v[124:127], v[80:83], v[16:19]
    ds_read_b64_tr_b16 v[140:141], v148 offset:256
    ds_read_b64_tr_b16 v[142:143], v148 offset:6400
    s_add_u32 m0, s43, 100352
    s_add_u32 s37, s40, 165888
    buffer_load_dwordx4 v154, s[8:11], s37 offen lds
    v_mfma_f32_16x16x32_bf16 v[52:55], v[124:127], v[84:87], v[52:55]
    buffer_load_dwordx4 v[112:115], v207, s[16:19], s52 offen
    s_add_u32 s52, s52, 1024
    s_waitcnt lgkmcnt(6)
    v_mfma_f32_16x16x32_bf16 v[20:23], v[128:131], v[80:83], v[20:23]
    ds_read_b64_tr_b16 v[120:121], v144 offset:0
    ds_read_b64_tr_b16 v[122:123], v144 offset:6144
    v_mfma_f32_16x16x32_bf16 v[56:59], v[128:131], v[84:87], v[56:59]
    s_add_u32 m0, s43, 122880
    s_add_u32 s37, s40, 202752
    buffer_load_dwordx4 v152, s[8:11], s37 offen lds
    s_waitcnt lgkmcnt(6)
    v_mfma_f32_16x16x32_bf16 v[24:27], v[132:135], v[80:83], v[24:27]
    ds_read_b64_tr_b16 v[124:125], v145 offset:0
    ds_read_b64_tr_b16 v[126:127], v145 offset:6144
    v_mfma_f32_16x16x32_bf16 v[60:63], v[132:135], v[84:87], v[60:63]
    buffer_load_dwordx4 v[116:119], v207, s[16:19], s53 offen
    s_add_u32 s53, s53, 1024
    s_waitcnt lgkmcnt(6)
    v_mfma_f32_16x16x32_bf16 v[28:31], v[136:139], v[80:83], v[28:31]
    ds_read_b64_tr_b16 v[128:129], v146 offset:0
    ds_read_b64_tr_b16 v[130:131], v146 offset:6144
    v_mfma_f32_16x16x32_bf16 v[64:67], v[136:139], v[84:87], v[64:67]
    s_add_u32 m0, s43, 123904
    s_add_u32 s37, s40, 202752
    buffer_load_dwordx4 v153, s[8:11], s37 offen lds
    s_waitcnt lgkmcnt(6)
    v_mfma_f32_16x16x32_bf16 v[32:35], v[140:143], v[80:83], v[32:35]
    ds_read_b64_tr_b16 v[132:133], v147 offset:0
    ds_read_b64_tr_b16 v[134:135], v147 offset:6144
    v_mfma_f32_16x16x32_bf16 v[68:71], v[140:143], v[84:87], v[68:71]
    s_add_u32 m0, s43, 124928
    s_add_u32 s37, s40, 202752
    buffer_load_dwordx4 v154, s[8:11], s37 offen lds
    s_waitcnt lgkmcnt(6)
    v_mfma_f32_16x16x32_bf16 v[0:3], v[120:123], v[88:91], v[0:3]
    ds_read_b64_tr_b16 v[136:137], v144 offset:128
    ds_read_b64_tr_b16 v[138:139], v144 offset:6272
    v_mfma_f32_16x16x32_bf16 v[36:39], v[120:123], v[92:95], v[36:39]
    s_add_u32 m0, s43, 0
    s_add_u32 s37, s40, 239616
    buffer_load_dwordx4 v152, s[8:11], s37 offen lds
    s_waitcnt lgkmcnt(6)
    v_mfma_f32_16x16x32_bf16 v[4:7], v[124:127], v[88:91], v[4:7]
    ds_read_b64_tr_b16 v[140:141], v145 offset:128
    ds_read_b64_tr_b16 v[142:143], v145 offset:6272
    v_mfma_f32_16x16x32_bf16 v[40:43], v[124:127], v[92:95], v[40:43]
    buffer_load_dwordx4 v[72:75], v207, s[16:19], s52 offen
    s_add_u32 s52, s52, 1024
    s_waitcnt lgkmcnt(6)
    v_mfma_f32_16x16x32_bf16 v[8:11], v[128:131], v[88:91], v[8:11]
    ds_read_b64_tr_b16 v[120:121], v146 offset:128
    ds_read_b64_tr_b16 v[122:123], v146 offset:6272
    v_mfma_f32_16x16x32_bf16 v[44:47], v[128:131], v[92:95], v[44:47]
    s_waitcnt lgkmcnt(6)
    v_mfma_f32_16x16x32_bf16 v[12:15], v[132:135], v[88:91], v[12:15]
    ds_read_b64_tr_b16 v[124:125], v147 offset:128
    ds_read_b64_tr_b16 v[126:127], v147 offset:6272
    s_add_u32 m0, s43, 1024
    s_add_u32 s37, s40, 239616
    buffer_load_dwordx4 v153, s[8:11], s37 offen lds
    v_mfma_f32_16x16x32_bf16 v[48:51], v[132:135], v[92:95], v[48:51]
    s_waitcnt vmcnt(13)
    s_barrier
    v_add_u32 v148, 24576, v144
    v_add_u32 v149, 24576, v145
    v_add_u32 v150, 24576, v146
    v_add_u32 v151, 24576, v147
    s_waitcnt lgkmcnt(6)
    v_mfma_f32_16x16x32_bf16 v[16:19], v[136:139], v[88:91], v[16:19]
    ds_read_b64_tr_b16 v[128:129], v144 offset:256
    ds_read_b64_tr_b16 v[130:131], v144 offset:6400
    v_mfma_f32_16x16x32_bf16 v[52:55], v[136:139], v[92:95], v[52:55]
    buffer_load_dwordx4 v[76:79], v207, s[16:19], s53 offen
    s_add_u32 s53, s53, 1024
    s_waitcnt lgkmcnt(6)
    v_mfma_f32_16x16x32_bf16 v[20:23], v[140:143], v[88:91], v[20:23]
    ds_read_b64_tr_b16 v[132:133], v148 offset:0
    ds_read_b64_tr_b16 v[134:135], v148 offset:6144
    v_mfma_f32_16x16x32_bf16 v[56:59], v[140:143], v[92:95], v[56:59]
    s_add_u32 m0, s43, 2048
    s_add_u32 s37, s40, 239616
    buffer_load_dwordx4 v154, s[8:11], s37 offen lds
    s_waitcnt lgkmcnt(6)
    v_mfma_f32_16x16x32_bf16 v[24:27], v[120:123], v[88:91], v[24:27]
    ds_read_b64_tr_b16 v[136:137], v149 offset:0
    ds_read_b64_tr_b16 v[138:139], v149 offset:6144
    v_mfma_f32_16x16x32_bf16 v[60:63], v[120:123], v[92:95], v[60:63]
    s_waitcnt lgkmcnt(6)
    v_mfma_f32_16x16x32_bf16 v[28:31], v[124:127], v[88:91], v[28:31]
    ds_read_b64_tr_b16 v[140:141], v150 offset:0
    ds_read_b64_tr_b16 v[142:143], v150 offset:6144
    buffer_load_dwordx4 v[80:83], v207, s[16:19], s52 offen
    s_add_u32 s52, s52, 1024
    v_mfma_f32_16x16x32_bf16 v[64:67], v[124:127], v[92:95], v[64:67]
    s_waitcnt lgkmcnt(6)
    v_mfma_f32_16x16x32_bf16 v[32:35], v[128:131], v[88:91], v[32:35]
    ds_read_b64_tr_b16 v[120:121], v151 offset:0
    ds_read_b64_tr_b16 v[122:123], v151 offset:6144
    buffer_load_dwordx4 v[84:87], v207, s[16:19], s53 offen
    s_add_u32 s53, s53, 1024
    v_mfma_f32_16x16x32_bf16 v[68:71], v[128:131], v[92:95], v[68:71]
    s_waitcnt lgkmcnt(6)
    v_mfma_f32_16x16x32_bf16 v[0:3], v[132:135], v[96:99], v[0:3]
    ds_read_b64_tr_b16 v[124:125], v148 offset:128
    ds_read_b64_tr_b16 v[126:127], v148 offset:6272
    v_mfma_f32_16x16x32_bf16 v[36:39], v[132:135], v[100:103], v[36:39]
    s_add_u32 m0, s43, 24576
    s_add_u32 s37, s40, 276480
    buffer_load_dwordx4 v152, s[8:11], s37 offen lds
    s_waitcnt lgkmcnt(6)
    v_mfma_f32_16x16x32_bf16 v[4:7], v[136:139], v[96:99], v[4:7]
    ds_read_b64_tr_b16 v[128:129], v149 offset:128
    ds_read_b64_tr_b16 v[130:131], v149 offset:6272
    v_mfma_f32_16x16x32_bf16 v[40:43], v[136:139], v[100:103], v[40:43]
    s_waitcnt lgkmcnt(6)
    v_mfma_f32_16x16x32_bf16 v[8:11], v[140:143], v[96:99], v[8:11]
    ds_read_b64_tr_b16 v[132:133], v150 offset:128
    ds_read_b64_tr_b16 v[134:135], v150 offset:6272
    v_mfma_f32_16x16x32_bf16 v[44:47], v[140:143], v[100:103], v[44:47]
    buffer_load_dwordx4 v[88:91], v207, s[16:19], s52 offen
    s_add_u32 s52, s52, 1024
    s_waitcnt lgkmcnt(6)
    v_mfma_f32_16x16x32_bf16 v[12:15], v[120:123], v[96:99], v[12:15]
    ds_read_b64_tr_b16 v[136:137], v151 offset:128
    ds_read_b64_tr_b16 v[138:139], v151 offset:6272
    v_mfma_f32_16x16x32_bf16 v[48:51], v[120:123], v[100:103], v[48:51]
    s_waitcnt vmcnt(14)
    s_barrier
    v_add_u32 v144, 24576, v148
    v_add_u32 v145, 24576, v149
    v_add_u32 v146, 24576, v150
    v_add_u32 v147, 24576, v151
    s_waitcnt lgkmcnt(6)
    v_mfma_f32_16x16x32_bf16 v[16:19], v[124:127], v[96:99], v[16:19]
    ds_read_b64_tr_b16 v[140:141], v148 offset:256
    ds_read_b64_tr_b16 v[142:143], v148 offset:6400
    v_mfma_f32_16x16x32_bf16 v[52:55], v[124:127], v[100:103], v[52:55]
    s_add_u32 m0, s43, 25600
    s_add_u32 s37, s40, 276480
    buffer_load_dwordx4 v153, s[8:11], s37 offen lds
    s_waitcnt lgkmcnt(6)
    v_mfma_f32_16x16x32_bf16 v[20:23], v[128:131], v[96:99], v[20:23]
    ds_read_b64_tr_b16 v[120:121], v144 offset:0
    ds_read_b64_tr_b16 v[122:123], v144 offset:6144
    v_mfma_f32_16x16x32_bf16 v[56:59], v[128:131], v[100:103], v[56:59]
    s_waitcnt lgkmcnt(6)
    v_mfma_f32_16x16x32_bf16 v[24:27], v[132:135], v[96:99], v[24:27]
    ds_read_b64_tr_b16 v[124:125], v145 offset:0
    ds_read_b64_tr_b16 v[126:127], v145 offset:6144
    buffer_load_dwordx4 v[92:95], v207, s[16:19], s53 offen
    s_add_u32 s53, s53, 1024
    v_mfma_f32_16x16x32_bf16 v[60:63], v[132:135], v[100:103], v[60:63]
    s_waitcnt lgkmcnt(6)
    v_mfma_f32_16x16x32_bf16 v[28:31], v[136:139], v[96:99], v[28:31]
    ds_read_b64_tr_b16 v[128:129], v146 offset:0
    ds_read_b64_tr_b16 v[130:131], v146 offset:6144
    v_mfma_f32_16x16x32_bf16 v[64:67], v[136:139], v[100:103], v[64:67]
    s_waitcnt lgkmcnt(6)
    v_mfma_f32_16x16x32_bf16 v[32:35], v[140:143], v[96:99], v[32:35]
    ds_read_b64_tr_b16 v[132:133], v147 offset:0
    ds_read_b64_tr_b16 v[134:135], v147 offset:6144
    s_add_u32 m0, s43, 26624
    s_add_u32 s37, s40, 276480
    buffer_load_dwordx4 v154, s[8:11], s37 offen lds
    v_mfma_f32_16x16x32_bf16 v[68:71], v[140:143], v[100:103], v[68:71]
    s_waitcnt lgkmcnt(6)
    v_mfma_f32_16x16x32_bf16 v[0:3], v[120:123], v[104:107], v[0:3]
    ds_read_b64_tr_b16 v[136:137], v144 offset:128
    ds_read_b64_tr_b16 v[138:139], v144 offset:6272
    v_mfma_f32_16x16x32_bf16 v[36:39], v[120:123], v[108:111], v[36:39]
    s_add_u32 m0, s43, 49152
    s_add_u32 s37, s40, 147456
    s_add_u32 s37, s37, s45
    buffer_load_dwordx4 v152, s[8:11], s37 offen lds
    s_waitcnt lgkmcnt(6)
    v_mfma_f32_16x16x32_bf16 v[4:7], v[124:127], v[104:107], v[4:7]
    ds_read_b64_tr_b16 v[140:141], v145 offset:128
    ds_read_b64_tr_b16 v[142:143], v145 offset:6272
    v_mfma_f32_16x16x32_bf16 v[40:43], v[124:127], v[108:111], v[40:43]
    s_waitcnt lgkmcnt(6)
    v_mfma_f32_16x16x32_bf16 v[8:11], v[128:131], v[104:107], v[8:11]
    ds_read_b64_tr_b16 v[120:121], v146 offset:128
    ds_read_b64_tr_b16 v[122:123], v146 offset:6272
    v_mfma_f32_16x16x32_bf16 v[44:47], v[128:131], v[108:111], v[44:47]
    buffer_load_dwordx4 v[96:99], v207, s[16:19], s52 offen
    s_add_u32 s52, s52, 1024
    s_waitcnt lgkmcnt(6)
    v_mfma_f32_16x16x32_bf16 v[12:15], v[132:135], v[104:107], v[12:15]
    ds_read_b64_tr_b16 v[124:125], v147 offset:128
    ds_read_b64_tr_b16 v[126:127], v147 offset:6272
    v_mfma_f32_16x16x32_bf16 v[48:51], v[132:135], v[108:111], v[48:51]
    s_waitcnt vmcnt(14)
    s_barrier
    v_add_u32 v148, 24576, v144
    v_add_u32 v149, 24576, v145
    v_add_u32 v150, 24576, v146
    v_add_u32 v151, 24576, v147
    s_waitcnt lgkmcnt(6)
    v_mfma_f32_16x16x32_bf16 v[16:19], v[136:139], v[104:107], v[16:19]
    ds_read_b64_tr_b16 v[128:129], v144 offset:256
    ds_read_b64_tr_b16 v[130:131], v144 offset:6400
    v_mfma_f32_16x16x32_bf16 v[52:55], v[136:139], v[108:111], v[52:55]
    s_add_u32 m0, s43, 50176
    s_add_u32 s37, s40, 147456
    s_add_u32 s37, s37, s45
    buffer_load_dwordx4 v153, s[8:11], s37 offen lds
    s_waitcnt lgkmcnt(6)
    v_mfma_f32_16x16x32_bf16 v[20:23], v[140:143], v[104:107], v[20:23]
    ds_read_b64_tr_b16 v[132:133], v148 offset:0
    ds_read_b64_tr_b16 v[134:135], v148 offset:6144
    v_mfma_f32_16x16x32_bf16 v[56:59], v[140:143], v[108:111], v[56:59]
    s_waitcnt lgkmcnt(6)
    v_mfma_f32_16x16x32_bf16 v[24:27], v[120:123], v[104:107], v[24:27]
    ds_read_b64_tr_b16 v[136:137], v149 offset:0
    ds_read_b64_tr_b16 v[138:139], v149 offset:6144
    buffer_load_dwordx4 v[100:103], v207, s[16:19], s53 offen
    s_add_u32 s53, s53, 1024
    v_mfma_f32_16x16x32_bf16 v[60:63], v[120:123], v[108:111], v[60:63]
    s_waitcnt lgkmcnt(6)
    v_mfma_f32_16x16x32_bf16 v[28:31], v[124:127], v[104:107], v[28:31]
    ds_read_b64_tr_b16 v[140:141], v150 offset:0
    ds_read_b64_tr_b16 v[142:143], v150 offset:6144
    v_mfma_f32_16x16x32_bf16 v[64:67], v[124:127], v[108:111], v[64:67]
    s_waitcnt lgkmcnt(6)
    v_mfma_f32_16x16x32_bf16 v[32:35], v[128:131], v[104:107], v[32:35]
    ds_read_b64_tr_b16 v[120:121], v151 offset:0
    ds_read_b64_tr_b16 v[122:123], v151 offset:6144
    s_add_u32 m0, s43, 51200
    s_add_u32 s37, s40, 147456
    s_add_u32 s37, s37, s45
    buffer_load_dwordx4 v154, s[8:11], s37 offen lds
    v_mfma_f32_16x16x32_bf16 v[68:71], v[128:131], v[108:111], v[68:71]
    s_waitcnt lgkmcnt(6)
    v_mfma_f32_16x16x32_bf16 v[0:3], v[132:135], v[112:115], v[0:3]
    ds_read_b64_tr_b16 v[124:125], v148 offset:128
    ds_read_b64_tr_b16 v[126:127], v148 offset:6272
    v_mfma_f32_16x16x32_bf16 v[36:39], v[132:135], v[116:119], v[36:39]
    s_add_u32 m0, s43, 73728
    s_add_u32 s37, s40, 331776
    buffer_load_dwordx4 v152, s[8:11], s37 offen lds
    s_waitcnt lgkmcnt(6)
    v_mfma_f32_16x16x32_bf16 v[4:7], v[136:139], v[112:115], v[4:7]
    ds_read_b64_tr_b16 v[128:129], v149 offset:128
    ds_read_b64_tr_b16 v[130:131], v149 offset:6272
    v_mfma_f32_16x16x32_bf16 v[40:43], v[136:139], v[116:119], v[40:43]
    s_waitcnt lgkmcnt(6)
    v_mfma_f32_16x16x32_bf16 v[8:11], v[140:143], v[112:115], v[8:11]
    ds_read_b64_tr_b16 v[132:133], v150 offset:128
    ds_read_b64_tr_b16 v[134:135], v150 offset:6272
    v_mfma_f32_16x16x32_bf16 v[44:47], v[140:143], v[116:119], v[44:47]
    buffer_load_dwordx4 v[104:107], v207, s[16:19], s52 offen
    s_add_u32 s52, s52, 1024
    s_waitcnt lgkmcnt(6)
    v_mfma_f32_16x16x32_bf16 v[12:15], v[120:123], v[112:115], v[12:15]
    ds_read_b64_tr_b16 v[136:137], v151 offset:128
    ds_read_b64_tr_b16 v[138:139], v151 offset:6272
    v_mfma_f32_16x16x32_bf16 v[48:51], v[120:123], v[116:119], v[48:51]
    s_waitcnt vmcnt(14)
    s_barrier
    v_add_u32 v144, -122880, v148
    v_add_u32 v145, -122880, v149
    v_add_u32 v146, -122880, v150
    v_add_u32 v147, -122880, v151
    s_waitcnt lgkmcnt(6)
    v_mfma_f32_16x16x32_bf16 v[16:19], v[124:127], v[112:115], v[16:19]
    ds_read_b64_tr_b16 v[140:141], v148 offset:256
    ds_read_b64_tr_b16 v[142:143], v148 offset:6400
    v_mfma_f32_16x16x32_bf16 v[52:55], v[124:127], v[116:119], v[52:55]
    s_add_u32 m0, s43, 74752
    s_add_u32 s37, s40, 331776
    buffer_load_dwordx4 v153, s[8:11], s37 offen lds
    s_waitcnt lgkmcnt(6)
    v_mfma_f32_16x16x32_bf16 v[20:23], v[128:131], v[112:115], v[20:23]
    ds_read_b64_tr_b16 v[120:121], v144 offset:0
    ds_read_b64_tr_b16 v[122:123], v144 offset:6144
    v_mfma_f32_16x16x32_bf16 v[56:59], v[128:131], v[116:119], v[56:59]
    s_waitcnt lgkmcnt(6)
    v_mfma_f32_16x16x32_bf16 v[24:27], v[132:135], v[112:115], v[24:27]
    ds_read_b64_tr_b16 v[124:125], v145 offset:0
    ds_read_b64_tr_b16 v[126:127], v145 offset:6144
    buffer_load_dwordx4 v[108:111], v207, s[16:19], s53 offen
    s_add_u32 s53, s53, 1024
    v_mfma_f32_16x16x32_bf16 v[60:63], v[132:135], v[116:119], v[60:63]
    s_waitcnt lgkmcnt(6)
    v_mfma_f32_16x16x32_bf16 v[28:31], v[136:139], v[112:115], v[28:31]
    ds_read_b64_tr_b16 v[128:129], v146 offset:0
    ds_read_b64_tr_b16 v[130:131], v146 offset:6144
    v_mfma_f32_16x16x32_bf16 v[64:67], v[136:139], v[116:119], v[64:67]
    s_waitcnt lgkmcnt(6)
    v_mfma_f32_16x16x32_bf16 v[32:35], v[140:143], v[112:115], v[32:35]
    ds_read_b64_tr_b16 v[132:133], v147 offset:0
    ds_read_b64_tr_b16 v[134:135], v147 offset:6144
    s_add_u32 m0, s43, 75776
    s_add_u32 s37, s40, 331776
    buffer_load_dwordx4 v154, s[8:11], s37 offen lds
    v_mfma_f32_16x16x32_bf16 v[68:71], v[140:143], v[116:119], v[68:71]
    s_waitcnt lgkmcnt(6)
    v_mfma_f32_16x16x32_bf16 v[0:3], v[120:123], v[72:75], v[0:3]
    ds_read_b64_tr_b16 v[136:137], v144 offset:128
    ds_read_b64_tr_b16 v[138:139], v144 offset:6272
    v_mfma_f32_16x16x32_bf16 v[36:39], v[120:123], v[76:79], v[36:39]
    s_add_u32 m0, s43, 98304
    s_add_u32 s37, s40, 368640
    buffer_load_dwordx4 v152, s[8:11], s37 offen lds
    s_waitcnt lgkmcnt(6)
    v_mfma_f32_16x16x32_bf16 v[4:7], v[124:127], v[72:75], v[4:7]
    ds_read_b64_tr_b16 v[140:141], v145 offset:128
    ds_read_b64_tr_b16 v[142:143], v145 offset:6272
    v_mfma_f32_16x16x32_bf16 v[40:43], v[124:127], v[76:79], v[40:43]
    s_waitcnt lgkmcnt(6)
    v_mfma_f32_16x16x32_bf16 v[8:11], v[128:131], v[72:75], v[8:11]
    ds_read_b64_tr_b16 v[120:121], v146 offset:128
    ds_read_b64_tr_b16 v[122:123], v146 offset:6272
    v_mfma_f32_16x16x32_bf16 v[44:47], v[128:131], v[76:79], v[44:47]
    buffer_load_dwordx4 v[112:115], v207, s[16:19], s52 offen
    s_add_u32 s52, s52, 1024
    s_waitcnt lgkmcnt(6)
    v_mfma_f32_16x16x32_bf16 v[12:15], v[132:135], v[72:75], v[12:15]
    ds_read_b64_tr_b16 v[124:125], v147 offset:128
    ds_read_b64_tr_b16 v[126:127], v147 offset:6272
    v_mfma_f32_16x16x32_bf16 v[48:51], v[132:135], v[76:79], v[48:51]
    s_waitcnt vmcnt(12)
    s_barrier
    v_add_u32 v148, 24576, v144
    v_add_u32 v149, 24576, v145
    v_add_u32 v150, 24576, v146
    v_add_u32 v151, 24576, v147
    s_waitcnt lgkmcnt(6)
    v_mfma_f32_16x16x32_bf16 v[16:19], v[136:139], v[72:75], v[16:19]
    ds_read_b64_tr_b16 v[128:129], v144 offset:256
    ds_read_b64_tr_b16 v[130:131], v144 offset:6400
    v_mfma_f32_16x16x32_bf16 v[52:55], v[136:139], v[76:79], v[52:55]
    s_add_u32 m0, s43, 99328
    s_add_u32 s37, s40, 368640
    buffer_load_dwordx4 v153, s[8:11], s37 offen lds
    s_waitcnt lgkmcnt(6)
    v_mfma_f32_16x16x32_bf16 v[20:23], v[140:143], v[72:75], v[20:23]
    ds_read_b64_tr_b16 v[132:133], v148 offset:0
    ds_read_b64_tr_b16 v[134:135], v148 offset:6144
    v_mfma_f32_16x16x32_bf16 v[56:59], v[140:143], v[76:79], v[56:59]
    s_waitcnt lgkmcnt(6)
    v_mfma_f32_16x16x32_bf16 v[24:27], v[120:123], v[72:75], v[24:27]
    ds_read_b64_tr_b16 v[136:137], v149 offset:0
    ds_read_b64_tr_b16 v[138:139], v149 offset:6144
    buffer_load_dwordx4 v[116:119], v207, s[16:19], s53 offen
    s_add_u32 s53, s53, 1024
    v_mfma_f32_16x16x32_bf16 v[60:63], v[120:123], v[76:79], v[60:63]
    s_waitcnt lgkmcnt(6)
    v_mfma_f32_16x16x32_bf16 v[28:31], v[124:127], v[72:75], v[28:31]
    ds_read_b64_tr_b16 v[140:141], v150 offset:0
    ds_read_b64_tr_b16 v[142:143], v150 offset:6144
    v_mfma_f32_16x16x32_bf16 v[64:67], v[124:127], v[76:79], v[64:67]
    s_waitcnt lgkmcnt(6)
    v_mfma_f32_16x16x32_bf16 v[32:35], v[128:131], v[72:75], v[32:35]
    ds_read_b64_tr_b16 v[120:121], v151 offset:0
    ds_read_b64_tr_b16 v[122:123], v151 offset:6144
    s_add_u32 m0, s43, 100352
    s_add_u32 s37, s40, 368640
    buffer_load_dwordx4 v154, s[8:11], s37 offen lds
    v_mfma_f32_16x16x32_bf16 v[68:71], v[128:131], v[76:79], v[68:71]
    s_waitcnt lgkmcnt(6)
    v_mfma_f32_16x16x32_bf16 v[0:3], v[132:135], v[80:83], v[0:3]
    ds_read_b64_tr_b16 v[124:125], v148 offset:128
    ds_read_b64_tr_b16 v[126:127], v148 offset:6272
    v_mfma_f32_16x16x32_bf16 v[36:39], v[132:135], v[84:87], v[36:39]
    s_add_u32 m0, s43, 122880
    s_add_u32 s37, s40, 405504
    buffer_load_dwordx4 v152, s[8:11], s37 offen lds
    s_waitcnt lgkmcnt(6)
    v_mfma_f32_16x16x32_bf16 v[4:7], v[136:139], v[80:83], v[4:7]
    ds_read_b64_tr_b16 v[128:129], v149 offset:128
    ds_read_b64_tr_b16 v[130:131], v149 offset:6272
    v_mfma_f32_16x16x32_bf16 v[40:43], v[136:139], v[84:87], v[40:43]
    s_waitcnt lgkmcnt(6)
    v_mfma_f32_16x16x32_bf16 v[8:11], v[140:143], v[80:83], v[8:11]
    ds_read_b64_tr_b16 v[132:133], v150 offset:128
    ds_read_b64_tr_b16 v[134:135], v150 offset:6272
    v_mfma_f32_16x16x32_bf16 v[44:47], v[140:143], v[84:87], v[44:47]
    buffer_load_dwordx4 v[72:75], v207, s[16:19], s52 offen
    s_add_u32 s52, s52, 1024
    s_waitcnt lgkmcnt(6)
    v_mfma_f32_16x16x32_bf16 v[12:15], v[120:123], v[80:83], v[12:15]
    ds_read_b64_tr_b16 v[136:137], v151 offset:128
    ds_read_b64_tr_b16 v[138:139], v151 offset:6272
    v_mfma_f32_16x16x32_bf16 v[48:51], v[120:123], v[84:87], v[48:51]
    s_waitcnt vmcnt(12)
    s_barrier
    v_add_u32 v144, 24576, v148
    v_add_u32 v145, 24576, v149
    v_add_u32 v146, 24576, v150
    v_add_u32 v147, 24576, v151
    s_waitcnt lgkmcnt(6)
    v_mfma_f32_16x16x32_bf16 v[16:19], v[124:127], v[80:83], v[16:19]
    ds_read_b64_tr_b16 v[140:141], v148 offset:256
    ds_read_b64_tr_b16 v[142:143], v148 offset:6400
    v_mfma_f32_16x16x32_bf16 v[52:55], v[124:127], v[84:87], v[52:55]
    s_add_u32 m0, s43, 123904
    s_add_u32 s37, s40, 405504
    buffer_load_dwordx4 v153, s[8:11], s37 offen lds
    s_waitcnt lgkmcnt(6)
    v_mfma_f32_16x16x32_bf16 v[20:23], v[128:131], v[80:83], v[20:23]
    ds_read_b64_tr_b16 v[120:121], v144 offset:0
    ds_read_b64_tr_b16 v[122:123], v144 offset:6144
    v_mfma_f32_16x16x32_bf16 v[56:59], v[128:131], v[84:87], v[56:59]
    s_waitcnt lgkmcnt(6)
    v_mfma_f32_16x16x32_bf16 v[24:27], v[132:135], v[80:83], v[24:27]
    ds_read_b64_tr_b16 v[124:125], v145 offset:0
    ds_read_b64_tr_b16 v[126:127], v145 offset:6144
    buffer_load_dwordx4 v[76:79], v207, s[16:19], s53 offen
    s_add_u32 s53, s53, 1024
    v_mfma_f32_16x16x32_bf16 v[60:63], v[132:135], v[84:87], v[60:63]
    s_waitcnt lgkmcnt(6)
    v_mfma_f32_16x16x32_bf16 v[28:31], v[136:139], v[80:83], v[28:31]
    ds_read_b64_tr_b16 v[128:129], v146 offset:0
    ds_read_b64_tr_b16 v[130:131], v146 offset:6144
    v_mfma_f32_16x16x32_bf16 v[64:67], v[136:139], v[84:87], v[64:67]
    s_waitcnt lgkmcnt(6)
    v_mfma_f32_16x16x32_bf16 v[32:35], v[140:143], v[80:83], v[32:35]
    ds_read_b64_tr_b16 v[132:133], v147 offset:0
    ds_read_b64_tr_b16 v[134:135], v147 offset:6144
    s_add_u32 m0, s43, 124928
    s_add_u32 s37, s40, 405504
    buffer_load_dwordx4 v154, s[8:11], s37 offen lds
    v_mfma_f32_16x16x32_bf16 v[68:71], v[140:143], v[84:87], v[68:71]
    s_waitcnt lgkmcnt(6)
    v_mfma_f32_16x16x32_bf16 v[0:3], v[120:123], v[88:91], v[0:3]
    ds_read_b64_tr_b16 v[136:137], v144 offset:128
    ds_read_b64_tr_b16 v[138:139], v144 offset:6272
    v_mfma_f32_16x16x32_bf16 v[36:39], v[120:123], v[92:95], v[36:39]
    s_add_u32 m0, s43, 0
    s_add_u32 s37, s40, 442368
    buffer_load_dwordx4 v152, s[8:11], s37 offen lds
    s_waitcnt lgkmcnt(6)
    v_mfma_f32_16x16x32_bf16 v[4:7], v[124:127], v[88:91], v[4:7]
    ds_read_b64_tr_b16 v[140:141], v145 offset:128
    ds_read_b64_tr_b16 v[142:143], v145 offset:6272
    v_mfma_f32_16x16x32_bf16 v[40:43], v[124:127], v[92:95], v[40:43]
    s_waitcnt lgkmcnt(6)
    v_mfma_f32_16x16x32_bf16 v[8:11], v[128:131], v[88:91], v[8:11]
    ds_read_b64_tr_b16 v[120:121], v146 offset:128
    ds_read_b64_tr_b16 v[122:123], v146 offset:6272
    v_mfma_f32_16x16x32_bf16 v[44:47], v[128:131], v[92:95], v[44:47]
    buffer_load_dwordx4 v[80:83], v207, s[16:19], s52 offen
    s_add_u32 s52, s52, 1024
    s_waitcnt lgkmcnt(6)
    v_mfma_f32_16x16x32_bf16 v[12:15], v[132:135], v[88:91], v[12:15]
    ds_read_b64_tr_b16 v[124:125], v147 offset:128
    ds_read_b64_tr_b16 v[126:127], v147 offset:6272
    v_mfma_f32_16x16x32_bf16 v[48:51], v[132:135], v[92:95], v[48:51]
    s_waitcnt vmcnt(12)
    s_barrier
    v_add_u32 v148, 24576, v144
    v_add_u32 v149, 24576, v145
    v_add_u32 v150, 24576, v146
    v_add_u32 v151, 24576, v147
    s_waitcnt lgkmcnt(6)
    v_mfma_f32_16x16x32_bf16 v[16:19], v[136:139], v[88:91], v[16:19]
    ds_read_b64_tr_b16 v[128:129], v144 offset:256
    ds_read_b64_tr_b16 v[130:131], v144 offset:6400
    v_mfma_f32_16x16x32_bf16 v[52:55], v[136:139], v[92:95], v[52:55]
    s_add_u32 m0, s43, 1024
    s_add_u32 s37, s40, 442368
    buffer_load_dwordx4 v153, s[8:11], s37 offen lds
    s_waitcnt lgkmcnt(6)
    v_mfma_f32_16x16x32_bf16 v[20:23], v[140:143], v[88:91], v[20:23]
    ds_read_b64_tr_b16 v[132:133], v148 offset:0
    ds_read_b64_tr_b16 v[134:135], v148 offset:6144
    v_mfma_f32_16x16x32_bf16 v[56:59], v[140:143], v[92:95], v[56:59]
    s_waitcnt lgkmcnt(6)
    v_mfma_f32_16x16x32_bf16 v[24:27], v[120:123], v[88:91], v[24:27]
    ds_read_b64_tr_b16 v[136:137], v149 offset:0
    ds_read_b64_tr_b16 v[138:139], v149 offset:6144
    buffer_load_dwordx4 v[84:87], v207, s[16:19], s53 offen
    s_add_u32 s53, s53, 1024
    v_mfma_f32_16x16x32_bf16 v[60:63], v[120:123], v[92:95], v[60:63]
    s_waitcnt lgkmcnt(6)
    v_mfma_f32_16x16x32_bf16 v[28:31], v[124:127], v[88:91], v[28:31]
    ds_read_b64_tr_b16 v[140:141], v150 offset:0
    ds_read_b64_tr_b16 v[142:143], v150 offset:6144
    v_mfma_f32_16x16x32_bf16 v[64:67], v[124:127], v[92:95], v[64:67]
    s_waitcnt lgkmcnt(6)
    v_mfma_f32_16x16x32_bf16 v[32:35], v[128:131], v[88:91], v[32:35]
    ds_read_b64_tr_b16 v[120:121], v151 offset:0
    ds_read_b64_tr_b16 v[122:123], v151 offset:6144
    s_add_u32 m0, s43, 2048
    s_add_u32 s37, s40, 442368
    buffer_load_dwordx4 v154, s[8:11], s37 offen lds
    v_mfma_f32_16x16x32_bf16 v[68:71], v[128:131], v[92:95], v[68:71]
    s_waitcnt lgkmcnt(6)
    v_mfma_f32_16x16x32_bf16 v[0:3], v[132:135], v[96:99], v[0:3]
    ds_read_b64_tr_b16 v[124:125], v148 offset:128
    ds_read_b64_tr_b16 v[126:127], v148 offset:6272
    v_mfma_f32_16x16x32_bf16 v[36:39], v[132:135], v[100:103], v[36:39]
    s_add_u32 m0, s43, 24576
    s_add_u32 s37, s40, 497664
    buffer_load_dwordx4 v152, s[8:11], s37 offen lds
    s_waitcnt lgkmcnt(6)
    v_mfma_f32_16x16x32_bf16 v[4:7], v[136:139], v[96:99], v[4:7]
    ds_read_b64_tr_b16 v[128:129], v149 offset:128
    ds_read_b64_tr_b16 v[130:131], v149 offset:6272
    v_mfma_f32_16x16x32_bf16 v[40:43], v[136:139], v[100:103], v[40:43]
    s_waitcnt lgkmcnt(6)
    v_mfma_f32_16x16x32_bf16 v[8:11], v[140:143], v[96:99], v[8:11]
    ds_read_b64_tr_b16 v[132:133], v150 offset:128
    ds_read_b64_tr_b16 v[134:135], v150 offset:6272
    v_mfma_f32_16x16x32_bf16 v[44:47], v[140:143], v[100:103], v[44:47]
    buffer_load_dwordx4 v[88:91], v207, s[16:19], s52 offen
    s_add_u32 s52, s52, 1024
    s_waitcnt lgkmcnt(6)
    v_mfma_f32_16x16x32_bf16 v[12:15], v[120:123], v[96:99], v[12:15]
    ds_read_b64_tr_b16 v[136:137], v151 offset:128
    ds_read_b64_tr_b16 v[138:139], v151 offset:6272
    v_mfma_f32_16x16x32_bf16 v[48:51], v[120:123], v[100:103], v[48:51]
    s_waitcnt vmcnt(12)
    s_barrier
    v_add_u32 v144, 24576, v148
    v_add_u32 v145, 24576, v149
    v_add_u32 v146, 24576, v150
    v_add_u32 v147, 24576, v151
    s_waitcnt lgkmcnt(6)
    v_mfma_f32_16x16x32_bf16 v[16:19], v[124:127], v[96:99], v[16:19]
    ds_read_b64_tr_b16 v[140:141], v148 offset:256
    ds_read_b64_tr_b16 v[142:143], v148 offset:6400
    v_mfma_f32_16x16x32_bf16 v[52:55], v[124:127], v[100:103], v[52:55]
    s_add_u32 m0, s43, 25600
    s_add_u32 s37, s40, 497664
    buffer_load_dwordx4 v153, s[8:11], s37 offen lds
    s_waitcnt lgkmcnt(6)
    v_mfma_f32_16x16x32_bf16 v[20:23], v[128:131], v[96:99], v[20:23]
    ds_read_b64_tr_b16 v[120:121], v144 offset:0
    ds_read_b64_tr_b16 v[122:123], v144 offset:6144
    v_mfma_f32_16x16x32_bf16 v[56:59], v[128:131], v[100:103], v[56:59]
    s_waitcnt lgkmcnt(6)
    v_mfma_f32_16x16x32_bf16 v[24:27], v[132:135], v[96:99], v[24:27]
    ds_read_b64_tr_b16 v[124:125], v145 offset:0
    ds_read_b64_tr_b16 v[126:127], v145 offset:6144
    buffer_load_dwordx4 v[92:95], v207, s[16:19], s53 offen
    s_add_u32 s53, s53, 1024
    v_mfma_f32_16x16x32_bf16 v[60:63], v[132:135], v[100:103], v[60:63]
    s_waitcnt lgkmcnt(6)
    v_mfma_f32_16x16x32_bf16 v[28:31], v[136:139], v[96:99], v[28:31]
    ds_read_b64_tr_b16 v[128:129], v146 offset:0
    ds_read_b64_tr_b16 v[130:131], v146 offset:6144
    v_mfma_f32_16x16x32_bf16 v[64:67], v[136:139], v[100:103], v[64:67]
    s_waitcnt lgkmcnt(6)
    v_mfma_f32_16x16x32_bf16 v[32:35], v[140:143], v[96:99], v[32:35]
    ds_read_b64_tr_b16 v[132:133], v147 offset:0
    ds_read_b64_tr_b16 v[134:135], v147 offset:6144
    s_add_u32 m0, s43, 26624
    s_add_u32 s37, s40, 497664
    buffer_load_dwordx4 v154, s[8:11], s37 offen lds
    v_mfma_f32_16x16x32_bf16 v[68:71], v[140:143], v[100:103], v[68:71]
    s_waitcnt lgkmcnt(6)
    v_mfma_f32_16x16x32_bf16 v[0:3], v[120:123], v[104:107], v[0:3]
    ds_read_b64_tr_b16 v[136:137], v144 offset:128
    ds_read_b64_tr_b16 v[138:139], v144 offset:6272
    v_mfma_f32_16x16x32_bf16 v[36:39], v[120:123], v[108:111], v[36:39]
    s_add_u32 m0, s43, 49152
    s_add_u32 s37, s40, 534528
    buffer_load_dwordx4 v152, s[8:11], s37 offen lds
    s_waitcnt lgkmcnt(6)
    v_mfma_f32_16x16x32_bf16 v[4:7], v[124:127], v[104:107], v[4:7]
    ds_read_b64_tr_b16 v[140:141], v145 offset:128
    ds_read_b64_tr_b16 v[142:143], v145 offset:6272
    v_mfma_f32_16x16x32_bf16 v[40:43], v[124:127], v[108:111], v[40:43]
    s_waitcnt lgkmcnt(6)
    v_mfma_f32_16x16x32_bf16 v[8:11], v[128:131], v[104:107], v[8:11]
    ds_read_b64_tr_b16 v[120:121], v146 offset:128
    ds_read_b64_tr_b16 v[122:123], v146 offset:6272
    v_mfma_f32_16x16x32_bf16 v[44:47], v[128:131], v[108:111], v[44:47]
    buffer_load_dwordx4 v[96:99], v207, s[16:19], s52 offen
    s_add_u32 s52, s52, 1024
    s_waitcnt lgkmcnt(6)
    v_mfma_f32_16x16x32_bf16 v[12:15], v[132:135], v[104:107], v[12:15]
    ds_read_b64_tr_b16 v[124:125], v147 offset:128
    ds_read_b64_tr_b16 v[126:127], v147 offset:6272
    v_mfma_f32_16x16x32_bf16 v[48:51], v[132:135], v[108:111], v[48:51]
    s_waitcnt vmcnt(12)
    s_barrier
    v_add_u32 v148, 24576, v144
    v_add_u32 v149, 24576, v145
    v_add_u32 v150, 24576, v146
    v_add_u32 v151, 24576, v147
    s_waitcnt lgkmcnt(6)
    v_mfma_f32_16x16x32_bf16 v[16:19], v[136:139], v[104:107], v[16:19]
    ds_read_b64_tr_b16 v[128:129], v144 offset:256
    ds_read_b64_tr_b16 v[130:131], v144 offset:6400
    v_mfma_f32_16x16x32_bf16 v[52:55], v[136:139], v[108:111], v[52:55]
    s_add_u32 m0, s43, 50176
    s_add_u32 s37, s40, 534528
    buffer_load_dwordx4 v153, s[8:11], s37 offen lds
    s_waitcnt lgkmcnt(6)
    v_mfma_f32_16x16x32_bf16 v[20:23], v[140:143], v[104:107], v[20:23]
    ds_read_b64_tr_b16 v[132:133], v148 offset:0
    ds_read_b64_tr_b16 v[134:135], v148 offset:6144
    v_mfma_f32_16x16x32_bf16 v[56:59], v[140:143], v[108:111], v[56:59]
    s_waitcnt lgkmcnt(6)
    v_mfma_f32_16x16x32_bf16 v[24:27], v[120:123], v[104:107], v[24:27]
    ds_read_b64_tr_b16 v[136:137], v149 offset:0
    ds_read_b64_tr_b16 v[138:139], v149 offset:6144
    buffer_load_dwordx4 v[100:103], v207, s[16:19], s53 offen
    s_add_u32 s53, s53, 1024
    v_mfma_f32_16x16x32_bf16 v[60:63], v[120:123], v[108:111], v[60:63]
    s_waitcnt lgkmcnt(6)
    v_mfma_f32_16x16x32_bf16 v[28:31], v[124:127], v[104:107], v[28:31]
    ds_read_b64_tr_b16 v[140:141], v150 offset:0
    ds_read_b64_tr_b16 v[142:143], v150 offset:6144
    v_mfma_f32_16x16x32_bf16 v[64:67], v[124:127], v[108:111], v[64:67]
    s_waitcnt lgkmcnt(6)
    v_mfma_f32_16x16x32_bf16 v[32:35], v[128:131], v[104:107], v[32:35]
    ds_read_b64_tr_b16 v[120:121], v151 offset:0
    ds_read_b64_tr_b16 v[122:123], v151 offset:6144
    s_add_u32 m0, s43, 51200
    s_add_u32 s37, s40, 534528
    buffer_load_dwordx4 v154, s[8:11], s37 offen lds
    v_mfma_f32_16x16x32_bf16 v[68:71], v[128:131], v[108:111], v[68:71]
    s_waitcnt lgkmcnt(6)
    v_mfma_f32_16x16x32_bf16 v[0:3], v[132:135], v[112:115], v[0:3]
    ds_read_b64_tr_b16 v[124:125], v148 offset:128
    ds_read_b64_tr_b16 v[126:127], v148 offset:6272
    v_mfma_f32_16x16x32_bf16 v[36:39], v[132:135], v[116:119], v[36:39]
    s_add_u32 m0, s43, 73728
    s_add_u32 s37, s40, 571392
    buffer_load_dwordx4 v152, s[8:11], s37 offen lds
    s_waitcnt lgkmcnt(6)
    v_mfma_f32_16x16x32_bf16 v[4:7], v[136:139], v[112:115], v[4:7]
    ds_read_b64_tr_b16 v[128:129], v149 offset:128
    ds_read_b64_tr_b16 v[130:131], v149 offset:6272
    v_mfma_f32_16x16x32_bf16 v[40:43], v[136:139], v[116:119], v[40:43]
    s_waitcnt lgkmcnt(6)
    v_mfma_f32_16x16x32_bf16 v[8:11], v[140:143], v[112:115], v[8:11]
    ds_read_b64_tr_b16 v[132:133], v150 offset:128
    ds_read_b64_tr_b16 v[134:135], v150 offset:6272
    v_mfma_f32_16x16x32_bf16 v[44:47], v[140:143], v[116:119], v[44:47]
    buffer_load_dwordx4 v[104:107], v207, s[16:19], s52 offen
    s_add_u32 s52, s52, 1024
    s_waitcnt lgkmcnt(6)
    v_mfma_f32_16x16x32_bf16 v[12:15], v[120:123], v[112:115], v[12:15]
    ds_read_b64_tr_b16 v[136:137], v151 offset:128
    ds_read_b64_tr_b16 v[138:139], v151 offset:6272
    v_mfma_f32_16x16x32_bf16 v[48:51], v[120:123], v[116:119], v[48:51]
    s_waitcnt vmcnt(12)
    s_barrier
    v_add_u32 v144, -122880, v148
    v_add_u32 v145, -122880, v149
    v_add_u32 v146, -122880, v150
    v_add_u32 v147, -122880, v151
    s_waitcnt lgkmcnt(6)
    v_mfma_f32_16x16x32_bf16 v[16:19], v[124:127], v[112:115], v[16:19]
    ds_read_b64_tr_b16 v[140:141], v148 offset:256
    ds_read_b64_tr_b16 v[142:143], v148 offset:6400
    v_mfma_f32_16x16x32_bf16 v[52:55], v[124:127], v[116:119], v[52:55]
    s_add_u32 m0, s43, 74752
    s_add_u32 s37, s40, 571392
    buffer_load_dwordx4 v153, s[8:11], s37 offen lds
    s_waitcnt lgkmcnt(6)
    v_mfma_f32_16x16x32_bf16 v[20:23], v[128:131], v[112:115], v[20:23]
    ds_read_b64_tr_b16 v[120:121], v144 offset:0
    ds_read_b64_tr_b16 v[122:123], v144 offset:6144
    v_mfma_f32_16x16x32_bf16 v[56:59], v[128:131], v[116:119], v[56:59]
    s_waitcnt lgkmcnt(6)
    v_mfma_f32_16x16x32_bf16 v[24:27], v[132:135], v[112:115], v[24:27]
    ds_read_b64_tr_b16 v[124:125], v145 offset:0
    ds_read_b64_tr_b16 v[126:127], v145 offset:6144
    buffer_load_dwordx4 v[108:111], v207, s[16:19], s53 offen
    s_add_u32 s53, s53, 1024
    v_mfma_f32_16x16x32_bf16 v[60:63], v[132:135], v[116:119], v[60:63]
    s_waitcnt lgkmcnt(6)
    v_mfma_f32_16x16x32_bf16 v[28:31], v[136:139], v[112:115], v[28:31]
    ds_read_b64_tr_b16 v[128:129], v146 offset:0
    ds_read_b64_tr_b16 v[130:131], v146 offset:6144
    v_mfma_f32_16x16x32_bf16 v[64:67], v[136:139], v[116:119], v[64:67]
    s_waitcnt lgkmcnt(6)
    v_mfma_f32_16x16x32_bf16 v[32:35], v[140:143], v[112:115], v[32:35]
    ds_read_b64_tr_b16 v[132:133], v147 offset:0
    ds_read_b64_tr_b16 v[134:135], v147 offset:6144
    s_add_u32 m0, s43, 75776
    s_add_u32 s37, s40, 571392
    buffer_load_dwordx4 v154, s[8:11], s37 offen lds
    v_mfma_f32_16x16x32_bf16 v[68:71], v[140:143], v[116:119], v[68:71]
    s_waitcnt lgkmcnt(6)
    v_mfma_f32_16x16x32_bf16 v[0:3], v[120:123], v[72:75], v[0:3]
    ds_read_b64_tr_b16 v[136:137], v144 offset:128
    ds_read_b64_tr_b16 v[138:139], v144 offset:6272
    v_mfma_f32_16x16x32_bf16 v[36:39], v[120:123], v[76:79], v[36:39]
    s_add_u32 m0, s43, 98304
    s_add_u32 s37, s40, 608256
    buffer_load_dwordx4 v152, s[8:11], s37 offen lds
    s_waitcnt lgkmcnt(6)
    v_mfma_f32_16x16x32_bf16 v[4:7], v[124:127], v[72:75], v[4:7]
    ds_read_b64_tr_b16 v[140:141], v145 offset:128
    ds_read_b64_tr_b16 v[142:143], v145 offset:6272
    v_mfma_f32_16x16x32_bf16 v[40:43], v[124:127], v[76:79], v[40:43]
    s_waitcnt lgkmcnt(6)
    v_mfma_f32_16x16x32_bf16 v[8:11], v[128:131], v[72:75], v[8:11]
    ds_read_b64_tr_b16 v[120:121], v146 offset:128
    ds_read_b64_tr_b16 v[122:123], v146 offset:6272
    v_mfma_f32_16x16x32_bf16 v[44:47], v[128:131], v[76:79], v[44:47]
    buffer_load_dwordx4 v[112:115], v207, s[16:19], s52 offen
    s_add_u32 s52, s52, 1024
    s_waitcnt lgkmcnt(6)
    v_mfma_f32_16x16x32_bf16 v[12:15], v[132:135], v[72:75], v[12:15]
    ds_read_b64_tr_b16 v[124:125], v147 offset:128
    ds_read_b64_tr_b16 v[126:127], v147 offset:6272
    v_mfma_f32_16x16x32_bf16 v[48:51], v[132:135], v[76:79], v[48:51]
    s_waitcnt vmcnt(12)
    s_barrier
    v_add_u32 v148, 24576, v144
    v_add_u32 v149, 24576, v145
    v_add_u32 v150, 24576, v146
    v_add_u32 v151, 24576, v147
    s_waitcnt lgkmcnt(6)
    v_mfma_f32_16x16x32_bf16 v[16:19], v[136:139], v[72:75], v[16:19]
    ds_read_b64_tr_b16 v[128:129], v144 offset:256
    ds_read_b64_tr_b16 v[130:131], v144 offset:6400
    v_mfma_f32_16x16x32_bf16 v[52:55], v[136:139], v[76:79], v[52:55]
    s_add_u32 m0, s43, 99328
    s_add_u32 s37, s40, 608256
    buffer_load_dwordx4 v153, s[8:11], s37 offen lds
    s_waitcnt lgkmcnt(6)
    v_mfma_f32_16x16x32_bf16 v[20:23], v[140:143], v[72:75], v[20:23]
    ds_read_b64_tr_b16 v[132:133], v148 offset:0
    ds_read_b64_tr_b16 v[134:135], v148 offset:6144
    v_mfma_f32_16x16x32_bf16 v[56:59], v[140:143], v[76:79], v[56:59]
    s_waitcnt lgkmcnt(6)
    v_mfma_f32_16x16x32_bf16 v[24:27], v[120:123], v[72:75], v[24:27]
    ds_read_b64_tr_b16 v[136:137], v149 offset:0
    ds_read_b64_tr_b16 v[138:139], v149 offset:6144
    buffer_load_dwordx4 v[116:119], v207, s[16:19], s53 offen
    s_add_u32 s53, s53, 1024
    v_mfma_f32_16x16x32_bf16 v[60:63], v[120:123], v[76:79], v[60:63]
    s_waitcnt lgkmcnt(6)
    v_mfma_f32_16x16x32_bf16 v[28:31], v[124:127], v[72:75], v[28:31]
    ds_read_b64_tr_b16 v[140:141], v150 offset:0
    ds_read_b64_tr_b16 v[142:143], v150 offset:6144
    v_mfma_f32_16x16x32_bf16 v[64:67], v[124:127], v[76:79], v[64:67]
    s_waitcnt lgkmcnt(6)
    v_mfma_f32_16x16x32_bf16 v[32:35], v[128:131], v[72:75], v[32:35]
    ds_read_b64_tr_b16 v[120:121], v151 offset:0
    ds_read_b64_tr_b16 v[122:123], v151 offset:6144
    s_add_u32 m0, s43, 100352
    s_add_u32 s37, s40, 608256
    buffer_load_dwordx4 v154, s[8:11], s37 offen lds
    v_mfma_f32_16x16x32_bf16 v[68:71], v[128:131], v[76:79], v[68:71]
    s_waitcnt lgkmcnt(6)
    v_mfma_f32_16x16x32_bf16 v[0:3], v[132:135], v[80:83], v[0:3]
    ds_read_b64_tr_b16 v[124:125], v148 offset:128
    ds_read_b64_tr_b16 v[126:127], v148 offset:6272
    v_mfma_f32_16x16x32_bf16 v[36:39], v[132:135], v[84:87], v[36:39]
    s_waitcnt lgkmcnt(6)
    v_mfma_f32_16x16x32_bf16 v[4:7], v[136:139], v[80:83], v[4:7]
    ds_read_b64_tr_b16 v[128:129], v149 offset:128
    ds_read_b64_tr_b16 v[130:131], v149 offset:6272
    v_mfma_f32_16x16x32_bf16 v[40:43], v[136:139], v[84:87], v[40:43]
    s_add_u32 m0, s43, 122880
    s_add_u32 s37, s40, 479232
    s_add_u32 s37, s37, s45
    buffer_load_dwordx4 v152, s[8:11], s37 offen lds
    s_waitcnt lgkmcnt(6)
    v_mfma_f32_16x16x32_bf16 v[8:11], v[140:143], v[80:83], v[8:11]
    ds_read_b64_tr_b16 v[132:133], v150 offset:128
    ds_read_b64_tr_b16 v[134:135], v150 offset:6272
    v_mfma_f32_16x16x32_bf16 v[44:47], v[140:143], v[84:87], v[44:47]
    s_waitcnt lgkmcnt(6)
    v_mfma_f32_16x16x32_bf16 v[12:15], v[120:123], v[80:83], v[12:15]
    ds_read_b64_tr_b16 v[136:137], v151 offset:128
    ds_read_b64_tr_b16 v[138:139], v151 offset:6272
    v_mfma_f32_16x16x32_bf16 v[48:51], v[120:123], v[84:87], v[48:51]
    s_waitcnt vmcnt(11)
    s_barrier
    v_add_u32 v144, 24576, v148
    v_add_u32 v145, 24576, v149
    v_add_u32 v146, 24576, v150
    v_add_u32 v147, 24576, v151
    s_waitcnt lgkmcnt(6)
    v_mfma_f32_16x16x32_bf16 v[16:19], v[124:127], v[80:83], v[16:19]
    ds_read_b64_tr_b16 v[140:141], v148 offset:256
    ds_read_b64_tr_b16 v[142:143], v148 offset:6400
    v_mfma_f32_16x16x32_bf16 v[52:55], v[124:127], v[84:87], v[52:55]
    s_add_u32 m0, s43, 123904
    s_add_u32 s37, s40, 479232
    s_add_u32 s37, s37, s45
    buffer_load_dwordx4 v153, s[8:11], s37 offen lds
    s_waitcnt lgkmcnt(6)
    v_mfma_f32_16x16x32_bf16 v[20:23], v[128:131], v[80:83], v[20:23]
    ds_read_b64_tr_b16 v[120:121], v144 offset:0
    ds_read_b64_tr_b16 v[122:123], v144 offset:6144
    v_mfma_f32_16x16x32_bf16 v[56:59], v[128:131], v[84:87], v[56:59]
    s_waitcnt lgkmcnt(6)
    v_mfma_f32_16x16x32_bf16 v[24:27], v[132:135], v[80:83], v[24:27]
    ds_read_b64_tr_b16 v[124:125], v145 offset:0
    ds_read_b64_tr_b16 v[126:127], v145 offset:6144
    v_mfma_f32_16x16x32_bf16 v[60:63], v[132:135], v[84:87], v[60:63]
    s_waitcnt lgkmcnt(6)
    v_mfma_f32_16x16x32_bf16 v[28:31], v[136:139], v[80:83], v[28:31]
    ds_read_b64_tr_b16 v[128:129], v146 offset:0
    ds_read_b64_tr_b16 v[130:131], v146 offset:6144
    v_mfma_f32_16x16x32_bf16 v[64:67], v[136:139], v[84:87], v[64:67]
    s_add_u32 m0, s43, 124928
    s_add_u32 s37, s40, 479232
    s_add_u32 s37, s37, s45
    buffer_load_dwordx4 v154, s[8:11], s37 offen lds
    s_waitcnt lgkmcnt(6)
    v_mfma_f32_16x16x32_bf16 v[32:35], v[140:143], v[80:83], v[32:35]
    ds_read_b64_tr_b16 v[132:133], v147 offset:0
    ds_read_b64_tr_b16 v[134:135], v147 offset:6144
    v_mfma_f32_16x16x32_bf16 v[68:71], v[140:143], v[84:87], v[68:71]
    s_waitcnt lgkmcnt(6)
    v_mfma_f32_16x16x32_bf16 v[0:3], v[120:123], v[88:91], v[0:3]
    ds_read_b64_tr_b16 v[136:137], v144 offset:128
    ds_read_b64_tr_b16 v[138:139], v144 offset:6272
    v_mfma_f32_16x16x32_bf16 v[36:39], v[120:123], v[92:95], v[36:39]
    s_waitcnt lgkmcnt(6)
    v_mfma_f32_16x16x32_bf16 v[4:7], v[124:127], v[88:91], v[4:7]
    ds_read_b64_tr_b16 v[140:141], v145 offset:128
    ds_read_b64_tr_b16 v[142:143], v145 offset:6272
    v_mfma_f32_16x16x32_bf16 v[40:43], v[124:127], v[92:95], v[40:43]
    s_waitcnt lgkmcnt(6)
    v_mfma_f32_16x16x32_bf16 v[8:11], v[128:131], v[88:91], v[8:11]
    ds_read_b64_tr_b16 v[120:121], v146 offset:128
    ds_read_b64_tr_b16 v[122:123], v146 offset:6272
    v_mfma_f32_16x16x32_bf16 v[44:47], v[128:131], v[92:95], v[44:47]
    s_waitcnt lgkmcnt(6)
    v_mfma_f32_16x16x32_bf16 v[12:15], v[132:135], v[88:91], v[12:15]
    ds_read_b64_tr_b16 v[124:125], v147 offset:128
    ds_read_b64_tr_b16 v[126:127], v147 offset:6272
    v_mfma_f32_16x16x32_bf16 v[48:51], v[132:135], v[92:95], v[48:51]
    s_waitcnt vmcnt(0)
    s_barrier
    v_add_u32 v148, 24576, v144
    v_add_u32 v149, 24576, v145
    v_add_u32 v150, 24576, v146
    v_add_u32 v151, 24576, v147
    s_waitcnt lgkmcnt(6)
    v_mfma_f32_16x16x32_bf16 v[16:19], v[136:139], v[88:91], v[16:19]
    ds_read_b64_tr_b16 v[128:129], v144 offset:256
    ds_read_b64_tr_b16 v[130:131], v144 offset:6400
    v_mfma_f32_16x16x32_bf16 v[52:55], v[136:139], v[92:95], v[52:55]
    v_add_u32 v144, 49152, v148
    v_add_u32 v145, 49152, v149
    v_add_u32 v146, 49152, v150
    v_add_u32 v147, 49152, v151
    s_lshl_b32 s46, s32, 2
    s_add_u32 s46, s46, s34
    s_lshl_b32 s47, s46, 3
    s_add_u32 s47, s47, s30
    s_mul_i32 s47, s47, 4608
    s_add_u32 s47, s47, 41943040
    s_mul_i32 s48, s33, 2359296
    s_add_u32 s48, s48, s47
    s_sub_u32 s54, s33, s30
    s_and_b32 s54, s54, 3
    s_add_u32 s49, s35, s39
    s_mul_i32 s49, s49, 36
    s_mul_i32 s50, s34, 9
    s_add_u32 s49, s49, s50
    s_lshl_b32 s49, s49, 9
    s_add_u32 s49, s49, 10485760
    v_lshrrev_b32 v211, 1, v207
    s_lshl_b32 s50, s30, 11
    s_add_u32 s50, s50, 24576
    v_add_u32 v209, s50, v207
    s_xor_b32 s50, s30, 4
    s_lshl_b32 s50, s50, 11
    s_add_u32 s50, s50, 24576
    v_add_u32 v210, s50, v207
    s_waitcnt lgkmcnt(6)
    v_mfma_f32_16x16x32_bf16 v[20:23], v[140:143], v[88:91], v[20:23]
    ds_read_b64_tr_b16 v[132:133], v148 offset:0
    ds_read_b64_tr_b16 v[134:135], v148 offset:6144
    v_mfma_f32_16x16x32_bf16 v[56:59], v[140:143], v[92:95], v[56:59]
    s_waitcnt lgkmcnt(6)
    v_mfma_f32_16x16x32_bf16 v[24:27], v[120:123], v[88:91], v[24:27]
    ds_read_b64_tr_b16 v[136:137], v148 offset:24576
    ds_read_b64_tr_b16 v[138:139], v148 offset:30720
    v_mfma_f32_16x16x32_bf16 v[60:63], v[120:123], v[92:95], v[60:63]
    s_waitcnt lgkmcnt(6)
    v_mfma_f32_16x16x32_bf16 v[28:31], v[124:127], v[88:91], v[28:31]
    ds_read_b64_tr_b16 v[140:141], v144 offset:0
    ds_read_b64_tr_b16 v[142:143], v144 offset:6144
    v_mfma_f32_16x16x32_bf16 v[64:67], v[124:127], v[92:95], v[64:67]
    s_waitcnt lgkmcnt(6)
    v_mfma_f32_16x16x32_bf16 v[32:35], v[128:131], v[88:91], v[32:35]
    ds_read_b64_tr_b16 v[120:121], v148 offset:128
    ds_read_b64_tr_b16 v[122:123], v148 offset:6272
    v_mfma_f32_16x16x32_bf16 v[68:71], v[128:131], v[92:95], v[68:71]
    s_waitcnt lgkmcnt(6)
    v_mfma_f32_16x16x32_bf16 v[0:3], v[132:135], v[96:99], v[0:3]
    ds_read_b64_tr_b16 v[124:125], v148 offset:24704
    ds_read_b64_tr_b16 v[126:127], v148 offset:30848
    v_mfma_f32_16x16x32_bf16 v[36:39], v[132:135], v[100:103], v[36:39]
    s_waitcnt lgkmcnt(6)
    v_mfma_f32_16x16x32_bf16 v[0:3], v[136:139], v[104:107], v[0:3]
    ds_read_b64_tr_b16 v[128:129], v144 offset:128
    ds_read_b64_tr_b16 v[130:131], v144 offset:6272
    v_mfma_f32_16x16x32_bf16 v[36:39], v[136:139], v[108:111], v[36:39]
    s_waitcnt lgkmcnt(6)
    v_mfma_f32_16x16x32_bf16 v[0:3], v[140:143], v[112:115], v[0:3]
    ds_read_b64_tr_b16 v[132:133], v149 offset:0
    ds_read_b64_tr_b16 v[134:135], v149 offset:6144
    v_mfma_f32_16x16x32_bf16 v[36:39], v[140:143], v[116:119], v[36:39]
    s_waitcnt lgkmcnt(6)
    v_mfma_f32_16x16x32_bf16 v[16:19], v[120:123], v[96:99], v[16:19]
    ds_read_b64_tr_b16 v[136:137], v149 offset:24576
    ds_read_b64_tr_b16 v[138:139], v149 offset:30720
    v_mfma_f32_16x16x32_bf16 v[52:55], v[120:123], v[100:103], v[52:55]
    s_waitcnt lgkmcnt(6)
    v_mfma_f32_16x16x32_bf16 v[16:19], v[124:127], v[104:107], v[16:19]
    ds_read_b64_tr_b16 v[140:141], v145 offset:0
    ds_read_b64_tr_b16 v[142:143], v145 offset:6144
    v_mfma_f32_16x16x32_bf16 v[52:55], v[124:127], v[108:111], v[52:55]
    s_waitcnt lgkmcnt(6)
    v_mfma_f32_16x16x32_bf16 v[16:19], v[128:131], v[112:115], v[16:19]
    ds_read_b64_tr_b16 v[120:121], v149 offset:128
    ds_read_b64_tr_b16 v[122:123], v149 offset:6272
    v_mfma_f32_16x16x32_bf16 v[52:55], v[128:131], v[116:119], v[52:55]
    s_waitcnt lgkmcnt(6)
    v_mfma_f32_16x16x32_bf16 v[4:7], v[132:135], v[96:99], v[4:7]
    ds_read_b64_tr_b16 v[124:125], v149 offset:24704
    ds_read_b64_tr_b16 v[126:127], v149 offset:30848
    v_mfma_f32_16x16x32_bf16 v[40:43], v[132:135], v[100:103], v[40:43]
    s_waitcnt lgkmcnt(6)
    v_mfma_f32_16x16x32_bf16 v[4:7], v[136:139], v[104:107], v[4:7]
    ds_read_b64_tr_b16 v[128:129], v145 offset:128
    ds_read_b64_tr_b16 v[130:131], v145 offset:6272
    v_mfma_f32_16x16x32_bf16 v[40:43], v[136:139], v[108:111], v[40:43]
    s_waitcnt lgkmcnt(6)
    v_mfma_f32_16x16x32_bf16 v[4:7], v[140:143], v[112:115], v[4:7]
    ds_read_b64_tr_b16 v[132:133], v150 offset:0
    ds_read_b64_tr_b16 v[134:135], v150 offset:6144
    v_mfma_f32_16x16x32_bf16 v[40:43], v[140:143], v[116:119], v[40:43]
    ds_write_b128 v209, v[36:39] offset:0
    ds_write_b128 v209, v[52:55] offset:1024
    s_waitcnt lgkmcnt(0)
    s_barrier
    ds_read_b128 v[188:191], v210 offset:0
    ds_read_b128 v[192:195], v210 offset:1024
    v_mfma_f32_16x16x32_bf16 v[20:23], v[120:123], v[96:99], v[20:23]
    ds_read_b64_tr_b16 v[136:137], v150 offset:24576
    ds_read_b64_tr_b16 v[138:139], v150 offset:30720
    v_mfma_f32_16x16x32_bf16 v[56:59], v[120:123], v[100:103], v[56:59]
    v_mfma_f32_16x16x32_bf16 v[20:23], v[124:127], v[104:107], v[20:23]
    ds_read_b64_tr_b16 v[140:141], v146 offset:0
    ds_read_b64_tr_b16 v[142:143], v146 offset:6144
    v_mfma_f32_16x16x32_bf16 v[56:59], v[124:127], v[108:111], v[56:59]
    v_mfma_f32_16x16x32_bf16 v[20:23], v[128:131], v[112:115], v[20:23]
    ds_read_b64_tr_b16 v[120:121], v150 offset:128
    ds_read_b64_tr_b16 v[122:123], v150 offset:6272
    v_mfma_f32_16x16x32_bf16 v[56:59], v[128:131], v[116:119], v[56:59]
    s_waitcnt lgkmcnt(7)
    v_add_f32 v0, v0, v188
    v_add_f32 v1, v1, v189
    v_add_f32 v2, v2, v190
    v_add_f32 v3, v3, v191
    s_waitcnt lgkmcnt(6)
    v_add_f32 v16, v16, v192
    v_add_f32 v17, v17, v193
    v_add_f32 v18, v18, v194
    v_add_f32 v19, v19, v195
    s_cmp_eq_u32 s54, 0
    s_cbranch_scc1 Lk4_kernel_own1
    v_cvt_pk_bf16_f32 v180, v0, v1
    v_cvt_pk_bf16_f32 v181, v2, v3
    v_cvt_pk_bf16_f32 v182, v16, v17
    v_cvt_pk_bf16_f32 v183, v18, v19
    buffer_store_dwordx4 v[180:183], v207, s[16:19], s48 offen offset:0 sc1
    s_branch Lk4_kernel_ownj1
Lk4_kernel_own1:
    s_add_u32 s50, s49, 0
    buffer_load_dwordx2 v[156:157], v211, s[16:19], s50 offen
    s_add_u32 s50, s49, 2048
    buffer_load_dwordx2 v[164:165], v211, s[16:19], s50 offen
Lk4_kernel_ownj1:
    v_mfma_f32_16x16x32_bf16 v[8:11], v[132:135], v[96:99], v[8:11]
    ds_read_b64_tr_b16 v[124:125], v150 offset:24704
    ds_read_b64_tr_b16 v[126:127], v150 offset:30848
    v_mfma_f32_16x16x32_bf16 v[44:47], v[132:135], v[100:103], v[44:47]
    s_waitcnt lgkmcnt(6)
    v_mfma_f32_16x16x32_bf16 v[8:11], v[136:139], v[104:107], v[8:11]
    ds_read_b64_tr_b16 v[128:129], v146 offset:128
    ds_read_b64_tr_b16 v[130:131], v146 offset:6272
    v_mfma_f32_16x16x32_bf16 v[44:47], v[136:139], v[108:111], v[44:47]
    s_waitcnt lgkmcnt(6)
    v_mfma_f32_16x16x32_bf16 v[8:11], v[140:143], v[112:115], v[8:11]
    ds_read_b64_tr_b16 v[132:133], v151 offset:0
    ds_read_b64_tr_b16 v[134:135], v151 offset:6144
    v_mfma_f32_16x16x32_bf16 v[44:47], v[140:143], v[116:119], v[44:47]
    ds_write_b128 v209, v[40:43] offset:24576
    ds_write_b128 v209, v[56:59] offset:25600
    s_waitcnt lgkmcnt(0)
    s_barrier
    ds_read_b128 v[188:191], v210 offset:24576
    ds_read_b128 v[192:195], v210 offset:25600
    v_mfma_f32_16x16x32_bf16 v[24:27], v[120:123], v[96:99], v[24:27]
    ds_read_b64_tr_b16 v[136:137], v151 offset:24576
    ds_read_b64_tr_b16 v[138:139], v151 offset:30720
    v_mfma_f32_16x16x32_bf16 v[60:63], v[120:123], v[100:103], v[60:63]
    v_mfma_f32_16x16x32_bf16 v[24:27], v[124:127], v[104:107], v[24:27]
    ds_read_b64_tr_b16 v[140:141], v147 offset:0
    ds_read_b64_tr_b16 v[142:143], v147 offset:6144
    v_mfma_f32_16x16x32_bf16 v[60:63], v[124:127], v[108:111], v[60:63]
    v_mfma_f32_16x16x32_bf16 v[24:27], v[128:131], v[112:115], v[24:27]
    ds_read_b64_tr_b16 v[120:121], v151 offset:128
    ds_read_b64_tr_b16 v[122:123], v151 offset:6272
    v_mfma_f32_16x16x32_bf16 v[60:63], v[128:131], v[116:119], v[60:63]
    s_waitcnt lgkmcnt(7)
    v_add_f32 v4, v4, v188
    v_add_f32 v5, v5, v189
    v_add_f32 v6, v6, v190
    v_add_f32 v7, v7, v191
    s_waitcnt lgkmcnt(6)
    v_add_f32 v20, v20, v192
    v_add_f32 v21, v21, v193
    v_add_f32 v22, v22, v194
    v_add_f32 v23, v23, v195
    s_cmp_eq_u32 s54, 1
    s_cbranch_scc1 Lk4_kernel_own2
    v_cvt_pk_bf16_f32 v176, v4, v5
    v_cvt_pk_bf16_f32 v177, v6, v7
    v_cvt_pk_bf16_f32 v178, v20, v21
    v_cvt_pk_bf16_f32 v179, v22, v23
    buffer_store_dwordx4 v[176:179], v207, s[16:19], s48 offen offset:1024 sc1
    s_branch Lk4_kernel_ownj2
Lk4_kernel_own2:
    s_add_u32 s50, s49, 512
    buffer_load_dwordx2 v[158:159], v211, s[16:19], s50 offen
    s_add_u32 s50, s49, 2560
    buffer_load_dwordx2 v[166:167], v211, s[16:19], s50 offen
Lk4_kernel_ownj2:
    v_mfma_f32_16x16x32_bf16 v[12:15], v[132:135], v[96:99], v[12:15]
    ds_read_b64_tr_b16 v[124:125], v151 offset:24704
    ds_read_b64_tr_b16 v[126:127], v151 offset:30848
    v_mfma_f32_16x16x32_bf16 v[48:51], v[132:135], v[100:103], v[48:51]
    s_waitcnt lgkmcnt(6)
    v_mfma_f32_16x16x32_bf16 v[12:15], v[136:139], v[104:107], v[12:15]
    ds_read_b64_tr_b16 v[128:129], v147 offset:128
    ds_read_b64_tr_b16 v[130:131], v147 offset:6272
    v_mfma_f32_16x16x32_bf16 v[48:51], v[136:139], v[108:111], v[48:51]
    s_waitcnt lgkmcnt(6)
    v_mfma_f32_16x16x32_bf16 v[12:15], v[140:143], v[112:115], v[12:15]
    ds_read_b64_tr_b16 v[132:133], v148 offset:256
    ds_read_b64_tr_b16 v[134:135], v148 offset:6400
    v_mfma_f32_16x16x32_bf16 v[48:51], v[140:143], v[116:119], v[48:51]
    ds_write_b128 v209, v[44:47] offset:0
    ds_write_b128 v209, v[60:63] offset:1024
    s_waitcnt lgkmcnt(0)
    s_barrier
    ds_read_b128 v[188:191], v210 offset:0
    ds_read_b128 v[192:195], v210 offset:1024
    v_mfma_f32_16x16x32_bf16 v[28:31], v[120:123], v[96:99], v[28:31]
    ds_read_b64_tr_b16 v[136:137], v148 offset:24832
    ds_read_b64_tr_b16 v[138:139], v148 offset:30976
    v_mfma_f32_16x16x32_bf16 v[64:67], v[120:123], v[100:103], v[64:67]
    v_mfma_f32_16x16x32_bf16 v[28:31], v[124:127], v[104:107], v[28:31]
    ds_read_b64_tr_b16 v[140:141], v144 offset:256
    ds_read_b64_tr_b16 v[142:143], v144 offset:6400
    v_mfma_f32_16x16x32_bf16 v[64:67], v[124:127], v[108:111], v[64:67]
    v_mfma_f32_16x16x32_bf16 v[28:31], v[128:131], v[112:115], v[28:31]
    v_mfma_f32_16x16x32_bf16 v[64:67], v[128:131], v[116:119], v[64:67]
    s_waitcnt lgkmcnt(5)
    v_add_f32 v8, v8, v188
    v_add_f32 v9, v9, v189
    v_add_f32 v10, v10, v190
    v_add_f32 v11, v11, v191
    s_waitcnt lgkmcnt(4)
    v_add_f32 v24, v24, v192
    v_add_f32 v25, v25, v193
    v_add_f32 v26, v26, v194
    v_add_f32 v27, v27, v195
    s_cmp_eq_u32 s54, 2
    s_cbranch_scc1 Lk4_kernel_own3
    v_cvt_pk_bf16_f32 v180, v8, v9
    v_cvt_pk_bf16_f32 v181, v10, v11
    v_cvt_pk_bf16_f32 v182, v24, v25
    v_cvt_pk_bf16_f32 v183, v26, v27
    buffer_store_dwordx4 v[180:183], v207, s[16:19], s48 offen offset:2048 sc1
    s_branch Lk4_kernel_ownj3
Lk4_kernel_own3:
    s_add_u32 s50, s49, 1024
    buffer_load_dwordx2 v[160:161], v211, s[16:19], s50 offen
    s_add_u32 s50, s49, 3072
    buffer_load_dwordx2 v[168:169], v211, s[16:19], s50 offen
Lk4_kernel_ownj3:
    v_mfma_f32_16x16x32_bf16 v[32:35], v[132:135], v[96:99], v[32:35]
    v_mfma_f32_16x16x32_bf16 v[68:71], v[132:135], v[100:103], v[68:71]
    s_waitcnt lgkmcnt(2)
    v_mfma_f32_16x16x32_bf16 v[32:35], v[136:139], v[104:107], v[32:35]
    v_mfma_f32_16x16x32_bf16 v[68:71], v[136:139], v[108:111], v[68:71]
    s_waitcnt lgkmcnt(0)
    v_mfma_f32_16x16x32_bf16 v[32:35], v[140:143], v[112:115], v[32:35]
    v_mfma_f32_16x16x32_bf16 v[68:71], v[140:143], v[116:119], v[68:71]
    ds_write_b128 v209, v[48:51] offset:24576
    ds_write_b128 v209, v[64:67] offset:25600
    s_waitcnt lgkmcnt(0)
    s_barrier
    ds_read_b128 v[188:191], v210 offset:24576
    ds_read_b128 v[192:195], v210 offset:25600
    s_waitcnt lgkmcnt(1)
    v_add_f32 v12, v12, v188
    v_add_f32 v13, v13, v189
    v_add_f32 v14, v14, v190
    v_add_f32 v15, v15, v191
    s_waitcnt lgkmcnt(0)
    v_add_f32 v28, v28, v192
    v_add_f32 v29, v29, v193
    v_add_f32 v30, v30, v194
    v_add_f32 v31, v31, v195
    s_cmp_eq_u32 s54, 3
    s_cbranch_scc1 Lk4_kernel_own4
    v_cvt_pk_bf16_f32 v176, v12, v13
    v_cvt_pk_bf16_f32 v177, v14, v15
    v_cvt_pk_bf16_f32 v178, v28, v29
    v_cvt_pk_bf16_f32 v179, v30, v31
    buffer_store_dwordx4 v[176:179], v207, s[16:19], s48 offen offset:3072 sc1
    s_branch Lk4_kernel_ownj4
Lk4_kernel_own4:
    s_add_u32 s50, s49, 1536
    buffer_load_dwordx2 v[162:163], v211, s[16:19], s50 offen
    s_add_u32 s50, s49, 3584
    buffer_load_dwordx2 v[170:171], v211, s[16:19], s50 offen
Lk4_kernel_ownj4:
    ds_write_b128 v209, v[68:71] offset:0
    s_waitcnt lgkmcnt(0)
    s_barrier
    ds_read_b128 v[188:191], v210 offset:0
    s_waitcnt lgkmcnt(0)
    v_add_f32 v32, v32, v188
    v_add_f32 v33, v33, v189
    v_add_f32 v34, v34, v190
    v_add_f32 v35, v35, v191
    s_cmp_eq_u32 s54, 0
    s_cbranch_scc1 Lk4_kernel_own5
    v_cvt_pk_bf16_f32 v180, v32, v33
    v_cvt_pk_bf16_f32 v181, v34, v35
    s_add_u32 s50, s48, 4096
    buffer_store_dwordx2 v[180:181], v211, s[16:19], s50 offen sc1
    s_branch Lk4_kernel_ownj5
Lk4_kernel_own5:
    s_add_u32 s50, s49, 4096
    buffer_load_dwordx2 v[172:173], v211, s[16:19], s50 offen
Lk4_kernel_ownj5:
    v_lshrrev_b32 v200, 4, v207
    v_and_b32 v201, 15, v200
    v_lshrrev_b32 v200, 4, v200
    v_mul_u32_u24 v201, 1152, v201
    v_lshl_add_u32 v201, v200, 3, v201
    s_add_u32 s49, s35, s39
    s_mul_i32 s49, s49, 18432
    s_mul_i32 s50, s34, 288
    s_add_u32 s49, s49, s50
    s_waitcnt vmcnt(0)
    s_barrier
    s_cmp_lg_u32 s30, 0
    s_cbranch_scc1 Lk4_kernel_noat
    s_lshl_b32 s50, s46, 7
    s_add_u32 s50, s50, 14417920
    s_lshl_b32 s51, s33, 2
    v_mov_b32 v212, s51
    v_mov_b32 v213, 1
    v_mov_b32 v214, 0
    s_mov_b64 exec, 1
    buffer_store_dword v213, v212, s[16:19], s50 offen sc1
Lk4_kernel_poll:
    buffer_load_dwordx4 v[196:199], v214, s[16:19], s50 offen sc1
    s_waitcnt vmcnt(0)
    v_and_b32 v196, v196, v197
    v_and_b32 v198, v198, v199
    v_and_b32 v196, v196, v198
    s_nop 0
    v_readfirstlane_b32 s51, v196
    s_nop 0
    s_cmp_lg_u32 s51, 1
    s_cbranch_scc1 Lk4_kernel_poll
    s_mov_b64 exec, -1
Lk4_kernel_noat:
    s_barrier
    s_lshl_b32 s55, s54, 10
    s_add_u32 s50, s33, 1
    s_and_b32 s50, s50, 3
    s_mul_i32 s50, s50, 2359296
    s_add_u32 s50, s50, s47
    s_add_u32 s56, s50, 4096
    s_add_u32 s50, s50, s55
    buffer_load_dwordx4 v[112:115], v207, s[16:19], s50 offen sc1
    s_add_u32 s50, s33, 2
    s_and_b32 s50, s50, 3
    s_mul_i32 s50, s50, 2359296
    s_add_u32 s50, s50, s47
    s_add_u32 s57, s50, 4096
    s_add_u32 s50, s50, s55
    buffer_load_dwordx4 v[116:119], v207, s[16:19], s50 offen sc1
    s_add_u32 s50, s33, 3
    s_and_b32 s50, s50, 3
    s_mul_i32 s50, s50, 2359296
    s_add_u32 s50, s50, s47
    s_add_u32 s58, s50, 4096
    s_add_u32 s50, s50, s55
    buffer_load_dwordx4 v[120:123], v207, s[16:19], s50 offen sc1
    s_cmp_lg_u32 s54, 0
    s_cbranch_scc1 Lk4_kernel_no8
    buffer_load_dwordx2 v[124:125], v211, s[16:19], s56 offen sc1
    buffer_load_dwordx2 v[126:127], v211, s[16:19], s57 offen sc1
    buffer_load_dwordx2 v[128:129], v211, s[16:19], s58 offen sc1
Lk4_kernel_no8:
    s_waitcnt vmcnt(0)
    s_cmp_lg_u32 s54, 0
    s_cbranch_scc1 Lk4_kernel_sk6
    v_lshlrev_b32 v202, 16, v112
    v_and_b32 v203, 0xffff0000, v112
    v_lshlrev_b32 v204, 16, v113
    v_and_b32 v205, 0xffff0000, v113
    v_add_f32 v0, v0, v202
    v_add_f32 v1, v1, v203
    v_add_f32 v2, v2, v204
    v_add_f32 v3, v3, v205
    v_lshlrev_b32 v202, 16, v116
    v_and_b32 v203, 0xffff0000, v116
    v_lshlrev_b32 v204, 16, v117
    v_and_b32 v205, 0xffff0000, v117
    v_add_f32 v0, v0, v202
    v_add_f32 v1, v1, v203
    v_add_f32 v2, v2, v204
    v_add_f32 v3, v3, v205
    v_lshlrev_b32 v202, 16, v120
    v_and_b32 v203, 0xffff0000, v120
    v_lshlrev_b32 v204, 16, v121
    v_and_b32 v205, 0xffff0000, v121
    v_add_f32 v0, v0, v202
    v_add_f32 v1, v1, v203
    v_add_f32 v2, v2, v204
    v_add_f32 v3, v3, v205
    v_lshlrev_b32 v202, 16, v156
    v_and_b32 v203, 0xffff0000, v156
    v_lshlrev_b32 v204, 16, v157
    v_and_b32 v205, 0xffff0000, v157
    v_add_f32 v0, v0, v202
    v_add_f32 v1, v1, v203
    v_add_f32 v2, v2, v204
    v_add_f32 v3, v3, v205
    v_cvt_pk_bf16_f32 v0, v0, v1
    v_cvt_pk_bf16_f32 v1, v2, v3
    buffer_store_dwordx2 v[0:1], v201, s[12:15], s49 offen offset:0
    v_lshlrev_b32 v202, 16, v114
    v_and_b32 v203, 0xffff0000, v114
    v_lshlrev_b32 v204, 16, v115
    v_and_b32 v205, 0xffff0000, v115
    v_add_f32 v16, v16, v202
    v_add_f32 v17, v17, v203
    v_add_f32 v18, v18, v204
    v_add_f32 v19, v19, v205
    v_lshlrev_b32 v202, 16, v118
    v_and_b32 v203, 0xffff0000, v118
    v_lshlrev_b32 v204, 16, v119
    v_and_b32 v205, 0xffff0000, v119
    v_add_f32 v16, v16, v202
    v_add_f32 v17, v17, v203
    v_add_f32 v18, v18, v204
    v_add_f32 v19, v19, v205
    v_lshlrev_b32 v202, 16, v122
    v_and_b32 v203, 0xffff0000, v122
    v_lshlrev_b32 v204, 16, v123
    v_and_b32 v205, 0xffff0000, v123
    v_add_f32 v16, v16, v202
    v_add_f32 v17, v17, v203
    v_add_f32 v18, v18, v204
    v_add_f32 v19, v19, v205
    v_lshlrev_b32 v202, 16, v164
    v_and_b32 v203, 0xffff0000, v164
    v_lshlrev_b32 v204, 16, v165
    v_and_b32 v205, 0xffff0000, v165
    v_add_f32 v16, v16, v202
    v_add_f32 v17, v17, v203
    v_add_f32 v18, v18, v204
    v_add_f32 v19, v19, v205
    v_cvt_pk_bf16_f32 v16, v16, v17
    v_cvt_pk_bf16_f32 v17, v18, v19
    buffer_store_dwordx2 v[16:17], v201, s[12:15], s49 offen offset:128
    v_lshlrev_b32 v202, 16, v124
    v_and_b32 v203, 0xffff0000, v124
    v_lshlrev_b32 v204, 16, v125
    v_and_b32 v205, 0xffff0000, v125
    v_add_f32 v32, v32, v202
    v_add_f32 v33, v33, v203
    v_add_f32 v34, v34, v204
    v_add_f32 v35, v35, v205
    v_lshlrev_b32 v202, 16, v126
    v_and_b32 v203, 0xffff0000, v126
    v_lshlrev_b32 v204, 16, v127
    v_and_b32 v205, 0xffff0000, v127
    v_add_f32 v32, v32, v202
    v_add_f32 v33, v33, v203
    v_add_f32 v34, v34, v204
    v_add_f32 v35, v35, v205
    v_lshlrev_b32 v202, 16, v128
    v_and_b32 v203, 0xffff0000, v128
    v_lshlrev_b32 v204, 16, v129
    v_and_b32 v205, 0xffff0000, v129
    v_add_f32 v32, v32, v202
    v_add_f32 v33, v33, v203
    v_add_f32 v34, v34, v204
    v_add_f32 v35, v35, v205
    v_lshlrev_b32 v202, 16, v172
    v_and_b32 v203, 0xffff0000, v172
    v_lshlrev_b32 v204, 16, v173
    v_and_b32 v205, 0xffff0000, v173
    v_add_f32 v32, v32, v202
    v_add_f32 v33, v33, v203
    v_add_f32 v34, v34, v204
    v_add_f32 v35, v35, v205
    v_cvt_pk_bf16_f32 v32, v32, v33
    v_cvt_pk_bf16_f32 v33, v34, v35
    buffer_store_dwordx2 v[32:33], v201, s[12:15], s49 offen offset:256
Lk4_kernel_sk6:
    s_cmp_lg_u32 s54, 1
    s_cbranch_scc1 Lk4_kernel_sk7
    v_lshlrev_b32 v202, 16, v112
    v_and_b32 v203, 0xffff0000, v112
    v_lshlrev_b32 v204, 16, v113
    v_and_b32 v205, 0xffff0000, v113
    v_add_f32 v4, v4, v202
    v_add_f32 v5, v5, v203
    v_add_f32 v6, v6, v204
    v_add_f32 v7, v7, v205
    v_lshlrev_b32 v202, 16, v116
    v_and_b32 v203, 0xffff0000, v116
    v_lshlrev_b32 v204, 16, v117
    v_and_b32 v205, 0xffff0000, v117
    v_add_f32 v4, v4, v202
    v_add_f32 v5, v5, v203
    v_add_f32 v6, v6, v204
    v_add_f32 v7, v7, v205
    v_lshlrev_b32 v202, 16, v120
    v_and_b32 v203, 0xffff0000, v120
    v_lshlrev_b32 v204, 16, v121
    v_and_b32 v205, 0xffff0000, v121
    v_add_f32 v4, v4, v202
    v_add_f32 v5, v5, v203
    v_add_f32 v6, v6, v204
    v_add_f32 v7, v7, v205
    v_lshlrev_b32 v202, 16, v158
    v_and_b32 v203, 0xffff0000, v158
    v_lshlrev_b32 v204, 16, v159
    v_and_b32 v205, 0xffff0000, v159
    v_add_f32 v4, v4, v202
    v_add_f32 v5, v5, v203
    v_add_f32 v6, v6, v204
    v_add_f32 v7, v7, v205
    v_cvt_pk_bf16_f32 v4, v4, v5
    v_cvt_pk_bf16_f32 v5, v6, v7
    buffer_store_dwordx2 v[4:5], v201, s[12:15], s49 offen offset:32
    v_lshlrev_b32 v202, 16, v114
    v_and_b32 v203, 0xffff0000, v114
    v_lshlrev_b32 v204, 16, v115
    v_and_b32 v205, 0xffff0000, v115
    v_add_f32 v20, v20, v202
    v_add_f32 v21, v21, v203
    v_add_f32 v22, v22, v204
    v_add_f32 v23, v23, v205
    v_lshlrev_b32 v202, 16, v118
    v_and_b32 v203, 0xffff0000, v118
    v_lshlrev_b32 v204, 16, v119
    v_and_b32 v205, 0xffff0000, v119
    v_add_f32 v20, v20, v202
    v_add_f32 v21, v21, v203
    v_add_f32 v22, v22, v204
    v_add_f32 v23, v23, v205
    v_lshlrev_b32 v202, 16, v122
    v_and_b32 v203, 0xffff0000, v122
    v_lshlrev_b32 v204, 16, v123
    v_and_b32 v205, 0xffff0000, v123
    v_add_f32 v20, v20, v202
    v_add_f32 v21, v21, v203
    v_add_f32 v22, v22, v204
    v_add_f32 v23, v23, v205
    v_lshlrev_b32 v202, 16, v166
    v_and_b32 v203, 0xffff0000, v166
    v_lshlrev_b32 v204, 16, v167
    v_and_b32 v205, 0xffff0000, v167
    v_add_f32 v20, v20, v202
    v_add_f32 v21, v21, v203
    v_add_f32 v22, v22, v204
    v_add_f32 v23, v23, v205
    v_cvt_pk_bf16_f32 v20, v20, v21
    v_cvt_pk_bf16_f32 v21, v22, v23
    buffer_store_dwordx2 v[20:21], v201, s[12:15], s49 offen offset:160
Lk4_kernel_sk7:
    s_cmp_lg_u32 s54, 2
    s_cbranch_scc1 Lk4_kernel_sk8
    v_lshlrev_b32 v202, 16, v112
    v_and_b32 v203, 0xffff0000, v112
    v_lshlrev_b32 v204, 16, v113
    v_and_b32 v205, 0xffff0000, v113
    v_add_f32 v8, v8, v202
    v_add_f32 v9, v9, v203
    v_add_f32 v10, v10, v204
    v_add_f32 v11, v11, v205
    v_lshlrev_b32 v202, 16, v116
    v_and_b32 v203, 0xffff0000, v116
    v_lshlrev_b32 v204, 16, v117
    v_and_b32 v205, 0xffff0000, v117
    v_add_f32 v8, v8, v202
    v_add_f32 v9, v9, v203
    v_add_f32 v10, v10, v204
    v_add_f32 v11, v11, v205
    v_lshlrev_b32 v202, 16, v120
    v_and_b32 v203, 0xffff0000, v120
    v_lshlrev_b32 v204, 16, v121
    v_and_b32 v205, 0xffff0000, v121
    v_add_f32 v8, v8, v202
    v_add_f32 v9, v9, v203
    v_add_f32 v10, v10, v204
    v_add_f32 v11, v11, v205
    v_lshlrev_b32 v202, 16, v160
    v_and_b32 v203, 0xffff0000, v160
    v_lshlrev_b32 v204, 16, v161
    v_and_b32 v205, 0xffff0000, v161
    v_add_f32 v8, v8, v202
    v_add_f32 v9, v9, v203
    v_add_f32 v10, v10, v204
    v_add_f32 v11, v11, v205
    v_cvt_pk_bf16_f32 v8, v8, v9
    v_cvt_pk_bf16_f32 v9, v10, v11
    buffer_store_dwordx2 v[8:9], v201, s[12:15], s49 offen offset:64
    v_lshlrev_b32 v202, 16, v114
    v_and_b32 v203, 0xffff0000, v114
    v_lshlrev_b32 v204, 16, v115
    v_and_b32 v205, 0xffff0000, v115
    v_add_f32 v24, v24, v202
    v_add_f32 v25, v25, v203
    v_add_f32 v26, v26, v204
    v_add_f32 v27, v27, v205
    v_lshlrev_b32 v202, 16, v118
    v_and_b32 v203, 0xffff0000, v118
    v_lshlrev_b32 v204, 16, v119
    v_and_b32 v205, 0xffff0000, v119
    v_add_f32 v24, v24, v202
    v_add_f32 v25, v25, v203
    v_add_f32 v26, v26, v204
    v_add_f32 v27, v27, v205
    v_lshlrev_b32 v202, 16, v122
    v_and_b32 v203, 0xffff0000, v122
    v_lshlrev_b32 v204, 16, v123
    v_and_b32 v205, 0xffff0000, v123
    v_add_f32 v24, v24, v202
    v_add_f32 v25, v25, v203
    v_add_f32 v26, v26, v204
    v_add_f32 v27, v27, v205
    v_lshlrev_b32 v202, 16, v168
    v_and_b32 v203, 0xffff0000, v168
    v_lshlrev_b32 v204, 16, v169
    v_and_b32 v205, 0xffff0000, v169
    v_add_f32 v24, v24, v202
    v_add_f32 v25, v25, v203
    v_add_f32 v26, v26, v204
    v_add_f32 v27, v27, v205
    v_cvt_pk_bf16_f32 v24, v24, v25
    v_cvt_pk_bf16_f32 v25, v26, v27
    buffer_store_dwordx2 v[24:25], v201, s[12:15], s49 offen offset:192
Lk4_kernel_sk8:
    s_cmp_lg_u32 s54, 3
    s_cbranch_scc1 Lk4_kernel_sk9
    v_lshlrev_b32 v202, 16, v112
    v_and_b32 v203, 0xffff0000, v112
    v_lshlrev_b32 v204, 16, v113
    v_and_b32 v205, 0xffff0000, v113
    v_add_f32 v12, v12, v202
    v_add_f32 v13, v13, v203
    v_add_f32 v14, v14, v204
    v_add_f32 v15, v15, v205
    v_lshlrev_b32 v202, 16, v116
    v_and_b32 v203, 0xffff0000, v116
    v_lshlrev_b32 v204, 16, v117
    v_and_b32 v205, 0xffff0000, v117
    v_add_f32 v12, v12, v202
    v_add_f32 v13, v13, v203
    v_add_f32 v14, v14, v204
    v_add_f32 v15, v15, v205
    v_lshlrev_b32 v202, 16, v120
    v_and_b32 v203, 0xffff0000, v120
    v_lshlrev_b32 v204, 16, v121
    v_and_b32 v205, 0xffff0000, v121
    v_add_f32 v12, v12, v202
    v_add_f32 v13, v13, v203
    v_add_f32 v14, v14, v204
    v_add_f32 v15, v15, v205
    v_lshlrev_b32 v202, 16, v162
    v_and_b32 v203, 0xffff0000, v162
    v_lshlrev_b32 v204, 16, v163
    v_and_b32 v205, 0xffff0000, v163
    v_add_f32 v12, v12, v202
    v_add_f32 v13, v13, v203
    v_add_f32 v14, v14, v204
    v_add_f32 v15, v15, v205
    v_cvt_pk_bf16_f32 v12, v12, v13
    v_cvt_pk_bf16_f32 v13, v14, v15
    buffer_store_dwordx2 v[12:13], v201, s[12:15], s49 offen offset:96
    v_lshlrev_b32 v202, 16, v114
    v_and_b32 v203, 0xffff0000, v114
    v_lshlrev_b32 v204, 16, v115
    v_and_b32 v205, 0xffff0000, v115
    v_add_f32 v28, v28, v202
    v_add_f32 v29, v29, v203
    v_add_f32 v30, v30, v204
    v_add_f32 v31, v31, v205
    v_lshlrev_b32 v202, 16, v118
    v_and_b32 v203, 0xffff0000, v118
    v_lshlrev_b32 v204, 16, v119
    v_and_b32 v205, 0xffff0000, v119
    v_add_f32 v28, v28, v202
    v_add_f32 v29, v29, v203
    v_add_f32 v30, v30, v204
    v_add_f32 v31, v31, v205
    v_lshlrev_b32 v202, 16, v122
    v_and_b32 v203, 0xffff0000, v122
    v_lshlrev_b32 v204, 16, v123
    v_and_b32 v205, 0xffff0000, v123
    v_add_f32 v28, v28, v202
    v_add_f32 v29, v29, v203
    v_add_f32 v30, v30, v204
    v_add_f32 v31, v31, v205
    v_lshlrev_b32 v202, 16, v170
    v_and_b32 v203, 0xffff0000, v170
    v_lshlrev_b32 v204, 16, v171
    v_and_b32 v205, 0xffff0000, v171
    v_add_f32 v28, v28, v202
    v_add_f32 v29, v29, v203
    v_add_f32 v30, v30, v204
    v_add_f32 v31, v31, v205
    v_cvt_pk_bf16_f32 v28, v28, v29
    v_cvt_pk_bf16_f32 v29, v30, v31
    buffer_store_dwordx2 v[28:29], v201, s[12:15], s49 offen offset:224
Lk4_kernel_sk9:
Lk4_kernel_end:
    s_endpgm
Lcode_end:
.section .rodata,"a"
.p2align 6
.amdhsa_kernel k1_kernel
  .amdhsa_next_free_vgpr 184
  .amdhsa_next_free_sgpr 102
  .amdhsa_accum_offset 184
  .amdhsa_group_segment_fixed_size 0
  .amdhsa_kernarg_size 80
  .amdhsa_user_sgpr_count 2
  .amdhsa_user_sgpr_kernarg_segment_ptr 1
  .amdhsa_system_sgpr_workgroup_id_x 1
  .amdhsa_float_denorm_mode_32 3
.end_amdhsa_kernel
.p2align 6
.amdhsa_kernel k2_kernel
  .amdhsa_next_free_vgpr 252
  .amdhsa_next_free_sgpr 102
  .amdhsa_accum_offset 252
  .amdhsa_group_segment_fixed_size 0
  .amdhsa_kernarg_size 80
  .amdhsa_user_sgpr_count 2
  .amdhsa_user_sgpr_kernarg_segment_ptr 1
  .amdhsa_system_sgpr_workgroup_id_x 1
  .amdhsa_float_denorm_mode_32 3
.end_amdhsa_kernel
.p2align 6
.amdhsa_kernel k3_kernel
  .amdhsa_next_free_vgpr 256
  .amdhsa_next_free_sgpr 102
  .amdhsa_accum_offset 256
  .amdhsa_group_segment_fixed_size 0
  .amdhsa_kernarg_size 80
  .amdhsa_user_sgpr_count 2
  .amdhsa_user_sgpr_kernarg_segment_ptr 1
  .amdhsa_system_sgpr_workgroup_id_x 1
  .amdhsa_float_denorm_mode_32 3
.end_amdhsa_kernel
.p2align 6
.amdhsa_kernel k4_kernel
  .amdhsa_next_free_vgpr 216
  .amdhsa_next_free_sgpr 102
  .amdhsa_accum_offset 216
  .amdhsa_group_segment_fixed_size 0
  .amdhsa_kernarg_size 80
  .amdhsa_user_sgpr_count 2
  .amdhsa_user_sgpr_kernarg_segment_ptr 1
  .amdhsa_system_sgpr_workgroup_id_x 1
  .amdhsa_float_denorm_mode_32 3
.end_amdhsa_kernel
```
